```python
import torch

def _softmax(x, axis=-1):
    return torch.softmax(x, dim=axis)
def _gelu(x):
    return torch.nn.functional.gelu(x, approximate="tanh")
def _silu(x):
    return torch.nn.functional.silu(x)
def _sigmoid(x):
    return torch.sigmoid(x)
def _layernorm(x, axis=-1, eps=1e-5):
    m = x.mean(dim=axis, keepdim=True)
    v = x.var(dim=axis, keepdim=True, unbiased=False)
    return (x - m) / torch.sqrt(v + eps)
def _scatter_add(tgt, idx, src, axis=0):
    return tgt.clone().index_add_(axis, idx, src)
def _segment_sum(src, seg, n):
    out = torch.zeros((n,) + src.shape[1:], dtype=src.dtype)
    return out.index_add_(0, seg, src)
def _pad(x, pw):
    flat = tuple(v for pair in reversed(pw) for v in pair)
    return torch.nn.functional.pad(x, flat)

kernel_name = 'gated_mix__compressed_kv_cla__glu_gated_glu__prompt'

def setup_inputs():

    _w = (lambda a: (lambda t: t.to(torch.bfloat16) if t.is_floating_point() else t)(torch.as_tensor(a)))
    def _A_setup():
        B, H, Sq, Sk, D, M = 1, 16, 2048, 2048, 256, 448
        Dc = 4 * D
        return {
            "x": _w((lambda *s: torch.randn(*s, dtype=torch.bfloat16) * 0.05)(B, Sq, M)),
            "c_kv": _w((lambda *s: torch.randn(*s, dtype=torch.bfloat16) * 0.8)(B, Sk, Dc)),
            "w_q": _w((lambda *s: torch.randn(*s, dtype=torch.bfloat16) * 6.4)(M, H, D) * (M ** -0.5)),
            "w_uk": _w((lambda *s: torch.randn(*s, dtype=torch.bfloat16) * 6.4)(Dc, H, D) * (Dc ** -0.5)),
            "w_uv": _w((lambda *s: torch.randn(*s, dtype=torch.bfloat16) * 0.8)(Dc, H, D) * (Dc ** -0.5)),
            "w_o": _w((lambda *s: torch.randn(*s, dtype=torch.bfloat16) * 0.8)(H, D, M) * ((H * D) ** -0.5)),
        }
    _A_in = _A_setup()

    def _B_setup():
        B, S, D, F = 1, 2048, 448, 1792
        return {
            "x": _w((lambda *s: torch.randn(*s, dtype=torch.bfloat16) * 0.05)(B, S, D)),
            "w_gate": _w((lambda *s: torch.randn(*s, dtype=torch.bfloat16) * 3.2)(D, F)),
            "w_up": _w((lambda *s: torch.randn(*s, dtype=torch.bfloat16) * 0.05)(D, F)),
            "w_down": _w((lambda *s: torch.randn(*s, dtype=torch.bfloat16) * 0.05)(F, D)),
        }
    _B_in = _B_setup()

    return {
        "A_x": _A_in["x"],
        "A_c_kv": _A_in["c_kv"],
        "A_w_q": _A_in["w_q"],
        "A_w_uk": _A_in["w_uk"],
        "A_w_uv": _A_in["w_uv"],
        "A_w_o": _A_in["w_o"],
        "B_x": _B_in["x"],
        "B_w_gate": _B_in["w_gate"],
        "B_w_up": _B_in["w_up"],
        "B_w_down": _B_in["w_down"],
        "gate_w": _w((lambda *s: torch.randn(*s, dtype=torch.bfloat16) * 0.05)(448) * 16.0),
    }

def reference(A_x, A_c_kv, A_w_q, A_w_uk, A_w_uv, A_w_o, B_x, B_w_gate, B_w_up, B_w_down, gate_w):
    def _A_ref(x, c_kv, w_q, w_uk, w_uv, w_o):
        B, Sq, M = x.shape[0], x.shape[1], x.shape[2]
        Sk = c_kv.shape[1]
        H, D = w_q.shape[1], w_q.shape[2]
        q = torch.einsum("bqm,mhd->bhqd", x, w_q)
        k = torch.einsum("bkc,chd->bhkd", c_kv, w_uk)
        v = torch.einsum("bkc,chd->bhkd", c_kv, w_uv)
        scores = torch.einsum("bhqd,bhkd->bhqk", q, k) * (D ** -0.5)
        off = Sk - Sq
        qi = torch.arange(Sq)[:, None]
        kj = torch.arange(Sk)[None, :]
        cmask = kj <= (qi + off)
        scores = torch.where(cmask[None, None], scores, -1e9)
        p = _softmax(scores, axis=-1)
        ctx = torch.einsum("bhqk,bhkd->bhqd", p, v)
        return torch.einsum("bhqd,hdm->bqm", ctx, w_o)

    def _B_ref(x, w_gate, w_up, w_down):
        g = torch.einsum("bsd,df->bsf", x, w_gate)
        u = torch.einsum("bsd,df->bsf", x, w_up)
        h = _sigmoid(g) * u
        return torch.einsum("bsf,fd->bsd", h, w_down)

    x = A_x
    g = _sigmoid((x * gate_w).sum(-1, keepdims=True))
    a = _A_ref(x, A_c_kv, A_w_q, A_w_uk, A_w_uv, A_w_o)
    b = _B_ref(x, B_w_gate, B_w_up, B_w_down)
    return g * a + (1 - g) * b
```

```asm
; @launch grid=(256,1,1) block=(256,1,1) lds=163840
.amdgcn_target "amdgcn-amd-amdhsa--gfx950"
.text
.globl gated_mix__compressed_kv_cla__glu_gated_glu__prompt_kernel
.p2align 8
.type gated_mix__compressed_kv_cla__glu_gated_glu__prompt_kernel,@function
gated_mix__compressed_kv_cla__glu_gated_glu__prompt_kernel:
    s_cmp_ge_u32 s2, 256
    s_cbranch_scc1 L_end
    s_load_dwordx8 s[60:67], s[0:1], 0
    s_load_dwordx2 s[68:69], s[0:1], 32
    s_load_dwordx4 s[72:75], s[0:1], 56
    s_load_dwordx2 s[70:71], s[0:1], 80
    s_load_dwordx2 s[76:77], s[0:1], 104
    s_load_dwordx2 s[80:81], s[0:1], 96
    s_load_dwordx2 s[90:91], s[0:1], 40
    s_load_dwordx2 s[92:93], s[0:1], 72
    v_lshrrev_b32 v1, 6, v0
    v_and_b32 v170, 63, v0
    s_nop 0
    v_readfirstlane_b32 s58, v1
    v_lshlrev_b32 v155, 4, v170
    v_mov_b32 v156, v155
    v_mov_b32 v162, 0
    s_and_b32 s59, s2, 7
    s_lshr_b32 s3, s2, 3
    s_lshl_b32 s99, s2, 7
    s_add_u32 s99, s99, 76546048
    s_getpc_b64 s[100:101]
L_pc:
    s_lshl_b32 s4, s3, 2
    s_add_u32 s4, s4, s58
    s_lshl_b32 s4, s4, 10
    v_and_b32 v2, 7, v170
    v_lshlrev_b32 v2, 7, v2
    v_add_u32 v2, s4, v2
    v_min_u32 v167, L_code_end-L_pc-4, v2
    global_load_dword v3, v167, s[100:101]
    s_lshr_b32 s57, s58, 1
    s_lshl_b32 s57, s57, 8
    s_mov_b32 s24, 2048
    s_mov_b32 s29, 8192
    s_mov_b32 s32, 16
    s_mov_b32 s22, 4194304
    s_mov_b32 s27, 8388608
    s_mov_b32 s37, 896
    s_mov_b32 s45, 7
    s_mov_b32 s35, 1835008
    s_cmp_ge_u32 s3, 10
    s_cbranch_scc1 L1_c2
    s_cmp_ge_u32 s3, 5
    s_cselect_b32 s4, 1, 0
    s_mul_i32 s6, s4, 5
    s_sub_u32 s6, s3, s6
    s_mov_b32 s55, s4
    s_add_u32 s56, s6, 3
    s_mov_b32 s44, 2
    s_add_u32 s6, s6, 11
    s_lshr_b32 s5, s6, 1
    s_and_b32 s31, s6, 1
    s_branch L1_c3
L1_c2:
    s_sub_u32 s7, s3, 10
    s_cmp_ge_u32 s7, 11
    s_cselect_b32 s4, 1, 0
    s_mul_i32 s6, s4, 11
    s_sub_u32 s6, s7, s6
    s_cmp_ge_u32 s6, 6
    s_cselect_b32 s31, 1, 0
    s_mul_i32 s5, s31, 6
    s_sub_u32 s5, s6, s5
    s_cmp_ge_u32 s7, 3
    s_cselect_b32 s55, 1, 0
    s_mul_i32 s56, s55, 3
    s_sub_u32 s56, s7, s56
    s_mov_b32 s44, 2
    s_cmp_lt_u32 s7, 6
    s_cbranch_scc1 L1_c3
    s_mul_i32 s6, s59, 14
    s_add_u32 s6, s6, s7
    s_sub_u32 s6, s6, 6
    s_and_b32 s56, s6, 7
    s_lshr_b32 s55, s6, 3
    s_mov_b32 s44, 3
    s_cmp_lt_u32 s7, 20
    s_cbranch_scc1 L1_c3
    s_mov_b32 s44, 4
    s_mov_b32 s56, 0
    s_mov_b32 s55, 0
    s_mov_b32 s35, 0
L1_c3:
    s_lshl_b32 s6, s59, 1
    s_add_u32 s4, s4, s6
    s_lshl_b32 s23, s5, 19
    s_lshl_b32 s28, s4, 9
    s_add_u32 s28, s28, s57
    s_lshl_b32 s30, s4, 20
    s_lshl_b32 s7, s5, 17
    s_add_u32 s30, s30, s7
    s_lshl_b32 s7, s31, 24
    s_add_u32 s30, s30, s7
    s_add_u32 s30, s30, 16777216
    s_mul_i32 s36, s56, 229376
    s_cmp_lg_u32 s44, 2
    s_cbranch_scc1 L1_p_ffn
    s_add_u32 s55, s55, s6
    s_lshl_b32 s41, s55, 9
    s_add_u32 s41, s41, s57
    s_mov_b32 s42, 8192
    s_mov_b32 s40, 3670016
    s_lshl_b32 s43, s55, 20
    s_lshl_b32 s7, s56, 17
    s_add_u32 s43, s43, s7
    s_waitcnt lgkmcnt(0)
    s_mov_b32 s38, s64
    s_mov_b32 s39, s65
    s_branch L1_p_done
L1_p_ffn:
    s_cmp_eq_u32 s44, 3
    s_cselect_b32 s40, 1605632, 0
    s_lshl_b32 s41, s55, 8
    s_mov_b32 s42, 3584
    s_mul_i32 s43, s56, 3014656
    s_lshl_b32 s7, s55, 12
    s_add_u32 s43, s43, s7
    s_add_u32 s43, s43, 50462720
    s_waitcnt lgkmcnt(0)
    s_cmp_lt_u32 s58, 2
    s_cselect_b32 s38, s72, s74
    s_cselect_b32 s39, s73, s75
L1_p_done:
    s_mov_b32 s33, s60
    s_mov_b32 s34, s61
    s_mov_b32 s20, s62
    s_mov_b32 s21, s63
    s_cmp_eq_u32 s31, 0
    s_cselect_b32 s25, s66, s68
    s_cselect_b32 s26, s67, s69
    s_mov_b32 s16, s76
    s_mov_b32 s17, s77
    s_mov_b32 s18, 268435456
    s_mov_b32 s19, 0x20000
    s_mov_b32 s82, 256
    s_mov_b32 s83, 0x20000
    s_cmp_lg_u32 s58, 0
    s_cbranch_scc1 Lpub1
    v_mov_b32 v161, 0
    s_mov_b64 exec, 1
    buffer_store_dword v161, off, s[16:19], s99 sc0 sc1
    s_mov_b64 exec, -1
Lpub1:
    s_cmp_ge_u32 s3, 10
    s_cbranch_scc1 L1_noswap
    s_mov_b32 s4, s20
    s_mov_b32 s20, s33
    s_mov_b32 s33, s4
    s_mov_b32 s4, s21
    s_mov_b32 s21, s34
    s_mov_b32 s34, s4
    s_mov_b32 s4, s22
    s_mov_b32 s22, s35
    s_mov_b32 s35, s4
    s_mov_b32 s4, s23
    s_mov_b32 s23, s36
    s_mov_b32 s36, s4
    s_mov_b32 s4, s24
    s_mov_b32 s24, s37
    s_mov_b32 s37, s4
    s_mov_b32 s4, s25
    s_mov_b32 s25, s38
    s_mov_b32 s38, s4
    s_mov_b32 s4, s26
    s_mov_b32 s26, s39
    s_mov_b32 s39, s4
    s_mov_b32 s4, s27
    s_mov_b32 s27, s40
    s_mov_b32 s40, s4
    s_mov_b32 s4, s28
    s_mov_b32 s28, s41
    s_mov_b32 s41, s4
    s_mov_b32 s4, s29
    s_mov_b32 s29, s42
    s_mov_b32 s42, s4
    s_mov_b32 s4, s30
    s_mov_b32 s30, s43
    s_mov_b32 s43, s4
    s_mov_b32 s4, s31
    s_mov_b32 s31, s44
    s_mov_b32 s44, s4
    s_mov_b32 s4, s32
    s_mov_b32 s32, s45
    s_mov_b32 s45, s4
L1_noswap:
    s_mov_b32 s8, s20
    s_mov_b32 s9, s21
    s_mov_b32 s10, s22
    s_mov_b32 s11, 0x20000
    s_mov_b32 s12, s25
    s_mov_b32 s13, s26
    s_mov_b32 s14, s27
    s_mov_b32 s15, 0x20000
    s_mov_b32 s46, s23
    s_mov_b32 s48, s28
    s_lshl_b32 s50, s24, 6
    s_lshl_b32 s49, s29, 5
    v_lshrrev_b32 v160, 3, v170
    s_lshr_b32 s4, s58, 1
    s_lshl_b32 s4, s4, 2
    s_and_b32 s5, s58, 1
    s_add_u32 s4, s4, s5
    s_lshl_b32 s4, s4, 5
    v_add_u32 v160, s4, v160
    v_lshrrev_b32 v161, 4, v170
    v_and_b32 v162, 7, v170
    v_mul_lo_u32 v163, v160, s24
    s_lshl_b32 s4, s24, 3
    s_sub_u32 s4, s4, 1024
    v_xor_b32 v164, v161, v162
    v_lshl_add_u32 v128, v164, 4, v163
    v_xor_b32 v164, 4, v164
    v_lshl_add_u32 v129, v164, 4, v163
    v_add_u32 v129, s4, v129
    s_lshl_b32 s4, s4, 1
    v_add_u32 v130, s4, v128
    v_add_u32 v131, s4, v129
    s_and_b32 s4, s58, 1
    s_lshl_b32 s4, s4, 4
    v_add_u32 v160, s4, v161
    v_and_b32 v162, 15, v170
    v_mul_lo_u32 v163, v160, s29
    s_lshl_b32 s4, s29, 2
    s_sub_u32 s4, s4, 1024
    v_lshlrev_b32 v164, 1, v161
    v_xor_b32 v164, v164, v162
    v_lshl_add_u32 v132, v164, 4, v163
    v_add_u32 v133, s4, v132
    v_xor_b32 v164, 8, v164
    v_lshl_add_u32 v134, v164, 4, v163
    s_lshl_b32 s5, s4, 1
    v_add_u32 v134, s5, v134
    v_add_u32 v135, s4, v134
    s_lshr_b32 s78, s58, 1
    s_lshl_b32 s78, s78, 2
    s_and_b32 s4, s58, 1
    s_add_u32 s78, s78, s4
    s_lshl_b32 s78, s78, 12
    s_add_u32 s78, s78, 65536
    s_add_u32 s79, s78, 98304
    s_mov_b32 s51, s78
    s_lshl_b32 s52, s58, 12
    s_mov_b32 m0, s52
    s_add_u32 s52, s52, 16384
    buffer_load_dwordx4 v132, s[12:15], s48 offen offset:0 sc1 lds
    buffer_load_dwordx4 v133, s[12:15], s48 offen offset:1024 sc1 lds
    buffer_load_dwordx4 v134, s[12:15], s48 offen offset:2048 sc1 lds
    buffer_load_dwordx4 v135, s[12:15], s48 offen offset:3072 sc1 lds
    s_add_u32 s48, s48, s49
    s_and_b32 s52, s52, 0xffff
    s_mov_b32 m0, s51
    s_add_u32 s47, s46, s50
    buffer_load_dwordx4 v128, s[8:11], s46 offen offset:0 sc1 lds
    buffer_load_dwordx4 v129, s[8:11], s46 offen offset:1024 sc1 lds
    buffer_load_dwordx4 v130, s[8:11], s46 offen offset:2048 sc1 lds
    buffer_load_dwordx4 v131, s[8:11], s46 offen offset:3072 sc1 lds
    s_add_u32 s46, s46, 128
    s_add_u32 m0, s51, 8192
    s_add_u32 s51, s51, 32768
    buffer_load_dwordx4 v128, s[8:11], s47 offen offset:0 sc1 lds
    buffer_load_dwordx4 v129, s[8:11], s47 offen offset:1024 sc1 lds
    buffer_load_dwordx4 v130, s[8:11], s47 offen offset:2048 sc1 lds
    buffer_load_dwordx4 v131, s[8:11], s47 offen offset:3072 sc1 lds
    s_cmp_ge_u32 s51, s79
    s_cselect_b32 s51, s78, s51
    s_mov_b32 m0, s52
    s_add_u32 s52, s52, 16384
    buffer_load_dwordx4 v132, s[12:15], s48 offen offset:0 sc1 lds
    buffer_load_dwordx4 v133, s[12:15], s48 offen offset:1024 sc1 lds
    buffer_load_dwordx4 v134, s[12:15], s48 offen offset:2048 sc1 lds
    buffer_load_dwordx4 v135, s[12:15], s48 offen offset:3072 sc1 lds
    s_add_u32 s48, s48, s49
    s_and_b32 s52, s52, 0xffff
    s_lshr_b32 s5, s2, 4
    s_mov_b32 s87, 0x20000
    s_mov_b32 s84, s62
    s_mov_b32 s85, s63
    s_mov_b32 s86, 4194304
    s_mov_b32 s88, 0
    s_mov_b32 s89, 524288
    s_mov_b32 s7, 0
    s_mov_b32 s55, 5
    s_mov_b32 s56, 4096
    s_cmp_lt_u32 s5, 2
    s_cbranch_scc1 L1_pfd
    s_mov_b32 s84, s72
    s_mov_b32 s85, s73
    s_mov_b32 s86, 1605632
    s_mov_b32 s88, 4287102976
    s_mov_b32 s89, 786432
    s_mov_b32 s7, 2
    s_mov_b32 s55, 5
    s_mov_b32 s56, 4096
    s_cmp_lt_u32 s5, 5
    s_cbranch_scc1 L1_pfd
    s_mov_b32 s84, s66
    s_mov_b32 s85, s67
    s_mov_b32 s86, 8388608
    s_mov_b32 s88, 1048576
    s_mov_b32 s89, 786432
    s_mov_b32 s7, 5
    s_mov_b32 s55, 3
    s_mov_b32 s56, 8192
    s_cmp_lt_u32 s5, 8
    s_cbranch_scc1 L1_pfd
    s_mov_b32 s84, s68
    s_mov_b32 s85, s69
    s_mov_b32 s86, 8388608
    s_mov_b32 s88, 1048576
    s_mov_b32 s89, 786432
    s_mov_b32 s7, 8
    s_mov_b32 s55, 3
    s_mov_b32 s56, 8192
    s_cmp_lt_u32 s5, 11
    s_cbranch_scc1 L1_pfd
    s_mov_b32 s84, s74
    s_mov_b32 s85, s75
    s_mov_b32 s86, 1605632
    s_mov_b32 s88, 4287102976
    s_mov_b32 s89, 786432
    s_mov_b32 s7, 11
    s_mov_b32 s55, 5
    s_mov_b32 s56, 4096
    s_cmp_lt_u32 s5, 14
    s_cbranch_scc1 L1_pfd
    s_mov_b32 s84, s60
    s_mov_b32 s85, s61
    s_mov_b32 s86, 688128
    s_mov_b32 s88, 4289724416
    s_mov_b32 s89, 524288
    s_mov_b32 s7, 14
    s_mov_b32 s55, 5
    s_mov_b32 s56, 4096
L1_pfd:
    s_lshl_b32 s7, s7, 1
    s_sub_u32 s5, s3, s7
    s_lshl_b32 s4, s5, 3
    s_add_u32 s4, s4, s59
    s_lshl_b32 s6, s59, 10
    s_cmp_eq_u32 s55, 3
    s_cselect_b32 s4, s5, s4
    s_cselect_b32 s6, s6, 0
    s_lshl_b32 s4, s4, 2
    s_add_u32 s4, s4, s58
    s_lshl_b32 s4, s4, 5
    v_add_u32 v158, s4, v170
    v_lshrrev_b32 v157, s55, v158
    v_mul_lo_u32 v157, v157, s56
    v_bfe_u32 v158, v158, 0, s55
    v_lshl_add_u32 v157, v158, 7, v157
    v_add_u32 v157, s6, v157
    v_mov_b32 v158, 0x80000000
    v_cmp_gt_u32 vcc, 32, v170
    s_nop 1
    v_cndmask_b32 v157, v158, v157, vcc
    v_lshrrev_b32 v160, 3, v170
    s_lshr_b32 s4, s58, 1
    s_lshl_b32 s4, s4, 2
    s_and_b32 s5, s58, 1
    s_add_u32 s4, s4, s5
    s_lshl_b32 s4, s4, 5
    v_add_u32 v160, s4, v160
    v_lshrrev_b32 v161, 4, v170
    v_and_b32 v162, 7, v170
    v_mul_lo_u32 v163, v160, s37
    s_lshl_b32 s4, s37, 3
    s_sub_u32 s4, s4, 1024
    v_xor_b32 v164, v161, v162
    v_lshl_add_u32 v136, v164, 4, v163
    v_xor_b32 v164, 4, v164
    v_lshl_add_u32 v137, v164, 4, v163
    v_add_u32 v137, s4, v137
    s_lshl_b32 s4, s4, 1
    v_add_u32 v138, s4, v136
    v_add_u32 v139, s4, v137
    s_and_b32 s4, s58, 1
    s_lshl_b32 s4, s4, 4
    v_add_u32 v160, s4, v161
    v_and_b32 v162, 15, v170
    v_mul_lo_u32 v163, v160, s42
    s_lshl_b32 s4, s42, 2
    s_sub_u32 s4, s4, 1024
    v_lshlrev_b32 v164, 1, v161
    v_xor_b32 v164, v164, v162
    v_lshl_add_u32 v140, v164, 4, v163
    v_add_u32 v141, s4, v140
    v_xor_b32 v164, 8, v164
    v_lshl_add_u32 v142, v164, 4, v163
    s_lshl_b32 s5, s4, 1
    v_add_u32 v142, s5, v142
    v_add_u32 v143, s4, v142
    v_and_b32 v160, 15, v170
    v_lshrrev_b32 v161, 4, v170
    v_lshrrev_b32 v162, 1, v160
    s_lshr_b32 s4, s58, 1
    s_lshl_b32 s4, s4, 14
    s_add_u32 s4, s4, 65536
    v_lshlrev_b32 v163, 7, v160
    v_add_u32 v163, s4, v163
    v_add_u32 v164, 0, v161
    v_xor_b32 v164, v164, v162
    v_lshlrev_b32 v164, 4, v164
    v_add_u32 v144, v163, v164
    v_add_u32 v164, 4, v161
    v_xor_b32 v164, v164, v162
    v_lshlrev_b32 v164, 4, v164
    v_add_u32 v145, v163, v164
    v_bfe_u32 v162, v170, 2, 2
    v_and_b32 v163, 3, v170
    v_and_b32 v164, 1, v161
    v_lshlrev_b32 v164, 2, v164
    v_or_b32 v164, v164, v162
    v_lshlrev_b32 v165, 3, v161
    v_add_u32 v165, v165, v162
    v_lshlrev_b32 v165, 8, v165
    v_lshlrev_b32 v163, 3, v163
    v_add_u32 v165, v165, v163
    s_and_b32 s4, s58, 1
    s_lshl_b32 s4, s4, 2
    s_add_u32 s5, s4, 0
    v_xor_b32 v166, s5, v164
    v_lshlrev_b32 v166, 5, v166
    v_add_u32 v146, v165, v166
    s_add_u32 s5, s4, 1
    v_xor_b32 v166, s5, v164
    v_lshlrev_b32 v166, 5, v166
    v_add_u32 v147, v165, v166
    s_add_u32 s5, s4, 2
    v_xor_b32 v166, s5, v164
    v_lshlrev_b32 v166, 5, v166
    v_add_u32 v148, v165, v166
    s_add_u32 s5, s4, 3
    v_xor_b32 v166, s5, v164
    v_lshlrev_b32 v166, 5, v166
    v_add_u32 v149, v165, v166
    s_bfe_u32 s90, s3, 0x10003
    s_and_b32 s91, s3, 7
    s_lshr_b32 s93, s3, 2
    s_sub_u32 s92, 15, s91
    s_and_b32 s4, s3, 0x17
    s_cmp_eq_u32 s4, 23
    s_cselect_b32 s92, 7, s92
    v_lshrrev_b32 v160, 4, v155
    s_mul_i32 s4, s90, 11
    s_add_u32 s4, s4, 10
    s_mul_i32 s5, s90, 5
    s_sub_u32 s5, s5, 13
    v_mov_b32 v164, s5
    v_mov_b32 v166, s4
    v_cmp_gt_u32 vcc, 13, v160
    v_mov_b32 v165, 2
    s_nop 0
    v_cndmask_b32 v164, v164, v166, vcc
    v_cndmask_b32_e64 v165, v165, 1, vcc
    v_add_u32 v164, v164, v160
    v_and_b32 v164, 31, v164
    v_lshlrev_b32 v164, 3, v164
    v_add_u32 v164, s59, v164
    s_lshl_b32 s4, s3, 3
    v_and_b32 v166, 7, v160
    v_add_u32 v166, s4, v166
    v_cmp_lt_u32 vcc, 31, v160
    s_nop 1
    v_cndmask_b32 v164, v164, v166, vcc
    v_cndmask_b32_e64 v165, v165, 5, vcc
    v_lshlrev_b32 v164, 7, v164
    v_add_u32 v164, 76546048, v164
    v_mov_b32 v166, 0
    s_lshr_b32 s4, s92, 1
    s_mul_i32 s5, s90, 5
    s_sub_u32 s5, s5, 3
    s_mul_i32 s6, s90, 3
    s_add_u32 s6, s6, 10
    s_cmp_ge_u32 s4, 3
    s_cselect_b32 s5, s5, s6
    s_cselect_b32 s6, 1, 2
    s_add_u32 s5, s5, s4
    s_lshl_b32 s7, s5, 3
    s_add_u32 s7, s7, s59
    s_lshl_b32 s7, s7, 7
    s_add_u32 s7, s7, 76546048
    v_writelane_b32 v164, s7, 11
    v_writelane_b32 v165, s6, 11
    s_and_b32 s5, s92, 1
    s_add_u32 s5, s5, 30
    s_lshl_b32 s7, s5, 3
    s_add_u32 s7, s7, s4
    s_lshl_b32 s7, s7, 7
    s_add_u32 s7, s7, 76546048
    v_writelane_b32 v164, s7, 12
    v_writelane_b32 v165, 2, 12
    s_lshr_b32 s4, s91, 1
    s_mul_i32 s5, s90, 5
    s_sub_u32 s5, s5, 3
    s_mul_i32 s6, s90, 3
    s_add_u32 s6, s6, 10
    s_cmp_ge_u32 s4, 3
    s_cselect_b32 s5, s5, s6
    s_cselect_b32 s6, 1, 2
    s_add_u32 s5, s5, s4
    s_lshl_b32 s7, s5, 3
    s_add_u32 s7, s7, s59
    s_lshl_b32 s7, s7, 7
    s_add_u32 s7, s7, 76546048
    v_writelane_b32 v164, s7, 24
    v_writelane_b32 v165, s6, 24
    s_and_b32 s5, s91, 1
    s_add_u32 s5, s5, 30
    s_lshl_b32 s7, s5, 3
    s_add_u32 s7, s7, s4
    s_lshl_b32 s7, s7, 7
    s_add_u32 s7, s7, 76546048
    v_writelane_b32 v164, s7, 25
    v_writelane_b32 v165, 2, 25
    s_sub_u32 s93, 15, s91
    s_cmp_lt_u32 s3, 16
    s_cselect_b32 s93, s93, s91
    s_lshr_b32 s93, s93, 1
    s_lshr_b32 s4, s59, 1
    s_mul_i32 s4, s4, 14
    s_and_b32 s5, s59, 1
    s_mul_i32 s5, s5, 7
    s_add_u32 s4, s4, s5
    s_bitcmp1_b32 s59, 0
    s_cselect_b32 s5, 0, 0
    s_add_u32 s4, s4, s5
    s_lshr_b32 s4, s4, 2
    s_lshl_b32 s4, s4, 3
    s_add_u32 s4, s4, s93
    s_mul_i32 s6, s4, 4682
    s_lshr_b32 s6, s6, 16
    s_mul_i32 s5, s6, 14
    s_sub_u32 s5, s4, s5
    s_add_u32 s5, s5, 16
    s_lshl_b32 s7, s5, 3
    s_add_u32 s7, s7, s6
    s_lshl_b32 s7, s7, 7
    s_add_u32 s7, s7, 76546048
    v_writelane_b32 v164, s7, 18
    v_writelane_b32 v165, 2, 18
    s_lshr_b32 s4, s59, 1
    s_mul_i32 s4, s4, 14
    s_and_b32 s5, s59, 1
    s_mul_i32 s5, s5, 7
    s_add_u32 s4, s4, s5
    s_bitcmp1_b32 s59, 0
    s_cselect_b32 s5, 3, 3
    s_add_u32 s4, s4, s5
    s_lshr_b32 s4, s4, 2
    s_lshl_b32 s4, s4, 3
    s_add_u32 s4, s4, s93
    s_mul_i32 s6, s4, 4682
    s_lshr_b32 s6, s6, 16
    s_mul_i32 s5, s6, 14
    s_sub_u32 s5, s4, s5
    s_add_u32 s5, s5, 16
    s_lshl_b32 s7, s5, 3
    s_add_u32 s7, s7, s6
    s_lshl_b32 s7, s7, 7
    s_add_u32 s7, s7, 76546048
    v_writelane_b32 v164, s7, 19
    v_writelane_b32 v165, 2, 19
    s_lshr_b32 s4, s59, 1
    s_mul_i32 s4, s4, 14
    s_and_b32 s5, s59, 1
    s_mul_i32 s5, s5, 7
    s_add_u32 s4, s4, s5
    s_bitcmp1_b32 s59, 0
    s_cselect_b32 s5, 6, 6
    s_add_u32 s4, s4, s5
    s_lshr_b32 s4, s4, 2
    s_lshl_b32 s4, s4, 3
    s_add_u32 s4, s4, s93
    s_mul_i32 s6, s4, 4682
    s_lshr_b32 s6, s6, 16
    s_mul_i32 s5, s6, 14
    s_sub_u32 s5, s4, s5
    s_add_u32 s5, s5, 16
    s_lshl_b32 s7, s5, 3
    s_add_u32 s7, s7, s6
    s_lshl_b32 s7, s7, 7
    s_add_u32 s7, s7, 76546048
    v_writelane_b32 v164, s7, 20
    v_writelane_b32 v165, 2, 20
    s_mul_i32 s93, s59, 14
    s_add_u32 s93, s93, s3
    s_and_b32 s93, s93, 7
    s_sub_u32 s4, s3, 16
    s_cmp_lt_u32 s4, 14
    s_cselect_b32 s6, 2, 0
    s_lshl_b32 s7, 30, 3
    s_add_u32 s7, s7, s93
    s_lshl_b32 s7, s7, 7
    s_add_u32 s7, s7, 76546048
    v_writelane_b32 v164, s7, 21
    v_writelane_b32 v165, s6, 21
    s_lshl_b32 s7, 31, 3
    s_add_u32 s7, s7, s93
    s_lshl_b32 s7, s7, 7
    s_add_u32 s7, s7, 76546048
    v_writelane_b32 v164, s7, 22
    v_writelane_b32 v165, s6, 22
    s_xor_b32 s5, s3, 16
    s_lshl_b32 s7, s5, 3
    s_add_u32 s7, s7, s59
    s_lshl_b32 s7, s7, 7
    s_add_u32 s7, s7, 76546048
    v_writelane_b32 v164, s7, 23
    v_writelane_b32 v165, 3, 23
    s_xor_b32 s5, s3, 8
    s_lshl_b32 s7, s5, 3
    s_add_u32 s7, s7, s59
    s_lshl_b32 s7, s7, 7
    s_add_u32 s7, s7, 76546048
    v_writelane_b32 v164, s7, 26
    v_writelane_b32 v165, 4, 26
    s_lshl_b32 s69, s93, 10
    s_lshr_b32 s4, s58, 1
    s_lshl_b32 s4, s4, 9
    s_add_u32 s69, s69, s4
    s_add_u32 s69, s69, 75505664
    s_lshl_b32 s4, s59, 1
    s_add_u32 s4, s4, s90
    s_lshl_b32 s4, s4, 20
    s_add_u32 s5, s4, 16777216
    s_add_u32 s62, s76, s5
    s_addc_u32 s63, s77, 0
    s_add_u32 s5, s4, 33554432
    s_add_u32 s64, s76, s5
    s_addc_u32 s65, s77, 0
    s_lshl_b32 s5, s92, 16
    s_add_u32 s4, s4, s5
    s_lshl_b32 s5, s58, 13
    s_add_u32 s67, s4, s5
    s_lshl_b32 s4, s91, 2
    s_sub_u32 s4, 28, s4
    s_lshl_b32 s4, s4, 14
    s_cmp_ge_u32 s3, 16
    s_cselect_b32 s66, 0, s4
    s_mov_b32 s68, 128
    s_mov_b64 s[76:77], s[100:101]
    s_mov_b32 s53, 0
    s_mov_b32 s54, 0
    v_add_u32 v151, s54, v146
    v_add_u32 v152, s54, v147
    v_add_u32 v153, s54, v148
    v_add_u32 v154, s54, v149
    s_sub_u32 s56, s32, 3
    s_sub_u32 s57, s32, 2
    s_sub_u32 s55, s32, 1
    s_mov_b32 s96, 0
    s_mov_b32 s97, 0x3db8aa3b
    s_mov_b32 m0, s51
    s_add_u32 s47, s46, s50
    buffer_load_dwordx4 v128, s[8:11], s46 offen offset:0 sc1 lds
    buffer_load_dwordx4 v129, s[8:11], s46 offen offset:1024 sc1 lds
    buffer_load_dwordx4 v130, s[8:11], s46 offen offset:2048 sc1 lds
    buffer_load_dwordx4 v131, s[8:11], s46 offen offset:3072 sc1 lds
    s_add_u32 s46, s46, s68
    s_mov_b32 m0, s52
    s_add_u32 s52, s52, 16384
    buffer_load_dwordx4 v132, s[12:15], s48 offen offset:0 sc1 lds
    buffer_load_dwordx4 v133, s[12:15], s48 offen offset:1024 sc1 lds
    buffer_load_dwordx4 v134, s[12:15], s48 offen offset:2048 sc1 lds
    buffer_load_dwordx4 v135, s[12:15], s48 offen offset:3072 sc1 lds
    s_add_u32 s48, s48, s49
    s_and_b32 s52, s52, 0xffff
    s_add_u32 m0, s51, 8192
    s_add_u32 s51, s51, 32768
    buffer_load_dwordx4 v128, s[8:11], s47 offen offset:0 sc1 lds
    buffer_load_dwordx4 v129, s[8:11], s47 offen offset:1024 sc1 lds
    buffer_load_dwordx4 v130, s[8:11], s47 offen offset:2048 sc1 lds
    buffer_load_dwordx4 v131, s[8:11], s47 offen offset:3072 sc1 lds
    s_cmp_ge_u32 s51, s79
    s_cselect_b32 s51, s78, s51
    s_waitcnt vmcnt(16)
    s_barrier
    ds_read_b128 a[32:35], v144 offset:8192
    ds_read_b128 a[36:39], v144 offset:10240
    ds_read_b128 a[40:43], v144 offset:12288
    ds_read_b128 a[44:47], v144 offset:14336
    ds_read_b64_tr_b16 a[64:65], v151 offset:0
    ds_read_b64_tr_b16 a[66:67], v151 offset:1024
    ds_read_b64_tr_b16 a[68:69], v152 offset:0
    ds_read_b64_tr_b16 a[70:71], v152 offset:1024
    ds_read_b64_tr_b16 a[72:73], v153 offset:0
    ds_read_b64_tr_b16 a[74:75], v153 offset:1024
    ds_read_b64_tr_b16 a[76:77], v154 offset:0
    ds_read_b64_tr_b16 a[78:79], v154 offset:1024
    ds_read_b64_tr_b16 a[80:81], v151 offset:8192
    ds_read_b64_tr_b16 a[82:83], v151 offset:9216
    ds_read_b64_tr_b16 a[84:85], v152 offset:8192
    ds_read_b64_tr_b16 a[86:87], v152 offset:9216
    ds_read_b64_tr_b16 a[88:89], v153 offset:8192
    ds_read_b64_tr_b16 a[90:91], v153 offset:9216
    ds_read_b64_tr_b16 a[92:93], v154 offset:8192
    ds_read_b64_tr_b16 a[94:95], v154 offset:9216
    s_cmp_lg_u32 s58, 0
    s_cbranch_scc1 L1_noadd
    s_lshl_b32 s4, s59, 5
    v_mov_b32 v161, 1
    s_mov_b64 exec, 1
    buffer_atomic_add v161, off, s[80:83], s4 sc1
    s_mov_b64 exec, -1
L1_noadd:
    s_cmp_eq_u32 s31, 1
    s_cbranch_scc1 L1_v
    s_waitcnt lgkmcnt(0)
    s_waitcnt vmcnt(12)
    s_barrier
    s_add_u32 s54, s54, 16384
    s_and_b32 s54, s54, 0xffff
    v_add_u32 v151, s54, v146
    v_add_u32 v152, s54, v147
    v_add_u32 v153, s54, v148
    v_add_u32 v154, s54, v149
    v_mfma_f32_16x16x32_bf16 v[192:195], a[64:67], a[32:35], 0
    ds_read_b128 a[0:3], v144 offset:0
    buffer_load_dword v158, v157, s[84:87], s88 offen
    v_mfma_f32_16x16x32_bf16 a[192:195], a[68:71], a[32:35], 0
    ds_read_b128 a[16:19], v145 offset:0
    s_add_u32 s88, s88, s89
    s_mov_b32 m0, s52
    v_mfma_f32_16x16x32_bf16 v[196:199], a[72:75], a[32:35], 0
    ds_read_b128 a[4:7], v144 offset:2048
    s_add_u32 s52, s52, 16384
    buffer_load_dwordx4 v132, s[12:15], s48 offen offset:0 sc1 lds
    v_mfma_f32_16x16x32_bf16 a[196:199], a[76:79], a[32:35], 0
    ds_read_b128 a[20:23], v145 offset:2048
    buffer_load_dwordx4 v133, s[12:15], s48 offen offset:1024 sc1 lds
    v_mfma_f32_16x16x32_bf16 v[200:203], a[80:83], a[32:35], 0
    buffer_load_dwordx4 v134, s[12:15], s48 offen offset:2048 sc1 lds
    v_mfma_f32_16x16x32_bf16 a[200:203], a[84:87], a[32:35], 0
    ds_read_b128 a[8:11], v144 offset:4096
    buffer_load_dwordx4 v135, s[12:15], s48 offen offset:3072 sc1 lds
    v_mfma_f32_16x16x32_bf16 v[204:207], a[88:91], a[32:35], 0
    ds_read_b128 a[24:27], v145 offset:4096
    s_add_u32 s48, s48, s49
    v_mfma_f32_16x16x32_bf16 a[204:207], a[92:95], a[32:35], 0
    ds_read_b128 a[12:15], v144 offset:6144
    s_and_b32 s52, s52, 0xffff
    s_mov_b32 m0, s51
    v_mfma_f32_16x16x32_bf16 a[220:223], a[92:95], a[36:39], 0
    ds_read_b128 a[28:31], v145 offset:6144
    s_add_u32 s47, s46, s50
    buffer_load_dwordx4 v128, s[8:11], s46 offen offset:0 sc1 lds
    v_mfma_f32_16x16x32_bf16 v[220:223], a[88:91], a[36:39], 0
    buffer_load_dwordx4 v129, s[8:11], s46 offen offset:1024 sc1 lds
    v_mfma_f32_16x16x32_bf16 a[216:219], a[84:87], a[36:39], 0
    ds_read_b64_tr_b16 a[124:125], v154 offset:8192
    buffer_load_dwordx4 v130, s[8:11], s46 offen offset:2048 sc1 lds
    v_mfma_f32_16x16x32_bf16 v[216:219], a[80:83], a[36:39], 0
    ds_read_b64_tr_b16 a[126:127], v154 offset:9216
    buffer_load_dwordx4 v131, s[8:11], s46 offen offset:3072 sc1 lds
    v_mfma_f32_16x16x32_bf16 a[212:215], a[76:79], a[36:39], 0
    ds_read_b64_tr_b16 a[120:121], v153 offset:8192
    s_add_u32 s46, s46, s68
    v_mfma_f32_16x16x32_bf16 v[212:215], a[72:75], a[36:39], 0
    ds_read_b64_tr_b16 a[122:123], v153 offset:9216
    s_sub_u32 s57, s57, 1
    s_cbranch_scc1 L1_sw1
L1_swr1:
    v_mfma_f32_16x16x32_bf16 a[208:211], a[68:71], a[36:39], 0
    s_mov_b32 m0, s52
    s_add_u32 s52, s52, 16384
    v_mfma_f32_16x16x32_bf16 v[208:211], a[64:67], a[36:39], 0
    ds_read_b64_tr_b16 a[116:117], v152 offset:8192
    buffer_load_dwordx4 v132, s[12:15], s48 offen offset:0 sc1 lds
    v_mfma_f32_16x16x32_bf16 v[224:227], a[64:67], a[40:43], 0
    ds_read_b64_tr_b16 a[118:119], v152 offset:9216
    buffer_load_dwordx4 v133, s[12:15], s48 offen offset:1024 sc1 lds
    v_mfma_f32_16x16x32_bf16 a[224:227], a[68:71], a[40:43], 0
    ds_read_b64_tr_b16 a[112:113], v151 offset:8192
    buffer_load_dwordx4 v134, s[12:15], s48 offen offset:2048 sc1 lds
    v_mfma_f32_16x16x32_bf16 v[228:231], a[72:75], a[40:43], 0
    ds_read_b64_tr_b16 a[114:115], v151 offset:9216
    buffer_load_dwordx4 v135, s[12:15], s48 offen offset:3072 sc1 lds
    v_mfma_f32_16x16x32_bf16 a[228:231], a[76:79], a[40:43], 0
    s_add_u32 s48, s48, s49
    v_mfma_f32_16x16x32_bf16 v[232:235], a[80:83], a[40:43], 0
    ds_read_b64_tr_b16 a[108:109], v154 offset:0
    s_and_b32 s52, s52, 0xffff
    s_add_u32 m0, s51, 8192
    v_mfma_f32_16x16x32_bf16 a[232:235], a[84:87], a[40:43], 0
    ds_read_b64_tr_b16 a[110:111], v154 offset:1024
    s_add_u32 s51, s51, 32768
    buffer_load_dwordx4 v128, s[8:11], s47 offen offset:0 sc1 lds
    v_mfma_f32_16x16x32_bf16 v[236:239], a[88:91], a[40:43], 0
    ds_read_b64_tr_b16 a[104:105], v153 offset:0
    buffer_load_dwordx4 v129, s[8:11], s47 offen offset:1024 sc1 lds
    v_mfma_f32_16x16x32_bf16 a[236:239], a[92:95], a[40:43], 0
    ds_read_b64_tr_b16 a[106:107], v153 offset:1024
    buffer_load_dwordx4 v130, s[8:11], s47 offen offset:2048 sc1 lds
    v_mfma_f32_16x16x32_bf16 a[252:255], a[92:95], a[44:47], 0
    buffer_load_dwordx4 v131, s[8:11], s47 offen offset:3072 sc1 lds
    v_mfma_f32_16x16x32_bf16 v[252:255], a[88:91], a[44:47], 0
    ds_read_b64_tr_b16 a[100:101], v152 offset:0
    s_cmp_ge_u32 s51, s79
    v_mfma_f32_16x16x32_bf16 a[248:251], a[84:87], a[44:47], 0
    ds_read_b64_tr_b16 a[102:103], v152 offset:1024
    s_cselect_b32 s51, s78, s51
    buffer_load_dword v158, v157, s[84:87], s88 offen
    v_mfma_f32_16x16x32_bf16 v[248:251], a[80:83], a[44:47], 0
    ds_read_b64_tr_b16 a[96:97], v151 offset:0
    s_add_u32 s88, s88, s89
    v_mfma_f32_16x16x32_bf16 a[244:247], a[76:79], a[44:47], 0
    ds_read_b64_tr_b16 a[98:99], v151 offset:1024
    s_add_u32 s53, s53, 1
    s_cmp_eq_u32 s53, 3
    v_mfma_f32_16x16x32_bf16 v[244:247], a[72:75], a[44:47], 0
    s_cselect_b32 s53, 0, s53
    s_cselect_b32 s93, -2, 1
    v_mfma_f32_16x16x32_bf16 a[240:243], a[68:71], a[44:47], 0
    s_lshl_b32 s93, s93, 15
    v_add_u32 v144, s93, v144
    v_mfma_f32_16x16x32_bf16 v[240:243], a[64:67], a[44:47], 0
    s_waitcnt lgkmcnt(15)
    v_mfma_f32_16x16x32_bf16 v[28:31], a[92:95], a[0:3], 0
    s_waitcnt lgkmcnt(14)
    s_add_u32 s54, s54, 16384
    v_mfma_f32_16x16x32_bf16 v[28:31], a[124:127], a[16:19], v[28:31]
    v_mfma_f32_16x16x32_bf16 v[24:27], a[88:91], a[0:3], 0
    s_waitcnt lgkmcnt(12)
    s_and_b32 s54, s54, 0xffff
    v_mfma_f32_16x16x32_bf16 v[24:27], a[120:123], a[16:19], v[24:27]
    v_mfma_f32_16x16x32_bf16 v[20:23], a[84:87], a[0:3], 0
    s_waitcnt lgkmcnt(10)
    v_add_u32 v151, s54, v146
    v_mfma_f32_16x16x32_bf16 v[20:23], a[116:119], a[16:19], v[20:23]
    v_mfma_f32_16x16x32_bf16 v[16:19], a[80:83], a[0:3], 0
    s_waitcnt lgkmcnt(8)
    v_add_u32 v152, s54, v147
    v_mfma_f32_16x16x32_bf16 v[16:19], a[112:115], a[16:19], v[16:19]
    v_mfma_f32_16x16x32_bf16 v[12:15], a[76:79], a[0:3], 0
    s_waitcnt lgkmcnt(6)
    v_add_u32 v153, s54, v148
    v_mfma_f32_16x16x32_bf16 v[12:15], a[108:111], a[16:19], v[12:15]
    v_mfma_f32_16x16x32_bf16 v[8:11], a[72:75], a[0:3], 0
    s_waitcnt lgkmcnt(4)
    v_add_u32 v154, s54, v149
    v_mfma_f32_16x16x32_bf16 v[8:11], a[104:107], a[16:19], v[8:11]
    v_mfma_f32_16x16x32_bf16 v[4:7], a[68:71], a[0:3], 0
    s_waitcnt lgkmcnt(2)
    v_mfma_f32_16x16x32_bf16 v[4:7], a[100:103], a[16:19], v[4:7]
    v_mfma_f32_16x16x32_bf16 v[0:3], a[64:67], a[0:3], 0
    s_waitcnt lgkmcnt(0)
    v_mfma_f32_16x16x32_bf16 v[0:3], a[96:99], a[16:19], v[0:3]
    s_waitcnt vmcnt(18)
    s_barrier
    v_mfma_f32_16x16x32_bf16 v[32:35], a[96:99], a[20:23], 0
    ds_read_b128 a[32:35], v144 offset:8192
    s_mov_b32 m0, s52
    v_mfma_f32_16x16x32_bf16 v[32:35], a[64:67], a[4:7], v[32:35]
    s_add_u32 s52, s52, 16384
    v_mfma_f32_16x16x32_bf16 v[36:39], a[68:71], a[4:7], 0
    buffer_load_dwordx4 v132, s[12:15], s48 offen offset:0 sc1 lds
    v_mfma_f32_16x16x32_bf16 v[36:39], a[100:103], a[20:23], v[36:39]
    ds_read_b128 a[48:51], v145 offset:8192
    v_mfma_f32_16x16x32_bf16 v[40:43], a[104:107], a[20:23], 0
    v_mfma_f32_16x16x32_bf16 v[40:43], a[72:75], a[4:7], v[40:43]
    buffer_load_dwordx4 v133, s[12:15], s48 offen offset:1024 sc1 lds
    v_mfma_f32_16x16x32_bf16 v[44:47], a[76:79], a[4:7], 0
    ds_read_b128 a[36:39], v144 offset:10240
    v_mfma_f32_16x16x32_bf16 v[44:47], a[108:111], a[20:23], v[44:47]
    buffer_load_dwordx4 v134, s[12:15], s48 offen offset:2048 sc1 lds
    v_mfma_f32_16x16x32_bf16 v[48:51], a[112:115], a[20:23], 0
    v_mfma_f32_16x16x32_bf16 v[48:51], a[80:83], a[4:7], v[48:51]
    ds_read_b128 a[52:55], v145 offset:10240
    v_mfma_f32_16x16x32_bf16 v[52:55], a[84:87], a[4:7], 0
    buffer_load_dwordx4 v135, s[12:15], s48 offen offset:3072 sc1 lds
    v_mfma_f32_16x16x32_bf16 v[52:55], a[116:119], a[20:23], v[52:55]
    v_mfma_f32_16x16x32_bf16 v[56:59], a[120:123], a[20:23], 0
    s_add_u32 s48, s48, s49
    v_mfma_f32_16x16x32_bf16 v[56:59], a[88:91], a[4:7], v[56:59]
    ds_read_b128 a[40:43], v144 offset:12288
    v_mfma_f32_16x16x32_bf16 v[60:63], a[92:95], a[4:7], 0
    s_and_b32 s52, s52, 0xffff
    v_mfma_f32_16x16x32_bf16 v[60:63], a[124:127], a[20:23], v[60:63]
    s_sub_u32 s56, s56, 1
    v_mfma_f32_16x16x32_bf16 v[92:95], a[124:127], a[24:27], 0
    ds_read_b128 a[56:59], v145 offset:12288
    s_cbranch_scc1 L1_sw2
L1_swr2:
    v_mfma_f32_16x16x32_bf16 v[92:95], a[92:95], a[8:11], v[92:95]
    v_mfma_f32_16x16x32_bf16 v[88:91], a[88:91], a[8:11], 0
    s_mov_b32 m0, s51
    v_mfma_f32_16x16x32_bf16 v[88:91], a[120:123], a[24:27], v[88:91]
    ds_read_b128 a[44:47], v144 offset:14336
    s_add_u32 s47, s46, s50
    v_mfma_f32_16x16x32_bf16 v[84:87], a[116:119], a[24:27], 0
    buffer_load_dwordx4 v128, s[8:11], s46 offen offset:0 sc1 lds
    v_mfma_f32_16x16x32_bf16 v[84:87], a[84:87], a[8:11], v[84:87]
    v_mfma_f32_16x16x32_bf16 v[80:83], a[80:83], a[8:11], 0
    ds_read_b128 a[60:63], v145 offset:14336
    v_mfma_f32_16x16x32_bf16 v[80:83], a[112:115], a[24:27], v[80:83]
    buffer_load_dwordx4 v129, s[8:11], s46 offen offset:1024 sc1 lds
    v_mfma_f32_16x16x32_bf16 v[76:79], a[108:111], a[24:27], 0
    v_mfma_f32_16x16x32_bf16 v[76:79], a[76:79], a[8:11], v[76:79]
    buffer_load_dwordx4 v130, s[8:11], s46 offen offset:2048 sc1 lds
    v_mfma_f32_16x16x32_bf16 v[72:75], a[72:75], a[8:11], 0
    v_mfma_f32_16x16x32_bf16 v[72:75], a[104:107], a[24:27], v[72:75]
    v_mfma_f32_16x16x32_bf16 v[68:71], a[100:103], a[24:27], 0
    buffer_load_dwordx4 v131, s[8:11], s46 offen offset:3072 sc1 lds
    v_mfma_f32_16x16x32_bf16 v[68:71], a[68:71], a[8:11], v[68:71]
    v_mfma_f32_16x16x32_bf16 v[64:67], a[64:67], a[8:11], 0
    v_mfma_f32_16x16x32_bf16 v[64:67], a[96:99], a[24:27], v[64:67]
    s_add_u32 s46, s46, s68
    s_waitcnt lgkmcnt(0)
    v_mfma_f32_16x16x32_bf16 v[96:99], a[64:67], a[12:15], 0
    ds_read_b64_tr_b16 a[64:65], v151 offset:0
    v_mfma_f32_16x16x32_bf16 v[96:99], a[96:99], a[28:31], v[96:99]
    ds_read_b64_tr_b16 a[66:67], v151 offset:1024
    v_mfma_f32_16x16x32_bf16 v[100:103], a[68:71], a[12:15], 0
    ds_read_b64_tr_b16 a[68:69], v152 offset:0
    v_mfma_f32_16x16x32_bf16 v[100:103], a[100:103], a[28:31], v[100:103]
    ds_read_b64_tr_b16 a[70:71], v152 offset:1024
    v_mfma_f32_16x16x32_bf16 v[104:107], a[72:75], a[12:15], 0
    ds_read_b64_tr_b16 a[72:73], v153 offset:0
    v_mfma_f32_16x16x32_bf16 v[104:107], a[104:107], a[28:31], v[104:107]
    ds_read_b64_tr_b16 a[74:75], v153 offset:1024
    v_mfma_f32_16x16x32_bf16 v[108:111], a[76:79], a[12:15], 0
    ds_read_b64_tr_b16 a[76:77], v154 offset:0
    v_mfma_f32_16x16x32_bf16 v[108:111], a[108:111], a[28:31], v[108:111]
    ds_read_b64_tr_b16 a[78:79], v154 offset:1024
    v_add_u32 v145, s93, v145
    v_mfma_f32_16x16x32_bf16 v[112:115], a[80:83], a[12:15], 0
    ds_read_b64_tr_b16 a[80:81], v151 offset:8192
    v_mfma_f32_16x16x32_bf16 v[112:115], a[112:115], a[28:31], v[112:115]
    ds_read_b64_tr_b16 a[82:83], v151 offset:9216
    v_mfma_f32_16x16x32_bf16 v[116:119], a[84:87], a[12:15], 0
    ds_read_b64_tr_b16 a[84:85], v152 offset:8192
    v_mfma_f32_16x16x32_bf16 v[116:119], a[116:119], a[28:31], v[116:119]
    ds_read_b64_tr_b16 a[86:87], v152 offset:9216
    v_mfma_f32_16x16x32_bf16 v[120:123], a[88:91], a[12:15], 0
    ds_read_b64_tr_b16 a[88:89], v153 offset:8192
    v_mfma_f32_16x16x32_bf16 v[120:123], a[120:123], a[28:31], v[120:123]
    ds_read_b64_tr_b16 a[90:91], v153 offset:9216
    v_mfma_f32_16x16x32_bf16 v[124:127], a[92:95], a[12:15], 0
    ds_read_b64_tr_b16 a[92:93], v154 offset:8192
    v_mfma_f32_16x16x32_bf16 v[124:127], a[124:127], a[28:31], v[124:127]
    ds_read_b64_tr_b16 a[94:95], v154 offset:9216
L1_kloop:
    v_mfma_f32_16x16x32_bf16 v[192:195], a[96:99], a[48:51], v[192:195]
    s_waitcnt lgkmcnt(14)
    s_add_u32 s54, s54, 16384
    v_mfma_f32_16x16x32_bf16 v[192:195], a[64:67], a[32:35], v[192:195]
    v_mfma_f32_16x16x32_bf16 a[192:195], a[100:103], a[48:51], a[192:195]
    s_waitcnt lgkmcnt(12)
    s_and_b32 s54, s54, 0xffff
    v_mfma_f32_16x16x32_bf16 a[192:195], a[68:71], a[32:35], a[192:195]
    v_mfma_f32_16x16x32_bf16 v[196:199], a[104:107], a[48:51], v[196:199]
    s_waitcnt lgkmcnt(10)
    v_add_u32 v151, s54, v146
    v_mfma_f32_16x16x32_bf16 v[196:199], a[72:75], a[32:35], v[196:199]
    v_mfma_f32_16x16x32_bf16 a[196:199], a[108:111], a[48:51], a[196:199]
    s_waitcnt lgkmcnt(8)
    v_add_u32 v152, s54, v147
    v_mfma_f32_16x16x32_bf16 a[196:199], a[76:79], a[32:35], a[196:199]
    v_mfma_f32_16x16x32_bf16 v[200:203], a[112:115], a[48:51], v[200:203]
    s_waitcnt lgkmcnt(6)
    v_add_u32 v153, s54, v148
    v_mfma_f32_16x16x32_bf16 v[200:203], a[80:83], a[32:35], v[200:203]
    v_mfma_f32_16x16x32_bf16 a[200:203], a[116:119], a[48:51], a[200:203]
    s_waitcnt lgkmcnt(4)
    v_add_u32 v154, s54, v149
    v_mfma_f32_16x16x32_bf16 a[200:203], a[84:87], a[32:35], a[200:203]
    v_mfma_f32_16x16x32_bf16 v[204:207], a[120:123], a[48:51], v[204:207]
    s_waitcnt lgkmcnt(2)
    v_mfma_f32_16x16x32_bf16 v[204:207], a[88:91], a[32:35], v[204:207]
    v_mfma_f32_16x16x32_bf16 a[204:207], a[124:127], a[48:51], a[204:207]
    s_waitcnt lgkmcnt(0)
    v_mfma_f32_16x16x32_bf16 a[204:207], a[92:95], a[32:35], a[204:207]
    s_waitcnt vmcnt(21)
    s_barrier
    v_mfma_f32_16x16x32_bf16 a[220:223], a[92:95], a[36:39], a[220:223]
    ds_read_b128 a[0:3], v144 offset:0
    s_sub_u32 s57, s57, 1
    v_mfma_f32_16x16x32_bf16 a[220:223], a[124:127], a[52:55], a[220:223]
    s_cbranch_scc1 L1_sw3
L1_swr3:
    v_mfma_f32_16x16x32_bf16 v[220:223], a[120:123], a[52:55], v[220:223]
    s_mov_b32 m0, s52
    v_mfma_f32_16x16x32_bf16 v[220:223], a[88:91], a[36:39], v[220:223]
    ds_read_b128 a[16:19], v145 offset:0
    s_add_u32 s52, s52, 16384
    v_mfma_f32_16x16x32_bf16 a[216:219], a[84:87], a[36:39], a[216:219]
    buffer_load_dwordx4 v132, s[12:15], s48 offen offset:0 sc1 lds
    v_mfma_f32_16x16x32_bf16 a[216:219], a[116:119], a[52:55], a[216:219]
    v_mfma_f32_16x16x32_bf16 v[216:219], a[112:115], a[52:55], v[216:219]
    ds_read_b128 a[4:7], v144 offset:2048
    v_mfma_f32_16x16x32_bf16 v[216:219], a[80:83], a[36:39], v[216:219]
    buffer_load_dwordx4 v133, s[12:15], s48 offen offset:1024 sc1 lds
    v_mfma_f32_16x16x32_bf16 a[212:215], a[76:79], a[36:39], a[212:215]
    buffer_load_dwordx4 v134, s[12:15], s48 offen offset:2048 sc1 lds
    v_mfma_f32_16x16x32_bf16 a[212:215], a[108:111], a[52:55], a[212:215]
    ds_read_b128 a[20:23], v145 offset:2048
    v_mfma_f32_16x16x32_bf16 v[212:215], a[104:107], a[52:55], v[212:215]
    v_mfma_f32_16x16x32_bf16 v[212:215], a[72:75], a[36:39], v[212:215]
    buffer_load_dwordx4 v135, s[12:15], s48 offen offset:3072 sc1 lds
    v_mfma_f32_16x16x32_bf16 a[208:211], a[68:71], a[36:39], a[208:211]
    v_mfma_f32_16x16x32_bf16 a[208:211], a[100:103], a[52:55], a[208:211]
    ds_read_b128 a[8:11], v144 offset:4096
    s_add_u32 s48, s48, s49
    v_mfma_f32_16x16x32_bf16 v[208:211], a[96:99], a[52:55], v[208:211]
    s_and_b32 s52, s52, 0xffff
    v_mfma_f32_16x16x32_bf16 v[208:211], a[64:67], a[36:39], v[208:211]
    s_add_u32 m0, s51, 8192
    v_mfma_f32_16x16x32_bf16 v[224:227], a[64:67], a[40:43], v[224:227]
    ds_read_b128 a[24:27], v145 offset:4096
    s_add_u32 s51, s51, 32768
    v_mfma_f32_16x16x32_bf16 v[224:227], a[96:99], a[56:59], v[224:227]
    buffer_load_dwordx4 v128, s[8:11], s47 offen offset:0 sc1 lds
    v_mfma_f32_16x16x32_bf16 a[224:227], a[100:103], a[56:59], a[224:227]
    v_mfma_f32_16x16x32_bf16 a[224:227], a[68:71], a[40:43], a[224:227]
    ds_read_b128 a[12:15], v144 offset:6144
    v_mfma_f32_16x16x32_bf16 v[228:231], a[72:75], a[40:43], v[228:231]
    buffer_load_dwordx4 v129, s[8:11], s47 offen offset:1024 sc1 lds
    v_mfma_f32_16x16x32_bf16 v[228:231], a[104:107], a[56:59], v[228:231]
    v_mfma_f32_16x16x32_bf16 a[228:231], a[108:111], a[56:59], a[228:231]
    ds_read_b128 a[28:31], v145 offset:6144
    v_mfma_f32_16x16x32_bf16 a[228:231], a[76:79], a[40:43], a[228:231]
    buffer_load_dwordx4 v130, s[8:11], s47 offen offset:2048 sc1 lds
    v_mfma_f32_16x16x32_bf16 v[232:235], a[80:83], a[40:43], v[232:235]
    buffer_load_dwordx4 v131, s[8:11], s47 offen offset:3072 sc1 lds
    v_mfma_f32_16x16x32_bf16 v[232:235], a[112:115], a[56:59], v[232:235]
    v_mfma_f32_16x16x32_bf16 a[232:235], a[116:119], a[56:59], a[232:235]
    s_cmp_ge_u32 s51, s79
    v_mfma_f32_16x16x32_bf16 a[232:235], a[84:87], a[40:43], a[232:235]
    s_cselect_b32 s51, s78, s51
    v_mfma_f32_16x16x32_bf16 v[236:239], a[88:91], a[40:43], v[236:239]
    buffer_load_dword v158, v157, s[84:87], s88 offen
    v_mfma_f32_16x16x32_bf16 v[236:239], a[120:123], a[56:59], v[236:239]
    v_mfma_f32_16x16x32_bf16 a[236:239], a[124:127], a[56:59], a[236:239]
    v_mfma_f32_16x16x32_bf16 a[236:239], a[92:95], a[40:43], a[236:239]
    s_add_u32 s88, s88, s89
    s_waitcnt lgkmcnt(0)
    v_mfma_f32_16x16x32_bf16 a[252:255], a[124:127], a[60:63], a[252:255]
    ds_read_b64_tr_b16 a[124:125], v154 offset:8192
    v_mfma_f32_16x16x32_bf16 a[252:255], a[92:95], a[44:47], a[252:255]
    ds_read_b64_tr_b16 a[126:127], v154 offset:9216
    s_add_u32 s53, s53, 1
    v_mfma_f32_16x16x32_bf16 v[252:255], a[120:123], a[60:63], v[252:255]
    ds_read_b64_tr_b16 a[120:121], v153 offset:8192
    v_mfma_f32_16x16x32_bf16 v[252:255], a[88:91], a[44:47], v[252:255]
    ds_read_b64_tr_b16 a[122:123], v153 offset:9216
    s_cmp_eq_u32 s53, 3
    v_mfma_f32_16x16x32_bf16 a[248:251], a[116:119], a[60:63], a[248:251]
    ds_read_b64_tr_b16 a[116:117], v152 offset:8192
    v_mfma_f32_16x16x32_bf16 a[248:251], a[84:87], a[44:47], a[248:251]
    ds_read_b64_tr_b16 a[118:119], v152 offset:9216
    s_cselect_b32 s53, 0, s53
    v_mfma_f32_16x16x32_bf16 v[248:251], a[112:115], a[60:63], v[248:251]
    ds_read_b64_tr_b16 a[112:113], v151 offset:8192
    v_mfma_f32_16x16x32_bf16 v[248:251], a[80:83], a[44:47], v[248:251]
    ds_read_b64_tr_b16 a[114:115], v151 offset:9216
    v_mfma_f32_16x16x32_bf16 a[244:247], a[108:111], a[60:63], a[244:247]
    ds_read_b64_tr_b16 a[108:109], v154 offset:0
    s_cselect_b32 s93, -2, 1
    v_mfma_f32_16x16x32_bf16 a[244:247], a[76:79], a[44:47], a[244:247]
    ds_read_b64_tr_b16 a[110:111], v154 offset:1024
    v_mfma_f32_16x16x32_bf16 v[244:247], a[104:107], a[60:63], v[244:247]
    ds_read_b64_tr_b16 a[104:105], v153 offset:0
    s_lshl_b32 s93, s93, 15
    v_mfma_f32_16x16x32_bf16 v[244:247], a[72:75], a[44:47], v[244:247]
    ds_read_b64_tr_b16 a[106:107], v153 offset:1024
    v_mfma_f32_16x16x32_bf16 a[240:243], a[100:103], a[60:63], a[240:243]
    ds_read_b64_tr_b16 a[100:101], v152 offset:0
    v_add_u32 v144, s93, v144
    v_mfma_f32_16x16x32_bf16 a[240:243], a[68:71], a[44:47], a[240:243]
    ds_read_b64_tr_b16 a[102:103], v152 offset:1024
    v_mfma_f32_16x16x32_bf16 v[240:243], a[96:99], a[60:63], v[240:243]
    ds_read_b64_tr_b16 a[96:97], v151 offset:0
    v_mfma_f32_16x16x32_bf16 v[240:243], a[64:67], a[44:47], v[240:243]
    ds_read_b64_tr_b16 a[98:99], v151 offset:1024
    v_mfma_f32_16x16x32_bf16 v[28:31], a[92:95], a[0:3], v[28:31]
    s_waitcnt lgkmcnt(14)
    s_add_u32 s54, s54, 16384
    v_mfma_f32_16x16x32_bf16 v[28:31], a[124:127], a[16:19], v[28:31]
    v_mfma_f32_16x16x32_bf16 v[24:27], a[88:91], a[0:3], v[24:27]
    s_waitcnt lgkmcnt(12)
    s_and_b32 s54, s54, 0xffff
    v_mfma_f32_16x16x32_bf16 v[24:27], a[120:123], a[16:19], v[24:27]
    v_mfma_f32_16x16x32_bf16 v[20:23], a[84:87], a[0:3], v[20:23]
    s_waitcnt lgkmcnt(10)
    v_add_u32 v151, s54, v146
    v_mfma_f32_16x16x32_bf16 v[20:23], a[116:119], a[16:19], v[20:23]
    v_mfma_f32_16x16x32_bf16 v[16:19], a[80:83], a[0:3], v[16:19]
    s_waitcnt lgkmcnt(8)
    v_add_u32 v152, s54, v147
    v_mfma_f32_16x16x32_bf16 v[16:19], a[112:115], a[16:19], v[16:19]
    v_mfma_f32_16x16x32_bf16 v[12:15], a[76:79], a[0:3], v[12:15]
    s_waitcnt lgkmcnt(6)
    v_add_u32 v153, s54, v148
    v_mfma_f32_16x16x32_bf16 v[12:15], a[108:111], a[16:19], v[12:15]
    v_mfma_f32_16x16x32_bf16 v[8:11], a[72:75], a[0:3], v[8:11]
    s_waitcnt lgkmcnt(4)
    v_add_u32 v154, s54, v149
    v_mfma_f32_16x16x32_bf16 v[8:11], a[104:107], a[16:19], v[8:11]
    v_mfma_f32_16x16x32_bf16 v[4:7], a[68:71], a[0:3], v[4:7]
    s_waitcnt lgkmcnt(2)
    v_mfma_f32_16x16x32_bf16 v[4:7], a[100:103], a[16:19], v[4:7]
    v_mfma_f32_16x16x32_bf16 v[0:3], a[64:67], a[0:3], v[0:3]
    s_waitcnt lgkmcnt(0)
    v_mfma_f32_16x16x32_bf16 v[0:3], a[96:99], a[16:19], v[0:3]
    s_waitcnt vmcnt(18)
    s_barrier
    v_mfma_f32_16x16x32_bf16 v[32:35], a[96:99], a[20:23], v[32:35]
    ds_read_b128 a[32:35], v144 offset:8192
    s_mov_b32 m0, s52
    v_mfma_f32_16x16x32_bf16 v[32:35], a[64:67], a[4:7], v[32:35]
    s_add_u32 s52, s52, 16384
    v_mfma_f32_16x16x32_bf16 v[36:39], a[68:71], a[4:7], v[36:39]
    buffer_load_dwordx4 v132, s[12:15], s48 offen offset:0 sc1 lds
    v_mfma_f32_16x16x32_bf16 v[36:39], a[100:103], a[20:23], v[36:39]
    ds_read_b128 a[48:51], v145 offset:8192
    v_mfma_f32_16x16x32_bf16 v[40:43], a[104:107], a[20:23], v[40:43]
    v_mfma_f32_16x16x32_bf16 v[40:43], a[72:75], a[4:7], v[40:43]
    buffer_load_dwordx4 v133, s[12:15], s48 offen offset:1024 sc1 lds
    v_mfma_f32_16x16x32_bf16 v[44:47], a[76:79], a[4:7], v[44:47]
    ds_read_b128 a[36:39], v144 offset:10240
    v_mfma_f32_16x16x32_bf16 v[44:47], a[108:111], a[20:23], v[44:47]
    buffer_load_dwordx4 v134, s[12:15], s48 offen offset:2048 sc1 lds
    v_mfma_f32_16x16x32_bf16 v[48:51], a[112:115], a[20:23], v[48:51]
    v_mfma_f32_16x16x32_bf16 v[48:51], a[80:83], a[4:7], v[48:51]
    ds_read_b128 a[52:55], v145 offset:10240
    v_mfma_f32_16x16x32_bf16 v[52:55], a[84:87], a[4:7], v[52:55]
    buffer_load_dwordx4 v135, s[12:15], s48 offen offset:3072 sc1 lds
    v_mfma_f32_16x16x32_bf16 v[52:55], a[116:119], a[20:23], v[52:55]
    v_mfma_f32_16x16x32_bf16 v[56:59], a[120:123], a[20:23], v[56:59]
    s_add_u32 s48, s48, s49
    v_mfma_f32_16x16x32_bf16 v[56:59], a[88:91], a[4:7], v[56:59]
    ds_read_b128 a[40:43], v144 offset:12288
    v_mfma_f32_16x16x32_bf16 v[60:63], a[92:95], a[4:7], v[60:63]
    s_and_b32 s52, s52, 0xffff
    v_mfma_f32_16x16x32_bf16 v[60:63], a[124:127], a[20:23], v[60:63]
    s_sub_u32 s56, s56, 1
    v_mfma_f32_16x16x32_bf16 v[92:95], a[124:127], a[24:27], v[92:95]
    ds_read_b128 a[56:59], v145 offset:12288
    s_cbranch_scc1 L1_sw4
L1_swr4:
    v_mfma_f32_16x16x32_bf16 v[92:95], a[92:95], a[8:11], v[92:95]
    v_mfma_f32_16x16x32_bf16 v[88:91], a[88:91], a[8:11], v[88:91]
    s_mov_b32 m0, s51
    v_mfma_f32_16x16x32_bf16 v[88:91], a[120:123], a[24:27], v[88:91]
    ds_read_b128 a[44:47], v144 offset:14336
    s_add_u32 s47, s46, s50
    v_mfma_f32_16x16x32_bf16 v[84:87], a[116:119], a[24:27], v[84:87]
    buffer_load_dwordx4 v128, s[8:11], s46 offen offset:0 sc1 lds
    v_mfma_f32_16x16x32_bf16 v[84:87], a[84:87], a[8:11], v[84:87]
    v_mfma_f32_16x16x32_bf16 v[80:83], a[80:83], a[8:11], v[80:83]
    ds_read_b128 a[60:63], v145 offset:14336
    v_mfma_f32_16x16x32_bf16 v[80:83], a[112:115], a[24:27], v[80:83]
    buffer_load_dwordx4 v129, s[8:11], s46 offen offset:1024 sc1 lds
    v_mfma_f32_16x16x32_bf16 v[76:79], a[108:111], a[24:27], v[76:79]
    v_mfma_f32_16x16x32_bf16 v[76:79], a[76:79], a[8:11], v[76:79]
    buffer_load_dwordx4 v130, s[8:11], s46 offen offset:2048 sc1 lds
    v_mfma_f32_16x16x32_bf16 v[72:75], a[72:75], a[8:11], v[72:75]
    v_mfma_f32_16x16x32_bf16 v[72:75], a[104:107], a[24:27], v[72:75]
    v_mfma_f32_16x16x32_bf16 v[68:71], a[100:103], a[24:27], v[68:71]
    buffer_load_dwordx4 v131, s[8:11], s46 offen offset:3072 sc1 lds
    v_mfma_f32_16x16x32_bf16 v[68:71], a[68:71], a[8:11], v[68:71]
    v_mfma_f32_16x16x32_bf16 v[64:67], a[64:67], a[8:11], v[64:67]
    v_mfma_f32_16x16x32_bf16 v[64:67], a[96:99], a[24:27], v[64:67]
    s_add_u32 s46, s46, s68
    s_waitcnt lgkmcnt(0)
    v_mfma_f32_16x16x32_bf16 v[96:99], a[64:67], a[12:15], v[96:99]
    ds_read_b64_tr_b16 a[64:65], v151 offset:0
    v_mfma_f32_16x16x32_bf16 v[96:99], a[96:99], a[28:31], v[96:99]
    ds_read_b64_tr_b16 a[66:67], v151 offset:1024
    v_mfma_f32_16x16x32_bf16 v[100:103], a[68:71], a[12:15], v[100:103]
    ds_read_b64_tr_b16 a[68:69], v152 offset:0
    v_mfma_f32_16x16x32_bf16 v[100:103], a[100:103], a[28:31], v[100:103]
    ds_read_b64_tr_b16 a[70:71], v152 offset:1024
    v_mfma_f32_16x16x32_bf16 v[104:107], a[72:75], a[12:15], v[104:107]
    ds_read_b64_tr_b16 a[72:73], v153 offset:0
    s_sub_u32 s55, s55, 1
    v_mfma_f32_16x16x32_bf16 v[104:107], a[104:107], a[28:31], v[104:107]
    ds_read_b64_tr_b16 a[74:75], v153 offset:1024
    v_mfma_f32_16x16x32_bf16 v[108:111], a[76:79], a[12:15], v[108:111]
    ds_read_b64_tr_b16 a[76:77], v154 offset:0
    v_mfma_f32_16x16x32_bf16 v[108:111], a[108:111], a[28:31], v[108:111]
    ds_read_b64_tr_b16 a[78:79], v154 offset:1024
    v_mfma_f32_16x16x32_bf16 v[112:115], a[80:83], a[12:15], v[112:115]
    ds_read_b64_tr_b16 a[80:81], v151 offset:8192
    v_mfma_f32_16x16x32_bf16 v[112:115], a[112:115], a[28:31], v[112:115]
    ds_read_b64_tr_b16 a[82:83], v151 offset:9216
    v_add_u32 v145, s93, v145
    v_mfma_f32_16x16x32_bf16 v[116:119], a[84:87], a[12:15], v[116:119]
    ds_read_b64_tr_b16 a[84:85], v152 offset:8192
    v_mfma_f32_16x16x32_bf16 v[116:119], a[116:119], a[28:31], v[116:119]
    ds_read_b64_tr_b16 a[86:87], v152 offset:9216
    v_mfma_f32_16x16x32_bf16 v[120:123], a[88:91], a[12:15], v[120:123]
    ds_read_b64_tr_b16 a[88:89], v153 offset:8192
    v_mfma_f32_16x16x32_bf16 v[120:123], a[120:123], a[28:31], v[120:123]
    ds_read_b64_tr_b16 a[90:91], v153 offset:9216
    v_mfma_f32_16x16x32_bf16 v[124:127], a[92:95], a[12:15], v[124:127]
    ds_read_b64_tr_b16 a[92:93], v154 offset:8192
    v_mfma_f32_16x16x32_bf16 v[124:127], a[124:127], a[28:31], v[124:127]
    ds_read_b64_tr_b16 a[94:95], v154 offset:9216
    s_cmp_lg_u32 s55, 0
    s_cbranch_scc1 L1_kloop
    s_cmp_eq_u32 s96, 1
    s_cbranch_scc1 L1_end2
    s_cmp_eq_u32 s31, 2
    s_cbranch_scc1 L1_epi1q
    v_mfma_f32_16x16x32_bf16 v[192:195], a[96:99], a[48:51], v[192:195]
    v_mfma_f32_16x16x32_bf16 a[192:195], a[100:103], a[48:51], a[192:195]
    v_mfma_f32_16x16x32_bf16 v[196:199], a[104:107], a[48:51], v[196:199]
    s_lshr_b32 s4, s58, 1
    s_lshl_b32 s4, s4, 16
    s_and_b32 s5, s58, 1
    v_mfma_f32_16x16x32_bf16 a[196:199], a[108:111], a[48:51], a[196:199]
    s_lshl_b32 s5, s5, 11
    s_add_u32 s4, s4, s5
    s_add_u32 s98, s4, s30
    v_mfma_f32_16x16x32_bf16 v[200:203], a[112:115], a[48:51], v[200:203]
    v_add_u32 v156, 4096, v155
    v_cvt_pk_bf16_f32 v0, v0, v1
    v_mfma_f32_16x16x32_bf16 a[200:203], a[116:119], a[48:51], a[200:203]
    v_cvt_pk_bf16_f32 v1, v2, v3
    v_cvt_pk_bf16_f32 v2, v4, v5
    v_mfma_f32_16x16x32_bf16 v[204:207], a[120:123], a[48:51], v[204:207]
    v_cvt_pk_bf16_f32 v3, v6, v7
    v_mfma_f32_16x16x32_bf16 a[204:207], a[124:127], a[48:51], a[204:207]
    buffer_store_dwordx4 v[0:3], v155, s[16:19], s98 offen offset:0 sc0 sc1
    v_mfma_f32_16x16x32_bf16 a[220:223], a[124:127], a[52:55], a[220:223]
    v_cvt_pk_bf16_f32 v8, v8, v9
    v_cvt_pk_bf16_f32 v9, v10, v11
    v_mfma_f32_16x16x32_bf16 v[220:223], a[120:123], a[52:55], v[220:223]
    v_cvt_pk_bf16_f32 v10, v12, v13
    v_cvt_pk_bf16_f32 v11, v14, v15
    v_mfma_f32_16x16x32_bf16 a[216:219], a[116:119], a[52:55], a[216:219]
    buffer_store_dwordx4 v[8:11], v155, s[16:19], s98 offen offset:1024 sc0 sc1
    v_mfma_f32_16x16x32_bf16 v[216:219], a[112:115], a[52:55], v[216:219]
    v_cvt_pk_bf16_f32 v16, v16, v17
    v_cvt_pk_bf16_f32 v17, v18, v19
    v_mfma_f32_16x16x32_bf16 a[212:215], a[108:111], a[52:55], a[212:215]
    v_cvt_pk_bf16_f32 v18, v20, v21
    v_cvt_pk_bf16_f32 v19, v22, v23
    v_mfma_f32_16x16x32_bf16 v[212:215], a[104:107], a[52:55], v[212:215]
    buffer_store_dwordx4 v[16:19], v156, s[16:19], s98 offen offset:0 sc0 sc1
    v_mfma_f32_16x16x32_bf16 a[208:211], a[100:103], a[52:55], a[208:211]
    v_cvt_pk_bf16_f32 v24, v24, v25
    v_cvt_pk_bf16_f32 v25, v26, v27
    v_mfma_f32_16x16x32_bf16 v[208:211], a[96:99], a[52:55], v[208:211]
    v_cvt_pk_bf16_f32 v26, v28, v29
    v_cvt_pk_bf16_f32 v27, v30, v31
    v_mfma_f32_16x16x32_bf16 v[224:227], a[96:99], a[56:59], v[224:227]
    buffer_store_dwordx4 v[24:27], v156, s[16:19], s98 offen offset:1024 sc0 sc1
    v_mfma_f32_16x16x32_bf16 a[224:227], a[100:103], a[56:59], a[224:227]
    s_add_u32 s98, s98, 8192
    v_cvt_pk_bf16_f32 v32, v32, v33
    v_cvt_pk_bf16_f32 v33, v34, v35
    v_mfma_f32_16x16x32_bf16 v[228:231], a[104:107], a[56:59], v[228:231]
    v_cvt_pk_bf16_f32 v34, v36, v37
    v_cvt_pk_bf16_f32 v35, v38, v39
    v_mfma_f32_16x16x32_bf16 a[228:231], a[108:111], a[56:59], a[228:231]
    buffer_store_dwordx4 v[32:35], v155, s[16:19], s98 offen offset:0 sc0 sc1
    v_mfma_f32_16x16x32_bf16 v[232:235], a[112:115], a[56:59], v[232:235]
    v_cvt_pk_bf16_f32 v40, v40, v41
    v_cvt_pk_bf16_f32 v41, v42, v43
    v_mfma_f32_16x16x32_bf16 a[232:235], a[116:119], a[56:59], a[232:235]
    v_cvt_pk_bf16_f32 v42, v44, v45
    v_cvt_pk_bf16_f32 v43, v46, v47
    v_mfma_f32_16x16x32_bf16 v[236:239], a[120:123], a[56:59], v[236:239]
    buffer_store_dwordx4 v[40:43], v155, s[16:19], s98 offen offset:1024 sc0 sc1
    v_mfma_f32_16x16x32_bf16 a[236:239], a[124:127], a[56:59], a[236:239]
    v_cvt_pk_bf16_f32 v48, v48, v49
    v_cvt_pk_bf16_f32 v49, v50, v51
    v_mfma_f32_16x16x32_bf16 a[252:255], a[124:127], a[60:63], a[252:255]
    v_cvt_pk_bf16_f32 v50, v52, v53
    v_cvt_pk_bf16_f32 v51, v54, v55
    v_mfma_f32_16x16x32_bf16 v[252:255], a[120:123], a[60:63], v[252:255]
    buffer_store_dwordx4 v[48:51], v156, s[16:19], s98 offen offset:0 sc0 sc1
    v_mfma_f32_16x16x32_bf16 a[248:251], a[116:119], a[60:63], a[248:251]
    v_cvt_pk_bf16_f32 v56, v56, v57
    v_cvt_pk_bf16_f32 v57, v58, v59
    v_mfma_f32_16x16x32_bf16 v[248:251], a[112:115], a[60:63], v[248:251]
    v_cvt_pk_bf16_f32 v58, v60, v61
    v_cvt_pk_bf16_f32 v59, v62, v63
    v_mfma_f32_16x16x32_bf16 a[244:247], a[108:111], a[60:63], a[244:247]
    buffer_store_dwordx4 v[56:59], v156, s[16:19], s98 offen offset:1024 sc0 sc1
    v_mfma_f32_16x16x32_bf16 v[244:247], a[104:107], a[60:63], v[244:247]
    s_add_u32 s98, s98, 8192
    v_cvt_pk_bf16_f32 v64, v64, v65
    v_cvt_pk_bf16_f32 v65, v66, v67
    v_mfma_f32_16x16x32_bf16 a[240:243], a[100:103], a[60:63], a[240:243]
    v_cvt_pk_bf16_f32 v66, v68, v69
    v_cvt_pk_bf16_f32 v67, v70, v71
    v_mfma_f32_16x16x32_bf16 v[240:243], a[96:99], a[60:63], v[240:243]
    buffer_store_dwordx4 v[64:67], v155, s[16:19], s98 offen offset:0 sc0 sc1
    v_cvt_pk_bf16_f32 v72, v72, v73
    v_cvt_pk_bf16_f32 v73, v74, v75
    v_cvt_pk_bf16_f32 v74, v76, v77
    v_cvt_pk_bf16_f32 v75, v78, v79
    buffer_store_dwordx4 v[72:75], v155, s[16:19], s98 offen offset:1024 sc0 sc1
    v_cvt_pk_bf16_f32 v168, v80, v81
    v_cvt_pk_bf16_f32 v169, v82, v83
    v_cvt_pk_bf16_f32 v170, v84, v85
    v_cvt_pk_bf16_f32 v171, v86, v87
    v_cvt_pk_bf16_f32 v172, v88, v89
    v_cvt_pk_bf16_f32 v173, v90, v91
    v_cvt_pk_bf16_f32 v174, v92, v93
    v_cvt_pk_bf16_f32 v175, v94, v95
    v_cvt_pk_bf16_f32 v176, v96, v97
    v_cvt_pk_bf16_f32 v177, v98, v99
    v_cvt_pk_bf16_f32 v178, v100, v101
    v_cvt_pk_bf16_f32 v179, v102, v103
    v_cvt_pk_bf16_f32 v180, v104, v105
    v_cvt_pk_bf16_f32 v181, v106, v107
    v_cvt_pk_bf16_f32 v182, v108, v109
    v_cvt_pk_bf16_f32 v183, v110, v111
    v_cvt_pk_bf16_f32 v184, v112, v113
    v_cvt_pk_bf16_f32 v185, v114, v115
    v_cvt_pk_bf16_f32 v186, v116, v117
    v_cvt_pk_bf16_f32 v187, v118, v119
    v_cvt_pk_bf16_f32 v188, v120, v121
    v_cvt_pk_bf16_f32 v189, v122, v123
    v_cvt_pk_bf16_f32 v190, v124, v125
    v_cvt_pk_bf16_f32 v191, v126, v127
    v_accvgpr_read_b32 v0, a192
    v_accvgpr_read_b32 v1, a193
    v_accvgpr_read_b32 v2, a194
    v_accvgpr_read_b32 v3, a195
    v_cvt_pk_bf16_f32 v192, v192, v193
    v_cvt_pk_bf16_f32 v193, v194, v195
    v_cvt_pk_bf16_f32 v194, v0, v1
    v_cvt_pk_bf16_f32 v195, v2, v3
    v_accvgpr_write_b32 a128, v192
    v_accvgpr_write_b32 a129, v193
    v_accvgpr_write_b32 a130, v194
    v_accvgpr_write_b32 a131, v195
    v_accvgpr_read_b32 v4, a196
    v_accvgpr_read_b32 v5, a197
    v_accvgpr_read_b32 v6, a198
    v_accvgpr_read_b32 v7, a199
    v_cvt_pk_bf16_f32 v196, v196, v197
    v_cvt_pk_bf16_f32 v197, v198, v199
    v_cvt_pk_bf16_f32 v198, v4, v5
    v_cvt_pk_bf16_f32 v199, v6, v7
    v_accvgpr_write_b32 a132, v196
    v_accvgpr_write_b32 a133, v197
    v_accvgpr_write_b32 a134, v198
    v_accvgpr_write_b32 a135, v199
    v_accvgpr_read_b32 v8, a200
    v_accvgpr_read_b32 v9, a201
    v_accvgpr_read_b32 v10, a202
    v_accvgpr_read_b32 v11, a203
    v_cvt_pk_bf16_f32 v200, v200, v201
    v_cvt_pk_bf16_f32 v201, v202, v203
    v_cvt_pk_bf16_f32 v202, v8, v9
    v_cvt_pk_bf16_f32 v203, v10, v11
    v_accvgpr_write_b32 a136, v200
    v_accvgpr_write_b32 a137, v201
    v_accvgpr_write_b32 a138, v202
    v_accvgpr_write_b32 a139, v203
    v_accvgpr_read_b32 v12, a204
    v_accvgpr_read_b32 v13, a205
    v_accvgpr_read_b32 v14, a206
    v_accvgpr_read_b32 v15, a207
    v_cvt_pk_bf16_f32 v204, v204, v205
    v_cvt_pk_bf16_f32 v205, v206, v207
    v_cvt_pk_bf16_f32 v206, v12, v13
    v_cvt_pk_bf16_f32 v207, v14, v15
    v_accvgpr_write_b32 a140, v204
    v_accvgpr_write_b32 a141, v205
    v_accvgpr_write_b32 a142, v206
    v_accvgpr_write_b32 a143, v207
    v_accvgpr_read_b32 v0, a208
    v_accvgpr_read_b32 v1, a209
    v_accvgpr_read_b32 v2, a210
    v_accvgpr_read_b32 v3, a211
    v_cvt_pk_bf16_f32 v208, v208, v209
    v_cvt_pk_bf16_f32 v209, v210, v211
    v_cvt_pk_bf16_f32 v210, v0, v1
    v_cvt_pk_bf16_f32 v211, v2, v3
    v_accvgpr_write_b32 a144, v208
    v_accvgpr_write_b32 a145, v209
    v_accvgpr_write_b32 a146, v210
    v_accvgpr_write_b32 a147, v211
    v_accvgpr_read_b32 v4, a212
    v_accvgpr_read_b32 v5, a213
    v_accvgpr_read_b32 v6, a214
    v_accvgpr_read_b32 v7, a215
    v_cvt_pk_bf16_f32 v212, v212, v213
    v_cvt_pk_bf16_f32 v213, v214, v215
    v_cvt_pk_bf16_f32 v214, v4, v5
    v_cvt_pk_bf16_f32 v215, v6, v7
    v_accvgpr_write_b32 a148, v212
    v_accvgpr_write_b32 a149, v213
    v_accvgpr_write_b32 a150, v214
    v_accvgpr_write_b32 a151, v215
    v_accvgpr_read_b32 v8, a216
    v_accvgpr_read_b32 v9, a217
    v_accvgpr_read_b32 v10, a218
    v_accvgpr_read_b32 v11, a219
    v_cvt_pk_bf16_f32 v216, v216, v217
    v_cvt_pk_bf16_f32 v217, v218, v219
    v_cvt_pk_bf16_f32 v218, v8, v9
    v_cvt_pk_bf16_f32 v219, v10, v11
    v_accvgpr_write_b32 a152, v216
    v_accvgpr_write_b32 a153, v217
    v_accvgpr_write_b32 a154, v218
    v_accvgpr_write_b32 a155, v219
    v_accvgpr_read_b32 v12, a220
    v_accvgpr_read_b32 v13, a221
    v_accvgpr_read_b32 v14, a222
    v_accvgpr_read_b32 v15, a223
    v_cvt_pk_bf16_f32 v220, v220, v221
    v_cvt_pk_bf16_f32 v221, v222, v223
    v_cvt_pk_bf16_f32 v222, v12, v13
    v_cvt_pk_bf16_f32 v223, v14, v15
    v_accvgpr_write_b32 a156, v220
    v_accvgpr_write_b32 a157, v221
    v_accvgpr_write_b32 a158, v222
    v_accvgpr_write_b32 a159, v223
    v_accvgpr_read_b32 v0, a224
    v_accvgpr_read_b32 v1, a225
    v_accvgpr_read_b32 v2, a226
    v_accvgpr_read_b32 v3, a227
    v_cvt_pk_bf16_f32 v224, v224, v225
    v_cvt_pk_bf16_f32 v225, v226, v227
    v_cvt_pk_bf16_f32 v226, v0, v1
    v_cvt_pk_bf16_f32 v227, v2, v3
    v_accvgpr_write_b32 a160, v224
    v_accvgpr_write_b32 a161, v225
    v_accvgpr_write_b32 a162, v226
    v_accvgpr_write_b32 a163, v227
    v_accvgpr_read_b32 v4, a228
    v_accvgpr_read_b32 v5, a229
    v_accvgpr_read_b32 v6, a230
    v_accvgpr_read_b32 v7, a231
    v_cvt_pk_bf16_f32 v228, v228, v229
    v_cvt_pk_bf16_f32 v229, v230, v231
    v_cvt_pk_bf16_f32 v230, v4, v5
    v_cvt_pk_bf16_f32 v231, v6, v7
    v_accvgpr_write_b32 a164, v228
    v_accvgpr_write_b32 a165, v229
    v_accvgpr_write_b32 a166, v230
    v_accvgpr_write_b32 a167, v231
    v_accvgpr_read_b32 v8, a232
    v_accvgpr_read_b32 v9, a233
    v_accvgpr_read_b32 v10, a234
    v_accvgpr_read_b32 v11, a235
    v_cvt_pk_bf16_f32 v232, v232, v233
    v_cvt_pk_bf16_f32 v233, v234, v235
    v_cvt_pk_bf16_f32 v234, v8, v9
    v_cvt_pk_bf16_f32 v235, v10, v11
    v_accvgpr_write_b32 a168, v232
    v_accvgpr_write_b32 a169, v233
    v_accvgpr_write_b32 a170, v234
    v_accvgpr_write_b32 a171, v235
    v_accvgpr_read_b32 v12, a236
    v_accvgpr_read_b32 v13, a237
    v_accvgpr_read_b32 v14, a238
    v_accvgpr_read_b32 v15, a239
    v_cvt_pk_bf16_f32 v236, v236, v237
    v_cvt_pk_bf16_f32 v237, v238, v239
    v_cvt_pk_bf16_f32 v238, v12, v13
    v_cvt_pk_bf16_f32 v239, v14, v15
    v_accvgpr_write_b32 a172, v236
    v_accvgpr_write_b32 a173, v237
    v_accvgpr_write_b32 a174, v238
    v_accvgpr_write_b32 a175, v239
    v_accvgpr_read_b32 v0, a240
    v_accvgpr_read_b32 v1, a241
    v_accvgpr_read_b32 v2, a242
    v_accvgpr_read_b32 v3, a243
    v_cvt_pk_bf16_f32 v240, v240, v241
    v_cvt_pk_bf16_f32 v241, v242, v243
    v_cvt_pk_bf16_f32 v242, v0, v1
    v_cvt_pk_bf16_f32 v243, v2, v3
    v_accvgpr_write_b32 a176, v240
    v_accvgpr_write_b32 a177, v241
    v_accvgpr_write_b32 a178, v242
    v_accvgpr_write_b32 a179, v243
    v_accvgpr_read_b32 v4, a244
    v_accvgpr_read_b32 v5, a245
    v_accvgpr_read_b32 v6, a246
    v_accvgpr_read_b32 v7, a247
    v_cvt_pk_bf16_f32 v244, v244, v245
    v_cvt_pk_bf16_f32 v245, v246, v247
    v_cvt_pk_bf16_f32 v246, v4, v5
    v_cvt_pk_bf16_f32 v247, v6, v7
    v_accvgpr_write_b32 a180, v244
    v_accvgpr_write_b32 a181, v245
    v_accvgpr_write_b32 a182, v246
    v_accvgpr_write_b32 a183, v247
    v_accvgpr_read_b32 v8, a248
    v_accvgpr_read_b32 v9, a249
    v_accvgpr_read_b32 v10, a250
    v_accvgpr_read_b32 v11, a251
    v_cvt_pk_bf16_f32 v248, v248, v249
    v_cvt_pk_bf16_f32 v249, v250, v251
    v_cvt_pk_bf16_f32 v250, v8, v9
    v_cvt_pk_bf16_f32 v251, v10, v11
    v_accvgpr_write_b32 a184, v248
    v_accvgpr_write_b32 a185, v249
    v_accvgpr_write_b32 a186, v250
    v_accvgpr_write_b32 a187, v251
    v_accvgpr_read_b32 v12, a252
    v_accvgpr_read_b32 v13, a253
    v_accvgpr_read_b32 v14, a254
    v_accvgpr_read_b32 v15, a255
    v_cvt_pk_bf16_f32 v252, v252, v253
    v_cvt_pk_bf16_f32 v253, v254, v255
    v_cvt_pk_bf16_f32 v254, v12, v13
    v_cvt_pk_bf16_f32 v255, v14, v15
    v_accvgpr_write_b32 a188, v252
    v_accvgpr_write_b32 a189, v253
    v_accvgpr_write_b32 a190, v254
    v_accvgpr_write_b32 a191, v255
L1_job2k:
    v_lshrrev_b32 v162, 4, v155
    v_and_b32 v162, 7, v162
    v_lshlrev_b32 v162, 5, v162
    buffer_load_dword v160, v162, s[80:83], 0 offen sc0 sc1
    s_mov_b32 s96, 1
    s_sub_u32 s55, s45, 4
    s_waitcnt lgkmcnt(0)
    s_waitcnt vmcnt(32)
    s_barrier
    s_add_u32 s54, s54, 16384
    s_and_b32 s54, s54, 0xffff
    v_add_u32 v151, s54, v146
    v_add_u32 v152, s54, v147
    v_add_u32 v153, s54, v148
    v_add_u32 v154, s54, v149
    v_mfma_f32_16x16x32_bf16 v[192:195], a[64:67], a[32:35], 0
    ds_read_b128 a[0:3], v144 offset:0
    s_sub_u32 s57, s57, 1
    s_cbranch_scc1 L1_sw5
L1_swr5:
    v_mfma_f32_16x16x32_bf16 a[192:195], a[68:71], a[32:35], 0
    ds_read_b128 a[16:19], v145 offset:0
    s_mov_b32 m0, s52
    v_mfma_f32_16x16x32_bf16 v[196:199], a[72:75], a[32:35], 0
    ds_read_b128 a[4:7], v144 offset:2048
    s_add_u32 s52, s52, 16384
    v_mfma_f32_16x16x32_bf16 a[196:199], a[76:79], a[32:35], 0
    ds_read_b128 a[20:23], v145 offset:2048
    buffer_load_dwordx4 v132, s[12:15], s48 offen offset:0 sc1 lds
    v_mfma_f32_16x16x32_bf16 v[200:203], a[80:83], a[32:35], 0
    v_mfma_f32_16x16x32_bf16 a[200:203], a[84:87], a[32:35], 0
    ds_read_b128 a[8:11], v144 offset:4096
    buffer_load_dwordx4 v133, s[12:15], s48 offen offset:1024 sc1 lds
    v_mfma_f32_16x16x32_bf16 v[204:207], a[88:91], a[32:35], 0
    ds_read_b128 a[24:27], v145 offset:4096
    v_mfma_f32_16x16x32_bf16 a[204:207], a[92:95], a[32:35], 0
    ds_read_b128 a[12:15], v144 offset:6144
    buffer_load_dwordx4 v134, s[12:15], s48 offen offset:2048 sc1 lds
    v_mfma_f32_16x16x32_bf16 a[220:223], a[92:95], a[36:39], 0
    ds_read_b128 a[28:31], v145 offset:6144
    buffer_load_dwordx4 v135, s[12:15], s48 offen offset:3072 sc1 lds
    v_mfma_f32_16x16x32_bf16 v[220:223], a[88:91], a[36:39], 0
    v_mfma_f32_16x16x32_bf16 a[216:219], a[84:87], a[36:39], 0
    ds_read_b64_tr_b16 a[124:125], v154 offset:8192
    s_add_u32 s48, s48, s49
    v_mfma_f32_16x16x32_bf16 v[216:219], a[80:83], a[36:39], 0
    ds_read_b64_tr_b16 a[126:127], v154 offset:9216
    s_and_b32 s52, s52, 0xffff
    v_mfma_f32_16x16x32_bf16 a[212:215], a[76:79], a[36:39], 0
    ds_read_b64_tr_b16 a[120:121], v153 offset:8192
    s_add_u32 m0, s51, 8192
    v_mfma_f32_16x16x32_bf16 v[212:215], a[72:75], a[36:39], 0
    ds_read_b64_tr_b16 a[122:123], v153 offset:9216
    s_add_u32 s51, s51, 32768
    v_mfma_f32_16x16x32_bf16 a[208:211], a[68:71], a[36:39], 0
    buffer_load_dwordx4 v128, s[8:11], s47 offen offset:0 sc1 lds
    v_mfma_f32_16x16x32_bf16 v[208:211], a[64:67], a[36:39], 0
    ds_read_b64_tr_b16 a[116:117], v152 offset:8192
    v_mfma_f32_16x16x32_bf16 v[224:227], a[64:67], a[40:43], 0
    ds_read_b64_tr_b16 a[118:119], v152 offset:9216
    buffer_load_dwordx4 v129, s[8:11], s47 offen offset:1024 sc1 lds
    v_mfma_f32_16x16x32_bf16 a[224:227], a[68:71], a[40:43], 0
    ds_read_b64_tr_b16 a[112:113], v151 offset:8192
    buffer_load_dwordx4 v130, s[8:11], s47 offen offset:2048 sc1 lds
    v_mfma_f32_16x16x32_bf16 v[228:231], a[72:75], a[40:43], 0
    ds_read_b64_tr_b16 a[114:115], v151 offset:9216
    v_mfma_f32_16x16x32_bf16 a[228:231], a[76:79], a[40:43], 0
    buffer_load_dwordx4 v131, s[8:11], s47 offen offset:3072 sc1 lds
    v_mfma_f32_16x16x32_bf16 v[232:235], a[80:83], a[40:43], 0
    ds_read_b64_tr_b16 a[108:109], v154 offset:0
    v_mfma_f32_16x16x32_bf16 a[232:235], a[84:87], a[40:43], 0
    ds_read_b64_tr_b16 a[110:111], v154 offset:1024
    s_cmp_ge_u32 s51, s79
    v_mfma_f32_16x16x32_bf16 v[236:239], a[88:91], a[40:43], 0
    ds_read_b64_tr_b16 a[104:105], v153 offset:0
    s_cselect_b32 s51, s78, s51
    v_mfma_f32_16x16x32_bf16 a[236:239], a[92:95], a[40:43], 0
    ds_read_b64_tr_b16 a[106:107], v153 offset:1024
    buffer_load_dword v158, v157, s[84:87], s88 offen
    v_mfma_f32_16x16x32_bf16 a[252:255], a[92:95], a[44:47], 0
    s_add_u32 s88, s88, s89
    v_mfma_f32_16x16x32_bf16 v[252:255], a[88:91], a[44:47], 0
    ds_read_b64_tr_b16 a[100:101], v152 offset:0
    s_add_u32 s53, s53, 1
    v_mfma_f32_16x16x32_bf16 a[248:251], a[84:87], a[44:47], 0
    ds_read_b64_tr_b16 a[102:103], v152 offset:1024
    s_cmp_eq_u32 s53, 3
    v_mfma_f32_16x16x32_bf16 v[248:251], a[80:83], a[44:47], 0
    ds_read_b64_tr_b16 a[96:97], v151 offset:0
    s_cselect_b32 s53, 0, s53
    v_mfma_f32_16x16x32_bf16 a[244:247], a[76:79], a[44:47], 0
    ds_read_b64_tr_b16 a[98:99], v151 offset:1024
    s_cselect_b32 s93, -2, 1
    v_mfma_f32_16x16x32_bf16 v[244:247], a[72:75], a[44:47], 0
    s_lshl_b32 s93, s93, 15
    v_mfma_f32_16x16x32_bf16 a[240:243], a[68:71], a[44:47], 0
    v_add_u32 v144, s93, v144
    v_mfma_f32_16x16x32_bf16 v[240:243], a[64:67], a[44:47], 0
    s_waitcnt lgkmcnt(15)
    v_mfma_f32_16x16x32_bf16 v[28:31], a[92:95], a[0:3], 0
    s_waitcnt lgkmcnt(14)
    s_add_u32 s54, s54, 16384
    v_mfma_f32_16x16x32_bf16 v[28:31], a[124:127], a[16:19], v[28:31]
    buffer_store_dwordx4 v[168:171], v156, s[16:19], s98 offen offset:0 sc0 sc1
    v_mfma_f32_16x16x32_bf16 v[24:27], a[88:91], a[0:3], 0
    s_waitcnt lgkmcnt(12)
    s_and_b32 s54, s54, 0xffff
    v_mfma_f32_16x16x32_bf16 v[24:27], a[120:123], a[16:19], v[24:27]
    v_mfma_f32_16x16x32_bf16 v[20:23], a[84:87], a[0:3], 0
    s_waitcnt lgkmcnt(10)
    v_add_u32 v151, s54, v146
    v_mfma_f32_16x16x32_bf16 v[20:23], a[116:119], a[16:19], v[20:23]
    buffer_store_dwordx4 v[172:175], v156, s[16:19], s98 offen offset:1024 sc0 sc1
    v_mfma_f32_16x16x32_bf16 v[16:19], a[80:83], a[0:3], 0
    s_waitcnt lgkmcnt(8)
    v_add_u32 v152, s54, v147
    v_mfma_f32_16x16x32_bf16 v[16:19], a[112:115], a[16:19], v[16:19]
    s_add_u32 s98, s98, 8192
    v_mfma_f32_16x16x32_bf16 v[12:15], a[76:79], a[0:3], 0
    s_waitcnt lgkmcnt(6)
    v_add_u32 v153, s54, v148
    v_mfma_f32_16x16x32_bf16 v[12:15], a[108:111], a[16:19], v[12:15]
    buffer_store_dwordx4 v[176:179], v155, s[16:19], s98 offen offset:0 sc0 sc1
    v_mfma_f32_16x16x32_bf16 v[8:11], a[72:75], a[0:3], 0
    s_waitcnt lgkmcnt(4)
    v_add_u32 v154, s54, v149
    v_mfma_f32_16x16x32_bf16 v[8:11], a[104:107], a[16:19], v[8:11]
    v_mfma_f32_16x16x32_bf16 v[4:7], a[68:71], a[0:3], 0
    s_waitcnt lgkmcnt(2)
    v_mfma_f32_16x16x32_bf16 v[4:7], a[100:103], a[16:19], v[4:7]
    buffer_store_dwordx4 v[180:183], v155, s[16:19], s98 offen offset:1024 sc0 sc1
    v_mfma_f32_16x16x32_bf16 v[0:3], a[64:67], a[0:3], 0
    s_waitcnt lgkmcnt(0)
    v_mfma_f32_16x16x32_bf16 v[0:3], a[96:99], a[16:19], v[0:3]
    s_waitcnt vmcnt(33)
    s_barrier
    v_mfma_f32_16x16x32_bf16 v[32:35], a[96:99], a[20:23], 0
    ds_read_b128 a[32:35], v144 offset:8192
    s_mov_b32 m0, s52
    v_mfma_f32_16x16x32_bf16 v[32:35], a[64:67], a[4:7], v[32:35]
    s_add_u32 s52, s52, 16384
    v_mfma_f32_16x16x32_bf16 v[36:39], a[68:71], a[4:7], 0
    buffer_load_dwordx4 v132, s[12:15], s48 offen offset:0 sc1 lds
    v_mfma_f32_16x16x32_bf16 v[36:39], a[100:103], a[20:23], v[36:39]
    ds_read_b128 a[48:51], v145 offset:8192
    v_mfma_f32_16x16x32_bf16 v[40:43], a[104:107], a[20:23], 0
    v_mfma_f32_16x16x32_bf16 v[40:43], a[72:75], a[4:7], v[40:43]
    buffer_load_dwordx4 v133, s[12:15], s48 offen offset:1024 sc1 lds
    v_mfma_f32_16x16x32_bf16 v[44:47], a[76:79], a[4:7], 0
    ds_read_b128 a[36:39], v144 offset:10240
    v_mfma_f32_16x16x32_bf16 v[44:47], a[108:111], a[20:23], v[44:47]
    buffer_load_dwordx4 v134, s[12:15], s48 offen offset:2048 sc1 lds
    v_mfma_f32_16x16x32_bf16 v[48:51], a[112:115], a[20:23], 0
    v_mfma_f32_16x16x32_bf16 v[48:51], a[80:83], a[4:7], v[48:51]
    ds_read_b128 a[52:55], v145 offset:10240
    v_mfma_f32_16x16x32_bf16 v[52:55], a[84:87], a[4:7], 0
    buffer_load_dwordx4 v135, s[12:15], s48 offen offset:3072 sc1 lds
    v_mfma_f32_16x16x32_bf16 v[52:55], a[116:119], a[20:23], v[52:55]
    v_mfma_f32_16x16x32_bf16 v[56:59], a[120:123], a[20:23], 0
    s_add_u32 s48, s48, s49
    v_mfma_f32_16x16x32_bf16 v[56:59], a[88:91], a[4:7], v[56:59]
    ds_read_b128 a[40:43], v144 offset:12288
    v_mfma_f32_16x16x32_bf16 v[60:63], a[92:95], a[4:7], 0
    s_and_b32 s52, s52, 0xffff
    v_mfma_f32_16x16x32_bf16 v[60:63], a[124:127], a[20:23], v[60:63]
    s_sub_u32 s56, s56, 1
    v_mfma_f32_16x16x32_bf16 v[92:95], a[124:127], a[24:27], 0
    ds_read_b128 a[56:59], v145 offset:12288
    s_cbranch_scc1 L1_sw6
L1_swr6:
    v_mfma_f32_16x16x32_bf16 v[92:95], a[92:95], a[8:11], v[92:95]
    v_mfma_f32_16x16x32_bf16 v[88:91], a[88:91], a[8:11], 0
    s_mov_b32 m0, s51
    v_mfma_f32_16x16x32_bf16 v[88:91], a[120:123], a[24:27], v[88:91]
    ds_read_b128 a[44:47], v144 offset:14336
    s_add_u32 s47, s46, s50
    v_mfma_f32_16x16x32_bf16 v[84:87], a[116:119], a[24:27], 0
    buffer_load_dwordx4 v128, s[8:11], s46 offen offset:0 sc1 lds
    v_mfma_f32_16x16x32_bf16 v[84:87], a[84:87], a[8:11], v[84:87]
    v_mfma_f32_16x16x32_bf16 v[80:83], a[80:83], a[8:11], 0
    ds_read_b128 a[60:63], v145 offset:14336
    v_mfma_f32_16x16x32_bf16 v[80:83], a[112:115], a[24:27], v[80:83]
    buffer_load_dwordx4 v129, s[8:11], s46 offen offset:1024 sc1 lds
    v_mfma_f32_16x16x32_bf16 v[76:79], a[108:111], a[24:27], 0
    v_mfma_f32_16x16x32_bf16 v[76:79], a[76:79], a[8:11], v[76:79]
    buffer_load_dwordx4 v130, s[8:11], s46 offen offset:2048 sc1 lds
    v_mfma_f32_16x16x32_bf16 v[72:75], a[72:75], a[8:11], 0
    v_mfma_f32_16x16x32_bf16 v[72:75], a[104:107], a[24:27], v[72:75]
    v_mfma_f32_16x16x32_bf16 v[68:71], a[100:103], a[24:27], 0
    buffer_load_dwordx4 v131, s[8:11], s46 offen offset:3072 sc1 lds
    v_mfma_f32_16x16x32_bf16 v[68:71], a[68:71], a[8:11], v[68:71]
    v_mfma_f32_16x16x32_bf16 v[64:67], a[64:67], a[8:11], 0
    v_mfma_f32_16x16x32_bf16 v[64:67], a[96:99], a[24:27], v[64:67]
    s_add_u32 s46, s46, s68
    s_waitcnt lgkmcnt(0)
    v_mfma_f32_16x16x32_bf16 v[96:99], a[64:67], a[12:15], 0
    ds_read_b64_tr_b16 a[64:65], v151 offset:0
    v_mfma_f32_16x16x32_bf16 v[96:99], a[96:99], a[28:31], v[96:99]
    ds_read_b64_tr_b16 a[66:67], v151 offset:1024
    v_mfma_f32_16x16x32_bf16 v[100:103], a[68:71], a[12:15], 0
    ds_read_b64_tr_b16 a[68:69], v152 offset:0
    v_mfma_f32_16x16x32_bf16 v[100:103], a[100:103], a[28:31], v[100:103]
    ds_read_b64_tr_b16 a[70:71], v152 offset:1024
    v_mfma_f32_16x16x32_bf16 v[104:107], a[72:75], a[12:15], 0
    ds_read_b64_tr_b16 a[72:73], v153 offset:0
    v_mfma_f32_16x16x32_bf16 v[104:107], a[104:107], a[28:31], v[104:107]
    ds_read_b64_tr_b16 a[74:75], v153 offset:1024
    v_mfma_f32_16x16x32_bf16 v[108:111], a[76:79], a[12:15], 0
    ds_read_b64_tr_b16 a[76:77], v154 offset:0
    v_mfma_f32_16x16x32_bf16 v[108:111], a[108:111], a[28:31], v[108:111]
    ds_read_b64_tr_b16 a[78:79], v154 offset:1024
    v_add_u32 v145, s93, v145
    v_mfma_f32_16x16x32_bf16 v[112:115], a[80:83], a[12:15], 0
    ds_read_b64_tr_b16 a[80:81], v151 offset:8192
    v_mfma_f32_16x16x32_bf16 v[112:115], a[112:115], a[28:31], v[112:115]
    ds_read_b64_tr_b16 a[82:83], v151 offset:9216
    v_mfma_f32_16x16x32_bf16 v[116:119], a[84:87], a[12:15], 0
    ds_read_b64_tr_b16 a[84:85], v152 offset:8192
    v_mfma_f32_16x16x32_bf16 v[116:119], a[116:119], a[28:31], v[116:119]
    ds_read_b64_tr_b16 a[86:87], v152 offset:9216
    v_mfma_f32_16x16x32_bf16 v[120:123], a[88:91], a[12:15], 0
    ds_read_b64_tr_b16 a[88:89], v153 offset:8192
    v_mfma_f32_16x16x32_bf16 v[120:123], a[120:123], a[28:31], v[120:123]
    ds_read_b64_tr_b16 a[90:91], v153 offset:9216
    v_mfma_f32_16x16x32_bf16 v[124:127], a[92:95], a[12:15], 0
    ds_read_b64_tr_b16 a[92:93], v154 offset:8192
    v_mfma_f32_16x16x32_bf16 v[124:127], a[124:127], a[28:31], v[124:127]
    ds_read_b64_tr_b16 a[94:95], v154 offset:9216
    v_mfma_f32_16x16x32_bf16 v[192:195], a[96:99], a[48:51], v[192:195]
    s_waitcnt lgkmcnt(14)
    s_add_u32 s54, s54, 16384
    v_mfma_f32_16x16x32_bf16 v[192:195], a[64:67], a[32:35], v[192:195]
    buffer_store_dwordx4 v[184:187], v156, s[16:19], s98 offen offset:0 sc0 sc1
    v_mfma_f32_16x16x32_bf16 a[192:195], a[100:103], a[48:51], a[192:195]
    s_waitcnt lgkmcnt(12)
    s_and_b32 s54, s54, 0xffff
    v_mfma_f32_16x16x32_bf16 a[192:195], a[68:71], a[32:35], a[192:195]
    v_mfma_f32_16x16x32_bf16 v[196:199], a[104:107], a[48:51], v[196:199]
    s_waitcnt lgkmcnt(10)
    v_add_u32 v151, s54, v146
    v_mfma_f32_16x16x32_bf16 v[196:199], a[72:75], a[32:35], v[196:199]
    buffer_store_dwordx4 v[188:191], v156, s[16:19], s98 offen offset:1024 sc0 sc1
    v_mfma_f32_16x16x32_bf16 a[196:199], a[108:111], a[48:51], a[196:199]
    s_waitcnt lgkmcnt(8)
    v_add_u32 v152, s54, v147
    v_mfma_f32_16x16x32_bf16 a[196:199], a[76:79], a[32:35], a[196:199]
    s_add_u32 s98, s98, 8192
    v_mfma_f32_16x16x32_bf16 v[200:203], a[112:115], a[48:51], v[200:203]
    s_waitcnt lgkmcnt(6)
    v_add_u32 v153, s54, v148
    v_mfma_f32_16x16x32_bf16 v[200:203], a[80:83], a[32:35], v[200:203]
    buffer_store_dwordx4 a[128:131], v155, s[16:19], s98 offen offset:0 sc0 sc1
    v_mfma_f32_16x16x32_bf16 a[200:203], a[116:119], a[48:51], a[200:203]
    s_waitcnt lgkmcnt(4)
    v_add_u32 v154, s54, v149
    v_mfma_f32_16x16x32_bf16 a[200:203], a[84:87], a[32:35], a[200:203]
    v_mfma_f32_16x16x32_bf16 v[204:207], a[120:123], a[48:51], v[204:207]
    s_waitcnt lgkmcnt(2)
    v_mfma_f32_16x16x32_bf16 v[204:207], a[88:91], a[32:35], v[204:207]
    buffer_store_dwordx4 a[132:135], v155, s[16:19], s98 offen offset:1024 sc0 sc1
    v_mfma_f32_16x16x32_bf16 a[204:207], a[124:127], a[48:51], a[204:207]
    s_waitcnt lgkmcnt(0)
    v_mfma_f32_16x16x32_bf16 a[204:207], a[92:95], a[32:35], a[204:207]
    s_waitcnt vmcnt(40)
    s_barrier
    v_mfma_f32_16x16x32_bf16 a[220:223], a[92:95], a[36:39], a[220:223]
    ds_read_b128 a[0:3], v144 offset:0
    s_sub_u32 s57, s57, 1
    v_mfma_f32_16x16x32_bf16 a[220:223], a[124:127], a[52:55], a[220:223]
    s_cbranch_scc1 L1_sw7
L1_swr7:
    v_mfma_f32_16x16x32_bf16 v[220:223], a[120:123], a[52:55], v[220:223]
    s_mov_b32 m0, s52
    v_mfma_f32_16x16x32_bf16 v[220:223], a[88:91], a[36:39], v[220:223]
    ds_read_b128 a[16:19], v145 offset:0
    s_add_u32 s52, s52, 16384
    v_mfma_f32_16x16x32_bf16 a[216:219], a[84:87], a[36:39], a[216:219]
    buffer_load_dwordx4 v132, s[12:15], s48 offen offset:0 sc1 lds
    v_mfma_f32_16x16x32_bf16 a[216:219], a[116:119], a[52:55], a[216:219]
    v_mfma_f32_16x16x32_bf16 v[216:219], a[112:115], a[52:55], v[216:219]
    ds_read_b128 a[4:7], v144 offset:2048
    v_mfma_f32_16x16x32_bf16 v[216:219], a[80:83], a[36:39], v[216:219]
    buffer_load_dwordx4 v133, s[12:15], s48 offen offset:1024 sc1 lds
    v_mfma_f32_16x16x32_bf16 a[212:215], a[76:79], a[36:39], a[212:215]
    buffer_load_dwordx4 v134, s[12:15], s48 offen offset:2048 sc1 lds
    v_mfma_f32_16x16x32_bf16 a[212:215], a[108:111], a[52:55], a[212:215]
    ds_read_b128 a[20:23], v145 offset:2048
    v_mfma_f32_16x16x32_bf16 v[212:215], a[104:107], a[52:55], v[212:215]
    v_mfma_f32_16x16x32_bf16 v[212:215], a[72:75], a[36:39], v[212:215]
    buffer_load_dwordx4 v135, s[12:15], s48 offen offset:3072 sc1 lds
    v_mfma_f32_16x16x32_bf16 a[208:211], a[68:71], a[36:39], a[208:211]
    v_mfma_f32_16x16x32_bf16 a[208:211], a[100:103], a[52:55], a[208:211]
    ds_read_b128 a[8:11], v144 offset:4096
    s_add_u32 s48, s48, s49
    v_mfma_f32_16x16x32_bf16 v[208:211], a[96:99], a[52:55], v[208:211]
    s_and_b32 s52, s52, 0xffff
    v_mfma_f32_16x16x32_bf16 v[208:211], a[64:67], a[36:39], v[208:211]
    s_add_u32 m0, s51, 8192
    v_mfma_f32_16x16x32_bf16 v[224:227], a[64:67], a[40:43], v[224:227]
    ds_read_b128 a[24:27], v145 offset:4096
    s_add_u32 s51, s51, 32768
    v_mfma_f32_16x16x32_bf16 v[224:227], a[96:99], a[56:59], v[224:227]
    buffer_load_dwordx4 v128, s[8:11], s47 offen offset:0 sc1 lds
    v_mfma_f32_16x16x32_bf16 a[224:227], a[100:103], a[56:59], a[224:227]
    v_mfma_f32_16x16x32_bf16 a[224:227], a[68:71], a[40:43], a[224:227]
    ds_read_b128 a[12:15], v144 offset:6144
    v_mfma_f32_16x16x32_bf16 v[228:231], a[72:75], a[40:43], v[228:231]
    buffer_load_dwordx4 v129, s[8:11], s47 offen offset:1024 sc1 lds
    v_mfma_f32_16x16x32_bf16 v[228:231], a[104:107], a[56:59], v[228:231]
    v_mfma_f32_16x16x32_bf16 a[228:231], a[108:111], a[56:59], a[228:231]
    ds_read_b128 a[28:31], v145 offset:6144
    v_mfma_f32_16x16x32_bf16 a[228:231], a[76:79], a[40:43], a[228:231]
    buffer_load_dwordx4 v130, s[8:11], s47 offen offset:2048 sc1 lds
    v_mfma_f32_16x16x32_bf16 v[232:235], a[80:83], a[40:43], v[232:235]
    buffer_load_dwordx4 v131, s[8:11], s47 offen offset:3072 sc1 lds
    v_mfma_f32_16x16x32_bf16 v[232:235], a[112:115], a[56:59], v[232:235]
    v_mfma_f32_16x16x32_bf16 a[232:235], a[116:119], a[56:59], a[232:235]
    s_cmp_ge_u32 s51, s79
    v_mfma_f32_16x16x32_bf16 a[232:235], a[84:87], a[40:43], a[232:235]
    s_cselect_b32 s51, s78, s51
    v_mfma_f32_16x16x32_bf16 v[236:239], a[88:91], a[40:43], v[236:239]
    buffer_load_dword v158, v157, s[84:87], s88 offen
    v_mfma_f32_16x16x32_bf16 v[236:239], a[120:123], a[56:59], v[236:239]
    v_mfma_f32_16x16x32_bf16 a[236:239], a[124:127], a[56:59], a[236:239]
    v_mfma_f32_16x16x32_bf16 a[236:239], a[92:95], a[40:43], a[236:239]
    s_add_u32 s88, s88, s89
    s_waitcnt lgkmcnt(0)
    v_mfma_f32_16x16x32_bf16 a[252:255], a[124:127], a[60:63], a[252:255]
    ds_read_b64_tr_b16 a[124:125], v154 offset:8192
    v_mfma_f32_16x16x32_bf16 a[252:255], a[92:95], a[44:47], a[252:255]
    ds_read_b64_tr_b16 a[126:127], v154 offset:9216
    s_add_u32 s53, s53, 1
    v_mfma_f32_16x16x32_bf16 v[252:255], a[120:123], a[60:63], v[252:255]
    ds_read_b64_tr_b16 a[120:121], v153 offset:8192
    v_mfma_f32_16x16x32_bf16 v[252:255], a[88:91], a[44:47], v[252:255]
    ds_read_b64_tr_b16 a[122:123], v153 offset:9216
    s_cmp_eq_u32 s53, 3
    v_mfma_f32_16x16x32_bf16 a[248:251], a[116:119], a[60:63], a[248:251]
    ds_read_b64_tr_b16 a[116:117], v152 offset:8192
    v_mfma_f32_16x16x32_bf16 a[248:251], a[84:87], a[44:47], a[248:251]
    ds_read_b64_tr_b16 a[118:119], v152 offset:9216
    s_cselect_b32 s53, 0, s53
    v_mfma_f32_16x16x32_bf16 v[248:251], a[112:115], a[60:63], v[248:251]
    ds_read_b64_tr_b16 a[112:113], v151 offset:8192
    v_mfma_f32_16x16x32_bf16 v[248:251], a[80:83], a[44:47], v[248:251]
    ds_read_b64_tr_b16 a[114:115], v151 offset:9216
    v_mfma_f32_16x16x32_bf16 a[244:247], a[108:111], a[60:63], a[244:247]
    ds_read_b64_tr_b16 a[108:109], v154 offset:0
    s_cselect_b32 s93, -2, 1
    v_mfma_f32_16x16x32_bf16 a[244:247], a[76:79], a[44:47], a[244:247]
    ds_read_b64_tr_b16 a[110:111], v154 offset:1024
    v_mfma_f32_16x16x32_bf16 v[244:247], a[104:107], a[60:63], v[244:247]
    ds_read_b64_tr_b16 a[104:105], v153 offset:0
    s_lshl_b32 s93, s93, 15
    v_mfma_f32_16x16x32_bf16 v[244:247], a[72:75], a[44:47], v[244:247]
    ds_read_b64_tr_b16 a[106:107], v153 offset:1024
    v_mfma_f32_16x16x32_bf16 a[240:243], a[100:103], a[60:63], a[240:243]
    ds_read_b64_tr_b16 a[100:101], v152 offset:0
    v_add_u32 v144, s93, v144
    v_mfma_f32_16x16x32_bf16 a[240:243], a[68:71], a[44:47], a[240:243]
    ds_read_b64_tr_b16 a[102:103], v152 offset:1024
    v_mfma_f32_16x16x32_bf16 v[240:243], a[96:99], a[60:63], v[240:243]
    ds_read_b64_tr_b16 a[96:97], v151 offset:0
    v_mfma_f32_16x16x32_bf16 v[240:243], a[64:67], a[44:47], v[240:243]
    ds_read_b64_tr_b16 a[98:99], v151 offset:1024
    v_mfma_f32_16x16x32_bf16 v[28:31], a[92:95], a[0:3], v[28:31]
    s_waitcnt lgkmcnt(14)
    s_add_u32 s54, s54, 16384
    v_mfma_f32_16x16x32_bf16 v[28:31], a[124:127], a[16:19], v[28:31]
    buffer_store_dwordx4 a[136:139], v156, s[16:19], s98 offen offset:0 sc0 sc1
    v_mfma_f32_16x16x32_bf16 v[24:27], a[88:91], a[0:3], v[24:27]
    s_waitcnt lgkmcnt(12)
    s_and_b32 s54, s54, 0xffff
    v_mfma_f32_16x16x32_bf16 v[24:27], a[120:123], a[16:19], v[24:27]
    v_mfma_f32_16x16x32_bf16 v[20:23], a[84:87], a[0:3], v[20:23]
    s_waitcnt lgkmcnt(10)
    v_add_u32 v151, s54, v146
    v_mfma_f32_16x16x32_bf16 v[20:23], a[116:119], a[16:19], v[20:23]
    buffer_store_dwordx4 a[140:143], v156, s[16:19], s98 offen offset:1024 sc0 sc1
    v_mfma_f32_16x16x32_bf16 v[16:19], a[80:83], a[0:3], v[16:19]
    s_waitcnt lgkmcnt(8)
    v_add_u32 v152, s54, v147
    v_mfma_f32_16x16x32_bf16 v[16:19], a[112:115], a[16:19], v[16:19]
    s_add_u32 s98, s98, 8192
    v_mfma_f32_16x16x32_bf16 v[12:15], a[76:79], a[0:3], v[12:15]
    s_waitcnt lgkmcnt(6)
    v_add_u32 v153, s54, v148
    v_mfma_f32_16x16x32_bf16 v[12:15], a[108:111], a[16:19], v[12:15]
    buffer_store_dwordx4 a[144:147], v155, s[16:19], s98 offen offset:0 sc0 sc1
    v_mfma_f32_16x16x32_bf16 v[8:11], a[72:75], a[0:3], v[8:11]
    s_waitcnt lgkmcnt(4)
    v_add_u32 v154, s54, v149
    v_mfma_f32_16x16x32_bf16 v[8:11], a[104:107], a[16:19], v[8:11]
    v_mfma_f32_16x16x32_bf16 v[4:7], a[68:71], a[0:3], v[4:7]
    s_waitcnt lgkmcnt(2)
    v_mfma_f32_16x16x32_bf16 v[4:7], a[100:103], a[16:19], v[4:7]
    buffer_store_dwordx4 a[148:151], v155, s[16:19], s98 offen offset:1024 sc0 sc1
    v_mfma_f32_16x16x32_bf16 v[0:3], a[64:67], a[0:3], v[0:3]
    s_waitcnt lgkmcnt(0)
    v_mfma_f32_16x16x32_bf16 v[0:3], a[96:99], a[16:19], v[0:3]
    s_waitcnt vmcnt(30)
    s_barrier
    v_mfma_f32_16x16x32_bf16 v[32:35], a[96:99], a[20:23], v[32:35]
    ds_read_b128 a[32:35], v144 offset:8192
    s_mov_b32 m0, s52
    v_mfma_f32_16x16x32_bf16 v[32:35], a[64:67], a[4:7], v[32:35]
    s_add_u32 s52, s52, 16384
    v_mfma_f32_16x16x32_bf16 v[36:39], a[68:71], a[4:7], v[36:39]
    buffer_load_dwordx4 v132, s[12:15], s48 offen offset:0 sc1 lds
    v_mfma_f32_16x16x32_bf16 v[36:39], a[100:103], a[20:23], v[36:39]
    ds_read_b128 a[48:51], v145 offset:8192
    v_mfma_f32_16x16x32_bf16 v[40:43], a[104:107], a[20:23], v[40:43]
    v_mfma_f32_16x16x32_bf16 v[40:43], a[72:75], a[4:7], v[40:43]
    buffer_load_dwordx4 v133, s[12:15], s48 offen offset:1024 sc1 lds
    v_mfma_f32_16x16x32_bf16 v[44:47], a[76:79], a[4:7], v[44:47]
    ds_read_b128 a[36:39], v144 offset:10240
    v_mfma_f32_16x16x32_bf16 v[44:47], a[108:111], a[20:23], v[44:47]
    buffer_load_dwordx4 v134, s[12:15], s48 offen offset:2048 sc1 lds
    v_mfma_f32_16x16x32_bf16 v[48:51], a[112:115], a[20:23], v[48:51]
    v_mfma_f32_16x16x32_bf16 v[48:51], a[80:83], a[4:7], v[48:51]
    ds_read_b128 a[52:55], v145 offset:10240
    v_mfma_f32_16x16x32_bf16 v[52:55], a[84:87], a[4:7], v[52:55]
    buffer_load_dwordx4 v135, s[12:15], s48 offen offset:3072 sc1 lds
    v_mfma_f32_16x16x32_bf16 v[52:55], a[116:119], a[20:23], v[52:55]
    v_mfma_f32_16x16x32_bf16 v[56:59], a[120:123], a[20:23], v[56:59]
    s_add_u32 s48, s48, s49
    v_mfma_f32_16x16x32_bf16 v[56:59], a[88:91], a[4:7], v[56:59]
    ds_read_b128 a[40:43], v144 offset:12288
    v_mfma_f32_16x16x32_bf16 v[60:63], a[92:95], a[4:7], v[60:63]
    s_and_b32 s52, s52, 0xffff
    v_mfma_f32_16x16x32_bf16 v[60:63], a[124:127], a[20:23], v[60:63]
    s_sub_u32 s56, s56, 1
    v_mfma_f32_16x16x32_bf16 v[92:95], a[124:127], a[24:27], v[92:95]
    ds_read_b128 a[56:59], v145 offset:12288
    s_cbranch_scc1 L1_sw8
L1_swr8:
    v_mfma_f32_16x16x32_bf16 v[92:95], a[92:95], a[8:11], v[92:95]
    v_mfma_f32_16x16x32_bf16 v[88:91], a[88:91], a[8:11], v[88:91]
    s_mov_b32 m0, s51
    v_mfma_f32_16x16x32_bf16 v[88:91], a[120:123], a[24:27], v[88:91]
    ds_read_b128 a[44:47], v144 offset:14336
    s_add_u32 s47, s46, s50
    v_mfma_f32_16x16x32_bf16 v[84:87], a[116:119], a[24:27], v[84:87]
    buffer_load_dwordx4 v128, s[8:11], s46 offen offset:0 sc1 lds
    v_mfma_f32_16x16x32_bf16 v[84:87], a[84:87], a[8:11], v[84:87]
    v_mfma_f32_16x16x32_bf16 v[80:83], a[80:83], a[8:11], v[80:83]
    ds_read_b128 a[60:63], v145 offset:14336
    v_mfma_f32_16x16x32_bf16 v[80:83], a[112:115], a[24:27], v[80:83]
    buffer_load_dwordx4 v129, s[8:11], s46 offen offset:1024 sc1 lds
    v_mfma_f32_16x16x32_bf16 v[76:79], a[108:111], a[24:27], v[76:79]
    v_mfma_f32_16x16x32_bf16 v[76:79], a[76:79], a[8:11], v[76:79]
    buffer_load_dwordx4 v130, s[8:11], s46 offen offset:2048 sc1 lds
    v_mfma_f32_16x16x32_bf16 v[72:75], a[72:75], a[8:11], v[72:75]
    v_mfma_f32_16x16x32_bf16 v[72:75], a[104:107], a[24:27], v[72:75]
    v_mfma_f32_16x16x32_bf16 v[68:71], a[100:103], a[24:27], v[68:71]
    buffer_load_dwordx4 v131, s[8:11], s46 offen offset:3072 sc1 lds
    v_mfma_f32_16x16x32_bf16 v[68:71], a[68:71], a[8:11], v[68:71]
    v_mfma_f32_16x16x32_bf16 v[64:67], a[64:67], a[8:11], v[64:67]
    v_mfma_f32_16x16x32_bf16 v[64:67], a[96:99], a[24:27], v[64:67]
    s_add_u32 s46, s46, s68
    s_waitcnt lgkmcnt(0)
    v_mfma_f32_16x16x32_bf16 v[96:99], a[64:67], a[12:15], v[96:99]
    ds_read_b64_tr_b16 a[64:65], v151 offset:0
    v_mfma_f32_16x16x32_bf16 v[96:99], a[96:99], a[28:31], v[96:99]
    ds_read_b64_tr_b16 a[66:67], v151 offset:1024
    v_mfma_f32_16x16x32_bf16 v[100:103], a[68:71], a[12:15], v[100:103]
    ds_read_b64_tr_b16 a[68:69], v152 offset:0
    v_mfma_f32_16x16x32_bf16 v[100:103], a[100:103], a[28:31], v[100:103]
    ds_read_b64_tr_b16 a[70:71], v152 offset:1024
    v_mfma_f32_16x16x32_bf16 v[104:107], a[72:75], a[12:15], v[104:107]
    ds_read_b64_tr_b16 a[72:73], v153 offset:0
    v_mfma_f32_16x16x32_bf16 v[104:107], a[104:107], a[28:31], v[104:107]
    ds_read_b64_tr_b16 a[74:75], v153 offset:1024
    v_mfma_f32_16x16x32_bf16 v[108:111], a[76:79], a[12:15], v[108:111]
    ds_read_b64_tr_b16 a[76:77], v154 offset:0
    v_mfma_f32_16x16x32_bf16 v[108:111], a[108:111], a[28:31], v[108:111]
    ds_read_b64_tr_b16 a[78:79], v154 offset:1024
    v_add_u32 v145, s93, v145
    v_mfma_f32_16x16x32_bf16 v[112:115], a[80:83], a[12:15], v[112:115]
    ds_read_b64_tr_b16 a[80:81], v151 offset:8192
    v_mfma_f32_16x16x32_bf16 v[112:115], a[112:115], a[28:31], v[112:115]
    ds_read_b64_tr_b16 a[82:83], v151 offset:9216
    v_mfma_f32_16x16x32_bf16 v[116:119], a[84:87], a[12:15], v[116:119]
    ds_read_b64_tr_b16 a[84:85], v152 offset:8192
    v_mfma_f32_16x16x32_bf16 v[116:119], a[116:119], a[28:31], v[116:119]
    ds_read_b64_tr_b16 a[86:87], v152 offset:9216
    v_mfma_f32_16x16x32_bf16 v[120:123], a[88:91], a[12:15], v[120:123]
    ds_read_b64_tr_b16 a[88:89], v153 offset:8192
    v_mfma_f32_16x16x32_bf16 v[120:123], a[120:123], a[28:31], v[120:123]
    ds_read_b64_tr_b16 a[90:91], v153 offset:9216
    v_mfma_f32_16x16x32_bf16 v[124:127], a[92:95], a[12:15], v[124:127]
    ds_read_b64_tr_b16 a[92:93], v154 offset:8192
    v_mfma_f32_16x16x32_bf16 v[124:127], a[124:127], a[28:31], v[124:127]
    ds_read_b64_tr_b16 a[94:95], v154 offset:9216
    v_mfma_f32_16x16x32_bf16 v[192:195], a[96:99], a[48:51], v[192:195]
    s_waitcnt lgkmcnt(14)
    s_add_u32 s54, s54, 16384
    v_mfma_f32_16x16x32_bf16 v[192:195], a[64:67], a[32:35], v[192:195]
    buffer_store_dwordx4 a[152:155], v156, s[16:19], s98 offen offset:0 sc0 sc1
    v_mfma_f32_16x16x32_bf16 a[192:195], a[100:103], a[48:51], a[192:195]
    s_waitcnt lgkmcnt(12)
    s_and_b32 s54, s54, 0xffff
    v_mfma_f32_16x16x32_bf16 a[192:195], a[68:71], a[32:35], a[192:195]
    v_mfma_f32_16x16x32_bf16 v[196:199], a[104:107], a[48:51], v[196:199]
    s_waitcnt lgkmcnt(10)
    v_add_u32 v151, s54, v146
    v_mfma_f32_16x16x32_bf16 v[196:199], a[72:75], a[32:35], v[196:199]
    buffer_store_dwordx4 a[156:159], v156, s[16:19], s98 offen offset:1024 sc0 sc1
    v_mfma_f32_16x16x32_bf16 a[196:199], a[108:111], a[48:51], a[196:199]
    s_waitcnt lgkmcnt(8)
    v_add_u32 v152, s54, v147
    v_mfma_f32_16x16x32_bf16 a[196:199], a[76:79], a[32:35], a[196:199]
    s_add_u32 s98, s98, 8192
    v_mfma_f32_16x16x32_bf16 v[200:203], a[112:115], a[48:51], v[200:203]
    s_waitcnt lgkmcnt(6)
    v_add_u32 v153, s54, v148
    v_mfma_f32_16x16x32_bf16 v[200:203], a[80:83], a[32:35], v[200:203]
    buffer_store_dwordx4 a[160:163], v155, s[16:19], s98 offen offset:0 sc0 sc1
    v_mfma_f32_16x16x32_bf16 a[200:203], a[116:119], a[48:51], a[200:203]
    s_waitcnt lgkmcnt(4)
    v_add_u32 v154, s54, v149
    v_mfma_f32_16x16x32_bf16 a[200:203], a[84:87], a[32:35], a[200:203]
    v_mfma_f32_16x16x32_bf16 v[204:207], a[120:123], a[48:51], v[204:207]
    s_waitcnt lgkmcnt(2)
    v_mfma_f32_16x16x32_bf16 v[204:207], a[88:91], a[32:35], v[204:207]
    buffer_store_dwordx4 a[164:167], v155, s[16:19], s98 offen offset:1024 sc0 sc1
    v_mfma_f32_16x16x32_bf16 a[204:207], a[124:127], a[48:51], a[204:207]
    s_waitcnt lgkmcnt(0)
    v_mfma_f32_16x16x32_bf16 a[204:207], a[92:95], a[32:35], a[204:207]
    s_waitcnt vmcnt(33)
    s_barrier
    v_mfma_f32_16x16x32_bf16 a[220:223], a[92:95], a[36:39], a[220:223]
    ds_read_b128 a[0:3], v144 offset:0
    s_sub_u32 s57, s57, 1
    v_mfma_f32_16x16x32_bf16 a[220:223], a[124:127], a[52:55], a[220:223]
    s_cbranch_scc1 L1_sw9
L1_swr9:
    v_mfma_f32_16x16x32_bf16 v[220:223], a[120:123], a[52:55], v[220:223]
    s_mov_b32 m0, s52
    v_mfma_f32_16x16x32_bf16 v[220:223], a[88:91], a[36:39], v[220:223]
    ds_read_b128 a[16:19], v145 offset:0
    s_add_u32 s52, s52, 16384
    v_mfma_f32_16x16x32_bf16 a[216:219], a[84:87], a[36:39], a[216:219]
    buffer_load_dwordx4 v132, s[12:15], s48 offen offset:0 sc1 lds
    v_mfma_f32_16x16x32_bf16 a[216:219], a[116:119], a[52:55], a[216:219]
    v_mfma_f32_16x16x32_bf16 v[216:219], a[112:115], a[52:55], v[216:219]
    ds_read_b128 a[4:7], v144 offset:2048
    v_mfma_f32_16x16x32_bf16 v[216:219], a[80:83], a[36:39], v[216:219]
    buffer_load_dwordx4 v133, s[12:15], s48 offen offset:1024 sc1 lds
    v_mfma_f32_16x16x32_bf16 a[212:215], a[76:79], a[36:39], a[212:215]
    buffer_load_dwordx4 v134, s[12:15], s48 offen offset:2048 sc1 lds
    v_mfma_f32_16x16x32_bf16 a[212:215], a[108:111], a[52:55], a[212:215]
    ds_read_b128 a[20:23], v145 offset:2048
    v_mfma_f32_16x16x32_bf16 v[212:215], a[104:107], a[52:55], v[212:215]
    v_mfma_f32_16x16x32_bf16 v[212:215], a[72:75], a[36:39], v[212:215]
    buffer_load_dwordx4 v135, s[12:15], s48 offen offset:3072 sc1 lds
    v_mfma_f32_16x16x32_bf16 a[208:211], a[68:71], a[36:39], a[208:211]
    v_mfma_f32_16x16x32_bf16 a[208:211], a[100:103], a[52:55], a[208:211]
    ds_read_b128 a[8:11], v144 offset:4096
    s_add_u32 s48, s48, s49
    v_mfma_f32_16x16x32_bf16 v[208:211], a[96:99], a[52:55], v[208:211]
    s_and_b32 s52, s52, 0xffff
    v_mfma_f32_16x16x32_bf16 v[208:211], a[64:67], a[36:39], v[208:211]
    s_add_u32 m0, s51, 8192
    v_mfma_f32_16x16x32_bf16 v[224:227], a[64:67], a[40:43], v[224:227]
    ds_read_b128 a[24:27], v145 offset:4096
    s_add_u32 s51, s51, 32768
    v_mfma_f32_16x16x32_bf16 v[224:227], a[96:99], a[56:59], v[224:227]
    buffer_load_dwordx4 v128, s[8:11], s47 offen offset:0 sc1 lds
    v_mfma_f32_16x16x32_bf16 a[224:227], a[100:103], a[56:59], a[224:227]
    v_mfma_f32_16x16x32_bf16 a[224:227], a[68:71], a[40:43], a[224:227]
    ds_read_b128 a[12:15], v144 offset:6144
    v_mfma_f32_16x16x32_bf16 v[228:231], a[72:75], a[40:43], v[228:231]
    buffer_load_dwordx4 v129, s[8:11], s47 offen offset:1024 sc1 lds
    v_mfma_f32_16x16x32_bf16 v[228:231], a[104:107], a[56:59], v[228:231]
    v_mfma_f32_16x16x32_bf16 a[228:231], a[108:111], a[56:59], a[228:231]
    ds_read_b128 a[28:31], v145 offset:6144
    v_mfma_f32_16x16x32_bf16 a[228:231], a[76:79], a[40:43], a[228:231]
    buffer_load_dwordx4 v130, s[8:11], s47 offen offset:2048 sc1 lds
    v_mfma_f32_16x16x32_bf16 v[232:235], a[80:83], a[40:43], v[232:235]
    buffer_load_dwordx4 v131, s[8:11], s47 offen offset:3072 sc1 lds
    v_mfma_f32_16x16x32_bf16 v[232:235], a[112:115], a[56:59], v[232:235]
    v_mfma_f32_16x16x32_bf16 a[232:235], a[116:119], a[56:59], a[232:235]
    s_cmp_ge_u32 s51, s79
    v_mfma_f32_16x16x32_bf16 a[232:235], a[84:87], a[40:43], a[232:235]
    s_cselect_b32 s51, s78, s51
    v_mfma_f32_16x16x32_bf16 v[236:239], a[88:91], a[40:43], v[236:239]
    buffer_load_dword v158, v157, s[84:87], s88 offen
    v_mfma_f32_16x16x32_bf16 v[236:239], a[120:123], a[56:59], v[236:239]
    v_mfma_f32_16x16x32_bf16 a[236:239], a[124:127], a[56:59], a[236:239]
    v_mfma_f32_16x16x32_bf16 a[236:239], a[92:95], a[40:43], a[236:239]
    s_add_u32 s88, s88, s89
    s_waitcnt lgkmcnt(0)
    v_mfma_f32_16x16x32_bf16 a[252:255], a[124:127], a[60:63], a[252:255]
    ds_read_b64_tr_b16 a[124:125], v154 offset:8192
    v_mfma_f32_16x16x32_bf16 a[252:255], a[92:95], a[44:47], a[252:255]
    ds_read_b64_tr_b16 a[126:127], v154 offset:9216
    s_add_u32 s53, s53, 1
    v_mfma_f32_16x16x32_bf16 v[252:255], a[120:123], a[60:63], v[252:255]
    ds_read_b64_tr_b16 a[120:121], v153 offset:8192
    v_mfma_f32_16x16x32_bf16 v[252:255], a[88:91], a[44:47], v[252:255]
    ds_read_b64_tr_b16 a[122:123], v153 offset:9216
    s_cmp_eq_u32 s53, 3
    v_mfma_f32_16x16x32_bf16 a[248:251], a[116:119], a[60:63], a[248:251]
    ds_read_b64_tr_b16 a[116:117], v152 offset:8192
    v_mfma_f32_16x16x32_bf16 a[248:251], a[84:87], a[44:47], a[248:251]
    ds_read_b64_tr_b16 a[118:119], v152 offset:9216
    s_cselect_b32 s53, 0, s53
    v_mfma_f32_16x16x32_bf16 v[248:251], a[112:115], a[60:63], v[248:251]
    ds_read_b64_tr_b16 a[112:113], v151 offset:8192
    v_mfma_f32_16x16x32_bf16 v[248:251], a[80:83], a[44:47], v[248:251]
    ds_read_b64_tr_b16 a[114:115], v151 offset:9216
    v_mfma_f32_16x16x32_bf16 a[244:247], a[108:111], a[60:63], a[244:247]
    ds_read_b64_tr_b16 a[108:109], v154 offset:0
    s_cselect_b32 s93, -2, 1
    v_mfma_f32_16x16x32_bf16 a[244:247], a[76:79], a[44:47], a[244:247]
    ds_read_b64_tr_b16 a[110:111], v154 offset:1024
    v_mfma_f32_16x16x32_bf16 v[244:247], a[104:107], a[60:63], v[244:247]
    ds_read_b64_tr_b16 a[104:105], v153 offset:0
    s_lshl_b32 s93, s93, 15
    v_mfma_f32_16x16x32_bf16 v[244:247], a[72:75], a[44:47], v[244:247]
    ds_read_b64_tr_b16 a[106:107], v153 offset:1024
    v_mfma_f32_16x16x32_bf16 a[240:243], a[100:103], a[60:63], a[240:243]
    ds_read_b64_tr_b16 a[100:101], v152 offset:0
    v_add_u32 v144, s93, v144
    v_mfma_f32_16x16x32_bf16 a[240:243], a[68:71], a[44:47], a[240:243]
    ds_read_b64_tr_b16 a[102:103], v152 offset:1024
    v_mfma_f32_16x16x32_bf16 v[240:243], a[96:99], a[60:63], v[240:243]
    ds_read_b64_tr_b16 a[96:97], v151 offset:0
    v_mfma_f32_16x16x32_bf16 v[240:243], a[64:67], a[44:47], v[240:243]
    ds_read_b64_tr_b16 a[98:99], v151 offset:1024
    v_mfma_f32_16x16x32_bf16 v[28:31], a[92:95], a[0:3], v[28:31]
    s_waitcnt lgkmcnt(14)
    s_add_u32 s54, s54, 16384
    v_mfma_f32_16x16x32_bf16 v[28:31], a[124:127], a[16:19], v[28:31]
    buffer_store_dwordx4 a[168:171], v156, s[16:19], s98 offen offset:0 sc0 sc1
    v_mfma_f32_16x16x32_bf16 v[24:27], a[88:91], a[0:3], v[24:27]
    s_waitcnt lgkmcnt(12)
    s_and_b32 s54, s54, 0xffff
    v_mfma_f32_16x16x32_bf16 v[24:27], a[120:123], a[16:19], v[24:27]
    v_mfma_f32_16x16x32_bf16 v[20:23], a[84:87], a[0:3], v[20:23]
    s_waitcnt lgkmcnt(10)
    v_add_u32 v151, s54, v146
    v_mfma_f32_16x16x32_bf16 v[20:23], a[116:119], a[16:19], v[20:23]
    buffer_store_dwordx4 a[172:175], v156, s[16:19], s98 offen offset:1024 sc0 sc1
    v_mfma_f32_16x16x32_bf16 v[16:19], a[80:83], a[0:3], v[16:19]
    s_waitcnt lgkmcnt(8)
    v_add_u32 v152, s54, v147
    v_mfma_f32_16x16x32_bf16 v[16:19], a[112:115], a[16:19], v[16:19]
    s_add_u32 s98, s98, 8192
    v_mfma_f32_16x16x32_bf16 v[12:15], a[76:79], a[0:3], v[12:15]
    s_waitcnt lgkmcnt(6)
    v_add_u32 v153, s54, v148
    v_mfma_f32_16x16x32_bf16 v[12:15], a[108:111], a[16:19], v[12:15]
    buffer_store_dwordx4 a[176:179], v155, s[16:19], s98 offen offset:0 sc0 sc1
    v_mfma_f32_16x16x32_bf16 v[8:11], a[72:75], a[0:3], v[8:11]
    s_waitcnt lgkmcnt(4)
    v_add_u32 v154, s54, v149
    v_mfma_f32_16x16x32_bf16 v[8:11], a[104:107], a[16:19], v[8:11]
    v_mfma_f32_16x16x32_bf16 v[4:7], a[68:71], a[0:3], v[4:7]
    s_waitcnt lgkmcnt(2)
    v_mfma_f32_16x16x32_bf16 v[4:7], a[100:103], a[16:19], v[4:7]
    v_mfma_f32_16x16x32_bf16 v[0:3], a[64:67], a[0:3], v[0:3]
    s_waitcnt lgkmcnt(0)
    v_mfma_f32_16x16x32_bf16 v[0:3], a[96:99], a[16:19], v[0:3]
    s_waitcnt vmcnt(29)
    s_barrier
    v_mfma_f32_16x16x32_bf16 v[32:35], a[96:99], a[20:23], v[32:35]
    ds_read_b128 a[32:35], v144 offset:8192
    s_mov_b32 m0, s52
    v_mfma_f32_16x16x32_bf16 v[32:35], a[64:67], a[4:7], v[32:35]
    s_add_u32 s52, s52, 16384
    v_mfma_f32_16x16x32_bf16 v[36:39], a[68:71], a[4:7], v[36:39]
    buffer_load_dwordx4 v132, s[12:15], s48 offen offset:0 sc1 lds
    v_mfma_f32_16x16x32_bf16 v[36:39], a[100:103], a[20:23], v[36:39]
    ds_read_b128 a[48:51], v145 offset:8192
    v_mfma_f32_16x16x32_bf16 v[40:43], a[104:107], a[20:23], v[40:43]
    v_mfma_f32_16x16x32_bf16 v[40:43], a[72:75], a[4:7], v[40:43]
    buffer_load_dwordx4 v133, s[12:15], s48 offen offset:1024 sc1 lds
    v_mfma_f32_16x16x32_bf16 v[44:47], a[76:79], a[4:7], v[44:47]
    ds_read_b128 a[36:39], v144 offset:10240
    v_mfma_f32_16x16x32_bf16 v[44:47], a[108:111], a[20:23], v[44:47]
    buffer_load_dwordx4 v134, s[12:15], s48 offen offset:2048 sc1 lds
    v_mfma_f32_16x16x32_bf16 v[48:51], a[112:115], a[20:23], v[48:51]
    v_mfma_f32_16x16x32_bf16 v[48:51], a[80:83], a[4:7], v[48:51]
    ds_read_b128 a[52:55], v145 offset:10240
    v_mfma_f32_16x16x32_bf16 v[52:55], a[84:87], a[4:7], v[52:55]
    buffer_load_dwordx4 v135, s[12:15], s48 offen offset:3072 sc1 lds
    v_mfma_f32_16x16x32_bf16 v[52:55], a[116:119], a[20:23], v[52:55]
    v_mfma_f32_16x16x32_bf16 v[56:59], a[120:123], a[20:23], v[56:59]
    s_add_u32 s48, s48, s49
    v_mfma_f32_16x16x32_bf16 v[56:59], a[88:91], a[4:7], v[56:59]
    ds_read_b128 a[40:43], v144 offset:12288
    v_mfma_f32_16x16x32_bf16 v[60:63], a[92:95], a[4:7], v[60:63]
    s_and_b32 s52, s52, 0xffff
    v_mfma_f32_16x16x32_bf16 v[60:63], a[124:127], a[20:23], v[60:63]
    s_sub_u32 s56, s56, 1
    v_mfma_f32_16x16x32_bf16 v[92:95], a[124:127], a[24:27], v[92:95]
    ds_read_b128 a[56:59], v145 offset:12288
    s_cbranch_scc1 L1_sw10
L1_swr10:
    v_mfma_f32_16x16x32_bf16 v[92:95], a[92:95], a[8:11], v[92:95]
    v_mfma_f32_16x16x32_bf16 v[88:91], a[88:91], a[8:11], v[88:91]
    s_mov_b32 m0, s51
    v_mfma_f32_16x16x32_bf16 v[88:91], a[120:123], a[24:27], v[88:91]
    ds_read_b128 a[44:47], v144 offset:14336
    s_add_u32 s47, s46, s50
    v_mfma_f32_16x16x32_bf16 v[84:87], a[116:119], a[24:27], v[84:87]
    buffer_load_dwordx4 v128, s[8:11], s46 offen offset:0 sc1 lds
    v_mfma_f32_16x16x32_bf16 v[84:87], a[84:87], a[8:11], v[84:87]
    v_mfma_f32_16x16x32_bf16 v[80:83], a[80:83], a[8:11], v[80:83]
    ds_read_b128 a[60:63], v145 offset:14336
    v_mfma_f32_16x16x32_bf16 v[80:83], a[112:115], a[24:27], v[80:83]
    buffer_load_dwordx4 v129, s[8:11], s46 offen offset:1024 sc1 lds
    v_mfma_f32_16x16x32_bf16 v[76:79], a[108:111], a[24:27], v[76:79]
    v_mfma_f32_16x16x32_bf16 v[76:79], a[76:79], a[8:11], v[76:79]
    buffer_load_dwordx4 v130, s[8:11], s46 offen offset:2048 sc1 lds
    v_mfma_f32_16x16x32_bf16 v[72:75], a[72:75], a[8:11], v[72:75]
    v_mfma_f32_16x16x32_bf16 v[72:75], a[104:107], a[24:27], v[72:75]
    v_mfma_f32_16x16x32_bf16 v[68:71], a[100:103], a[24:27], v[68:71]
    buffer_load_dwordx4 v131, s[8:11], s46 offen offset:3072 sc1 lds
    v_mfma_f32_16x16x32_bf16 v[68:71], a[68:71], a[8:11], v[68:71]
    v_mfma_f32_16x16x32_bf16 v[64:67], a[64:67], a[8:11], v[64:67]
    v_mfma_f32_16x16x32_bf16 v[64:67], a[96:99], a[24:27], v[64:67]
    s_add_u32 s46, s46, s68
    s_waitcnt lgkmcnt(0)
    v_mfma_f32_16x16x32_bf16 v[96:99], a[64:67], a[12:15], v[96:99]
    ds_read_b64_tr_b16 a[64:65], v151 offset:0
    v_mfma_f32_16x16x32_bf16 v[96:99], a[96:99], a[28:31], v[96:99]
    ds_read_b64_tr_b16 a[66:67], v151 offset:1024
    v_mfma_f32_16x16x32_bf16 v[100:103], a[68:71], a[12:15], v[100:103]
    ds_read_b64_tr_b16 a[68:69], v152 offset:0
    v_mfma_f32_16x16x32_bf16 v[100:103], a[100:103], a[28:31], v[100:103]
    ds_read_b64_tr_b16 a[70:71], v152 offset:1024
    v_mfma_f32_16x16x32_bf16 v[104:107], a[72:75], a[12:15], v[104:107]
    ds_read_b64_tr_b16 a[72:73], v153 offset:0
    v_mfma_f32_16x16x32_bf16 v[104:107], a[104:107], a[28:31], v[104:107]
    ds_read_b64_tr_b16 a[74:75], v153 offset:1024
    v_mfma_f32_16x16x32_bf16 v[108:111], a[76:79], a[12:15], v[108:111]
    ds_read_b64_tr_b16 a[76:77], v154 offset:0
    v_mfma_f32_16x16x32_bf16 v[108:111], a[108:111], a[28:31], v[108:111]
    ds_read_b64_tr_b16 a[78:79], v154 offset:1024
    v_add_u32 v145, s93, v145
    v_mfma_f32_16x16x32_bf16 v[112:115], a[80:83], a[12:15], v[112:115]
    ds_read_b64_tr_b16 a[80:81], v151 offset:8192
    v_mfma_f32_16x16x32_bf16 v[112:115], a[112:115], a[28:31], v[112:115]
    ds_read_b64_tr_b16 a[82:83], v151 offset:9216
    v_mfma_f32_16x16x32_bf16 v[116:119], a[84:87], a[12:15], v[116:119]
    ds_read_b64_tr_b16 a[84:85], v152 offset:8192
    v_mfma_f32_16x16x32_bf16 v[116:119], a[116:119], a[28:31], v[116:119]
    ds_read_b64_tr_b16 a[86:87], v152 offset:9216
    v_mfma_f32_16x16x32_bf16 v[120:123], a[88:91], a[12:15], v[120:123]
    ds_read_b64_tr_b16 a[88:89], v153 offset:8192
    v_mfma_f32_16x16x32_bf16 v[120:123], a[120:123], a[28:31], v[120:123]
    ds_read_b64_tr_b16 a[90:91], v153 offset:9216
    v_mfma_f32_16x16x32_bf16 v[124:127], a[92:95], a[12:15], v[124:127]
    ds_read_b64_tr_b16 a[92:93], v154 offset:8192
    v_mfma_f32_16x16x32_bf16 v[124:127], a[124:127], a[28:31], v[124:127]
    ds_read_b64_tr_b16 a[94:95], v154 offset:9216
    v_mfma_f32_16x16x32_bf16 v[192:195], a[96:99], a[48:51], v[192:195]
    s_waitcnt lgkmcnt(14)
    s_add_u32 s54, s54, 16384
    v_mfma_f32_16x16x32_bf16 v[192:195], a[64:67], a[32:35], v[192:195]
    buffer_store_dwordx4 a[180:183], v155, s[16:19], s98 offen offset:1024 sc0 sc1
    v_mfma_f32_16x16x32_bf16 a[192:195], a[100:103], a[48:51], a[192:195]
    s_waitcnt lgkmcnt(12)
    s_and_b32 s54, s54, 0xffff
    v_mfma_f32_16x16x32_bf16 a[192:195], a[68:71], a[32:35], a[192:195]
    v_mfma_f32_16x16x32_bf16 v[196:199], a[104:107], a[48:51], v[196:199]
    s_waitcnt lgkmcnt(10)
    v_add_u32 v151, s54, v146
    v_mfma_f32_16x16x32_bf16 v[196:199], a[72:75], a[32:35], v[196:199]
    buffer_store_dwordx4 a[184:187], v156, s[16:19], s98 offen offset:0 sc0 sc1
    v_mfma_f32_16x16x32_bf16 a[196:199], a[108:111], a[48:51], a[196:199]
    s_waitcnt lgkmcnt(8)
    v_add_u32 v152, s54, v147
    v_mfma_f32_16x16x32_bf16 a[196:199], a[76:79], a[32:35], a[196:199]
    v_mfma_f32_16x16x32_bf16 v[200:203], a[112:115], a[48:51], v[200:203]
    s_waitcnt lgkmcnt(6)
    v_add_u32 v153, s54, v148
    v_mfma_f32_16x16x32_bf16 v[200:203], a[80:83], a[32:35], v[200:203]
    buffer_store_dwordx4 a[188:191], v156, s[16:19], s98 offen offset:1024 sc0 sc1
    v_mfma_f32_16x16x32_bf16 a[200:203], a[116:119], a[48:51], a[200:203]
    s_waitcnt lgkmcnt(4)
    v_add_u32 v154, s54, v149
    v_mfma_f32_16x16x32_bf16 a[200:203], a[84:87], a[32:35], a[200:203]
    s_add_u32 s98, s98, 8192
    v_mfma_f32_16x16x32_bf16 v[204:207], a[120:123], a[48:51], v[204:207]
    s_waitcnt lgkmcnt(2)
    v_mfma_f32_16x16x32_bf16 v[204:207], a[88:91], a[32:35], v[204:207]
    v_mfma_f32_16x16x32_bf16 a[204:207], a[124:127], a[48:51], a[204:207]
    s_waitcnt lgkmcnt(0)
    v_mfma_f32_16x16x32_bf16 a[204:207], a[92:95], a[32:35], a[204:207]
    s_waitcnt vmcnt(31)
    s_barrier
    v_mfma_f32_16x16x32_bf16 a[220:223], a[92:95], a[36:39], a[220:223]
    ds_read_b128 a[0:3], v144 offset:0
    s_sub_u32 s57, s57, 1
    v_mfma_f32_16x16x32_bf16 a[220:223], a[124:127], a[52:55], a[220:223]
    s_cbranch_scc1 L1_sw11
L1_swr11:
    v_mfma_f32_16x16x32_bf16 v[220:223], a[120:123], a[52:55], v[220:223]
    s_mov_b32 m0, s52
    v_mfma_f32_16x16x32_bf16 v[220:223], a[88:91], a[36:39], v[220:223]
    ds_read_b128 a[16:19], v145 offset:0
    s_add_u32 s52, s52, 16384
    v_mfma_f32_16x16x32_bf16 a[216:219], a[84:87], a[36:39], a[216:219]
    buffer_load_dwordx4 v132, s[12:15], s48 offen offset:0 sc1 lds
    v_mfma_f32_16x16x32_bf16 a[216:219], a[116:119], a[52:55], a[216:219]
    v_mfma_f32_16x16x32_bf16 v[216:219], a[112:115], a[52:55], v[216:219]
    ds_read_b128 a[4:7], v144 offset:2048
    v_mfma_f32_16x16x32_bf16 v[216:219], a[80:83], a[36:39], v[216:219]
    buffer_load_dwordx4 v133, s[12:15], s48 offen offset:1024 sc1 lds
    v_mfma_f32_16x16x32_bf16 a[212:215], a[76:79], a[36:39], a[212:215]
    buffer_load_dwordx4 v134, s[12:15], s48 offen offset:2048 sc1 lds
    v_mfma_f32_16x16x32_bf16 a[212:215], a[108:111], a[52:55], a[212:215]
    ds_read_b128 a[20:23], v145 offset:2048
    v_mfma_f32_16x16x32_bf16 v[212:215], a[104:107], a[52:55], v[212:215]
    v_mfma_f32_16x16x32_bf16 v[212:215], a[72:75], a[36:39], v[212:215]
    buffer_load_dwordx4 v135, s[12:15], s48 offen offset:3072 sc1 lds
    v_mfma_f32_16x16x32_bf16 a[208:211], a[68:71], a[36:39], a[208:211]
    v_mfma_f32_16x16x32_bf16 a[208:211], a[100:103], a[52:55], a[208:211]
    ds_read_b128 a[8:11], v144 offset:4096
    s_add_u32 s48, s48, s49
    v_mfma_f32_16x16x32_bf16 v[208:211], a[96:99], a[52:55], v[208:211]
    s_and_b32 s52, s52, 0xffff
    v_mfma_f32_16x16x32_bf16 v[208:211], a[64:67], a[36:39], v[208:211]
    s_add_u32 m0, s51, 8192
    v_mfma_f32_16x16x32_bf16 v[224:227], a[64:67], a[40:43], v[224:227]
    ds_read_b128 a[24:27], v145 offset:4096
    s_add_u32 s51, s51, 32768
    v_mfma_f32_16x16x32_bf16 v[224:227], a[96:99], a[56:59], v[224:227]
    buffer_load_dwordx4 v128, s[8:11], s47 offen offset:0 sc1 lds
    v_mfma_f32_16x16x32_bf16 a[224:227], a[100:103], a[56:59], a[224:227]
    v_mfma_f32_16x16x32_bf16 a[224:227], a[68:71], a[40:43], a[224:227]
    ds_read_b128 a[12:15], v144 offset:6144
    v_mfma_f32_16x16x32_bf16 v[228:231], a[72:75], a[40:43], v[228:231]
    buffer_load_dwordx4 v129, s[8:11], s47 offen offset:1024 sc1 lds
    v_mfma_f32_16x16x32_bf16 v[228:231], a[104:107], a[56:59], v[228:231]
    v_mfma_f32_16x16x32_bf16 a[228:231], a[108:111], a[56:59], a[228:231]
    ds_read_b128 a[28:31], v145 offset:6144
    v_mfma_f32_16x16x32_bf16 a[228:231], a[76:79], a[40:43], a[228:231]
    buffer_load_dwordx4 v130, s[8:11], s47 offen offset:2048 sc1 lds
    v_mfma_f32_16x16x32_bf16 v[232:235], a[80:83], a[40:43], v[232:235]
    buffer_load_dwordx4 v131, s[8:11], s47 offen offset:3072 sc1 lds
    v_mfma_f32_16x16x32_bf16 v[232:235], a[112:115], a[56:59], v[232:235]
    v_mfma_f32_16x16x32_bf16 a[232:235], a[116:119], a[56:59], a[232:235]
    s_cmp_ge_u32 s51, s79
    v_mfma_f32_16x16x32_bf16 a[232:235], a[84:87], a[40:43], a[232:235]
    s_cselect_b32 s51, s78, s51
    v_mfma_f32_16x16x32_bf16 v[236:239], a[88:91], a[40:43], v[236:239]
    buffer_load_dword v158, v157, s[84:87], s88 offen
    v_mfma_f32_16x16x32_bf16 v[236:239], a[120:123], a[56:59], v[236:239]
    v_mfma_f32_16x16x32_bf16 a[236:239], a[124:127], a[56:59], a[236:239]
    v_mfma_f32_16x16x32_bf16 a[236:239], a[92:95], a[40:43], a[236:239]
    s_add_u32 s88, s88, s89
    s_waitcnt lgkmcnt(0)
    v_mfma_f32_16x16x32_bf16 a[252:255], a[124:127], a[60:63], a[252:255]
    ds_read_b64_tr_b16 a[124:125], v154 offset:8192
    v_mfma_f32_16x16x32_bf16 a[252:255], a[92:95], a[44:47], a[252:255]
    ds_read_b64_tr_b16 a[126:127], v154 offset:9216
    s_add_u32 s53, s53, 1
    v_mfma_f32_16x16x32_bf16 v[252:255], a[120:123], a[60:63], v[252:255]
    ds_read_b64_tr_b16 a[120:121], v153 offset:8192
    v_mfma_f32_16x16x32_bf16 v[252:255], a[88:91], a[44:47], v[252:255]
    ds_read_b64_tr_b16 a[122:123], v153 offset:9216
    s_cmp_eq_u32 s53, 3
    v_mfma_f32_16x16x32_bf16 a[248:251], a[116:119], a[60:63], a[248:251]
    ds_read_b64_tr_b16 a[116:117], v152 offset:8192
    v_mfma_f32_16x16x32_bf16 a[248:251], a[84:87], a[44:47], a[248:251]
    ds_read_b64_tr_b16 a[118:119], v152 offset:9216
    s_cselect_b32 s53, 0, s53
    v_mfma_f32_16x16x32_bf16 v[248:251], a[112:115], a[60:63], v[248:251]
    ds_read_b64_tr_b16 a[112:113], v151 offset:8192
    v_mfma_f32_16x16x32_bf16 v[248:251], a[80:83], a[44:47], v[248:251]
    ds_read_b64_tr_b16 a[114:115], v151 offset:9216
    v_mfma_f32_16x16x32_bf16 a[244:247], a[108:111], a[60:63], a[244:247]
    ds_read_b64_tr_b16 a[108:109], v154 offset:0
    s_cselect_b32 s93, -2, 1
    v_mfma_f32_16x16x32_bf16 a[244:247], a[76:79], a[44:47], a[244:247]
    ds_read_b64_tr_b16 a[110:111], v154 offset:1024
    v_mfma_f32_16x16x32_bf16 v[244:247], a[104:107], a[60:63], v[244:247]
    ds_read_b64_tr_b16 a[104:105], v153 offset:0
    s_lshl_b32 s93, s93, 15
    v_mfma_f32_16x16x32_bf16 v[244:247], a[72:75], a[44:47], v[244:247]
    ds_read_b64_tr_b16 a[106:107], v153 offset:1024
    v_mfma_f32_16x16x32_bf16 a[240:243], a[100:103], a[60:63], a[240:243]
    ds_read_b64_tr_b16 a[100:101], v152 offset:0
    v_add_u32 v144, s93, v144
    v_mfma_f32_16x16x32_bf16 a[240:243], a[68:71], a[44:47], a[240:243]
    ds_read_b64_tr_b16 a[102:103], v152 offset:1024
    v_mfma_f32_16x16x32_bf16 v[240:243], a[96:99], a[60:63], v[240:243]
    ds_read_b64_tr_b16 a[96:97], v151 offset:0
    v_mfma_f32_16x16x32_bf16 v[240:243], a[64:67], a[44:47], v[240:243]
    ds_read_b64_tr_b16 a[98:99], v151 offset:1024
    v_mfma_f32_16x16x32_bf16 v[28:31], a[92:95], a[0:3], v[28:31]
    s_waitcnt lgkmcnt(14)
    s_add_u32 s54, s54, 16384
    v_mfma_f32_16x16x32_bf16 v[28:31], a[124:127], a[16:19], v[28:31]
    v_mfma_f32_16x16x32_bf16 v[24:27], a[88:91], a[0:3], v[24:27]
    s_waitcnt lgkmcnt(12)
    s_and_b32 s54, s54, 0xffff
    v_mfma_f32_16x16x32_bf16 v[24:27], a[120:123], a[16:19], v[24:27]
    v_mfma_f32_16x16x32_bf16 v[20:23], a[84:87], a[0:3], v[20:23]
    s_waitcnt lgkmcnt(10)
    v_add_u32 v151, s54, v146
    v_mfma_f32_16x16x32_bf16 v[20:23], a[116:119], a[16:19], v[20:23]
    v_mfma_f32_16x16x32_bf16 v[16:19], a[80:83], a[0:3], v[16:19]
    s_waitcnt lgkmcnt(8)
    v_add_u32 v152, s54, v147
    v_mfma_f32_16x16x32_bf16 v[16:19], a[112:115], a[16:19], v[16:19]
    v_mfma_f32_16x16x32_bf16 v[12:15], a[76:79], a[0:3], v[12:15]
    s_waitcnt lgkmcnt(6)
    v_add_u32 v153, s54, v148
    v_mfma_f32_16x16x32_bf16 v[12:15], a[108:111], a[16:19], v[12:15]
    v_mfma_f32_16x16x32_bf16 v[8:11], a[72:75], a[0:3], v[8:11]
    s_waitcnt lgkmcnt(4)
    v_add_u32 v154, s54, v149
    v_mfma_f32_16x16x32_bf16 v[8:11], a[104:107], a[16:19], v[8:11]
    v_mfma_f32_16x16x32_bf16 v[4:7], a[68:71], a[0:3], v[4:7]
    s_waitcnt lgkmcnt(2)
    v_mfma_f32_16x16x32_bf16 v[4:7], a[100:103], a[16:19], v[4:7]
    v_mfma_f32_16x16x32_bf16 v[0:3], a[64:67], a[0:3], v[0:3]
    s_waitcnt lgkmcnt(0)
    v_mfma_f32_16x16x32_bf16 v[0:3], a[96:99], a[16:19], v[0:3]
    s_waitcnt vmcnt(9)
    s_barrier
    s_cmp_lg_u32 s58, 0
    s_cbranch_scc1 Lpub2
    v_mov_b32 v161, 1
    s_mov_b64 exec, 1
    buffer_store_dword v161, off, s[16:19], s99 sc0 sc1
    s_mov_b64 exec, -1
Lpub2:
    v_mfma_f32_16x16x32_bf16 v[32:35], a[96:99], a[20:23], v[32:35]
    ds_read_b128 a[32:35], v144 offset:8192
    s_mov_b32 m0, s52
    v_mfma_f32_16x16x32_bf16 v[32:35], a[64:67], a[4:7], v[32:35]
    s_add_u32 s52, s52, 16384
    v_mfma_f32_16x16x32_bf16 v[36:39], a[68:71], a[4:7], v[36:39]
    buffer_load_dwordx4 v132, s[12:15], s48 offen offset:0 sc1 lds
    v_mfma_f32_16x16x32_bf16 v[36:39], a[100:103], a[20:23], v[36:39]
    ds_read_b128 a[48:51], v145 offset:8192
    v_mfma_f32_16x16x32_bf16 v[40:43], a[104:107], a[20:23], v[40:43]
    v_mfma_f32_16x16x32_bf16 v[40:43], a[72:75], a[4:7], v[40:43]
    buffer_load_dwordx4 v133, s[12:15], s48 offen offset:1024 sc1 lds
    v_mfma_f32_16x16x32_bf16 v[44:47], a[76:79], a[4:7], v[44:47]
    ds_read_b128 a[36:39], v144 offset:10240
    v_mfma_f32_16x16x32_bf16 v[44:47], a[108:111], a[20:23], v[44:47]
    buffer_load_dwordx4 v134, s[12:15], s48 offen offset:2048 sc1 lds
    v_mfma_f32_16x16x32_bf16 v[48:51], a[112:115], a[20:23], v[48:51]
    v_mfma_f32_16x16x32_bf16 v[48:51], a[80:83], a[4:7], v[48:51]
    ds_read_b128 a[52:55], v145 offset:10240
    v_mfma_f32_16x16x32_bf16 v[52:55], a[84:87], a[4:7], v[52:55]
    buffer_load_dwordx4 v135, s[12:15], s48 offen offset:3072 sc1 lds
    v_mfma_f32_16x16x32_bf16 v[52:55], a[116:119], a[20:23], v[52:55]
    v_mfma_f32_16x16x32_bf16 v[56:59], a[120:123], a[20:23], v[56:59]
    s_add_u32 s48, s48, s49
    v_mfma_f32_16x16x32_bf16 v[56:59], a[88:91], a[4:7], v[56:59]
    ds_read_b128 a[40:43], v144 offset:12288
    v_mfma_f32_16x16x32_bf16 v[60:63], a[92:95], a[4:7], v[60:63]
    s_and_b32 s52, s52, 0xffff
    v_mfma_f32_16x16x32_bf16 v[60:63], a[124:127], a[20:23], v[60:63]
    s_sub_u32 s56, s56, 1
    v_mfma_f32_16x16x32_bf16 v[92:95], a[124:127], a[24:27], v[92:95]
    ds_read_b128 a[56:59], v145 offset:12288
    s_cbranch_scc1 L1_sw12
L1_swr12:
    v_mfma_f32_16x16x32_bf16 v[92:95], a[92:95], a[8:11], v[92:95]
    v_mfma_f32_16x16x32_bf16 v[88:91], a[88:91], a[8:11], v[88:91]
    s_mov_b32 m0, s51
    v_mfma_f32_16x16x32_bf16 v[88:91], a[120:123], a[24:27], v[88:91]
    ds_read_b128 a[44:47], v144 offset:14336
    s_add_u32 s47, s46, s50
    v_mfma_f32_16x16x32_bf16 v[84:87], a[116:119], a[24:27], v[84:87]
    buffer_load_dwordx4 v128, s[8:11], s46 offen offset:0 sc1 lds
    v_mfma_f32_16x16x32_bf16 v[84:87], a[84:87], a[8:11], v[84:87]
    v_mfma_f32_16x16x32_bf16 v[80:83], a[80:83], a[8:11], v[80:83]
    ds_read_b128 a[60:63], v145 offset:14336
    v_mfma_f32_16x16x32_bf16 v[80:83], a[112:115], a[24:27], v[80:83]
    buffer_load_dwordx4 v129, s[8:11], s46 offen offset:1024 sc1 lds
    v_mfma_f32_16x16x32_bf16 v[76:79], a[108:111], a[24:27], v[76:79]
    v_mfma_f32_16x16x32_bf16 v[76:79], a[76:79], a[8:11], v[76:79]
    buffer_load_dwordx4 v130, s[8:11], s46 offen offset:2048 sc1 lds
    v_mfma_f32_16x16x32_bf16 v[72:75], a[72:75], a[8:11], v[72:75]
    v_mfma_f32_16x16x32_bf16 v[72:75], a[104:107], a[24:27], v[72:75]
    v_mfma_f32_16x16x32_bf16 v[68:71], a[100:103], a[24:27], v[68:71]
    buffer_load_dwordx4 v131, s[8:11], s46 offen offset:3072 sc1 lds
    v_mfma_f32_16x16x32_bf16 v[68:71], a[68:71], a[8:11], v[68:71]
    v_mfma_f32_16x16x32_bf16 v[64:67], a[64:67], a[8:11], v[64:67]
    v_mfma_f32_16x16x32_bf16 v[64:67], a[96:99], a[24:27], v[64:67]
    s_add_u32 s46, s46, s68
    s_waitcnt lgkmcnt(0)
    v_mfma_f32_16x16x32_bf16 v[96:99], a[64:67], a[12:15], v[96:99]
    ds_read_b64_tr_b16 a[64:65], v151 offset:0
    v_mfma_f32_16x16x32_bf16 v[96:99], a[96:99], a[28:31], v[96:99]
    ds_read_b64_tr_b16 a[66:67], v151 offset:1024
    v_mfma_f32_16x16x32_bf16 v[100:103], a[68:71], a[12:15], v[100:103]
    ds_read_b64_tr_b16 a[68:69], v152 offset:0
    v_mfma_f32_16x16x32_bf16 v[100:103], a[100:103], a[28:31], v[100:103]
    ds_read_b64_tr_b16 a[70:71], v152 offset:1024
    v_mfma_f32_16x16x32_bf16 v[104:107], a[72:75], a[12:15], v[104:107]
    ds_read_b64_tr_b16 a[72:73], v153 offset:0
    v_mfma_f32_16x16x32_bf16 v[104:107], a[104:107], a[28:31], v[104:107]
    ds_read_b64_tr_b16 a[74:75], v153 offset:1024
    v_mfma_f32_16x16x32_bf16 v[108:111], a[76:79], a[12:15], v[108:111]
    ds_read_b64_tr_b16 a[76:77], v154 offset:0
    v_mfma_f32_16x16x32_bf16 v[108:111], a[108:111], a[28:31], v[108:111]
    ds_read_b64_tr_b16 a[78:79], v154 offset:1024
    v_add_u32 v145, s93, v145
    v_mfma_f32_16x16x32_bf16 v[112:115], a[80:83], a[12:15], v[112:115]
    ds_read_b64_tr_b16 a[80:81], v151 offset:8192
    v_mfma_f32_16x16x32_bf16 v[112:115], a[112:115], a[28:31], v[112:115]
    ds_read_b64_tr_b16 a[82:83], v151 offset:9216
    v_mfma_f32_16x16x32_bf16 v[116:119], a[84:87], a[12:15], v[116:119]
    ds_read_b64_tr_b16 a[84:85], v152 offset:8192
    v_mfma_f32_16x16x32_bf16 v[116:119], a[116:119], a[28:31], v[116:119]
    ds_read_b64_tr_b16 a[86:87], v152 offset:9216
    v_mfma_f32_16x16x32_bf16 v[120:123], a[88:91], a[12:15], v[120:123]
    ds_read_b64_tr_b16 a[88:89], v153 offset:8192
    v_mfma_f32_16x16x32_bf16 v[120:123], a[120:123], a[28:31], v[120:123]
    ds_read_b64_tr_b16 a[90:91], v153 offset:9216
    v_mfma_f32_16x16x32_bf16 v[124:127], a[92:95], a[12:15], v[124:127]
    ds_read_b64_tr_b16 a[92:93], v154 offset:8192
    v_mfma_f32_16x16x32_bf16 v[124:127], a[124:127], a[28:31], v[124:127]
    ds_read_b64_tr_b16 a[94:95], v154 offset:9216
    s_branch L1_kloop
L1_epi1q:
    v_mfma_f32_16x16x32_bf16 v[192:195], a[96:99], a[48:51], v[192:195]
    v_mfma_f32_16x16x32_bf16 a[192:195], a[100:103], a[48:51], a[192:195]
    v_mfma_f32_16x16x32_bf16 v[196:199], a[104:107], a[48:51], v[196:199]
    s_lshr_b32 s4, s58, 1
    s_lshl_b32 s4, s4, 16
    s_and_b32 s5, s58, 1
    v_mfma_f32_16x16x32_bf16 a[196:199], a[108:111], a[48:51], a[196:199]
    s_lshl_b32 s5, s5, 11
    s_add_u32 s4, s4, s5
    s_add_u32 s98, s4, s30
    v_mfma_f32_16x16x32_bf16 v[200:203], a[112:115], a[48:51], v[200:203]
    v_add_u32 v156, 4096, v155
    v_pk_mul_f32 v[0:1], v[0:1], s[96:97] op_sel:[0,1] op_sel_hi:[1,1]
    v_mfma_f32_16x16x32_bf16 a[200:203], a[116:119], a[48:51], a[200:203]
    v_pk_mul_f32 v[2:3], v[2:3], s[96:97] op_sel:[0,1] op_sel_hi:[1,1]
    v_pk_mul_f32 v[4:5], v[4:5], s[96:97] op_sel:[0,1] op_sel_hi:[1,1]
    v_mfma_f32_16x16x32_bf16 v[204:207], a[120:123], a[48:51], v[204:207]
    v_pk_mul_f32 v[6:7], v[6:7], s[96:97] op_sel:[0,1] op_sel_hi:[1,1]
    v_cvt_pk_bf16_f32 v0, v0, v1
    v_mfma_f32_16x16x32_bf16 a[204:207], a[124:127], a[48:51], a[204:207]
    v_cvt_pk_bf16_f32 v1, v2, v3
    v_cvt_pk_bf16_f32 v2, v4, v5
    v_mfma_f32_16x16x32_bf16 a[220:223], a[124:127], a[52:55], a[220:223]
    v_cvt_pk_bf16_f32 v3, v6, v7
    v_mfma_f32_16x16x32_bf16 v[220:223], a[120:123], a[52:55], v[220:223]
    buffer_store_dwordx4 v[0:3], v155, s[16:19], s98 offen offset:0 sc0 sc1
    v_mfma_f32_16x16x32_bf16 a[216:219], a[116:119], a[52:55], a[216:219]
    v_pk_mul_f32 v[8:9], v[8:9], s[96:97] op_sel:[0,1] op_sel_hi:[1,1]
    v_pk_mul_f32 v[10:11], v[10:11], s[96:97] op_sel:[0,1] op_sel_hi:[1,1]
    v_mfma_f32_16x16x32_bf16 v[216:219], a[112:115], a[52:55], v[216:219]
    v_pk_mul_f32 v[12:13], v[12:13], s[96:97] op_sel:[0,1] op_sel_hi:[1,1]
    v_pk_mul_f32 v[14:15], v[14:15], s[96:97] op_sel:[0,1] op_sel_hi:[1,1]
    v_mfma_f32_16x16x32_bf16 a[212:215], a[108:111], a[52:55], a[212:215]
    v_cvt_pk_bf16_f32 v8, v8, v9
    v_cvt_pk_bf16_f32 v9, v10, v11
    v_mfma_f32_16x16x32_bf16 v[212:215], a[104:107], a[52:55], v[212:215]
    v_cvt_pk_bf16_f32 v10, v12, v13
    v_cvt_pk_bf16_f32 v11, v14, v15
    v_mfma_f32_16x16x32_bf16 a[208:211], a[100:103], a[52:55], a[208:211]
    buffer_store_dwordx4 v[8:11], v155, s[16:19], s98 offen offset:1024 sc0 sc1
    v_mfma_f32_16x16x32_bf16 v[208:211], a[96:99], a[52:55], v[208:211]
    v_pk_mul_f32 v[16:17], v[16:17], s[96:97] op_sel:[0,1] op_sel_hi:[1,1]
    v_pk_mul_f32 v[18:19], v[18:19], s[96:97] op_sel:[0,1] op_sel_hi:[1,1]
    v_mfma_f32_16x16x32_bf16 v[224:227], a[96:99], a[56:59], v[224:227]
    v_pk_mul_f32 v[20:21], v[20:21], s[96:97] op_sel:[0,1] op_sel_hi:[1,1]
    v_pk_mul_f32 v[22:23], v[22:23], s[96:97] op_sel:[0,1] op_sel_hi:[1,1]
    v_mfma_f32_16x16x32_bf16 a[224:227], a[100:103], a[56:59], a[224:227]
    v_cvt_pk_bf16_f32 v16, v16, v17
    v_cvt_pk_bf16_f32 v17, v18, v19
    v_mfma_f32_16x16x32_bf16 v[228:231], a[104:107], a[56:59], v[228:231]
    v_cvt_pk_bf16_f32 v18, v20, v21
    v_cvt_pk_bf16_f32 v19, v22, v23
    v_mfma_f32_16x16x32_bf16 a[228:231], a[108:111], a[56:59], a[228:231]
    buffer_store_dwordx4 v[16:19], v156, s[16:19], s98 offen offset:0 sc0 sc1
    v_mfma_f32_16x16x32_bf16 v[232:235], a[112:115], a[56:59], v[232:235]
    v_pk_mul_f32 v[24:25], v[24:25], s[96:97] op_sel:[0,1] op_sel_hi:[1,1]
    v_pk_mul_f32 v[26:27], v[26:27], s[96:97] op_sel:[0,1] op_sel_hi:[1,1]
    v_mfma_f32_16x16x32_bf16 a[232:235], a[116:119], a[56:59], a[232:235]
    v_pk_mul_f32 v[28:29], v[28:29], s[96:97] op_sel:[0,1] op_sel_hi:[1,1]
    v_pk_mul_f32 v[30:31], v[30:31], s[96:97] op_sel:[0,1] op_sel_hi:[1,1]
    v_mfma_f32_16x16x32_bf16 v[236:239], a[120:123], a[56:59], v[236:239]
    v_cvt_pk_bf16_f32 v24, v24, v25
    v_cvt_pk_bf16_f32 v25, v26, v27
    v_mfma_f32_16x16x32_bf16 a[236:239], a[124:127], a[56:59], a[236:239]
    v_cvt_pk_bf16_f32 v26, v28, v29
    v_cvt_pk_bf16_f32 v27, v30, v31
    v_mfma_f32_16x16x32_bf16 a[252:255], a[124:127], a[60:63], a[252:255]
    buffer_store_dwordx4 v[24:27], v156, s[16:19], s98 offen offset:1024 sc0 sc1
    v_mfma_f32_16x16x32_bf16 v[252:255], a[120:123], a[60:63], v[252:255]
    s_add_u32 s98, s98, 8192
    v_pk_mul_f32 v[32:33], v[32:33], s[96:97] op_sel:[0,1] op_sel_hi:[1,1]
    v_pk_mul_f32 v[34:35], v[34:35], s[96:97] op_sel:[0,1] op_sel_hi:[1,1]
    v_mfma_f32_16x16x32_bf16 a[248:251], a[116:119], a[60:63], a[248:251]
    v_pk_mul_f32 v[36:37], v[36:37], s[96:97] op_sel:[0,1] op_sel_hi:[1,1]
    v_pk_mul_f32 v[38:39], v[38:39], s[96:97] op_sel:[0,1] op_sel_hi:[1,1]
    v_mfma_f32_16x16x32_bf16 v[248:251], a[112:115], a[60:63], v[248:251]
    v_cvt_pk_bf16_f32 v32, v32, v33
    v_cvt_pk_bf16_f32 v33, v34, v35
    v_mfma_f32_16x16x32_bf16 a[244:247], a[108:111], a[60:63], a[244:247]
    v_cvt_pk_bf16_f32 v34, v36, v37
    v_cvt_pk_bf16_f32 v35, v38, v39
    v_mfma_f32_16x16x32_bf16 v[244:247], a[104:107], a[60:63], v[244:247]
    buffer_store_dwordx4 v[32:35], v155, s[16:19], s98 offen offset:0 sc0 sc1
    v_mfma_f32_16x16x32_bf16 a[240:243], a[100:103], a[60:63], a[240:243]
    v_pk_mul_f32 v[40:41], v[40:41], s[96:97] op_sel:[0,1] op_sel_hi:[1,1]
    v_pk_mul_f32 v[42:43], v[42:43], s[96:97] op_sel:[0,1] op_sel_hi:[1,1]
    v_mfma_f32_16x16x32_bf16 v[240:243], a[96:99], a[60:63], v[240:243]
    v_pk_mul_f32 v[44:45], v[44:45], s[96:97] op_sel:[0,1] op_sel_hi:[1,1]
    v_pk_mul_f32 v[46:47], v[46:47], s[96:97] op_sel:[0,1] op_sel_hi:[1,1]
    v_cvt_pk_bf16_f32 v40, v40, v41
    v_cvt_pk_bf16_f32 v41, v42, v43
    v_cvt_pk_bf16_f32 v42, v44, v45
    v_cvt_pk_bf16_f32 v43, v46, v47
    buffer_store_dwordx4 v[40:43], v155, s[16:19], s98 offen offset:1024 sc0 sc1
    v_pk_mul_f32 v[48:49], v[48:49], s[96:97] op_sel:[0,1] op_sel_hi:[1,1]
    v_pk_mul_f32 v[50:51], v[50:51], s[96:97] op_sel:[0,1] op_sel_hi:[1,1]
    v_pk_mul_f32 v[52:53], v[52:53], s[96:97] op_sel:[0,1] op_sel_hi:[1,1]
    v_pk_mul_f32 v[54:55], v[54:55], s[96:97] op_sel:[0,1] op_sel_hi:[1,1]
    v_cvt_pk_bf16_f32 v48, v48, v49
    v_cvt_pk_bf16_f32 v49, v50, v51
    v_cvt_pk_bf16_f32 v50, v52, v53
    v_cvt_pk_bf16_f32 v51, v54, v55
    buffer_store_dwordx4 v[48:51], v156, s[16:19], s98 offen offset:0 sc0 sc1
    v_pk_mul_f32 v[56:57], v[56:57], s[96:97] op_sel:[0,1] op_sel_hi:[1,1]
    v_pk_mul_f32 v[58:59], v[58:59], s[96:97] op_sel:[0,1] op_sel_hi:[1,1]
    v_pk_mul_f32 v[60:61], v[60:61], s[96:97] op_sel:[0,1] op_sel_hi:[1,1]
    v_pk_mul_f32 v[62:63], v[62:63], s[96:97] op_sel:[0,1] op_sel_hi:[1,1]
    v_cvt_pk_bf16_f32 v56, v56, v57
    v_cvt_pk_bf16_f32 v57, v58, v59
    v_cvt_pk_bf16_f32 v58, v60, v61
    v_cvt_pk_bf16_f32 v59, v62, v63
    buffer_store_dwordx4 v[56:59], v156, s[16:19], s98 offen offset:1024 sc0 sc1
    s_add_u32 s98, s98, 8192
    v_pk_mul_f32 v[64:65], v[64:65], s[96:97] op_sel:[0,1] op_sel_hi:[1,1]
    v_pk_mul_f32 v[66:67], v[66:67], s[96:97] op_sel:[0,1] op_sel_hi:[1,1]
    v_pk_mul_f32 v[68:69], v[68:69], s[96:97] op_sel:[0,1] op_sel_hi:[1,1]
    v_pk_mul_f32 v[70:71], v[70:71], s[96:97] op_sel:[0,1] op_sel_hi:[1,1]
    v_cvt_pk_bf16_f32 v64, v64, v65
    v_cvt_pk_bf16_f32 v65, v66, v67
    v_cvt_pk_bf16_f32 v66, v68, v69
    v_cvt_pk_bf16_f32 v67, v70, v71
    buffer_store_dwordx4 v[64:67], v155, s[16:19], s98 offen offset:0 sc0 sc1
    v_pk_mul_f32 v[72:73], v[72:73], s[96:97] op_sel:[0,1] op_sel_hi:[1,1]
    v_pk_mul_f32 v[74:75], v[74:75], s[96:97] op_sel:[0,1] op_sel_hi:[1,1]
    v_pk_mul_f32 v[76:77], v[76:77], s[96:97] op_sel:[0,1] op_sel_hi:[1,1]
    v_pk_mul_f32 v[78:79], v[78:79], s[96:97] op_sel:[0,1] op_sel_hi:[1,1]
    v_cvt_pk_bf16_f32 v72, v72, v73
    v_cvt_pk_bf16_f32 v73, v74, v75
    v_cvt_pk_bf16_f32 v74, v76, v77
    v_cvt_pk_bf16_f32 v75, v78, v79
    buffer_store_dwordx4 v[72:75], v155, s[16:19], s98 offen offset:1024 sc0 sc1
    v_pk_mul_f32 v[80:81], v[80:81], s[96:97] op_sel:[0,1] op_sel_hi:[1,1]
    v_pk_mul_f32 v[82:83], v[82:83], s[96:97] op_sel:[0,1] op_sel_hi:[1,1]
    v_pk_mul_f32 v[84:85], v[84:85], s[96:97] op_sel:[0,1] op_sel_hi:[1,1]
    v_pk_mul_f32 v[86:87], v[86:87], s[96:97] op_sel:[0,1] op_sel_hi:[1,1]
    v_cvt_pk_bf16_f32 v168, v80, v81
    v_cvt_pk_bf16_f32 v169, v82, v83
    v_cvt_pk_bf16_f32 v170, v84, v85
    v_cvt_pk_bf16_f32 v171, v86, v87
    v_pk_mul_f32 v[88:89], v[88:89], s[96:97] op_sel:[0,1] op_sel_hi:[1,1]
    v_pk_mul_f32 v[90:91], v[90:91], s[96:97] op_sel:[0,1] op_sel_hi:[1,1]
    v_pk_mul_f32 v[92:93], v[92:93], s[96:97] op_sel:[0,1] op_sel_hi:[1,1]
    v_pk_mul_f32 v[94:95], v[94:95], s[96:97] op_sel:[0,1] op_sel_hi:[1,1]
    v_cvt_pk_bf16_f32 v172, v88, v89
    v_cvt_pk_bf16_f32 v173, v90, v91
    v_cvt_pk_bf16_f32 v174, v92, v93
    v_cvt_pk_bf16_f32 v175, v94, v95
    v_pk_mul_f32 v[96:97], v[96:97], s[96:97] op_sel:[0,1] op_sel_hi:[1,1]
    v_pk_mul_f32 v[98:99], v[98:99], s[96:97] op_sel:[0,1] op_sel_hi:[1,1]
    v_pk_mul_f32 v[100:101], v[100:101], s[96:97] op_sel:[0,1] op_sel_hi:[1,1]
    v_pk_mul_f32 v[102:103], v[102:103], s[96:97] op_sel:[0,1] op_sel_hi:[1,1]
    v_cvt_pk_bf16_f32 v176, v96, v97
    v_cvt_pk_bf16_f32 v177, v98, v99
    v_cvt_pk_bf16_f32 v178, v100, v101
    v_cvt_pk_bf16_f32 v179, v102, v103
    v_pk_mul_f32 v[104:105], v[104:105], s[96:97] op_sel:[0,1] op_sel_hi:[1,1]
    v_pk_mul_f32 v[106:107], v[106:107], s[96:97] op_sel:[0,1] op_sel_hi:[1,1]
    v_pk_mul_f32 v[108:109], v[108:109], s[96:97] op_sel:[0,1] op_sel_hi:[1,1]
    v_pk_mul_f32 v[110:111], v[110:111], s[96:97] op_sel:[0,1] op_sel_hi:[1,1]
    v_cvt_pk_bf16_f32 v180, v104, v105
    v_cvt_pk_bf16_f32 v181, v106, v107
    v_cvt_pk_bf16_f32 v182, v108, v109
    v_cvt_pk_bf16_f32 v183, v110, v111
    v_pk_mul_f32 v[112:113], v[112:113], s[96:97] op_sel:[0,1] op_sel_hi:[1,1]
    v_pk_mul_f32 v[114:115], v[114:115], s[96:97] op_sel:[0,1] op_sel_hi:[1,1]
    v_pk_mul_f32 v[116:117], v[116:117], s[96:97] op_sel:[0,1] op_sel_hi:[1,1]
    v_pk_mul_f32 v[118:119], v[118:119], s[96:97] op_sel:[0,1] op_sel_hi:[1,1]
    v_cvt_pk_bf16_f32 v184, v112, v113
    v_cvt_pk_bf16_f32 v185, v114, v115
    v_cvt_pk_bf16_f32 v186, v116, v117
    v_cvt_pk_bf16_f32 v187, v118, v119
    v_pk_mul_f32 v[120:121], v[120:121], s[96:97] op_sel:[0,1] op_sel_hi:[1,1]
    v_pk_mul_f32 v[122:123], v[122:123], s[96:97] op_sel:[0,1] op_sel_hi:[1,1]
    v_pk_mul_f32 v[124:125], v[124:125], s[96:97] op_sel:[0,1] op_sel_hi:[1,1]
    v_pk_mul_f32 v[126:127], v[126:127], s[96:97] op_sel:[0,1] op_sel_hi:[1,1]
    v_cvt_pk_bf16_f32 v188, v120, v121
    v_cvt_pk_bf16_f32 v189, v122, v123
    v_cvt_pk_bf16_f32 v190, v124, v125
    v_cvt_pk_bf16_f32 v191, v126, v127
    v_accvgpr_read_b32 v0, a192
    v_accvgpr_read_b32 v1, a193
    v_accvgpr_read_b32 v2, a194
    v_accvgpr_read_b32 v3, a195
    v_pk_mul_f32 v[192:193], v[192:193], s[96:97] op_sel:[0,1] op_sel_hi:[1,1]
    v_pk_mul_f32 v[194:195], v[194:195], s[96:97] op_sel:[0,1] op_sel_hi:[1,1]
    v_pk_mul_f32 v[0:1], v[0:1], s[96:97] op_sel:[0,1] op_sel_hi:[1,1]
    v_pk_mul_f32 v[2:3], v[2:3], s[96:97] op_sel:[0,1] op_sel_hi:[1,1]
    v_cvt_pk_bf16_f32 v192, v192, v193
    v_cvt_pk_bf16_f32 v193, v194, v195
    v_cvt_pk_bf16_f32 v194, v0, v1
    v_cvt_pk_bf16_f32 v195, v2, v3
    v_accvgpr_write_b32 a128, v192
    v_accvgpr_write_b32 a129, v193
    v_accvgpr_write_b32 a130, v194
    v_accvgpr_write_b32 a131, v195
    v_accvgpr_read_b32 v4, a196
    v_accvgpr_read_b32 v5, a197
    v_accvgpr_read_b32 v6, a198
    v_accvgpr_read_b32 v7, a199
    v_pk_mul_f32 v[196:197], v[196:197], s[96:97] op_sel:[0,1] op_sel_hi:[1,1]
    v_pk_mul_f32 v[198:199], v[198:199], s[96:97] op_sel:[0,1] op_sel_hi:[1,1]
    v_pk_mul_f32 v[4:5], v[4:5], s[96:97] op_sel:[0,1] op_sel_hi:[1,1]
    v_pk_mul_f32 v[6:7], v[6:7], s[96:97] op_sel:[0,1] op_sel_hi:[1,1]
    v_cvt_pk_bf16_f32 v196, v196, v197
    v_cvt_pk_bf16_f32 v197, v198, v199
    v_cvt_pk_bf16_f32 v198, v4, v5
    v_cvt_pk_bf16_f32 v199, v6, v7
    v_accvgpr_write_b32 a132, v196
    v_accvgpr_write_b32 a133, v197
    v_accvgpr_write_b32 a134, v198
    v_accvgpr_write_b32 a135, v199
    v_accvgpr_read_b32 v8, a200
    v_accvgpr_read_b32 v9, a201
    v_accvgpr_read_b32 v10, a202
    v_accvgpr_read_b32 v11, a203
    v_pk_mul_f32 v[200:201], v[200:201], s[96:97] op_sel:[0,1] op_sel_hi:[1,1]
    v_pk_mul_f32 v[202:203], v[202:203], s[96:97] op_sel:[0,1] op_sel_hi:[1,1]
    v_pk_mul_f32 v[8:9], v[8:9], s[96:97] op_sel:[0,1] op_sel_hi:[1,1]
    v_pk_mul_f32 v[10:11], v[10:11], s[96:97] op_sel:[0,1] op_sel_hi:[1,1]
    v_cvt_pk_bf16_f32 v200, v200, v201
    v_cvt_pk_bf16_f32 v201, v202, v203
    v_cvt_pk_bf16_f32 v202, v8, v9
    v_cvt_pk_bf16_f32 v203, v10, v11
    v_accvgpr_write_b32 a136, v200
    v_accvgpr_write_b32 a137, v201
    v_accvgpr_write_b32 a138, v202
    v_accvgpr_write_b32 a139, v203
    v_accvgpr_read_b32 v12, a204
    v_accvgpr_read_b32 v13, a205
    v_accvgpr_read_b32 v14, a206
    v_accvgpr_read_b32 v15, a207
    v_pk_mul_f32 v[204:205], v[204:205], s[96:97] op_sel:[0,1] op_sel_hi:[1,1]
    v_pk_mul_f32 v[206:207], v[206:207], s[96:97] op_sel:[0,1] op_sel_hi:[1,1]
    v_pk_mul_f32 v[12:13], v[12:13], s[96:97] op_sel:[0,1] op_sel_hi:[1,1]
    v_pk_mul_f32 v[14:15], v[14:15], s[96:97] op_sel:[0,1] op_sel_hi:[1,1]
    v_cvt_pk_bf16_f32 v204, v204, v205
    v_cvt_pk_bf16_f32 v205, v206, v207
    v_cvt_pk_bf16_f32 v206, v12, v13
    v_cvt_pk_bf16_f32 v207, v14, v15
    v_accvgpr_write_b32 a140, v204
    v_accvgpr_write_b32 a141, v205
    v_accvgpr_write_b32 a142, v206
    v_accvgpr_write_b32 a143, v207
    v_accvgpr_read_b32 v0, a208
    v_accvgpr_read_b32 v1, a209
    v_accvgpr_read_b32 v2, a210
    v_accvgpr_read_b32 v3, a211
    v_pk_mul_f32 v[208:209], v[208:209], s[96:97] op_sel:[0,1] op_sel_hi:[1,1]
    v_pk_mul_f32 v[210:211], v[210:211], s[96:97] op_sel:[0,1] op_sel_hi:[1,1]
    v_pk_mul_f32 v[0:1], v[0:1], s[96:97] op_sel:[0,1] op_sel_hi:[1,1]
    v_pk_mul_f32 v[2:3], v[2:3], s[96:97] op_sel:[0,1] op_sel_hi:[1,1]
    v_cvt_pk_bf16_f32 v208, v208, v209
    v_cvt_pk_bf16_f32 v209, v210, v211
    v_cvt_pk_bf16_f32 v210, v0, v1
    v_cvt_pk_bf16_f32 v211, v2, v3
    v_accvgpr_write_b32 a144, v208
    v_accvgpr_write_b32 a145, v209
    v_accvgpr_write_b32 a146, v210
    v_accvgpr_write_b32 a147, v211
    v_accvgpr_read_b32 v4, a212
    v_accvgpr_read_b32 v5, a213
    v_accvgpr_read_b32 v6, a214
    v_accvgpr_read_b32 v7, a215
    v_pk_mul_f32 v[212:213], v[212:213], s[96:97] op_sel:[0,1] op_sel_hi:[1,1]
    v_pk_mul_f32 v[214:215], v[214:215], s[96:97] op_sel:[0,1] op_sel_hi:[1,1]
    v_pk_mul_f32 v[4:5], v[4:5], s[96:97] op_sel:[0,1] op_sel_hi:[1,1]
    v_pk_mul_f32 v[6:7], v[6:7], s[96:97] op_sel:[0,1] op_sel_hi:[1,1]
    v_cvt_pk_bf16_f32 v212, v212, v213
    v_cvt_pk_bf16_f32 v213, v214, v215
    v_cvt_pk_bf16_f32 v214, v4, v5
    v_cvt_pk_bf16_f32 v215, v6, v7
    v_accvgpr_write_b32 a148, v212
    v_accvgpr_write_b32 a149, v213
    v_accvgpr_write_b32 a150, v214
    v_accvgpr_write_b32 a151, v215
    v_accvgpr_read_b32 v8, a216
    v_accvgpr_read_b32 v9, a217
    v_accvgpr_read_b32 v10, a218
    v_accvgpr_read_b32 v11, a219
    v_pk_mul_f32 v[216:217], v[216:217], s[96:97] op_sel:[0,1] op_sel_hi:[1,1]
    v_pk_mul_f32 v[218:219], v[218:219], s[96:97] op_sel:[0,1] op_sel_hi:[1,1]
    v_pk_mul_f32 v[8:9], v[8:9], s[96:97] op_sel:[0,1] op_sel_hi:[1,1]
    v_pk_mul_f32 v[10:11], v[10:11], s[96:97] op_sel:[0,1] op_sel_hi:[1,1]
    v_cvt_pk_bf16_f32 v216, v216, v217
    v_cvt_pk_bf16_f32 v217, v218, v219
    v_cvt_pk_bf16_f32 v218, v8, v9
    v_cvt_pk_bf16_f32 v219, v10, v11
    v_accvgpr_write_b32 a152, v216
    v_accvgpr_write_b32 a153, v217
    v_accvgpr_write_b32 a154, v218
    v_accvgpr_write_b32 a155, v219
    v_accvgpr_read_b32 v12, a220
    v_accvgpr_read_b32 v13, a221
    v_accvgpr_read_b32 v14, a222
    v_accvgpr_read_b32 v15, a223
    v_pk_mul_f32 v[220:221], v[220:221], s[96:97] op_sel:[0,1] op_sel_hi:[1,1]
    v_pk_mul_f32 v[222:223], v[222:223], s[96:97] op_sel:[0,1] op_sel_hi:[1,1]
    v_pk_mul_f32 v[12:13], v[12:13], s[96:97] op_sel:[0,1] op_sel_hi:[1,1]
    v_pk_mul_f32 v[14:15], v[14:15], s[96:97] op_sel:[0,1] op_sel_hi:[1,1]
    v_cvt_pk_bf16_f32 v220, v220, v221
    v_cvt_pk_bf16_f32 v221, v222, v223
    v_cvt_pk_bf16_f32 v222, v12, v13
    v_cvt_pk_bf16_f32 v223, v14, v15
    v_accvgpr_write_b32 a156, v220
    v_accvgpr_write_b32 a157, v221
    v_accvgpr_write_b32 a158, v222
    v_accvgpr_write_b32 a159, v223
    v_accvgpr_read_b32 v0, a224
    v_accvgpr_read_b32 v1, a225
    v_accvgpr_read_b32 v2, a226
    v_accvgpr_read_b32 v3, a227
    v_pk_mul_f32 v[224:225], v[224:225], s[96:97] op_sel:[0,1] op_sel_hi:[1,1]
    v_pk_mul_f32 v[226:227], v[226:227], s[96:97] op_sel:[0,1] op_sel_hi:[1,1]
    v_pk_mul_f32 v[0:1], v[0:1], s[96:97] op_sel:[0,1] op_sel_hi:[1,1]
    v_pk_mul_f32 v[2:3], v[2:3], s[96:97] op_sel:[0,1] op_sel_hi:[1,1]
    v_cvt_pk_bf16_f32 v224, v224, v225
    v_cvt_pk_bf16_f32 v225, v226, v227
    v_cvt_pk_bf16_f32 v226, v0, v1
    v_cvt_pk_bf16_f32 v227, v2, v3
    v_accvgpr_write_b32 a160, v224
    v_accvgpr_write_b32 a161, v225
    v_accvgpr_write_b32 a162, v226
    v_accvgpr_write_b32 a163, v227
    v_accvgpr_read_b32 v4, a228
    v_accvgpr_read_b32 v5, a229
    v_accvgpr_read_b32 v6, a230
    v_accvgpr_read_b32 v7, a231
    v_pk_mul_f32 v[228:229], v[228:229], s[96:97] op_sel:[0,1] op_sel_hi:[1,1]
    v_pk_mul_f32 v[230:231], v[230:231], s[96:97] op_sel:[0,1] op_sel_hi:[1,1]
    v_pk_mul_f32 v[4:5], v[4:5], s[96:97] op_sel:[0,1] op_sel_hi:[1,1]
    v_pk_mul_f32 v[6:7], v[6:7], s[96:97] op_sel:[0,1] op_sel_hi:[1,1]
    v_cvt_pk_bf16_f32 v228, v228, v229
    v_cvt_pk_bf16_f32 v229, v230, v231
    v_cvt_pk_bf16_f32 v230, v4, v5
    v_cvt_pk_bf16_f32 v231, v6, v7
    v_accvgpr_write_b32 a164, v228
    v_accvgpr_write_b32 a165, v229
    v_accvgpr_write_b32 a166, v230
    v_accvgpr_write_b32 a167, v231
    v_accvgpr_read_b32 v8, a232
    v_accvgpr_read_b32 v9, a233
    v_accvgpr_read_b32 v10, a234
    v_accvgpr_read_b32 v11, a235
    v_pk_mul_f32 v[232:233], v[232:233], s[96:97] op_sel:[0,1] op_sel_hi:[1,1]
    v_pk_mul_f32 v[234:235], v[234:235], s[96:97] op_sel:[0,1] op_sel_hi:[1,1]
    v_pk_mul_f32 v[8:9], v[8:9], s[96:97] op_sel:[0,1] op_sel_hi:[1,1]
    v_pk_mul_f32 v[10:11], v[10:11], s[96:97] op_sel:[0,1] op_sel_hi:[1,1]
    v_cvt_pk_bf16_f32 v232, v232, v233
    v_cvt_pk_bf16_f32 v233, v234, v235
    v_cvt_pk_bf16_f32 v234, v8, v9
    v_cvt_pk_bf16_f32 v235, v10, v11
    v_accvgpr_write_b32 a168, v232
    v_accvgpr_write_b32 a169, v233
    v_accvgpr_write_b32 a170, v234
    v_accvgpr_write_b32 a171, v235
    v_accvgpr_read_b32 v12, a236
    v_accvgpr_read_b32 v13, a237
    v_accvgpr_read_b32 v14, a238
    v_accvgpr_read_b32 v15, a239
    v_pk_mul_f32 v[236:237], v[236:237], s[96:97] op_sel:[0,1] op_sel_hi:[1,1]
    v_pk_mul_f32 v[238:239], v[238:239], s[96:97] op_sel:[0,1] op_sel_hi:[1,1]
    v_pk_mul_f32 v[12:13], v[12:13], s[96:97] op_sel:[0,1] op_sel_hi:[1,1]
    v_pk_mul_f32 v[14:15], v[14:15], s[96:97] op_sel:[0,1] op_sel_hi:[1,1]
    v_cvt_pk_bf16_f32 v236, v236, v237
    v_cvt_pk_bf16_f32 v237, v238, v239
    v_cvt_pk_bf16_f32 v238, v12, v13
    v_cvt_pk_bf16_f32 v239, v14, v15
    v_accvgpr_write_b32 a172, v236
    v_accvgpr_write_b32 a173, v237
    v_accvgpr_write_b32 a174, v238
    v_accvgpr_write_b32 a175, v239
    v_accvgpr_read_b32 v0, a240
    v_accvgpr_read_b32 v1, a241
    v_accvgpr_read_b32 v2, a242
    v_accvgpr_read_b32 v3, a243
    v_pk_mul_f32 v[240:241], v[240:241], s[96:97] op_sel:[0,1] op_sel_hi:[1,1]
    v_pk_mul_f32 v[242:243], v[242:243], s[96:97] op_sel:[0,1] op_sel_hi:[1,1]
    v_pk_mul_f32 v[0:1], v[0:1], s[96:97] op_sel:[0,1] op_sel_hi:[1,1]
    v_pk_mul_f32 v[2:3], v[2:3], s[96:97] op_sel:[0,1] op_sel_hi:[1,1]
    v_cvt_pk_bf16_f32 v240, v240, v241
    v_cvt_pk_bf16_f32 v241, v242, v243
    v_cvt_pk_bf16_f32 v242, v0, v1
    v_cvt_pk_bf16_f32 v243, v2, v3
    v_accvgpr_write_b32 a176, v240
    v_accvgpr_write_b32 a177, v241
    v_accvgpr_write_b32 a178, v242
    v_accvgpr_write_b32 a179, v243
    v_accvgpr_read_b32 v4, a244
    v_accvgpr_read_b32 v5, a245
    v_accvgpr_read_b32 v6, a246
    v_accvgpr_read_b32 v7, a247
    v_pk_mul_f32 v[244:245], v[244:245], s[96:97] op_sel:[0,1] op_sel_hi:[1,1]
    v_pk_mul_f32 v[246:247], v[246:247], s[96:97] op_sel:[0,1] op_sel_hi:[1,1]
    v_pk_mul_f32 v[4:5], v[4:5], s[96:97] op_sel:[0,1] op_sel_hi:[1,1]
    v_pk_mul_f32 v[6:7], v[6:7], s[96:97] op_sel:[0,1] op_sel_hi:[1,1]
    v_cvt_pk_bf16_f32 v244, v244, v245
    v_cvt_pk_bf16_f32 v245, v246, v247
    v_cvt_pk_bf16_f32 v246, v4, v5
    v_cvt_pk_bf16_f32 v247, v6, v7
    v_accvgpr_write_b32 a180, v244
    v_accvgpr_write_b32 a181, v245
    v_accvgpr_write_b32 a182, v246
    v_accvgpr_write_b32 a183, v247
    v_accvgpr_read_b32 v8, a248
    v_accvgpr_read_b32 v9, a249
    v_accvgpr_read_b32 v10, a250
    v_accvgpr_read_b32 v11, a251
    v_pk_mul_f32 v[248:249], v[248:249], s[96:97] op_sel:[0,1] op_sel_hi:[1,1]
    v_pk_mul_f32 v[250:251], v[250:251], s[96:97] op_sel:[0,1] op_sel_hi:[1,1]
    v_pk_mul_f32 v[8:9], v[8:9], s[96:97] op_sel:[0,1] op_sel_hi:[1,1]
    v_pk_mul_f32 v[10:11], v[10:11], s[96:97] op_sel:[0,1] op_sel_hi:[1,1]
    v_cvt_pk_bf16_f32 v248, v248, v249
    v_cvt_pk_bf16_f32 v249, v250, v251
    v_cvt_pk_bf16_f32 v250, v8, v9
    v_cvt_pk_bf16_f32 v251, v10, v11
    v_accvgpr_write_b32 a184, v248
    v_accvgpr_write_b32 a185, v249
    v_accvgpr_write_b32 a186, v250
    v_accvgpr_write_b32 a187, v251
    v_accvgpr_read_b32 v12, a252
    v_accvgpr_read_b32 v13, a253
    v_accvgpr_read_b32 v14, a254
    v_accvgpr_read_b32 v15, a255
    v_pk_mul_f32 v[252:253], v[252:253], s[96:97] op_sel:[0,1] op_sel_hi:[1,1]
    v_pk_mul_f32 v[254:255], v[254:255], s[96:97] op_sel:[0,1] op_sel_hi:[1,1]
    v_pk_mul_f32 v[12:13], v[12:13], s[96:97] op_sel:[0,1] op_sel_hi:[1,1]
    v_pk_mul_f32 v[14:15], v[14:15], s[96:97] op_sel:[0,1] op_sel_hi:[1,1]
    v_cvt_pk_bf16_f32 v252, v252, v253
    v_cvt_pk_bf16_f32 v253, v254, v255
    v_cvt_pk_bf16_f32 v254, v12, v13
    v_cvt_pk_bf16_f32 v255, v14, v15
    v_accvgpr_write_b32 a188, v252
    v_accvgpr_write_b32 a189, v253
    v_accvgpr_write_b32 a190, v254
    v_accvgpr_write_b32 a191, v255
    s_cmp_eq_u32 s44, 0
    s_cbranch_scc1 L1_job2k
    v_lshrrev_b32 v162, 4, v155
    v_and_b32 v162, 7, v162
    v_lshlrev_b32 v162, 5, v162
    buffer_load_dword v160, v162, s[80:83], 0 offen sc0 sc1
    s_mov_b32 s96, 1
    s_sub_u32 s55, s45, 4
    s_waitcnt lgkmcnt(0)
    s_waitcnt vmcnt(32)
    s_barrier
    s_add_u32 s54, s54, 16384
    s_and_b32 s54, s54, 0xffff
    v_add_u32 v151, s54, v146
    v_add_u32 v152, s54, v147
    v_add_u32 v153, s54, v148
    v_add_u32 v154, s54, v149
    v_mfma_f32_16x16x32_bf16 v[192:195], a[32:35], a[64:67], 0
    ds_read_b128 a[0:3], v144 offset:0
    s_sub_u32 s57, s57, 1
    s_cbranch_scc1 L1_sw13
L1_swr13:
    v_mfma_f32_16x16x32_bf16 v[196:199], a[32:35], a[68:71], 0
    ds_read_b128 a[16:19], v145 offset:0
    s_mov_b32 m0, s52
    v_mfma_f32_16x16x32_bf16 v[200:203], a[32:35], a[72:75], 0
    ds_read_b128 a[4:7], v144 offset:2048
    s_add_u32 s52, s52, 16384
    v_mfma_f32_16x16x32_bf16 v[204:207], a[32:35], a[76:79], 0
    ds_read_b128 a[20:23], v145 offset:2048
    buffer_load_dwordx4 v132, s[12:15], s48 offen offset:0 sc1 lds
    v_mfma_f32_16x16x32_bf16 v[208:211], a[32:35], a[80:83], 0
    v_mfma_f32_16x16x32_bf16 v[212:215], a[32:35], a[84:87], 0
    ds_read_b128 a[8:11], v144 offset:4096
    buffer_load_dwordx4 v133, s[12:15], s48 offen offset:1024 sc1 lds
    v_mfma_f32_16x16x32_bf16 v[216:219], a[32:35], a[88:91], 0
    ds_read_b128 a[24:27], v145 offset:4096
    v_mfma_f32_16x16x32_bf16 v[220:223], a[32:35], a[92:95], 0
    ds_read_b128 a[12:15], v144 offset:6144
    buffer_load_dwordx4 v134, s[12:15], s48 offen offset:2048 sc1 lds
    v_mfma_f32_16x16x32_bf16 a[220:223], a[36:39], a[92:95], 0
    ds_read_b128 a[28:31], v145 offset:6144
    buffer_load_dwordx4 v135, s[12:15], s48 offen offset:3072 sc1 lds
    v_mfma_f32_16x16x32_bf16 a[216:219], a[36:39], a[88:91], 0
    v_mfma_f32_16x16x32_bf16 a[212:215], a[36:39], a[84:87], 0
    ds_read_b64_tr_b16 a[124:125], v154 offset:8192
    s_add_u32 s48, s48, s49
    v_mfma_f32_16x16x32_bf16 a[208:211], a[36:39], a[80:83], 0
    ds_read_b64_tr_b16 a[126:127], v154 offset:9216
    s_and_b32 s52, s52, 0xffff
    v_mfma_f32_16x16x32_bf16 a[204:207], a[36:39], a[76:79], 0
    ds_read_b64_tr_b16 a[120:121], v153 offset:8192
    s_add_u32 m0, s51, 8192
    v_mfma_f32_16x16x32_bf16 a[200:203], a[36:39], a[72:75], 0
    ds_read_b64_tr_b16 a[122:123], v153 offset:9216
    s_add_u32 s51, s51, 32768
    v_mfma_f32_16x16x32_bf16 a[196:199], a[36:39], a[68:71], 0
    buffer_load_dwordx4 v128, s[8:11], s47 offen offset:0 sc1 lds
    v_mfma_f32_16x16x32_bf16 a[192:195], a[36:39], a[64:67], 0
    ds_read_b64_tr_b16 a[116:117], v152 offset:8192
    v_mfma_f32_16x16x32_bf16 v[224:227], a[40:43], a[64:67], 0
    ds_read_b64_tr_b16 a[118:119], v152 offset:9216
    buffer_load_dwordx4 v129, s[8:11], s47 offen offset:1024 sc1 lds
    v_mfma_f32_16x16x32_bf16 v[228:231], a[40:43], a[68:71], 0
    ds_read_b64_tr_b16 a[112:113], v151 offset:8192
    buffer_load_dwordx4 v130, s[8:11], s47 offen offset:2048 sc1 lds
    v_mfma_f32_16x16x32_bf16 v[232:235], a[40:43], a[72:75], 0
    ds_read_b64_tr_b16 a[114:115], v151 offset:9216
    v_mfma_f32_16x16x32_bf16 v[236:239], a[40:43], a[76:79], 0
    buffer_load_dwordx4 v131, s[8:11], s47 offen offset:3072 sc1 lds
    v_mfma_f32_16x16x32_bf16 v[240:243], a[40:43], a[80:83], 0
    ds_read_b64_tr_b16 a[108:109], v154 offset:0
    v_mfma_f32_16x16x32_bf16 v[244:247], a[40:43], a[84:87], 0
    ds_read_b64_tr_b16 a[110:111], v154 offset:1024
    s_cmp_ge_u32 s51, s79
    v_mfma_f32_16x16x32_bf16 v[248:251], a[40:43], a[88:91], 0
    ds_read_b64_tr_b16 a[104:105], v153 offset:0
    s_cselect_b32 s51, s78, s51
    v_mfma_f32_16x16x32_bf16 v[252:255], a[40:43], a[92:95], 0
    ds_read_b64_tr_b16 a[106:107], v153 offset:1024
    buffer_load_dword v158, v157, s[84:87], s88 offen
    v_mfma_f32_16x16x32_bf16 a[252:255], a[44:47], a[92:95], 0
    s_add_u32 s88, s88, s89
    v_mfma_f32_16x16x32_bf16 a[248:251], a[44:47], a[88:91], 0
    ds_read_b64_tr_b16 a[100:101], v152 offset:0
    s_add_u32 s53, s53, 1
    v_mfma_f32_16x16x32_bf16 a[244:247], a[44:47], a[84:87], 0
    ds_read_b64_tr_b16 a[102:103], v152 offset:1024
    s_cmp_eq_u32 s53, 3
    v_mfma_f32_16x16x32_bf16 a[240:243], a[44:47], a[80:83], 0
    ds_read_b64_tr_b16 a[96:97], v151 offset:0
    s_cselect_b32 s53, 0, s53
    v_mfma_f32_16x16x32_bf16 a[236:239], a[44:47], a[76:79], 0
    ds_read_b64_tr_b16 a[98:99], v151 offset:1024
    s_cselect_b32 s93, -2, 1
    v_mfma_f32_16x16x32_bf16 a[232:235], a[44:47], a[72:75], 0
    s_lshl_b32 s93, s93, 15
    v_mfma_f32_16x16x32_bf16 a[228:231], a[44:47], a[68:71], 0
    v_add_u32 v144, s93, v144
    v_mfma_f32_16x16x32_bf16 a[224:227], a[44:47], a[64:67], 0
    s_waitcnt lgkmcnt(15)
    v_mfma_f32_16x16x32_bf16 v[28:31], a[0:3], a[92:95], 0
    s_waitcnt lgkmcnt(14)
    s_add_u32 s54, s54, 16384
    v_mfma_f32_16x16x32_bf16 v[28:31], a[16:19], a[124:127], v[28:31]
    buffer_store_dwordx4 v[168:171], v156, s[16:19], s98 offen offset:0 sc0 sc1
    v_mfma_f32_16x16x32_bf16 v[24:27], a[0:3], a[88:91], 0
    s_waitcnt lgkmcnt(12)
    s_and_b32 s54, s54, 0xffff
    v_mfma_f32_16x16x32_bf16 v[24:27], a[16:19], a[120:123], v[24:27]
    v_mfma_f32_16x16x32_bf16 v[20:23], a[0:3], a[84:87], 0
    s_waitcnt lgkmcnt(10)
    v_add_u32 v151, s54, v146
    v_mfma_f32_16x16x32_bf16 v[20:23], a[16:19], a[116:119], v[20:23]
    buffer_store_dwordx4 v[172:175], v156, s[16:19], s98 offen offset:1024 sc0 sc1
    v_mfma_f32_16x16x32_bf16 v[16:19], a[0:3], a[80:83], 0
    s_waitcnt lgkmcnt(8)
    v_add_u32 v152, s54, v147
    v_mfma_f32_16x16x32_bf16 v[16:19], a[16:19], a[112:115], v[16:19]
    s_add_u32 s98, s98, 8192
    v_mfma_f32_16x16x32_bf16 v[12:15], a[0:3], a[76:79], 0
    s_waitcnt lgkmcnt(6)
    v_add_u32 v153, s54, v148
    v_mfma_f32_16x16x32_bf16 v[12:15], a[16:19], a[108:111], v[12:15]
    buffer_store_dwordx4 v[176:179], v155, s[16:19], s98 offen offset:0 sc0 sc1
    v_mfma_f32_16x16x32_bf16 v[8:11], a[0:3], a[72:75], 0
    s_waitcnt lgkmcnt(4)
    v_add_u32 v154, s54, v149
    v_mfma_f32_16x16x32_bf16 v[8:11], a[16:19], a[104:107], v[8:11]
    v_mfma_f32_16x16x32_bf16 v[4:7], a[0:3], a[68:71], 0
    s_waitcnt lgkmcnt(2)
    v_mfma_f32_16x16x32_bf16 v[4:7], a[16:19], a[100:103], v[4:7]
    buffer_store_dwordx4 v[180:183], v155, s[16:19], s98 offen offset:1024 sc0 sc1
    v_mfma_f32_16x16x32_bf16 v[0:3], a[0:3], a[64:67], 0
    s_waitcnt lgkmcnt(0)
    v_mfma_f32_16x16x32_bf16 v[0:3], a[16:19], a[96:99], v[0:3]
    s_waitcnt vmcnt(33)
    s_barrier
    v_mfma_f32_16x16x32_bf16 v[32:35], a[20:23], a[96:99], 0
    ds_read_b128 a[32:35], v144 offset:8192
    s_mov_b32 m0, s52
    v_mfma_f32_16x16x32_bf16 v[32:35], a[4:7], a[64:67], v[32:35]
    s_add_u32 s52, s52, 16384
    v_mfma_f32_16x16x32_bf16 v[36:39], a[4:7], a[68:71], 0
    buffer_load_dwordx4 v132, s[12:15], s48 offen offset:0 sc1 lds
    v_mfma_f32_16x16x32_bf16 v[36:39], a[20:23], a[100:103], v[36:39]
    ds_read_b128 a[48:51], v145 offset:8192
    v_mfma_f32_16x16x32_bf16 v[40:43], a[20:23], a[104:107], 0
    v_mfma_f32_16x16x32_bf16 v[40:43], a[4:7], a[72:75], v[40:43]
    buffer_load_dwordx4 v133, s[12:15], s48 offen offset:1024 sc1 lds
    v_mfma_f32_16x16x32_bf16 v[44:47], a[4:7], a[76:79], 0
    ds_read_b128 a[36:39], v144 offset:10240
    v_mfma_f32_16x16x32_bf16 v[44:47], a[20:23], a[108:111], v[44:47]
    buffer_load_dwordx4 v134, s[12:15], s48 offen offset:2048 sc1 lds
    v_mfma_f32_16x16x32_bf16 v[48:51], a[20:23], a[112:115], 0
    v_mfma_f32_16x16x32_bf16 v[48:51], a[4:7], a[80:83], v[48:51]
    ds_read_b128 a[52:55], v145 offset:10240
    v_mfma_f32_16x16x32_bf16 v[52:55], a[4:7], a[84:87], 0
    buffer_load_dwordx4 v135, s[12:15], s48 offen offset:3072 sc1 lds
    v_mfma_f32_16x16x32_bf16 v[52:55], a[20:23], a[116:119], v[52:55]
    v_mfma_f32_16x16x32_bf16 v[56:59], a[20:23], a[120:123], 0
    s_add_u32 s48, s48, s49
    v_mfma_f32_16x16x32_bf16 v[56:59], a[4:7], a[88:91], v[56:59]
    ds_read_b128 a[40:43], v144 offset:12288
    v_mfma_f32_16x16x32_bf16 v[60:63], a[4:7], a[92:95], 0
    s_and_b32 s52, s52, 0xffff
    v_mfma_f32_16x16x32_bf16 v[60:63], a[20:23], a[124:127], v[60:63]
    s_sub_u32 s56, s56, 1
    v_mfma_f32_16x16x32_bf16 v[92:95], a[24:27], a[124:127], 0
    ds_read_b128 a[56:59], v145 offset:12288
    s_cbranch_scc1 L1_sw14
L1_swr14:
    v_mfma_f32_16x16x32_bf16 v[92:95], a[8:11], a[92:95], v[92:95]
    v_mfma_f32_16x16x32_bf16 v[88:91], a[8:11], a[88:91], 0
    s_mov_b32 m0, s51
    v_mfma_f32_16x16x32_bf16 v[88:91], a[24:27], a[120:123], v[88:91]
    ds_read_b128 a[44:47], v144 offset:14336
    s_add_u32 s47, s46, s50
    v_mfma_f32_16x16x32_bf16 v[84:87], a[24:27], a[116:119], 0
    buffer_load_dwordx4 v128, s[8:11], s46 offen offset:0 sc1 lds
    v_mfma_f32_16x16x32_bf16 v[84:87], a[8:11], a[84:87], v[84:87]
    v_mfma_f32_16x16x32_bf16 v[80:83], a[8:11], a[80:83], 0
    ds_read_b128 a[60:63], v145 offset:14336
    v_mfma_f32_16x16x32_bf16 v[80:83], a[24:27], a[112:115], v[80:83]
    buffer_load_dwordx4 v129, s[8:11], s46 offen offset:1024 sc1 lds
    v_mfma_f32_16x16x32_bf16 v[76:79], a[24:27], a[108:111], 0
    v_mfma_f32_16x16x32_bf16 v[76:79], a[8:11], a[76:79], v[76:79]
    buffer_load_dwordx4 v130, s[8:11], s46 offen offset:2048 sc1 lds
    v_mfma_f32_16x16x32_bf16 v[72:75], a[8:11], a[72:75], 0
    v_mfma_f32_16x16x32_bf16 v[72:75], a[24:27], a[104:107], v[72:75]
    v_mfma_f32_16x16x32_bf16 v[68:71], a[24:27], a[100:103], 0
    buffer_load_dwordx4 v131, s[8:11], s46 offen offset:3072 sc1 lds
    v_mfma_f32_16x16x32_bf16 v[68:71], a[8:11], a[68:71], v[68:71]
    v_mfma_f32_16x16x32_bf16 v[64:67], a[8:11], a[64:67], 0
    v_mfma_f32_16x16x32_bf16 v[64:67], a[24:27], a[96:99], v[64:67]
    s_add_u32 s46, s46, s68
    s_waitcnt lgkmcnt(0)
    v_mfma_f32_16x16x32_bf16 v[96:99], a[12:15], a[64:67], 0
    ds_read_b64_tr_b16 a[64:65], v151 offset:0
    v_mfma_f32_16x16x32_bf16 v[96:99], a[28:31], a[96:99], v[96:99]
    ds_read_b64_tr_b16 a[66:67], v151 offset:1024
    v_mfma_f32_16x16x32_bf16 v[100:103], a[12:15], a[68:71], 0
    ds_read_b64_tr_b16 a[68:69], v152 offset:0
    v_mfma_f32_16x16x32_bf16 v[100:103], a[28:31], a[100:103], v[100:103]
    ds_read_b64_tr_b16 a[70:71], v152 offset:1024
    v_mfma_f32_16x16x32_bf16 v[104:107], a[12:15], a[72:75], 0
    ds_read_b64_tr_b16 a[72:73], v153 offset:0
    v_mfma_f32_16x16x32_bf16 v[104:107], a[28:31], a[104:107], v[104:107]
    ds_read_b64_tr_b16 a[74:75], v153 offset:1024
    v_mfma_f32_16x16x32_bf16 v[108:111], a[12:15], a[76:79], 0
    ds_read_b64_tr_b16 a[76:77], v154 offset:0
    v_mfma_f32_16x16x32_bf16 v[108:111], a[28:31], a[108:111], v[108:111]
    ds_read_b64_tr_b16 a[78:79], v154 offset:1024
    v_add_u32 v145, s93, v145
    v_mfma_f32_16x16x32_bf16 v[112:115], a[12:15], a[80:83], 0
    ds_read_b64_tr_b16 a[80:81], v151 offset:8192
    v_mfma_f32_16x16x32_bf16 v[112:115], a[28:31], a[112:115], v[112:115]
    ds_read_b64_tr_b16 a[82:83], v151 offset:9216
    v_mfma_f32_16x16x32_bf16 v[116:119], a[12:15], a[84:87], 0
    ds_read_b64_tr_b16 a[84:85], v152 offset:8192
    v_mfma_f32_16x16x32_bf16 v[116:119], a[28:31], a[116:119], v[116:119]
    ds_read_b64_tr_b16 a[86:87], v152 offset:9216
    v_mfma_f32_16x16x32_bf16 v[120:123], a[12:15], a[88:91], 0
    ds_read_b64_tr_b16 a[88:89], v153 offset:8192
    v_mfma_f32_16x16x32_bf16 v[120:123], a[28:31], a[120:123], v[120:123]
    ds_read_b64_tr_b16 a[90:91], v153 offset:9216
    v_mfma_f32_16x16x32_bf16 v[124:127], a[12:15], a[92:95], 0
    ds_read_b64_tr_b16 a[92:93], v154 offset:8192
    v_mfma_f32_16x16x32_bf16 v[124:127], a[28:31], a[124:127], v[124:127]
    ds_read_b64_tr_b16 a[94:95], v154 offset:9216
    v_mfma_f32_16x16x32_bf16 v[192:195], a[48:51], a[96:99], v[192:195]
    s_waitcnt lgkmcnt(14)
    s_add_u32 s54, s54, 16384
    v_mfma_f32_16x16x32_bf16 v[192:195], a[32:35], a[64:67], v[192:195]
    buffer_store_dwordx4 v[184:187], v156, s[16:19], s98 offen offset:0 sc0 sc1
    v_mfma_f32_16x16x32_bf16 v[196:199], a[48:51], a[100:103], v[196:199]
    s_waitcnt lgkmcnt(12)
    s_and_b32 s54, s54, 0xffff
    v_mfma_f32_16x16x32_bf16 v[196:199], a[32:35], a[68:71], v[196:199]
    v_mfma_f32_16x16x32_bf16 v[200:203], a[48:51], a[104:107], v[200:203]
    s_waitcnt lgkmcnt(10)
    v_add_u32 v151, s54, v146
    v_mfma_f32_16x16x32_bf16 v[200:203], a[32:35], a[72:75], v[200:203]
    buffer_store_dwordx4 v[188:191], v156, s[16:19], s98 offen offset:1024 sc0 sc1
    v_mfma_f32_16x16x32_bf16 v[204:207], a[48:51], a[108:111], v[204:207]
    s_waitcnt lgkmcnt(8)
    v_add_u32 v152, s54, v147
    v_mfma_f32_16x16x32_bf16 v[204:207], a[32:35], a[76:79], v[204:207]
    s_add_u32 s98, s98, 8192
    v_mfma_f32_16x16x32_bf16 v[208:211], a[48:51], a[112:115], v[208:211]
    s_waitcnt lgkmcnt(6)
    v_add_u32 v153, s54, v148
    v_mfma_f32_16x16x32_bf16 v[208:211], a[32:35], a[80:83], v[208:211]
    buffer_store_dwordx4 a[128:131], v155, s[16:19], s98 offen offset:0 sc0 sc1
    v_mfma_f32_16x16x32_bf16 v[212:215], a[48:51], a[116:119], v[212:215]
    s_waitcnt lgkmcnt(4)
    v_add_u32 v154, s54, v149
    v_mfma_f32_16x16x32_bf16 v[212:215], a[32:35], a[84:87], v[212:215]
    v_mfma_f32_16x16x32_bf16 v[216:219], a[48:51], a[120:123], v[216:219]
    s_waitcnt lgkmcnt(2)
    v_mfma_f32_16x16x32_bf16 v[216:219], a[32:35], a[88:91], v[216:219]
    buffer_store_dwordx4 a[132:135], v155, s[16:19], s98 offen offset:1024 sc0 sc1
    v_mfma_f32_16x16x32_bf16 v[220:223], a[48:51], a[124:127], v[220:223]
    s_waitcnt lgkmcnt(0)
    v_mfma_f32_16x16x32_bf16 v[220:223], a[32:35], a[92:95], v[220:223]
    s_waitcnt vmcnt(40)
    s_barrier
    v_mfma_f32_16x16x32_bf16 a[220:223], a[36:39], a[92:95], a[220:223]
    ds_read_b128 a[0:3], v144 offset:0
    s_sub_u32 s57, s57, 1
    v_mfma_f32_16x16x32_bf16 a[220:223], a[52:55], a[124:127], a[220:223]
    s_cbranch_scc1 L1_sw15
L1_swr15:
    v_mfma_f32_16x16x32_bf16 a[216:219], a[52:55], a[120:123], a[216:219]
    s_mov_b32 m0, s52
    v_mfma_f32_16x16x32_bf16 a[216:219], a[36:39], a[88:91], a[216:219]
    ds_read_b128 a[16:19], v145 offset:0
    s_add_u32 s52, s52, 16384
    v_mfma_f32_16x16x32_bf16 a[212:215], a[36:39], a[84:87], a[212:215]
    buffer_load_dwordx4 v132, s[12:15], s48 offen offset:0 sc1 lds
    v_mfma_f32_16x16x32_bf16 a[212:215], a[52:55], a[116:119], a[212:215]
    v_mfma_f32_16x16x32_bf16 a[208:211], a[52:55], a[112:115], a[208:211]
    ds_read_b128 a[4:7], v144 offset:2048
    v_mfma_f32_16x16x32_bf16 a[208:211], a[36:39], a[80:83], a[208:211]
    buffer_load_dwordx4 v133, s[12:15], s48 offen offset:1024 sc1 lds
    v_mfma_f32_16x16x32_bf16 a[204:207], a[36:39], a[76:79], a[204:207]
    buffer_load_dwordx4 v134, s[12:15], s48 offen offset:2048 sc1 lds
    v_mfma_f32_16x16x32_bf16 a[204:207], a[52:55], a[108:111], a[204:207]
    ds_read_b128 a[20:23], v145 offset:2048
    v_mfma_f32_16x16x32_bf16 a[200:203], a[52:55], a[104:107], a[200:203]
    v_mfma_f32_16x16x32_bf16 a[200:203], a[36:39], a[72:75], a[200:203]
    buffer_load_dwordx4 v135, s[12:15], s48 offen offset:3072 sc1 lds
    v_mfma_f32_16x16x32_bf16 a[196:199], a[36:39], a[68:71], a[196:199]
    v_mfma_f32_16x16x32_bf16 a[196:199], a[52:55], a[100:103], a[196:199]
    ds_read_b128 a[8:11], v144 offset:4096
    s_add_u32 s48, s48, s49
    v_mfma_f32_16x16x32_bf16 a[192:195], a[52:55], a[96:99], a[192:195]
    s_and_b32 s52, s52, 0xffff
    v_mfma_f32_16x16x32_bf16 a[192:195], a[36:39], a[64:67], a[192:195]
    s_add_u32 m0, s51, 8192
    v_mfma_f32_16x16x32_bf16 v[224:227], a[40:43], a[64:67], v[224:227]
    ds_read_b128 a[24:27], v145 offset:4096
    s_add_u32 s51, s51, 32768
    v_mfma_f32_16x16x32_bf16 v[224:227], a[56:59], a[96:99], v[224:227]
    buffer_load_dwordx4 v128, s[8:11], s47 offen offset:0 sc1 lds
    v_mfma_f32_16x16x32_bf16 v[228:231], a[56:59], a[100:103], v[228:231]
    v_mfma_f32_16x16x32_bf16 v[228:231], a[40:43], a[68:71], v[228:231]
    ds_read_b128 a[12:15], v144 offset:6144
    v_mfma_f32_16x16x32_bf16 v[232:235], a[40:43], a[72:75], v[232:235]
    buffer_load_dwordx4 v129, s[8:11], s47 offen offset:1024 sc1 lds
    v_mfma_f32_16x16x32_bf16 v[232:235], a[56:59], a[104:107], v[232:235]
    v_mfma_f32_16x16x32_bf16 v[236:239], a[56:59], a[108:111], v[236:239]
    ds_read_b128 a[28:31], v145 offset:6144
    v_mfma_f32_16x16x32_bf16 v[236:239], a[40:43], a[76:79], v[236:239]
    buffer_load_dwordx4 v130, s[8:11], s47 offen offset:2048 sc1 lds
    v_mfma_f32_16x16x32_bf16 v[240:243], a[40:43], a[80:83], v[240:243]
    buffer_load_dwordx4 v131, s[8:11], s47 offen offset:3072 sc1 lds
    v_mfma_f32_16x16x32_bf16 v[240:243], a[56:59], a[112:115], v[240:243]
    v_mfma_f32_16x16x32_bf16 v[244:247], a[56:59], a[116:119], v[244:247]
    s_cmp_ge_u32 s51, s79
    v_mfma_f32_16x16x32_bf16 v[244:247], a[40:43], a[84:87], v[244:247]
    s_cselect_b32 s51, s78, s51
    v_mfma_f32_16x16x32_bf16 v[248:251], a[40:43], a[88:91], v[248:251]
    buffer_load_dword v158, v157, s[84:87], s88 offen
    v_mfma_f32_16x16x32_bf16 v[248:251], a[56:59], a[120:123], v[248:251]
    v_mfma_f32_16x16x32_bf16 v[252:255], a[56:59], a[124:127], v[252:255]
    v_mfma_f32_16x16x32_bf16 v[252:255], a[40:43], a[92:95], v[252:255]
    s_add_u32 s88, s88, s89
    s_waitcnt lgkmcnt(0)
    v_mfma_f32_16x16x32_bf16 a[252:255], a[60:63], a[124:127], a[252:255]
    ds_read_b64_tr_b16 a[124:125], v154 offset:8192
    v_mfma_f32_16x16x32_bf16 a[252:255], a[44:47], a[92:95], a[252:255]
    ds_read_b64_tr_b16 a[126:127], v154 offset:9216
    s_add_u32 s53, s53, 1
    v_mfma_f32_16x16x32_bf16 a[248:251], a[60:63], a[120:123], a[248:251]
    ds_read_b64_tr_b16 a[120:121], v153 offset:8192
    v_mfma_f32_16x16x32_bf16 a[248:251], a[44:47], a[88:91], a[248:251]
    ds_read_b64_tr_b16 a[122:123], v153 offset:9216
    s_cmp_eq_u32 s53, 3
    v_mfma_f32_16x16x32_bf16 a[244:247], a[60:63], a[116:119], a[244:247]
    ds_read_b64_tr_b16 a[116:117], v152 offset:8192
    v_mfma_f32_16x16x32_bf16 a[244:247], a[44:47], a[84:87], a[244:247]
    ds_read_b64_tr_b16 a[118:119], v152 offset:9216
    s_cselect_b32 s53, 0, s53
    v_mfma_f32_16x16x32_bf16 a[240:243], a[60:63], a[112:115], a[240:243]
    ds_read_b64_tr_b16 a[112:113], v151 offset:8192
    v_mfma_f32_16x16x32_bf16 a[240:243], a[44:47], a[80:83], a[240:243]
    ds_read_b64_tr_b16 a[114:115], v151 offset:9216
    v_mfma_f32_16x16x32_bf16 a[236:239], a[60:63], a[108:111], a[236:239]
    ds_read_b64_tr_b16 a[108:109], v154 offset:0
    s_cselect_b32 s93, -2, 1
    v_mfma_f32_16x16x32_bf16 a[236:239], a[44:47], a[76:79], a[236:239]
    ds_read_b64_tr_b16 a[110:111], v154 offset:1024
    v_mfma_f32_16x16x32_bf16 a[232:235], a[60:63], a[104:107], a[232:235]
    ds_read_b64_tr_b16 a[104:105], v153 offset:0
    s_lshl_b32 s93, s93, 15
    v_mfma_f32_16x16x32_bf16 a[232:235], a[44:47], a[72:75], a[232:235]
    ds_read_b64_tr_b16 a[106:107], v153 offset:1024
    v_mfma_f32_16x16x32_bf16 a[228:231], a[60:63], a[100:103], a[228:231]
    ds_read_b64_tr_b16 a[100:101], v152 offset:0
    v_add_u32 v144, s93, v144
    v_mfma_f32_16x16x32_bf16 a[228:231], a[44:47], a[68:71], a[228:231]
    ds_read_b64_tr_b16 a[102:103], v152 offset:1024
    v_mfma_f32_16x16x32_bf16 a[224:227], a[60:63], a[96:99], a[224:227]
    ds_read_b64_tr_b16 a[96:97], v151 offset:0
    v_mfma_f32_16x16x32_bf16 a[224:227], a[44:47], a[64:67], a[224:227]
    ds_read_b64_tr_b16 a[98:99], v151 offset:1024
    v_mfma_f32_16x16x32_bf16 v[28:31], a[0:3], a[92:95], v[28:31]
    s_waitcnt lgkmcnt(14)
    s_add_u32 s54, s54, 16384
    v_mfma_f32_16x16x32_bf16 v[28:31], a[16:19], a[124:127], v[28:31]
    buffer_store_dwordx4 a[136:139], v156, s[16:19], s98 offen offset:0 sc0 sc1
    v_mfma_f32_16x16x32_bf16 v[24:27], a[0:3], a[88:91], v[24:27]
    s_waitcnt lgkmcnt(12)
    s_and_b32 s54, s54, 0xffff
    v_mfma_f32_16x16x32_bf16 v[24:27], a[16:19], a[120:123], v[24:27]
    v_mfma_f32_16x16x32_bf16 v[20:23], a[0:3], a[84:87], v[20:23]
    s_waitcnt lgkmcnt(10)
    v_add_u32 v151, s54, v146
    v_mfma_f32_16x16x32_bf16 v[20:23], a[16:19], a[116:119], v[20:23]
    buffer_store_dwordx4 a[140:143], v156, s[16:19], s98 offen offset:1024 sc0 sc1
    v_mfma_f32_16x16x32_bf16 v[16:19], a[0:3], a[80:83], v[16:19]
    s_waitcnt lgkmcnt(8)
    v_add_u32 v152, s54, v147
    v_mfma_f32_16x16x32_bf16 v[16:19], a[16:19], a[112:115], v[16:19]
    s_add_u32 s98, s98, 8192
    v_mfma_f32_16x16x32_bf16 v[12:15], a[0:3], a[76:79], v[12:15]
    s_waitcnt lgkmcnt(6)
    v_add_u32 v153, s54, v148
    v_mfma_f32_16x16x32_bf16 v[12:15], a[16:19], a[108:111], v[12:15]
    buffer_store_dwordx4 a[144:147], v155, s[16:19], s98 offen offset:0 sc0 sc1
    v_mfma_f32_16x16x32_bf16 v[8:11], a[0:3], a[72:75], v[8:11]
    s_waitcnt lgkmcnt(4)
    v_add_u32 v154, s54, v149
    v_mfma_f32_16x16x32_bf16 v[8:11], a[16:19], a[104:107], v[8:11]
    v_mfma_f32_16x16x32_bf16 v[4:7], a[0:3], a[68:71], v[4:7]
    s_waitcnt lgkmcnt(2)
    v_mfma_f32_16x16x32_bf16 v[4:7], a[16:19], a[100:103], v[4:7]
    buffer_store_dwordx4 a[148:151], v155, s[16:19], s98 offen offset:1024 sc0 sc1
    v_mfma_f32_16x16x32_bf16 v[0:3], a[0:3], a[64:67], v[0:3]
    s_waitcnt lgkmcnt(0)
    v_mfma_f32_16x16x32_bf16 v[0:3], a[16:19], a[96:99], v[0:3]
    s_waitcnt vmcnt(30)
    s_barrier
    v_mfma_f32_16x16x32_bf16 v[32:35], a[20:23], a[96:99], v[32:35]
    ds_read_b128 a[32:35], v144 offset:8192
    s_mov_b32 m0, s52
    v_mfma_f32_16x16x32_bf16 v[32:35], a[4:7], a[64:67], v[32:35]
    s_add_u32 s52, s52, 16384
    v_mfma_f32_16x16x32_bf16 v[36:39], a[4:7], a[68:71], v[36:39]
    buffer_load_dwordx4 v132, s[12:15], s48 offen offset:0 sc1 lds
    v_mfma_f32_16x16x32_bf16 v[36:39], a[20:23], a[100:103], v[36:39]
    ds_read_b128 a[48:51], v145 offset:8192
    v_mfma_f32_16x16x32_bf16 v[40:43], a[20:23], a[104:107], v[40:43]
    v_mfma_f32_16x16x32_bf16 v[40:43], a[4:7], a[72:75], v[40:43]
    buffer_load_dwordx4 v133, s[12:15], s48 offen offset:1024 sc1 lds
    v_mfma_f32_16x16x32_bf16 v[44:47], a[4:7], a[76:79], v[44:47]
    ds_read_b128 a[36:39], v144 offset:10240
    v_mfma_f32_16x16x32_bf16 v[44:47], a[20:23], a[108:111], v[44:47]
    buffer_load_dwordx4 v134, s[12:15], s48 offen offset:2048 sc1 lds
    v_mfma_f32_16x16x32_bf16 v[48:51], a[20:23], a[112:115], v[48:51]
    v_mfma_f32_16x16x32_bf16 v[48:51], a[4:7], a[80:83], v[48:51]
    ds_read_b128 a[52:55], v145 offset:10240
    v_mfma_f32_16x16x32_bf16 v[52:55], a[4:7], a[84:87], v[52:55]
    buffer_load_dwordx4 v135, s[12:15], s48 offen offset:3072 sc1 lds
    v_mfma_f32_16x16x32_bf16 v[52:55], a[20:23], a[116:119], v[52:55]
    v_mfma_f32_16x16x32_bf16 v[56:59], a[20:23], a[120:123], v[56:59]
    s_add_u32 s48, s48, s49
    v_mfma_f32_16x16x32_bf16 v[56:59], a[4:7], a[88:91], v[56:59]
    ds_read_b128 a[40:43], v144 offset:12288
    v_mfma_f32_16x16x32_bf16 v[60:63], a[4:7], a[92:95], v[60:63]
    s_and_b32 s52, s52, 0xffff
    v_mfma_f32_16x16x32_bf16 v[60:63], a[20:23], a[124:127], v[60:63]
    s_sub_u32 s56, s56, 1
    v_mfma_f32_16x16x32_bf16 v[92:95], a[24:27], a[124:127], v[92:95]
    ds_read_b128 a[56:59], v145 offset:12288
    s_cbranch_scc1 L1_sw16
L1_swr16:
    v_mfma_f32_16x16x32_bf16 v[92:95], a[8:11], a[92:95], v[92:95]
    v_mfma_f32_16x16x32_bf16 v[88:91], a[8:11], a[88:91], v[88:91]
    s_mov_b32 m0, s51
    v_mfma_f32_16x16x32_bf16 v[88:91], a[24:27], a[120:123], v[88:91]
    ds_read_b128 a[44:47], v144 offset:14336
    s_add_u32 s47, s46, s50
    v_mfma_f32_16x16x32_bf16 v[84:87], a[24:27], a[116:119], v[84:87]
    buffer_load_dwordx4 v128, s[8:11], s46 offen offset:0 sc1 lds
    v_mfma_f32_16x16x32_bf16 v[84:87], a[8:11], a[84:87], v[84:87]
    v_mfma_f32_16x16x32_bf16 v[80:83], a[8:11], a[80:83], v[80:83]
    ds_read_b128 a[60:63], v145 offset:14336
    v_mfma_f32_16x16x32_bf16 v[80:83], a[24:27], a[112:115], v[80:83]
    buffer_load_dwordx4 v129, s[8:11], s46 offen offset:1024 sc1 lds
    v_mfma_f32_16x16x32_bf16 v[76:79], a[24:27], a[108:111], v[76:79]
    v_mfma_f32_16x16x32_bf16 v[76:79], a[8:11], a[76:79], v[76:79]
    buffer_load_dwordx4 v130, s[8:11], s46 offen offset:2048 sc1 lds
    v_mfma_f32_16x16x32_bf16 v[72:75], a[8:11], a[72:75], v[72:75]
    v_mfma_f32_16x16x32_bf16 v[72:75], a[24:27], a[104:107], v[72:75]
    v_mfma_f32_16x16x32_bf16 v[68:71], a[24:27], a[100:103], v[68:71]
    buffer_load_dwordx4 v131, s[8:11], s46 offen offset:3072 sc1 lds
    v_mfma_f32_16x16x32_bf16 v[68:71], a[8:11], a[68:71], v[68:71]
    v_mfma_f32_16x16x32_bf16 v[64:67], a[8:11], a[64:67], v[64:67]
    v_mfma_f32_16x16x32_bf16 v[64:67], a[24:27], a[96:99], v[64:67]
    s_add_u32 s46, s46, s68
    s_waitcnt lgkmcnt(0)
    v_mfma_f32_16x16x32_bf16 v[96:99], a[12:15], a[64:67], v[96:99]
    ds_read_b64_tr_b16 a[64:65], v151 offset:0
    v_mfma_f32_16x16x32_bf16 v[96:99], a[28:31], a[96:99], v[96:99]
    ds_read_b64_tr_b16 a[66:67], v151 offset:1024
    v_mfma_f32_16x16x32_bf16 v[100:103], a[12:15], a[68:71], v[100:103]
    ds_read_b64_tr_b16 a[68:69], v152 offset:0
    v_mfma_f32_16x16x32_bf16 v[100:103], a[28:31], a[100:103], v[100:103]
    ds_read_b64_tr_b16 a[70:71], v152 offset:1024
    v_mfma_f32_16x16x32_bf16 v[104:107], a[12:15], a[72:75], v[104:107]
    ds_read_b64_tr_b16 a[72:73], v153 offset:0
    v_mfma_f32_16x16x32_bf16 v[104:107], a[28:31], a[104:107], v[104:107]
    ds_read_b64_tr_b16 a[74:75], v153 offset:1024
    v_mfma_f32_16x16x32_bf16 v[108:111], a[12:15], a[76:79], v[108:111]
    ds_read_b64_tr_b16 a[76:77], v154 offset:0
    v_mfma_f32_16x16x32_bf16 v[108:111], a[28:31], a[108:111], v[108:111]
    ds_read_b64_tr_b16 a[78:79], v154 offset:1024
    v_add_u32 v145, s93, v145
    v_mfma_f32_16x16x32_bf16 v[112:115], a[12:15], a[80:83], v[112:115]
    ds_read_b64_tr_b16 a[80:81], v151 offset:8192
    v_mfma_f32_16x16x32_bf16 v[112:115], a[28:31], a[112:115], v[112:115]
    ds_read_b64_tr_b16 a[82:83], v151 offset:9216
    v_mfma_f32_16x16x32_bf16 v[116:119], a[12:15], a[84:87], v[116:119]
    ds_read_b64_tr_b16 a[84:85], v152 offset:8192
    v_mfma_f32_16x16x32_bf16 v[116:119], a[28:31], a[116:119], v[116:119]
    ds_read_b64_tr_b16 a[86:87], v152 offset:9216
    v_mfma_f32_16x16x32_bf16 v[120:123], a[12:15], a[88:91], v[120:123]
    ds_read_b64_tr_b16 a[88:89], v153 offset:8192
    v_mfma_f32_16x16x32_bf16 v[120:123], a[28:31], a[120:123], v[120:123]
    ds_read_b64_tr_b16 a[90:91], v153 offset:9216
    v_mfma_f32_16x16x32_bf16 v[124:127], a[12:15], a[92:95], v[124:127]
    ds_read_b64_tr_b16 a[92:93], v154 offset:8192
    v_mfma_f32_16x16x32_bf16 v[124:127], a[28:31], a[124:127], v[124:127]
    ds_read_b64_tr_b16 a[94:95], v154 offset:9216
    v_mfma_f32_16x16x32_bf16 v[192:195], a[48:51], a[96:99], v[192:195]
    s_waitcnt lgkmcnt(14)
    s_add_u32 s54, s54, 16384
    v_mfma_f32_16x16x32_bf16 v[192:195], a[32:35], a[64:67], v[192:195]
    buffer_store_dwordx4 a[152:155], v156, s[16:19], s98 offen offset:0 sc0 sc1
    v_mfma_f32_16x16x32_bf16 v[196:199], a[48:51], a[100:103], v[196:199]
    s_waitcnt lgkmcnt(12)
    s_and_b32 s54, s54, 0xffff
    v_mfma_f32_16x16x32_bf16 v[196:199], a[32:35], a[68:71], v[196:199]
    v_mfma_f32_16x16x32_bf16 v[200:203], a[48:51], a[104:107], v[200:203]
    s_waitcnt lgkmcnt(10)
    v_add_u32 v151, s54, v146
    v_mfma_f32_16x16x32_bf16 v[200:203], a[32:35], a[72:75], v[200:203]
    buffer_store_dwordx4 a[156:159], v156, s[16:19], s98 offen offset:1024 sc0 sc1
    v_mfma_f32_16x16x32_bf16 v[204:207], a[48:51], a[108:111], v[204:207]
    s_waitcnt lgkmcnt(8)
    v_add_u32 v152, s54, v147
    v_mfma_f32_16x16x32_bf16 v[204:207], a[32:35], a[76:79], v[204:207]
    s_add_u32 s98, s98, 8192
    v_mfma_f32_16x16x32_bf16 v[208:211], a[48:51], a[112:115], v[208:211]
    s_waitcnt lgkmcnt(6)
    v_add_u32 v153, s54, v148
    v_mfma_f32_16x16x32_bf16 v[208:211], a[32:35], a[80:83], v[208:211]
    buffer_store_dwordx4 a[160:163], v155, s[16:19], s98 offen offset:0 sc0 sc1
    v_mfma_f32_16x16x32_bf16 v[212:215], a[48:51], a[116:119], v[212:215]
    s_waitcnt lgkmcnt(4)
    v_add_u32 v154, s54, v149
    v_mfma_f32_16x16x32_bf16 v[212:215], a[32:35], a[84:87], v[212:215]
    v_mfma_f32_16x16x32_bf16 v[216:219], a[48:51], a[120:123], v[216:219]
    s_waitcnt lgkmcnt(2)
    v_mfma_f32_16x16x32_bf16 v[216:219], a[32:35], a[88:91], v[216:219]
    buffer_store_dwordx4 a[164:167], v155, s[16:19], s98 offen offset:1024 sc0 sc1
    v_mfma_f32_16x16x32_bf16 v[220:223], a[48:51], a[124:127], v[220:223]
    s_waitcnt lgkmcnt(0)
    v_mfma_f32_16x16x32_bf16 v[220:223], a[32:35], a[92:95], v[220:223]
    s_waitcnt vmcnt(33)
    s_barrier
    v_mfma_f32_16x16x32_bf16 a[220:223], a[36:39], a[92:95], a[220:223]
    ds_read_b128 a[0:3], v144 offset:0
    s_sub_u32 s57, s57, 1
    v_mfma_f32_16x16x32_bf16 a[220:223], a[52:55], a[124:127], a[220:223]
    s_cbranch_scc1 L1_sw17
L1_swr17:
    v_mfma_f32_16x16x32_bf16 a[216:219], a[52:55], a[120:123], a[216:219]
    s_mov_b32 m0, s52
    v_mfma_f32_16x16x32_bf16 a[216:219], a[36:39], a[88:91], a[216:219]
    ds_read_b128 a[16:19], v145 offset:0
    s_add_u32 s52, s52, 16384
    v_mfma_f32_16x16x32_bf16 a[212:215], a[36:39], a[84:87], a[212:215]
    buffer_load_dwordx4 v132, s[12:15], s48 offen offset:0 sc1 lds
    v_mfma_f32_16x16x32_bf16 a[212:215], a[52:55], a[116:119], a[212:215]
    v_mfma_f32_16x16x32_bf16 a[208:211], a[52:55], a[112:115], a[208:211]
    ds_read_b128 a[4:7], v144 offset:2048
    v_mfma_f32_16x16x32_bf16 a[208:211], a[36:39], a[80:83], a[208:211]
    buffer_load_dwordx4 v133, s[12:15], s48 offen offset:1024 sc1 lds
    v_mfma_f32_16x16x32_bf16 a[204:207], a[36:39], a[76:79], a[204:207]
    buffer_load_dwordx4 v134, s[12:15], s48 offen offset:2048 sc1 lds
    v_mfma_f32_16x16x32_bf16 a[204:207], a[52:55], a[108:111], a[204:207]
    ds_read_b128 a[20:23], v145 offset:2048
    v_mfma_f32_16x16x32_bf16 a[200:203], a[52:55], a[104:107], a[200:203]
    v_mfma_f32_16x16x32_bf16 a[200:203], a[36:39], a[72:75], a[200:203]
    buffer_load_dwordx4 v135, s[12:15], s48 offen offset:3072 sc1 lds
    v_mfma_f32_16x16x32_bf16 a[196:199], a[36:39], a[68:71], a[196:199]
    v_mfma_f32_16x16x32_bf16 a[196:199], a[52:55], a[100:103], a[196:199]
    ds_read_b128 a[8:11], v144 offset:4096
    s_add_u32 s48, s48, s49
    v_mfma_f32_16x16x32_bf16 a[192:195], a[52:55], a[96:99], a[192:195]
    s_and_b32 s52, s52, 0xffff
    v_mfma_f32_16x16x32_bf16 a[192:195], a[36:39], a[64:67], a[192:195]
    s_add_u32 m0, s51, 8192
    v_mfma_f32_16x16x32_bf16 v[224:227], a[40:43], a[64:67], v[224:227]
    ds_read_b128 a[24:27], v145 offset:4096
    s_add_u32 s51, s51, 32768
    v_mfma_f32_16x16x32_bf16 v[224:227], a[56:59], a[96:99], v[224:227]
    buffer_load_dwordx4 v128, s[8:11], s47 offen offset:0 sc1 lds
    v_mfma_f32_16x16x32_bf16 v[228:231], a[56:59], a[100:103], v[228:231]
    v_mfma_f32_16x16x32_bf16 v[228:231], a[40:43], a[68:71], v[228:231]
    ds_read_b128 a[12:15], v144 offset:6144
    v_mfma_f32_16x16x32_bf16 v[232:235], a[40:43], a[72:75], v[232:235]
    buffer_load_dwordx4 v129, s[8:11], s47 offen offset:1024 sc1 lds
    v_mfma_f32_16x16x32_bf16 v[232:235], a[56:59], a[104:107], v[232:235]
    v_mfma_f32_16x16x32_bf16 v[236:239], a[56:59], a[108:111], v[236:239]
    ds_read_b128 a[28:31], v145 offset:6144
    v_mfma_f32_16x16x32_bf16 v[236:239], a[40:43], a[76:79], v[236:239]
    buffer_load_dwordx4 v130, s[8:11], s47 offen offset:2048 sc1 lds
    v_mfma_f32_16x16x32_bf16 v[240:243], a[40:43], a[80:83], v[240:243]
    buffer_load_dwordx4 v131, s[8:11], s47 offen offset:3072 sc1 lds
    v_mfma_f32_16x16x32_bf16 v[240:243], a[56:59], a[112:115], v[240:243]
    v_mfma_f32_16x16x32_bf16 v[244:247], a[56:59], a[116:119], v[244:247]
    s_cmp_ge_u32 s51, s79
    v_mfma_f32_16x16x32_bf16 v[244:247], a[40:43], a[84:87], v[244:247]
    s_cselect_b32 s51, s78, s51
    v_mfma_f32_16x16x32_bf16 v[248:251], a[40:43], a[88:91], v[248:251]
    buffer_load_dword v158, v157, s[84:87], s88 offen
    v_mfma_f32_16x16x32_bf16 v[248:251], a[56:59], a[120:123], v[248:251]
    v_mfma_f32_16x16x32_bf16 v[252:255], a[56:59], a[124:127], v[252:255]
    v_mfma_f32_16x16x32_bf16 v[252:255], a[40:43], a[92:95], v[252:255]
    s_add_u32 s88, s88, s89
    s_waitcnt lgkmcnt(0)
    v_mfma_f32_16x16x32_bf16 a[252:255], a[60:63], a[124:127], a[252:255]
    ds_read_b64_tr_b16 a[124:125], v154 offset:8192
    v_mfma_f32_16x16x32_bf16 a[252:255], a[44:47], a[92:95], a[252:255]
    ds_read_b64_tr_b16 a[126:127], v154 offset:9216
    s_add_u32 s53, s53, 1
    v_mfma_f32_16x16x32_bf16 a[248:251], a[60:63], a[120:123], a[248:251]
    ds_read_b64_tr_b16 a[120:121], v153 offset:8192
    v_mfma_f32_16x16x32_bf16 a[248:251], a[44:47], a[88:91], a[248:251]
    ds_read_b64_tr_b16 a[122:123], v153 offset:9216
    s_cmp_eq_u32 s53, 3
    v_mfma_f32_16x16x32_bf16 a[244:247], a[60:63], a[116:119], a[244:247]
    ds_read_b64_tr_b16 a[116:117], v152 offset:8192
    v_mfma_f32_16x16x32_bf16 a[244:247], a[44:47], a[84:87], a[244:247]
    ds_read_b64_tr_b16 a[118:119], v152 offset:9216
    s_cselect_b32 s53, 0, s53
    v_mfma_f32_16x16x32_bf16 a[240:243], a[60:63], a[112:115], a[240:243]
    ds_read_b64_tr_b16 a[112:113], v151 offset:8192
    v_mfma_f32_16x16x32_bf16 a[240:243], a[44:47], a[80:83], a[240:243]
    ds_read_b64_tr_b16 a[114:115], v151 offset:9216
    v_mfma_f32_16x16x32_bf16 a[236:239], a[60:63], a[108:111], a[236:239]
    ds_read_b64_tr_b16 a[108:109], v154 offset:0
    s_cselect_b32 s93, -2, 1
    v_mfma_f32_16x16x32_bf16 a[236:239], a[44:47], a[76:79], a[236:239]
    ds_read_b64_tr_b16 a[110:111], v154 offset:1024
    v_mfma_f32_16x16x32_bf16 a[232:235], a[60:63], a[104:107], a[232:235]
    ds_read_b64_tr_b16 a[104:105], v153 offset:0
    s_lshl_b32 s93, s93, 15
    v_mfma_f32_16x16x32_bf16 a[232:235], a[44:47], a[72:75], a[232:235]
    ds_read_b64_tr_b16 a[106:107], v153 offset:1024
    v_mfma_f32_16x16x32_bf16 a[228:231], a[60:63], a[100:103], a[228:231]
    ds_read_b64_tr_b16 a[100:101], v152 offset:0
    v_add_u32 v144, s93, v144
    v_mfma_f32_16x16x32_bf16 a[228:231], a[44:47], a[68:71], a[228:231]
    ds_read_b64_tr_b16 a[102:103], v152 offset:1024
    v_mfma_f32_16x16x32_bf16 a[224:227], a[60:63], a[96:99], a[224:227]
    ds_read_b64_tr_b16 a[96:97], v151 offset:0
    v_mfma_f32_16x16x32_bf16 a[224:227], a[44:47], a[64:67], a[224:227]
    ds_read_b64_tr_b16 a[98:99], v151 offset:1024
    v_mfma_f32_16x16x32_bf16 v[28:31], a[0:3], a[92:95], v[28:31]
    s_waitcnt lgkmcnt(14)
    s_add_u32 s54, s54, 16384
    v_mfma_f32_16x16x32_bf16 v[28:31], a[16:19], a[124:127], v[28:31]
    buffer_store_dwordx4 a[168:171], v156, s[16:19], s98 offen offset:0 sc0 sc1
    v_mfma_f32_16x16x32_bf16 v[24:27], a[0:3], a[88:91], v[24:27]
    s_waitcnt lgkmcnt(12)
    s_and_b32 s54, s54, 0xffff
    v_mfma_f32_16x16x32_bf16 v[24:27], a[16:19], a[120:123], v[24:27]
    v_mfma_f32_16x16x32_bf16 v[20:23], a[0:3], a[84:87], v[20:23]
    s_waitcnt lgkmcnt(10)
    v_add_u32 v151, s54, v146
    v_mfma_f32_16x16x32_bf16 v[20:23], a[16:19], a[116:119], v[20:23]
    buffer_store_dwordx4 a[172:175], v156, s[16:19], s98 offen offset:1024 sc0 sc1
    v_mfma_f32_16x16x32_bf16 v[16:19], a[0:3], a[80:83], v[16:19]
    s_waitcnt lgkmcnt(8)
    v_add_u32 v152, s54, v147
    v_mfma_f32_16x16x32_bf16 v[16:19], a[16:19], a[112:115], v[16:19]
    s_add_u32 s98, s98, 8192
    v_mfma_f32_16x16x32_bf16 v[12:15], a[0:3], a[76:79], v[12:15]
    s_waitcnt lgkmcnt(6)
    v_add_u32 v153, s54, v148
    v_mfma_f32_16x16x32_bf16 v[12:15], a[16:19], a[108:111], v[12:15]
    buffer_store_dwordx4 a[176:179], v155, s[16:19], s98 offen offset:0 sc0 sc1
    v_mfma_f32_16x16x32_bf16 v[8:11], a[0:3], a[72:75], v[8:11]
    s_waitcnt lgkmcnt(4)
    v_add_u32 v154, s54, v149
    v_mfma_f32_16x16x32_bf16 v[8:11], a[16:19], a[104:107], v[8:11]
    v_mfma_f32_16x16x32_bf16 v[4:7], a[0:3], a[68:71], v[4:7]
    s_waitcnt lgkmcnt(2)
    v_mfma_f32_16x16x32_bf16 v[4:7], a[16:19], a[100:103], v[4:7]
    v_mfma_f32_16x16x32_bf16 v[0:3], a[0:3], a[64:67], v[0:3]
    s_waitcnt lgkmcnt(0)
    v_mfma_f32_16x16x32_bf16 v[0:3], a[16:19], a[96:99], v[0:3]
    s_waitcnt vmcnt(29)
    s_barrier
    v_mfma_f32_16x16x32_bf16 v[32:35], a[20:23], a[96:99], v[32:35]
    ds_read_b128 a[32:35], v144 offset:8192
    s_mov_b32 m0, s52
    v_mfma_f32_16x16x32_bf16 v[32:35], a[4:7], a[64:67], v[32:35]
    s_add_u32 s52, s52, 16384
    v_mfma_f32_16x16x32_bf16 v[36:39], a[4:7], a[68:71], v[36:39]
    buffer_load_dwordx4 v132, s[12:15], s48 offen offset:0 sc1 lds
    v_mfma_f32_16x16x32_bf16 v[36:39], a[20:23], a[100:103], v[36:39]
    ds_read_b128 a[48:51], v145 offset:8192
    v_mfma_f32_16x16x32_bf16 v[40:43], a[20:23], a[104:107], v[40:43]
    v_mfma_f32_16x16x32_bf16 v[40:43], a[4:7], a[72:75], v[40:43]
    buffer_load_dwordx4 v133, s[12:15], s48 offen offset:1024 sc1 lds
    v_mfma_f32_16x16x32_bf16 v[44:47], a[4:7], a[76:79], v[44:47]
    ds_read_b128 a[36:39], v144 offset:10240
    v_mfma_f32_16x16x32_bf16 v[44:47], a[20:23], a[108:111], v[44:47]
    buffer_load_dwordx4 v134, s[12:15], s48 offen offset:2048 sc1 lds
    v_mfma_f32_16x16x32_bf16 v[48:51], a[20:23], a[112:115], v[48:51]
    v_mfma_f32_16x16x32_bf16 v[48:51], a[4:7], a[80:83], v[48:51]
    ds_read_b128 a[52:55], v145 offset:10240
    v_mfma_f32_16x16x32_bf16 v[52:55], a[4:7], a[84:87], v[52:55]
    buffer_load_dwordx4 v135, s[12:15], s48 offen offset:3072 sc1 lds
    v_mfma_f32_16x16x32_bf16 v[52:55], a[20:23], a[116:119], v[52:55]
    v_mfma_f32_16x16x32_bf16 v[56:59], a[20:23], a[120:123], v[56:59]
    s_add_u32 s48, s48, s49
    v_mfma_f32_16x16x32_bf16 v[56:59], a[4:7], a[88:91], v[56:59]
    ds_read_b128 a[40:43], v144 offset:12288
    v_mfma_f32_16x16x32_bf16 v[60:63], a[4:7], a[92:95], v[60:63]
    s_and_b32 s52, s52, 0xffff
    v_mfma_f32_16x16x32_bf16 v[60:63], a[20:23], a[124:127], v[60:63]
    s_sub_u32 s56, s56, 1
    v_mfma_f32_16x16x32_bf16 v[92:95], a[24:27], a[124:127], v[92:95]
    ds_read_b128 a[56:59], v145 offset:12288
    s_cbranch_scc1 L1_sw18
L1_swr18:
    v_mfma_f32_16x16x32_bf16 v[92:95], a[8:11], a[92:95], v[92:95]
    v_mfma_f32_16x16x32_bf16 v[88:91], a[8:11], a[88:91], v[88:91]
    s_mov_b32 m0, s51
    v_mfma_f32_16x16x32_bf16 v[88:91], a[24:27], a[120:123], v[88:91]
    ds_read_b128 a[44:47], v144 offset:14336
    s_add_u32 s47, s46, s50
    v_mfma_f32_16x16x32_bf16 v[84:87], a[24:27], a[116:119], v[84:87]
    buffer_load_dwordx4 v128, s[8:11], s46 offen offset:0 sc1 lds
    v_mfma_f32_16x16x32_bf16 v[84:87], a[8:11], a[84:87], v[84:87]
    v_mfma_f32_16x16x32_bf16 v[80:83], a[8:11], a[80:83], v[80:83]
    ds_read_b128 a[60:63], v145 offset:14336
    v_mfma_f32_16x16x32_bf16 v[80:83], a[24:27], a[112:115], v[80:83]
    buffer_load_dwordx4 v129, s[8:11], s46 offen offset:1024 sc1 lds
    v_mfma_f32_16x16x32_bf16 v[76:79], a[24:27], a[108:111], v[76:79]
    v_mfma_f32_16x16x32_bf16 v[76:79], a[8:11], a[76:79], v[76:79]
    buffer_load_dwordx4 v130, s[8:11], s46 offen offset:2048 sc1 lds
    v_mfma_f32_16x16x32_bf16 v[72:75], a[8:11], a[72:75], v[72:75]
    v_mfma_f32_16x16x32_bf16 v[72:75], a[24:27], a[104:107], v[72:75]
    v_mfma_f32_16x16x32_bf16 v[68:71], a[24:27], a[100:103], v[68:71]
    buffer_load_dwordx4 v131, s[8:11], s46 offen offset:3072 sc1 lds
    v_mfma_f32_16x16x32_bf16 v[68:71], a[8:11], a[68:71], v[68:71]
    v_mfma_f32_16x16x32_bf16 v[64:67], a[8:11], a[64:67], v[64:67]
    v_mfma_f32_16x16x32_bf16 v[64:67], a[24:27], a[96:99], v[64:67]
    s_add_u32 s46, s46, s68
    s_waitcnt lgkmcnt(0)
    v_mfma_f32_16x16x32_bf16 v[96:99], a[12:15], a[64:67], v[96:99]
    ds_read_b64_tr_b16 a[64:65], v151 offset:0
    v_mfma_f32_16x16x32_bf16 v[96:99], a[28:31], a[96:99], v[96:99]
    ds_read_b64_tr_b16 a[66:67], v151 offset:1024
    v_mfma_f32_16x16x32_bf16 v[100:103], a[12:15], a[68:71], v[100:103]
    ds_read_b64_tr_b16 a[68:69], v152 offset:0
    v_mfma_f32_16x16x32_bf16 v[100:103], a[28:31], a[100:103], v[100:103]
    ds_read_b64_tr_b16 a[70:71], v152 offset:1024
    v_mfma_f32_16x16x32_bf16 v[104:107], a[12:15], a[72:75], v[104:107]
    ds_read_b64_tr_b16 a[72:73], v153 offset:0
    v_mfma_f32_16x16x32_bf16 v[104:107], a[28:31], a[104:107], v[104:107]
    ds_read_b64_tr_b16 a[74:75], v153 offset:1024
    v_mfma_f32_16x16x32_bf16 v[108:111], a[12:15], a[76:79], v[108:111]
    ds_read_b64_tr_b16 a[76:77], v154 offset:0
    v_mfma_f32_16x16x32_bf16 v[108:111], a[28:31], a[108:111], v[108:111]
    ds_read_b64_tr_b16 a[78:79], v154 offset:1024
    v_add_u32 v145, s93, v145
    v_mfma_f32_16x16x32_bf16 v[112:115], a[12:15], a[80:83], v[112:115]
    ds_read_b64_tr_b16 a[80:81], v151 offset:8192
    v_mfma_f32_16x16x32_bf16 v[112:115], a[28:31], a[112:115], v[112:115]
    ds_read_b64_tr_b16 a[82:83], v151 offset:9216
    v_mfma_f32_16x16x32_bf16 v[116:119], a[12:15], a[84:87], v[116:119]
    ds_read_b64_tr_b16 a[84:85], v152 offset:8192
    v_mfma_f32_16x16x32_bf16 v[116:119], a[28:31], a[116:119], v[116:119]
    ds_read_b64_tr_b16 a[86:87], v152 offset:9216
    v_mfma_f32_16x16x32_bf16 v[120:123], a[12:15], a[88:91], v[120:123]
    ds_read_b64_tr_b16 a[88:89], v153 offset:8192
    v_mfma_f32_16x16x32_bf16 v[120:123], a[28:31], a[120:123], v[120:123]
    ds_read_b64_tr_b16 a[90:91], v153 offset:9216
    v_mfma_f32_16x16x32_bf16 v[124:127], a[12:15], a[92:95], v[124:127]
    ds_read_b64_tr_b16 a[92:93], v154 offset:8192
    v_mfma_f32_16x16x32_bf16 v[124:127], a[28:31], a[124:127], v[124:127]
    ds_read_b64_tr_b16 a[94:95], v154 offset:9216
    v_mfma_f32_16x16x32_bf16 v[192:195], a[48:51], a[96:99], v[192:195]
    s_waitcnt lgkmcnt(14)
    s_add_u32 s54, s54, 16384
    v_mfma_f32_16x16x32_bf16 v[192:195], a[32:35], a[64:67], v[192:195]
    buffer_store_dwordx4 a[180:183], v155, s[16:19], s98 offen offset:1024 sc0 sc1
    v_mfma_f32_16x16x32_bf16 v[196:199], a[48:51], a[100:103], v[196:199]
    s_waitcnt lgkmcnt(12)
    s_and_b32 s54, s54, 0xffff
    v_mfma_f32_16x16x32_bf16 v[196:199], a[32:35], a[68:71], v[196:199]
    v_mfma_f32_16x16x32_bf16 v[200:203], a[48:51], a[104:107], v[200:203]
    s_waitcnt lgkmcnt(10)
    v_add_u32 v151, s54, v146
    v_mfma_f32_16x16x32_bf16 v[200:203], a[32:35], a[72:75], v[200:203]
    buffer_store_dwordx4 a[184:187], v156, s[16:19], s98 offen offset:0 sc0 sc1
    v_mfma_f32_16x16x32_bf16 v[204:207], a[48:51], a[108:111], v[204:207]
    s_waitcnt lgkmcnt(8)
    v_add_u32 v152, s54, v147
    v_mfma_f32_16x16x32_bf16 v[204:207], a[32:35], a[76:79], v[204:207]
    v_mfma_f32_16x16x32_bf16 v[208:211], a[48:51], a[112:115], v[208:211]
    s_waitcnt lgkmcnt(6)
    v_add_u32 v153, s54, v148
    v_mfma_f32_16x16x32_bf16 v[208:211], a[32:35], a[80:83], v[208:211]
    buffer_store_dwordx4 a[188:191], v156, s[16:19], s98 offen offset:1024 sc0 sc1
    v_mfma_f32_16x16x32_bf16 v[212:215], a[48:51], a[116:119], v[212:215]
    s_waitcnt lgkmcnt(4)
    v_add_u32 v154, s54, v149
    v_mfma_f32_16x16x32_bf16 v[212:215], a[32:35], a[84:87], v[212:215]
    s_add_u32 s98, s98, 8192
    v_mfma_f32_16x16x32_bf16 v[216:219], a[48:51], a[120:123], v[216:219]
    s_waitcnt lgkmcnt(2)
    v_mfma_f32_16x16x32_bf16 v[216:219], a[32:35], a[88:91], v[216:219]
    v_mfma_f32_16x16x32_bf16 v[220:223], a[48:51], a[124:127], v[220:223]
    s_waitcnt lgkmcnt(0)
    v_mfma_f32_16x16x32_bf16 v[220:223], a[32:35], a[92:95], v[220:223]
    s_waitcnt vmcnt(31)
    s_barrier
    v_mfma_f32_16x16x32_bf16 a[220:223], a[36:39], a[92:95], a[220:223]
    ds_read_b128 a[0:3], v144 offset:0
    s_sub_u32 s57, s57, 1
    v_mfma_f32_16x16x32_bf16 a[220:223], a[52:55], a[124:127], a[220:223]
    s_cbranch_scc1 L1_sw19
L1_swr19:
    v_mfma_f32_16x16x32_bf16 a[216:219], a[52:55], a[120:123], a[216:219]
    s_mov_b32 m0, s52
    v_mfma_f32_16x16x32_bf16 a[216:219], a[36:39], a[88:91], a[216:219]
    ds_read_b128 a[16:19], v145 offset:0
    s_add_u32 s52, s52, 16384
    v_mfma_f32_16x16x32_bf16 a[212:215], a[36:39], a[84:87], a[212:215]
    buffer_load_dwordx4 v132, s[12:15], s48 offen offset:0 sc1 lds
    v_mfma_f32_16x16x32_bf16 a[212:215], a[52:55], a[116:119], a[212:215]
    v_mfma_f32_16x16x32_bf16 a[208:211], a[52:55], a[112:115], a[208:211]
    ds_read_b128 a[4:7], v144 offset:2048
    v_mfma_f32_16x16x32_bf16 a[208:211], a[36:39], a[80:83], a[208:211]
    buffer_load_dwordx4 v133, s[12:15], s48 offen offset:1024 sc1 lds
    v_mfma_f32_16x16x32_bf16 a[204:207], a[36:39], a[76:79], a[204:207]
    buffer_load_dwordx4 v134, s[12:15], s48 offen offset:2048 sc1 lds
    v_mfma_f32_16x16x32_bf16 a[204:207], a[52:55], a[108:111], a[204:207]
    ds_read_b128 a[20:23], v145 offset:2048
    v_mfma_f32_16x16x32_bf16 a[200:203], a[52:55], a[104:107], a[200:203]
    v_mfma_f32_16x16x32_bf16 a[200:203], a[36:39], a[72:75], a[200:203]
    buffer_load_dwordx4 v135, s[12:15], s48 offen offset:3072 sc1 lds
    v_mfma_f32_16x16x32_bf16 a[196:199], a[36:39], a[68:71], a[196:199]
    v_mfma_f32_16x16x32_bf16 a[196:199], a[52:55], a[100:103], a[196:199]
    ds_read_b128 a[8:11], v144 offset:4096
    s_add_u32 s48, s48, s49
    v_mfma_f32_16x16x32_bf16 a[192:195], a[52:55], a[96:99], a[192:195]
    s_and_b32 s52, s52, 0xffff
    v_mfma_f32_16x16x32_bf16 a[192:195], a[36:39], a[64:67], a[192:195]
    s_add_u32 m0, s51, 8192
    v_mfma_f32_16x16x32_bf16 v[224:227], a[40:43], a[64:67], v[224:227]
    ds_read_b128 a[24:27], v145 offset:4096
    s_add_u32 s51, s51, 32768
    v_mfma_f32_16x16x32_bf16 v[224:227], a[56:59], a[96:99], v[224:227]
    buffer_load_dwordx4 v128, s[8:11], s47 offen offset:0 sc1 lds
    v_mfma_f32_16x16x32_bf16 v[228:231], a[56:59], a[100:103], v[228:231]
    v_mfma_f32_16x16x32_bf16 v[228:231], a[40:43], a[68:71], v[228:231]
    ds_read_b128 a[12:15], v144 offset:6144
    v_mfma_f32_16x16x32_bf16 v[232:235], a[40:43], a[72:75], v[232:235]
    buffer_load_dwordx4 v129, s[8:11], s47 offen offset:1024 sc1 lds
    v_mfma_f32_16x16x32_bf16 v[232:235], a[56:59], a[104:107], v[232:235]
    v_mfma_f32_16x16x32_bf16 v[236:239], a[56:59], a[108:111], v[236:239]
    ds_read_b128 a[28:31], v145 offset:6144
    v_mfma_f32_16x16x32_bf16 v[236:239], a[40:43], a[76:79], v[236:239]
    buffer_load_dwordx4 v130, s[8:11], s47 offen offset:2048 sc1 lds
    v_mfma_f32_16x16x32_bf16 v[240:243], a[40:43], a[80:83], v[240:243]
    buffer_load_dwordx4 v131, s[8:11], s47 offen offset:3072 sc1 lds
    v_mfma_f32_16x16x32_bf16 v[240:243], a[56:59], a[112:115], v[240:243]
    v_mfma_f32_16x16x32_bf16 v[244:247], a[56:59], a[116:119], v[244:247]
    s_cmp_ge_u32 s51, s79
    v_mfma_f32_16x16x32_bf16 v[244:247], a[40:43], a[84:87], v[244:247]
    s_cselect_b32 s51, s78, s51
    v_mfma_f32_16x16x32_bf16 v[248:251], a[40:43], a[88:91], v[248:251]
    buffer_load_dword v158, v157, s[84:87], s88 offen
    v_mfma_f32_16x16x32_bf16 v[248:251], a[56:59], a[120:123], v[248:251]
    v_mfma_f32_16x16x32_bf16 v[252:255], a[56:59], a[124:127], v[252:255]
    v_mfma_f32_16x16x32_bf16 v[252:255], a[40:43], a[92:95], v[252:255]
    s_add_u32 s88, s88, s89
    s_waitcnt lgkmcnt(0)
    v_mfma_f32_16x16x32_bf16 a[252:255], a[60:63], a[124:127], a[252:255]
    ds_read_b64_tr_b16 a[124:125], v154 offset:8192
    v_mfma_f32_16x16x32_bf16 a[252:255], a[44:47], a[92:95], a[252:255]
    ds_read_b64_tr_b16 a[126:127], v154 offset:9216
    s_add_u32 s53, s53, 1
    v_mfma_f32_16x16x32_bf16 a[248:251], a[60:63], a[120:123], a[248:251]
    ds_read_b64_tr_b16 a[120:121], v153 offset:8192
    v_mfma_f32_16x16x32_bf16 a[248:251], a[44:47], a[88:91], a[248:251]
    ds_read_b64_tr_b16 a[122:123], v153 offset:9216
    s_cmp_eq_u32 s53, 3
    v_mfma_f32_16x16x32_bf16 a[244:247], a[60:63], a[116:119], a[244:247]
    ds_read_b64_tr_b16 a[116:117], v152 offset:8192
    v_mfma_f32_16x16x32_bf16 a[244:247], a[44:47], a[84:87], a[244:247]
    ds_read_b64_tr_b16 a[118:119], v152 offset:9216
    s_cselect_b32 s53, 0, s53
    v_mfma_f32_16x16x32_bf16 a[240:243], a[60:63], a[112:115], a[240:243]
    ds_read_b64_tr_b16 a[112:113], v151 offset:8192
    v_mfma_f32_16x16x32_bf16 a[240:243], a[44:47], a[80:83], a[240:243]
    ds_read_b64_tr_b16 a[114:115], v151 offset:9216
    v_mfma_f32_16x16x32_bf16 a[236:239], a[60:63], a[108:111], a[236:239]
    ds_read_b64_tr_b16 a[108:109], v154 offset:0
    s_cselect_b32 s93, -2, 1
    v_mfma_f32_16x16x32_bf16 a[236:239], a[44:47], a[76:79], a[236:239]
    ds_read_b64_tr_b16 a[110:111], v154 offset:1024
    v_mfma_f32_16x16x32_bf16 a[232:235], a[60:63], a[104:107], a[232:235]
    ds_read_b64_tr_b16 a[104:105], v153 offset:0
    s_lshl_b32 s93, s93, 15
    v_mfma_f32_16x16x32_bf16 a[232:235], a[44:47], a[72:75], a[232:235]
    ds_read_b64_tr_b16 a[106:107], v153 offset:1024
    v_mfma_f32_16x16x32_bf16 a[228:231], a[60:63], a[100:103], a[228:231]
    ds_read_b64_tr_b16 a[100:101], v152 offset:0
    v_add_u32 v144, s93, v144
    v_mfma_f32_16x16x32_bf16 a[228:231], a[44:47], a[68:71], a[228:231]
    ds_read_b64_tr_b16 a[102:103], v152 offset:1024
    v_mfma_f32_16x16x32_bf16 a[224:227], a[60:63], a[96:99], a[224:227]
    ds_read_b64_tr_b16 a[96:97], v151 offset:0
    v_mfma_f32_16x16x32_bf16 a[224:227], a[44:47], a[64:67], a[224:227]
    ds_read_b64_tr_b16 a[98:99], v151 offset:1024
    v_mfma_f32_16x16x32_bf16 v[28:31], a[0:3], a[92:95], v[28:31]
    s_waitcnt lgkmcnt(14)
    s_add_u32 s54, s54, 16384
    v_mfma_f32_16x16x32_bf16 v[28:31], a[16:19], a[124:127], v[28:31]
    v_mfma_f32_16x16x32_bf16 v[24:27], a[0:3], a[88:91], v[24:27]
    s_waitcnt lgkmcnt(12)
    s_and_b32 s54, s54, 0xffff
    v_mfma_f32_16x16x32_bf16 v[24:27], a[16:19], a[120:123], v[24:27]
    v_mfma_f32_16x16x32_bf16 v[20:23], a[0:3], a[84:87], v[20:23]
    s_waitcnt lgkmcnt(10)
    v_add_u32 v151, s54, v146
    v_mfma_f32_16x16x32_bf16 v[20:23], a[16:19], a[116:119], v[20:23]
    v_mfma_f32_16x16x32_bf16 v[16:19], a[0:3], a[80:83], v[16:19]
    s_waitcnt lgkmcnt(8)
    v_add_u32 v152, s54, v147
    v_mfma_f32_16x16x32_bf16 v[16:19], a[16:19], a[112:115], v[16:19]
    v_mfma_f32_16x16x32_bf16 v[12:15], a[0:3], a[76:79], v[12:15]
    s_waitcnt lgkmcnt(6)
    v_add_u32 v153, s54, v148
    v_mfma_f32_16x16x32_bf16 v[12:15], a[16:19], a[108:111], v[12:15]
    v_mfma_f32_16x16x32_bf16 v[8:11], a[0:3], a[72:75], v[8:11]
    s_waitcnt lgkmcnt(4)
    v_add_u32 v154, s54, v149
    v_mfma_f32_16x16x32_bf16 v[8:11], a[16:19], a[104:107], v[8:11]
    v_mfma_f32_16x16x32_bf16 v[4:7], a[0:3], a[68:71], v[4:7]
    s_waitcnt lgkmcnt(2)
    v_mfma_f32_16x16x32_bf16 v[4:7], a[16:19], a[100:103], v[4:7]
    v_mfma_f32_16x16x32_bf16 v[0:3], a[0:3], a[64:67], v[0:3]
    s_waitcnt lgkmcnt(0)
    v_mfma_f32_16x16x32_bf16 v[0:3], a[16:19], a[96:99], v[0:3]
    s_waitcnt vmcnt(9)
    s_barrier
    s_cmp_lg_u32 s58, 0
    s_cbranch_scc1 Lpub3
    v_mov_b32 v161, 1
    s_mov_b64 exec, 1
    buffer_store_dword v161, off, s[16:19], s99 sc0 sc1
    s_mov_b64 exec, -1
Lpub3:
    v_mfma_f32_16x16x32_bf16 v[32:35], a[20:23], a[96:99], v[32:35]
    ds_read_b128 a[32:35], v144 offset:8192
    s_mov_b32 m0, s52
    v_mfma_f32_16x16x32_bf16 v[32:35], a[4:7], a[64:67], v[32:35]
    s_add_u32 s52, s52, 16384
    v_mfma_f32_16x16x32_bf16 v[36:39], a[4:7], a[68:71], v[36:39]
    buffer_load_dwordx4 v132, s[12:15], s48 offen offset:0 sc1 lds
    v_mfma_f32_16x16x32_bf16 v[36:39], a[20:23], a[100:103], v[36:39]
    ds_read_b128 a[48:51], v145 offset:8192
    v_mfma_f32_16x16x32_bf16 v[40:43], a[20:23], a[104:107], v[40:43]
    v_mfma_f32_16x16x32_bf16 v[40:43], a[4:7], a[72:75], v[40:43]
    buffer_load_dwordx4 v133, s[12:15], s48 offen offset:1024 sc1 lds
    v_mfma_f32_16x16x32_bf16 v[44:47], a[4:7], a[76:79], v[44:47]
    ds_read_b128 a[36:39], v144 offset:10240
    v_mfma_f32_16x16x32_bf16 v[44:47], a[20:23], a[108:111], v[44:47]
    buffer_load_dwordx4 v134, s[12:15], s48 offen offset:2048 sc1 lds
    v_mfma_f32_16x16x32_bf16 v[48:51], a[20:23], a[112:115], v[48:51]
    v_mfma_f32_16x16x32_bf16 v[48:51], a[4:7], a[80:83], v[48:51]
    ds_read_b128 a[52:55], v145 offset:10240
    v_mfma_f32_16x16x32_bf16 v[52:55], a[4:7], a[84:87], v[52:55]
    buffer_load_dwordx4 v135, s[12:15], s48 offen offset:3072 sc1 lds
    v_mfma_f32_16x16x32_bf16 v[52:55], a[20:23], a[116:119], v[52:55]
    v_mfma_f32_16x16x32_bf16 v[56:59], a[20:23], a[120:123], v[56:59]
    s_add_u32 s48, s48, s49
    v_mfma_f32_16x16x32_bf16 v[56:59], a[4:7], a[88:91], v[56:59]
    ds_read_b128 a[40:43], v144 offset:12288
    v_mfma_f32_16x16x32_bf16 v[60:63], a[4:7], a[92:95], v[60:63]
    s_and_b32 s52, s52, 0xffff
    v_mfma_f32_16x16x32_bf16 v[60:63], a[20:23], a[124:127], v[60:63]
    s_sub_u32 s56, s56, 1
    v_mfma_f32_16x16x32_bf16 v[92:95], a[24:27], a[124:127], v[92:95]
    ds_read_b128 a[56:59], v145 offset:12288
    s_cbranch_scc1 L1_sw20
L1_swr20:
    v_mfma_f32_16x16x32_bf16 v[92:95], a[8:11], a[92:95], v[92:95]
    v_mfma_f32_16x16x32_bf16 v[88:91], a[8:11], a[88:91], v[88:91]
    s_mov_b32 m0, s51
    v_mfma_f32_16x16x32_bf16 v[88:91], a[24:27], a[120:123], v[88:91]
    ds_read_b128 a[44:47], v144 offset:14336
    s_add_u32 s47, s46, s50
    v_mfma_f32_16x16x32_bf16 v[84:87], a[24:27], a[116:119], v[84:87]
    buffer_load_dwordx4 v128, s[8:11], s46 offen offset:0 sc1 lds
    v_mfma_f32_16x16x32_bf16 v[84:87], a[8:11], a[84:87], v[84:87]
    v_mfma_f32_16x16x32_bf16 v[80:83], a[8:11], a[80:83], v[80:83]
    ds_read_b128 a[60:63], v145 offset:14336
    v_mfma_f32_16x16x32_bf16 v[80:83], a[24:27], a[112:115], v[80:83]
    buffer_load_dwordx4 v129, s[8:11], s46 offen offset:1024 sc1 lds
    v_mfma_f32_16x16x32_bf16 v[76:79], a[24:27], a[108:111], v[76:79]
    v_mfma_f32_16x16x32_bf16 v[76:79], a[8:11], a[76:79], v[76:79]
    buffer_load_dwordx4 v130, s[8:11], s46 offen offset:2048 sc1 lds
    v_mfma_f32_16x16x32_bf16 v[72:75], a[8:11], a[72:75], v[72:75]
    v_mfma_f32_16x16x32_bf16 v[72:75], a[24:27], a[104:107], v[72:75]
    v_mfma_f32_16x16x32_bf16 v[68:71], a[24:27], a[100:103], v[68:71]
    buffer_load_dwordx4 v131, s[8:11], s46 offen offset:3072 sc1 lds
    v_mfma_f32_16x16x32_bf16 v[68:71], a[8:11], a[68:71], v[68:71]
    v_mfma_f32_16x16x32_bf16 v[64:67], a[8:11], a[64:67], v[64:67]
    v_mfma_f32_16x16x32_bf16 v[64:67], a[24:27], a[96:99], v[64:67]
    s_add_u32 s46, s46, s68
    s_waitcnt lgkmcnt(0)
    v_mfma_f32_16x16x32_bf16 v[96:99], a[12:15], a[64:67], v[96:99]
    ds_read_b64_tr_b16 a[64:65], v151 offset:0
    v_mfma_f32_16x16x32_bf16 v[96:99], a[28:31], a[96:99], v[96:99]
    ds_read_b64_tr_b16 a[66:67], v151 offset:1024
    v_mfma_f32_16x16x32_bf16 v[100:103], a[12:15], a[68:71], v[100:103]
    ds_read_b64_tr_b16 a[68:69], v152 offset:0
    v_mfma_f32_16x16x32_bf16 v[100:103], a[28:31], a[100:103], v[100:103]
    ds_read_b64_tr_b16 a[70:71], v152 offset:1024
    v_mfma_f32_16x16x32_bf16 v[104:107], a[12:15], a[72:75], v[104:107]
    ds_read_b64_tr_b16 a[72:73], v153 offset:0
    v_mfma_f32_16x16x32_bf16 v[104:107], a[28:31], a[104:107], v[104:107]
    ds_read_b64_tr_b16 a[74:75], v153 offset:1024
    v_mfma_f32_16x16x32_bf16 v[108:111], a[12:15], a[76:79], v[108:111]
    ds_read_b64_tr_b16 a[76:77], v154 offset:0
    v_mfma_f32_16x16x32_bf16 v[108:111], a[28:31], a[108:111], v[108:111]
    ds_read_b64_tr_b16 a[78:79], v154 offset:1024
    v_add_u32 v145, s93, v145
    v_mfma_f32_16x16x32_bf16 v[112:115], a[12:15], a[80:83], v[112:115]
    ds_read_b64_tr_b16 a[80:81], v151 offset:8192
    v_mfma_f32_16x16x32_bf16 v[112:115], a[28:31], a[112:115], v[112:115]
    ds_read_b64_tr_b16 a[82:83], v151 offset:9216
    v_mfma_f32_16x16x32_bf16 v[116:119], a[12:15], a[84:87], v[116:119]
    ds_read_b64_tr_b16 a[84:85], v152 offset:8192
    v_mfma_f32_16x16x32_bf16 v[116:119], a[28:31], a[116:119], v[116:119]
    ds_read_b64_tr_b16 a[86:87], v152 offset:9216
    v_mfma_f32_16x16x32_bf16 v[120:123], a[12:15], a[88:91], v[120:123]
    ds_read_b64_tr_b16 a[88:89], v153 offset:8192
    v_mfma_f32_16x16x32_bf16 v[120:123], a[28:31], a[120:123], v[120:123]
    ds_read_b64_tr_b16 a[90:91], v153 offset:9216
    v_mfma_f32_16x16x32_bf16 v[124:127], a[12:15], a[92:95], v[124:127]
    ds_read_b64_tr_b16 a[92:93], v154 offset:8192
    v_mfma_f32_16x16x32_bf16 v[124:127], a[28:31], a[124:127], v[124:127]
    ds_read_b64_tr_b16 a[94:95], v154 offset:9216
    s_branch L1_vloop
L1_v:
    s_waitcnt lgkmcnt(0)
    s_waitcnt vmcnt(12)
    s_barrier
    s_add_u32 s54, s54, 16384
    s_and_b32 s54, s54, 0xffff
    v_add_u32 v151, s54, v146
    v_add_u32 v152, s54, v147
    v_add_u32 v153, s54, v148
    v_add_u32 v154, s54, v149
    v_mfma_f32_16x16x32_bf16 v[192:195], a[32:35], a[64:67], 0
    ds_read_b128 a[0:3], v144 offset:0
    buffer_load_dword v158, v157, s[84:87], s88 offen
    v_mfma_f32_16x16x32_bf16 v[196:199], a[32:35], a[68:71], 0
    ds_read_b128 a[16:19], v145 offset:0
    s_add_u32 s88, s88, s89
    s_mov_b32 m0, s52
    v_mfma_f32_16x16x32_bf16 v[200:203], a[32:35], a[72:75], 0
    ds_read_b128 a[4:7], v144 offset:2048
    s_add_u32 s52, s52, 16384
    buffer_load_dwordx4 v132, s[12:15], s48 offen offset:0 sc1 lds
    v_mfma_f32_16x16x32_bf16 v[204:207], a[32:35], a[76:79], 0
    ds_read_b128 a[20:23], v145 offset:2048
    buffer_load_dwordx4 v133, s[12:15], s48 offen offset:1024 sc1 lds
    v_mfma_f32_16x16x32_bf16 v[208:211], a[32:35], a[80:83], 0
    buffer_load_dwordx4 v134, s[12:15], s48 offen offset:2048 sc1 lds
    v_mfma_f32_16x16x32_bf16 v[212:215], a[32:35], a[84:87], 0
    ds_read_b128 a[8:11], v144 offset:4096
    buffer_load_dwordx4 v135, s[12:15], s48 offen offset:3072 sc1 lds
    v_mfma_f32_16x16x32_bf16 v[216:219], a[32:35], a[88:91], 0
    ds_read_b128 a[24:27], v145 offset:4096
    s_add_u32 s48, s48, s49
    v_mfma_f32_16x16x32_bf16 v[220:223], a[32:35], a[92:95], 0
    ds_read_b128 a[12:15], v144 offset:6144
    s_and_b32 s52, s52, 0xffff
    s_mov_b32 m0, s51
    v_mfma_f32_16x16x32_bf16 a[220:223], a[36:39], a[92:95], 0
    ds_read_b128 a[28:31], v145 offset:6144
    s_add_u32 s47, s46, s50
    buffer_load_dwordx4 v128, s[8:11], s46 offen offset:0 sc1 lds
    v_mfma_f32_16x16x32_bf16 a[216:219], a[36:39], a[88:91], 0
    buffer_load_dwordx4 v129, s[8:11], s46 offen offset:1024 sc1 lds
    v_mfma_f32_16x16x32_bf16 a[212:215], a[36:39], a[84:87], 0
    ds_read_b64_tr_b16 a[124:125], v154 offset:8192
    buffer_load_dwordx4 v130, s[8:11], s46 offen offset:2048 sc1 lds
    v_mfma_f32_16x16x32_bf16 a[208:211], a[36:39], a[80:83], 0
    ds_read_b64_tr_b16 a[126:127], v154 offset:9216
    buffer_load_dwordx4 v131, s[8:11], s46 offen offset:3072 sc1 lds
    v_mfma_f32_16x16x32_bf16 a[204:207], a[36:39], a[76:79], 0
    ds_read_b64_tr_b16 a[120:121], v153 offset:8192
    s_add_u32 s46, s46, s68
    v_mfma_f32_16x16x32_bf16 a[200:203], a[36:39], a[72:75], 0
    ds_read_b64_tr_b16 a[122:123], v153 offset:9216
    s_sub_u32 s57, s57, 1
    s_cbranch_scc1 L1_sw21
L1_swr21:
    v_mfma_f32_16x16x32_bf16 a[196:199], a[36:39], a[68:71], 0
    s_mov_b32 m0, s52
    s_add_u32 s52, s52, 16384
    v_mfma_f32_16x16x32_bf16 a[192:195], a[36:39], a[64:67], 0
    ds_read_b64_tr_b16 a[116:117], v152 offset:8192
    buffer_load_dwordx4 v132, s[12:15], s48 offen offset:0 sc1 lds
    v_mfma_f32_16x16x32_bf16 v[224:227], a[40:43], a[64:67], 0
    ds_read_b64_tr_b16 a[118:119], v152 offset:9216
    buffer_load_dwordx4 v133, s[12:15], s48 offen offset:1024 sc1 lds
    v_mfma_f32_16x16x32_bf16 v[228:231], a[40:43], a[68:71], 0
    ds_read_b64_tr_b16 a[112:113], v151 offset:8192
    buffer_load_dwordx4 v134, s[12:15], s48 offen offset:2048 sc1 lds
    v_mfma_f32_16x16x32_bf16 v[232:235], a[40:43], a[72:75], 0
    ds_read_b64_tr_b16 a[114:115], v151 offset:9216
    buffer_load_dwordx4 v135, s[12:15], s48 offen offset:3072 sc1 lds
    v_mfma_f32_16x16x32_bf16 v[236:239], a[40:43], a[76:79], 0
    s_add_u32 s48, s48, s49
    v_mfma_f32_16x16x32_bf16 v[240:243], a[40:43], a[80:83], 0
    ds_read_b64_tr_b16 a[108:109], v154 offset:0
    s_and_b32 s52, s52, 0xffff
    s_add_u32 m0, s51, 8192
    v_mfma_f32_16x16x32_bf16 v[244:247], a[40:43], a[84:87], 0
    ds_read_b64_tr_b16 a[110:111], v154 offset:1024
    s_add_u32 s51, s51, 32768
    buffer_load_dwordx4 v128, s[8:11], s47 offen offset:0 sc1 lds
    v_mfma_f32_16x16x32_bf16 v[248:251], a[40:43], a[88:91], 0
    ds_read_b64_tr_b16 a[104:105], v153 offset:0
    buffer_load_dwordx4 v129, s[8:11], s47 offen offset:1024 sc1 lds
    v_mfma_f32_16x16x32_bf16 v[252:255], a[40:43], a[92:95], 0
    ds_read_b64_tr_b16 a[106:107], v153 offset:1024
    buffer_load_dwordx4 v130, s[8:11], s47 offen offset:2048 sc1 lds
    v_mfma_f32_16x16x32_bf16 a[252:255], a[44:47], a[92:95], 0
    buffer_load_dwordx4 v131, s[8:11], s47 offen offset:3072 sc1 lds
    v_mfma_f32_16x16x32_bf16 a[248:251], a[44:47], a[88:91], 0
    ds_read_b64_tr_b16 a[100:101], v152 offset:0
    s_cmp_ge_u32 s51, s79
    v_mfma_f32_16x16x32_bf16 a[244:247], a[44:47], a[84:87], 0
    ds_read_b64_tr_b16 a[102:103], v152 offset:1024
    s_cselect_b32 s51, s78, s51
    buffer_load_dword v158, v157, s[84:87], s88 offen
    v_mfma_f32_16x16x32_bf16 a[240:243], a[44:47], a[80:83], 0
    ds_read_b64_tr_b16 a[96:97], v151 offset:0
    s_add_u32 s88, s88, s89
    v_mfma_f32_16x16x32_bf16 a[236:239], a[44:47], a[76:79], 0
    ds_read_b64_tr_b16 a[98:99], v151 offset:1024
    s_add_u32 s53, s53, 1
    s_cmp_eq_u32 s53, 3
    v_mfma_f32_16x16x32_bf16 a[232:235], a[44:47], a[72:75], 0
    s_cselect_b32 s53, 0, s53
    s_cselect_b32 s93, -2, 1
    v_mfma_f32_16x16x32_bf16 a[228:231], a[44:47], a[68:71], 0
    s_lshl_b32 s93, s93, 15
    v_add_u32 v144, s93, v144
    v_mfma_f32_16x16x32_bf16 a[224:227], a[44:47], a[64:67], 0
    s_waitcnt lgkmcnt(15)
    v_mfma_f32_16x16x32_bf16 v[28:31], a[0:3], a[92:95], 0
    s_waitcnt lgkmcnt(14)
    s_add_u32 s54, s54, 16384
    v_mfma_f32_16x16x32_bf16 v[28:31], a[16:19], a[124:127], v[28:31]
    v_mfma_f32_16x16x32_bf16 v[24:27], a[0:3], a[88:91], 0
    s_waitcnt lgkmcnt(12)
    s_and_b32 s54, s54, 0xffff
    v_mfma_f32_16x16x32_bf16 v[24:27], a[16:19], a[120:123], v[24:27]
    v_mfma_f32_16x16x32_bf16 v[20:23], a[0:3], a[84:87], 0
    s_waitcnt lgkmcnt(10)
    v_add_u32 v151, s54, v146
    v_mfma_f32_16x16x32_bf16 v[20:23], a[16:19], a[116:119], v[20:23]
    v_mfma_f32_16x16x32_bf16 v[16:19], a[0:3], a[80:83], 0
    s_waitcnt lgkmcnt(8)
    v_add_u32 v152, s54, v147
    v_mfma_f32_16x16x32_bf16 v[16:19], a[16:19], a[112:115], v[16:19]
    v_mfma_f32_16x16x32_bf16 v[12:15], a[0:3], a[76:79], 0
    s_waitcnt lgkmcnt(6)
    v_add_u32 v153, s54, v148
    v_mfma_f32_16x16x32_bf16 v[12:15], a[16:19], a[108:111], v[12:15]
    v_mfma_f32_16x16x32_bf16 v[8:11], a[0:3], a[72:75], 0
    s_waitcnt lgkmcnt(4)
    v_add_u32 v154, s54, v149
    v_mfma_f32_16x16x32_bf16 v[8:11], a[16:19], a[104:107], v[8:11]
    v_mfma_f32_16x16x32_bf16 v[4:7], a[0:3], a[68:71], 0
    s_waitcnt lgkmcnt(2)
    v_mfma_f32_16x16x32_bf16 v[4:7], a[16:19], a[100:103], v[4:7]
    v_mfma_f32_16x16x32_bf16 v[0:3], a[0:3], a[64:67], 0
    s_waitcnt lgkmcnt(0)
    v_mfma_f32_16x16x32_bf16 v[0:3], a[16:19], a[96:99], v[0:3]
    s_waitcnt vmcnt(18)
    s_barrier
    v_mfma_f32_16x16x32_bf16 v[32:35], a[20:23], a[96:99], 0
    ds_read_b128 a[32:35], v144 offset:8192
    s_mov_b32 m0, s52
    v_mfma_f32_16x16x32_bf16 v[32:35], a[4:7], a[64:67], v[32:35]
    s_add_u32 s52, s52, 16384
    v_mfma_f32_16x16x32_bf16 v[36:39], a[4:7], a[68:71], 0
    buffer_load_dwordx4 v132, s[12:15], s48 offen offset:0 sc1 lds
    v_mfma_f32_16x16x32_bf16 v[36:39], a[20:23], a[100:103], v[36:39]
    ds_read_b128 a[48:51], v145 offset:8192
    v_mfma_f32_16x16x32_bf16 v[40:43], a[20:23], a[104:107], 0
    v_mfma_f32_16x16x32_bf16 v[40:43], a[4:7], a[72:75], v[40:43]
    buffer_load_dwordx4 v133, s[12:15], s48 offen offset:1024 sc1 lds
    v_mfma_f32_16x16x32_bf16 v[44:47], a[4:7], a[76:79], 0
    ds_read_b128 a[36:39], v144 offset:10240
    v_mfma_f32_16x16x32_bf16 v[44:47], a[20:23], a[108:111], v[44:47]
    buffer_load_dwordx4 v134, s[12:15], s48 offen offset:2048 sc1 lds
    v_mfma_f32_16x16x32_bf16 v[48:51], a[20:23], a[112:115], 0
    v_mfma_f32_16x16x32_bf16 v[48:51], a[4:7], a[80:83], v[48:51]
    ds_read_b128 a[52:55], v145 offset:10240
    v_mfma_f32_16x16x32_bf16 v[52:55], a[4:7], a[84:87], 0
    buffer_load_dwordx4 v135, s[12:15], s48 offen offset:3072 sc1 lds
    v_mfma_f32_16x16x32_bf16 v[52:55], a[20:23], a[116:119], v[52:55]
    v_mfma_f32_16x16x32_bf16 v[56:59], a[20:23], a[120:123], 0
    s_add_u32 s48, s48, s49
    v_mfma_f32_16x16x32_bf16 v[56:59], a[4:7], a[88:91], v[56:59]
    ds_read_b128 a[40:43], v144 offset:12288
    v_mfma_f32_16x16x32_bf16 v[60:63], a[4:7], a[92:95], 0
    s_and_b32 s52, s52, 0xffff
    v_mfma_f32_16x16x32_bf16 v[60:63], a[20:23], a[124:127], v[60:63]
    s_sub_u32 s56, s56, 1
    v_mfma_f32_16x16x32_bf16 v[92:95], a[24:27], a[124:127], 0
    ds_read_b128 a[56:59], v145 offset:12288
    s_cbranch_scc1 L1_sw22
L1_swr22:
    v_mfma_f32_16x16x32_bf16 v[92:95], a[8:11], a[92:95], v[92:95]
    v_mfma_f32_16x16x32_bf16 v[88:91], a[8:11], a[88:91], 0
    s_mov_b32 m0, s51
    v_mfma_f32_16x16x32_bf16 v[88:91], a[24:27], a[120:123], v[88:91]
    ds_read_b128 a[44:47], v144 offset:14336
    s_add_u32 s47, s46, s50
    v_mfma_f32_16x16x32_bf16 v[84:87], a[24:27], a[116:119], 0
    buffer_load_dwordx4 v128, s[8:11], s46 offen offset:0 sc1 lds
    v_mfma_f32_16x16x32_bf16 v[84:87], a[8:11], a[84:87], v[84:87]
    v_mfma_f32_16x16x32_bf16 v[80:83], a[8:11], a[80:83], 0
    ds_read_b128 a[60:63], v145 offset:14336
    v_mfma_f32_16x16x32_bf16 v[80:83], a[24:27], a[112:115], v[80:83]
    buffer_load_dwordx4 v129, s[8:11], s46 offen offset:1024 sc1 lds
    v_mfma_f32_16x16x32_bf16 v[76:79], a[24:27], a[108:111], 0
    v_mfma_f32_16x16x32_bf16 v[76:79], a[8:11], a[76:79], v[76:79]
    buffer_load_dwordx4 v130, s[8:11], s46 offen offset:2048 sc1 lds
    v_mfma_f32_16x16x32_bf16 v[72:75], a[8:11], a[72:75], 0
    v_mfma_f32_16x16x32_bf16 v[72:75], a[24:27], a[104:107], v[72:75]
    v_mfma_f32_16x16x32_bf16 v[68:71], a[24:27], a[100:103], 0
    buffer_load_dwordx4 v131, s[8:11], s46 offen offset:3072 sc1 lds
    v_mfma_f32_16x16x32_bf16 v[68:71], a[8:11], a[68:71], v[68:71]
    v_mfma_f32_16x16x32_bf16 v[64:67], a[8:11], a[64:67], 0
    v_mfma_f32_16x16x32_bf16 v[64:67], a[24:27], a[96:99], v[64:67]
    s_add_u32 s46, s46, s68
    s_waitcnt lgkmcnt(0)
    v_mfma_f32_16x16x32_bf16 v[96:99], a[12:15], a[64:67], 0
    ds_read_b64_tr_b16 a[64:65], v151 offset:0
    v_mfma_f32_16x16x32_bf16 v[96:99], a[28:31], a[96:99], v[96:99]
    ds_read_b64_tr_b16 a[66:67], v151 offset:1024
    v_mfma_f32_16x16x32_bf16 v[100:103], a[12:15], a[68:71], 0
    ds_read_b64_tr_b16 a[68:69], v152 offset:0
    v_mfma_f32_16x16x32_bf16 v[100:103], a[28:31], a[100:103], v[100:103]
    ds_read_b64_tr_b16 a[70:71], v152 offset:1024
    v_mfma_f32_16x16x32_bf16 v[104:107], a[12:15], a[72:75], 0
    ds_read_b64_tr_b16 a[72:73], v153 offset:0
    v_mfma_f32_16x16x32_bf16 v[104:107], a[28:31], a[104:107], v[104:107]
    ds_read_b64_tr_b16 a[74:75], v153 offset:1024
    v_mfma_f32_16x16x32_bf16 v[108:111], a[12:15], a[76:79], 0
    ds_read_b64_tr_b16 a[76:77], v154 offset:0
    v_mfma_f32_16x16x32_bf16 v[108:111], a[28:31], a[108:111], v[108:111]
    ds_read_b64_tr_b16 a[78:79], v154 offset:1024
    v_add_u32 v145, s93, v145
    v_mfma_f32_16x16x32_bf16 v[112:115], a[12:15], a[80:83], 0
    ds_read_b64_tr_b16 a[80:81], v151 offset:8192
    v_mfma_f32_16x16x32_bf16 v[112:115], a[28:31], a[112:115], v[112:115]
    ds_read_b64_tr_b16 a[82:83], v151 offset:9216
    v_mfma_f32_16x16x32_bf16 v[116:119], a[12:15], a[84:87], 0
    ds_read_b64_tr_b16 a[84:85], v152 offset:8192
    v_mfma_f32_16x16x32_bf16 v[116:119], a[28:31], a[116:119], v[116:119]
    ds_read_b64_tr_b16 a[86:87], v152 offset:9216
    v_mfma_f32_16x16x32_bf16 v[120:123], a[12:15], a[88:91], 0
    ds_read_b64_tr_b16 a[88:89], v153 offset:8192
    v_mfma_f32_16x16x32_bf16 v[120:123], a[28:31], a[120:123], v[120:123]
    ds_read_b64_tr_b16 a[90:91], v153 offset:9216
    v_mfma_f32_16x16x32_bf16 v[124:127], a[12:15], a[92:95], 0
    ds_read_b64_tr_b16 a[92:93], v154 offset:8192
    v_mfma_f32_16x16x32_bf16 v[124:127], a[28:31], a[124:127], v[124:127]
    ds_read_b64_tr_b16 a[94:95], v154 offset:9216
L1_vloop:
    v_mfma_f32_16x16x32_bf16 v[192:195], a[48:51], a[96:99], v[192:195]
    s_waitcnt lgkmcnt(14)
    s_add_u32 s54, s54, 16384
    v_mfma_f32_16x16x32_bf16 v[192:195], a[32:35], a[64:67], v[192:195]
    v_mfma_f32_16x16x32_bf16 v[196:199], a[48:51], a[100:103], v[196:199]
    s_waitcnt lgkmcnt(12)
    s_and_b32 s54, s54, 0xffff
    v_mfma_f32_16x16x32_bf16 v[196:199], a[32:35], a[68:71], v[196:199]
    v_mfma_f32_16x16x32_bf16 v[200:203], a[48:51], a[104:107], v[200:203]
    s_waitcnt lgkmcnt(10)
    v_add_u32 v151, s54, v146
    v_mfma_f32_16x16x32_bf16 v[200:203], a[32:35], a[72:75], v[200:203]
    v_mfma_f32_16x16x32_bf16 v[204:207], a[48:51], a[108:111], v[204:207]
    s_waitcnt lgkmcnt(8)
    v_add_u32 v152, s54, v147
    v_mfma_f32_16x16x32_bf16 v[204:207], a[32:35], a[76:79], v[204:207]
    v_mfma_f32_16x16x32_bf16 v[208:211], a[48:51], a[112:115], v[208:211]
    s_waitcnt lgkmcnt(6)
    v_add_u32 v153, s54, v148
    v_mfma_f32_16x16x32_bf16 v[208:211], a[32:35], a[80:83], v[208:211]
    v_mfma_f32_16x16x32_bf16 v[212:215], a[48:51], a[116:119], v[212:215]
    s_waitcnt lgkmcnt(4)
    v_add_u32 v154, s54, v149
    v_mfma_f32_16x16x32_bf16 v[212:215], a[32:35], a[84:87], v[212:215]
    v_mfma_f32_16x16x32_bf16 v[216:219], a[48:51], a[120:123], v[216:219]
    s_waitcnt lgkmcnt(2)
    v_mfma_f32_16x16x32_bf16 v[216:219], a[32:35], a[88:91], v[216:219]
    v_mfma_f32_16x16x32_bf16 v[220:223], a[48:51], a[124:127], v[220:223]
    s_waitcnt lgkmcnt(0)
    v_mfma_f32_16x16x32_bf16 v[220:223], a[32:35], a[92:95], v[220:223]
    s_waitcnt vmcnt(21)
    s_barrier
    v_mfma_f32_16x16x32_bf16 a[220:223], a[36:39], a[92:95], a[220:223]
    ds_read_b128 a[0:3], v144 offset:0
    s_sub_u32 s57, s57, 1
    v_mfma_f32_16x16x32_bf16 a[220:223], a[52:55], a[124:127], a[220:223]
    s_cbranch_scc1 L1_sw23
L1_swr23:
    v_mfma_f32_16x16x32_bf16 a[216:219], a[52:55], a[120:123], a[216:219]
    s_mov_b32 m0, s52
    v_mfma_f32_16x16x32_bf16 a[216:219], a[36:39], a[88:91], a[216:219]
    ds_read_b128 a[16:19], v145 offset:0
    s_add_u32 s52, s52, 16384
    v_mfma_f32_16x16x32_bf16 a[212:215], a[36:39], a[84:87], a[212:215]
    buffer_load_dwordx4 v132, s[12:15], s48 offen offset:0 sc1 lds
    v_mfma_f32_16x16x32_bf16 a[212:215], a[52:55], a[116:119], a[212:215]
    v_mfma_f32_16x16x32_bf16 a[208:211], a[52:55], a[112:115], a[208:211]
    ds_read_b128 a[4:7], v144 offset:2048
    v_mfma_f32_16x16x32_bf16 a[208:211], a[36:39], a[80:83], a[208:211]
    buffer_load_dwordx4 v133, s[12:15], s48 offen offset:1024 sc1 lds
    v_mfma_f32_16x16x32_bf16 a[204:207], a[36:39], a[76:79], a[204:207]
    buffer_load_dwordx4 v134, s[12:15], s48 offen offset:2048 sc1 lds
    v_mfma_f32_16x16x32_bf16 a[204:207], a[52:55], a[108:111], a[204:207]
    ds_read_b128 a[20:23], v145 offset:2048
    v_mfma_f32_16x16x32_bf16 a[200:203], a[52:55], a[104:107], a[200:203]
    v_mfma_f32_16x16x32_bf16 a[200:203], a[36:39], a[72:75], a[200:203]
    buffer_load_dwordx4 v135, s[12:15], s48 offen offset:3072 sc1 lds
    v_mfma_f32_16x16x32_bf16 a[196:199], a[36:39], a[68:71], a[196:199]
    v_mfma_f32_16x16x32_bf16 a[196:199], a[52:55], a[100:103], a[196:199]
    ds_read_b128 a[8:11], v144 offset:4096
    s_add_u32 s48, s48, s49
    v_mfma_f32_16x16x32_bf16 a[192:195], a[52:55], a[96:99], a[192:195]
    s_and_b32 s52, s52, 0xffff
    v_mfma_f32_16x16x32_bf16 a[192:195], a[36:39], a[64:67], a[192:195]
    s_add_u32 m0, s51, 8192
    v_mfma_f32_16x16x32_bf16 v[224:227], a[40:43], a[64:67], v[224:227]
    ds_read_b128 a[24:27], v145 offset:4096
    s_add_u32 s51, s51, 32768
    v_mfma_f32_16x16x32_bf16 v[224:227], a[56:59], a[96:99], v[224:227]
    buffer_load_dwordx4 v128, s[8:11], s47 offen offset:0 sc1 lds
    v_mfma_f32_16x16x32_bf16 v[228:231], a[56:59], a[100:103], v[228:231]
    v_mfma_f32_16x16x32_bf16 v[228:231], a[40:43], a[68:71], v[228:231]
    ds_read_b128 a[12:15], v144 offset:6144
    v_mfma_f32_16x16x32_bf16 v[232:235], a[40:43], a[72:75], v[232:235]
    buffer_load_dwordx4 v129, s[8:11], s47 offen offset:1024 sc1 lds
    v_mfma_f32_16x16x32_bf16 v[232:235], a[56:59], a[104:107], v[232:235]
    v_mfma_f32_16x16x32_bf16 v[236:239], a[56:59], a[108:111], v[236:239]
    ds_read_b128 a[28:31], v145 offset:6144
    v_mfma_f32_16x16x32_bf16 v[236:239], a[40:43], a[76:79], v[236:239]
    buffer_load_dwordx4 v130, s[8:11], s47 offen offset:2048 sc1 lds
    v_mfma_f32_16x16x32_bf16 v[240:243], a[40:43], a[80:83], v[240:243]
    buffer_load_dwordx4 v131, s[8:11], s47 offen offset:3072 sc1 lds
    v_mfma_f32_16x16x32_bf16 v[240:243], a[56:59], a[112:115], v[240:243]
    v_mfma_f32_16x16x32_bf16 v[244:247], a[56:59], a[116:119], v[244:247]
    s_cmp_ge_u32 s51, s79
    v_mfma_f32_16x16x32_bf16 v[244:247], a[40:43], a[84:87], v[244:247]
    s_cselect_b32 s51, s78, s51
    v_mfma_f32_16x16x32_bf16 v[248:251], a[40:43], a[88:91], v[248:251]
    buffer_load_dword v158, v157, s[84:87], s88 offen
    v_mfma_f32_16x16x32_bf16 v[248:251], a[56:59], a[120:123], v[248:251]
    v_mfma_f32_16x16x32_bf16 v[252:255], a[56:59], a[124:127], v[252:255]
    v_mfma_f32_16x16x32_bf16 v[252:255], a[40:43], a[92:95], v[252:255]
    s_add_u32 s88, s88, s89
    s_waitcnt lgkmcnt(0)
    v_mfma_f32_16x16x32_bf16 a[252:255], a[60:63], a[124:127], a[252:255]
    ds_read_b64_tr_b16 a[124:125], v154 offset:8192
    v_mfma_f32_16x16x32_bf16 a[252:255], a[44:47], a[92:95], a[252:255]
    ds_read_b64_tr_b16 a[126:127], v154 offset:9216
    s_add_u32 s53, s53, 1
    v_mfma_f32_16x16x32_bf16 a[248:251], a[60:63], a[120:123], a[248:251]
    ds_read_b64_tr_b16 a[120:121], v153 offset:8192
    v_mfma_f32_16x16x32_bf16 a[248:251], a[44:47], a[88:91], a[248:251]
    ds_read_b64_tr_b16 a[122:123], v153 offset:9216
    s_cmp_eq_u32 s53, 3
    v_mfma_f32_16x16x32_bf16 a[244:247], a[60:63], a[116:119], a[244:247]
    ds_read_b64_tr_b16 a[116:117], v152 offset:8192
    v_mfma_f32_16x16x32_bf16 a[244:247], a[44:47], a[84:87], a[244:247]
    ds_read_b64_tr_b16 a[118:119], v152 offset:9216
    s_cselect_b32 s53, 0, s53
    v_mfma_f32_16x16x32_bf16 a[240:243], a[60:63], a[112:115], a[240:243]
    ds_read_b64_tr_b16 a[112:113], v151 offset:8192
    v_mfma_f32_16x16x32_bf16 a[240:243], a[44:47], a[80:83], a[240:243]
    ds_read_b64_tr_b16 a[114:115], v151 offset:9216
    v_mfma_f32_16x16x32_bf16 a[236:239], a[60:63], a[108:111], a[236:239]
    ds_read_b64_tr_b16 a[108:109], v154 offset:0
    s_cselect_b32 s93, -2, 1
    v_mfma_f32_16x16x32_bf16 a[236:239], a[44:47], a[76:79], a[236:239]
    ds_read_b64_tr_b16 a[110:111], v154 offset:1024
    v_mfma_f32_16x16x32_bf16 a[232:235], a[60:63], a[104:107], a[232:235]
    ds_read_b64_tr_b16 a[104:105], v153 offset:0
    s_lshl_b32 s93, s93, 15
    v_mfma_f32_16x16x32_bf16 a[232:235], a[44:47], a[72:75], a[232:235]
    ds_read_b64_tr_b16 a[106:107], v153 offset:1024
    v_mfma_f32_16x16x32_bf16 a[228:231], a[60:63], a[100:103], a[228:231]
    ds_read_b64_tr_b16 a[100:101], v152 offset:0
    v_add_u32 v144, s93, v144
    v_mfma_f32_16x16x32_bf16 a[228:231], a[44:47], a[68:71], a[228:231]
    ds_read_b64_tr_b16 a[102:103], v152 offset:1024
    v_mfma_f32_16x16x32_bf16 a[224:227], a[60:63], a[96:99], a[224:227]
    ds_read_b64_tr_b16 a[96:97], v151 offset:0
    v_mfma_f32_16x16x32_bf16 a[224:227], a[44:47], a[64:67], a[224:227]
    ds_read_b64_tr_b16 a[98:99], v151 offset:1024
    v_mfma_f32_16x16x32_bf16 v[28:31], a[0:3], a[92:95], v[28:31]
    s_waitcnt lgkmcnt(14)
    s_add_u32 s54, s54, 16384
    v_mfma_f32_16x16x32_bf16 v[28:31], a[16:19], a[124:127], v[28:31]
    v_mfma_f32_16x16x32_bf16 v[24:27], a[0:3], a[88:91], v[24:27]
    s_waitcnt lgkmcnt(12)
    s_and_b32 s54, s54, 0xffff
    v_mfma_f32_16x16x32_bf16 v[24:27], a[16:19], a[120:123], v[24:27]
    v_mfma_f32_16x16x32_bf16 v[20:23], a[0:3], a[84:87], v[20:23]
    s_waitcnt lgkmcnt(10)
    v_add_u32 v151, s54, v146
    v_mfma_f32_16x16x32_bf16 v[20:23], a[16:19], a[116:119], v[20:23]
    v_mfma_f32_16x16x32_bf16 v[16:19], a[0:3], a[80:83], v[16:19]
    s_waitcnt lgkmcnt(8)
    v_add_u32 v152, s54, v147
    v_mfma_f32_16x16x32_bf16 v[16:19], a[16:19], a[112:115], v[16:19]
    v_mfma_f32_16x16x32_bf16 v[12:15], a[0:3], a[76:79], v[12:15]
    s_waitcnt lgkmcnt(6)
    v_add_u32 v153, s54, v148
    v_mfma_f32_16x16x32_bf16 v[12:15], a[16:19], a[108:111], v[12:15]
    v_mfma_f32_16x16x32_bf16 v[8:11], a[0:3], a[72:75], v[8:11]
    s_waitcnt lgkmcnt(4)
    v_add_u32 v154, s54, v149
    v_mfma_f32_16x16x32_bf16 v[8:11], a[16:19], a[104:107], v[8:11]
    v_mfma_f32_16x16x32_bf16 v[4:7], a[0:3], a[68:71], v[4:7]
    s_waitcnt lgkmcnt(2)
    v_mfma_f32_16x16x32_bf16 v[4:7], a[16:19], a[100:103], v[4:7]
    v_mfma_f32_16x16x32_bf16 v[0:3], a[0:3], a[64:67], v[0:3]
    s_waitcnt lgkmcnt(0)
    v_mfma_f32_16x16x32_bf16 v[0:3], a[16:19], a[96:99], v[0:3]
    s_waitcnt vmcnt(18)
    s_barrier
    v_mfma_f32_16x16x32_bf16 v[32:35], a[20:23], a[96:99], v[32:35]
    ds_read_b128 a[32:35], v144 offset:8192
    s_mov_b32 m0, s52
    v_mfma_f32_16x16x32_bf16 v[32:35], a[4:7], a[64:67], v[32:35]
    s_add_u32 s52, s52, 16384
    v_mfma_f32_16x16x32_bf16 v[36:39], a[4:7], a[68:71], v[36:39]
    buffer_load_dwordx4 v132, s[12:15], s48 offen offset:0 sc1 lds
    v_mfma_f32_16x16x32_bf16 v[36:39], a[20:23], a[100:103], v[36:39]
    ds_read_b128 a[48:51], v145 offset:8192
    v_mfma_f32_16x16x32_bf16 v[40:43], a[20:23], a[104:107], v[40:43]
    v_mfma_f32_16x16x32_bf16 v[40:43], a[4:7], a[72:75], v[40:43]
    buffer_load_dwordx4 v133, s[12:15], s48 offen offset:1024 sc1 lds
    v_mfma_f32_16x16x32_bf16 v[44:47], a[4:7], a[76:79], v[44:47]
    ds_read_b128 a[36:39], v144 offset:10240
    v_mfma_f32_16x16x32_bf16 v[44:47], a[20:23], a[108:111], v[44:47]
    buffer_load_dwordx4 v134, s[12:15], s48 offen offset:2048 sc1 lds
    v_mfma_f32_16x16x32_bf16 v[48:51], a[20:23], a[112:115], v[48:51]
    v_mfma_f32_16x16x32_bf16 v[48:51], a[4:7], a[80:83], v[48:51]
    ds_read_b128 a[52:55], v145 offset:10240
    v_mfma_f32_16x16x32_bf16 v[52:55], a[4:7], a[84:87], v[52:55]
    buffer_load_dwordx4 v135, s[12:15], s48 offen offset:3072 sc1 lds
    v_mfma_f32_16x16x32_bf16 v[52:55], a[20:23], a[116:119], v[52:55]
    v_mfma_f32_16x16x32_bf16 v[56:59], a[20:23], a[120:123], v[56:59]
    s_add_u32 s48, s48, s49
    v_mfma_f32_16x16x32_bf16 v[56:59], a[4:7], a[88:91], v[56:59]
    ds_read_b128 a[40:43], v144 offset:12288
    v_mfma_f32_16x16x32_bf16 v[60:63], a[4:7], a[92:95], v[60:63]
    s_and_b32 s52, s52, 0xffff
    v_mfma_f32_16x16x32_bf16 v[60:63], a[20:23], a[124:127], v[60:63]
    s_sub_u32 s56, s56, 1
    v_mfma_f32_16x16x32_bf16 v[92:95], a[24:27], a[124:127], v[92:95]
    ds_read_b128 a[56:59], v145 offset:12288
    s_cbranch_scc1 L1_sw24
L1_swr24:
    v_mfma_f32_16x16x32_bf16 v[92:95], a[8:11], a[92:95], v[92:95]
    v_mfma_f32_16x16x32_bf16 v[88:91], a[8:11], a[88:91], v[88:91]
    s_mov_b32 m0, s51
    v_mfma_f32_16x16x32_bf16 v[88:91], a[24:27], a[120:123], v[88:91]
    ds_read_b128 a[44:47], v144 offset:14336
    s_add_u32 s47, s46, s50
    v_mfma_f32_16x16x32_bf16 v[84:87], a[24:27], a[116:119], v[84:87]
    buffer_load_dwordx4 v128, s[8:11], s46 offen offset:0 sc1 lds
    v_mfma_f32_16x16x32_bf16 v[84:87], a[8:11], a[84:87], v[84:87]
    v_mfma_f32_16x16x32_bf16 v[80:83], a[8:11], a[80:83], v[80:83]
    ds_read_b128 a[60:63], v145 offset:14336
    v_mfma_f32_16x16x32_bf16 v[80:83], a[24:27], a[112:115], v[80:83]
    buffer_load_dwordx4 v129, s[8:11], s46 offen offset:1024 sc1 lds
    v_mfma_f32_16x16x32_bf16 v[76:79], a[24:27], a[108:111], v[76:79]
    v_mfma_f32_16x16x32_bf16 v[76:79], a[8:11], a[76:79], v[76:79]
    buffer_load_dwordx4 v130, s[8:11], s46 offen offset:2048 sc1 lds
    v_mfma_f32_16x16x32_bf16 v[72:75], a[8:11], a[72:75], v[72:75]
    v_mfma_f32_16x16x32_bf16 v[72:75], a[24:27], a[104:107], v[72:75]
    v_mfma_f32_16x16x32_bf16 v[68:71], a[24:27], a[100:103], v[68:71]
    buffer_load_dwordx4 v131, s[8:11], s46 offen offset:3072 sc1 lds
    v_mfma_f32_16x16x32_bf16 v[68:71], a[8:11], a[68:71], v[68:71]
    v_mfma_f32_16x16x32_bf16 v[64:67], a[8:11], a[64:67], v[64:67]
    v_mfma_f32_16x16x32_bf16 v[64:67], a[24:27], a[96:99], v[64:67]
    s_add_u32 s46, s46, s68
    s_waitcnt lgkmcnt(0)
    v_mfma_f32_16x16x32_bf16 v[96:99], a[12:15], a[64:67], v[96:99]
    ds_read_b64_tr_b16 a[64:65], v151 offset:0
    v_mfma_f32_16x16x32_bf16 v[96:99], a[28:31], a[96:99], v[96:99]
    ds_read_b64_tr_b16 a[66:67], v151 offset:1024
    v_mfma_f32_16x16x32_bf16 v[100:103], a[12:15], a[68:71], v[100:103]
    ds_read_b64_tr_b16 a[68:69], v152 offset:0
    v_mfma_f32_16x16x32_bf16 v[100:103], a[28:31], a[100:103], v[100:103]
    ds_read_b64_tr_b16 a[70:71], v152 offset:1024
    v_mfma_f32_16x16x32_bf16 v[104:107], a[12:15], a[72:75], v[104:107]
    ds_read_b64_tr_b16 a[72:73], v153 offset:0
    s_sub_u32 s55, s55, 1
    v_mfma_f32_16x16x32_bf16 v[104:107], a[28:31], a[104:107], v[104:107]
    ds_read_b64_tr_b16 a[74:75], v153 offset:1024
    v_mfma_f32_16x16x32_bf16 v[108:111], a[12:15], a[76:79], v[108:111]
    ds_read_b64_tr_b16 a[76:77], v154 offset:0
    v_mfma_f32_16x16x32_bf16 v[108:111], a[28:31], a[108:111], v[108:111]
    ds_read_b64_tr_b16 a[78:79], v154 offset:1024
    v_mfma_f32_16x16x32_bf16 v[112:115], a[12:15], a[80:83], v[112:115]
    ds_read_b64_tr_b16 a[80:81], v151 offset:8192
    v_mfma_f32_16x16x32_bf16 v[112:115], a[28:31], a[112:115], v[112:115]
    ds_read_b64_tr_b16 a[82:83], v151 offset:9216
    v_add_u32 v145, s93, v145
    v_mfma_f32_16x16x32_bf16 v[116:119], a[12:15], a[84:87], v[116:119]
    ds_read_b64_tr_b16 a[84:85], v152 offset:8192
    v_mfma_f32_16x16x32_bf16 v[116:119], a[28:31], a[116:119], v[116:119]
    ds_read_b64_tr_b16 a[86:87], v152 offset:9216
    v_mfma_f32_16x16x32_bf16 v[120:123], a[12:15], a[88:91], v[120:123]
    ds_read_b64_tr_b16 a[88:89], v153 offset:8192
    v_mfma_f32_16x16x32_bf16 v[120:123], a[28:31], a[120:123], v[120:123]
    ds_read_b64_tr_b16 a[90:91], v153 offset:9216
    v_mfma_f32_16x16x32_bf16 v[124:127], a[12:15], a[92:95], v[124:127]
    ds_read_b64_tr_b16 a[92:93], v154 offset:8192
    v_mfma_f32_16x16x32_bf16 v[124:127], a[28:31], a[124:127], v[124:127]
    ds_read_b64_tr_b16 a[94:95], v154 offset:9216
    s_cmp_lg_u32 s55, 0
    s_cbranch_scc1 L1_vloop
    s_cmp_eq_u32 s96, 1
    s_cbranch_scc1 L1_end2v
    s_cmp_eq_u32 s44, 4
    s_cbranch_scc1 L1_gate
    v_mfma_f32_16x16x32_bf16 v[192:195], a[48:51], a[96:99], v[192:195]
    v_mfma_f32_16x16x32_bf16 v[196:199], a[48:51], a[100:103], v[196:199]
    v_mfma_f32_16x16x32_bf16 v[200:203], a[48:51], a[104:107], v[200:203]
    s_lshr_b32 s4, s58, 1
    s_lshl_b32 s4, s4, 16
    s_and_b32 s5, s58, 1
    v_mfma_f32_16x16x32_bf16 v[204:207], a[48:51], a[108:111], v[204:207]
    s_lshl_b32 s5, s5, 12
    s_add_u32 s4, s4, s5
    s_add_u32 s98, s4, s30
    v_mfma_f32_16x16x32_bf16 v[208:211], a[48:51], a[112:115], v[208:211]
    v_add_u32 v156, 2048, v155
    v_cvt_pk_bf16_f32 v0, v0, v1
    v_mfma_f32_16x16x32_bf16 v[212:215], a[48:51], a[116:119], v[212:215]
    v_cvt_pk_bf16_f32 v1, v2, v3
    v_cvt_pk_bf16_f32 v2, v32, v33
    v_mfma_f32_16x16x32_bf16 v[216:219], a[48:51], a[120:123], v[216:219]
    v_cvt_pk_bf16_f32 v3, v34, v35
    v_mfma_f32_16x16x32_bf16 v[220:223], a[48:51], a[124:127], v[220:223]
    buffer_store_dwordx4 v[0:3], v155, s[16:19], s98 offen offset:0 sc0 sc1
    v_mfma_f32_16x16x32_bf16 a[220:223], a[52:55], a[124:127], a[220:223]
    v_cvt_pk_bf16_f32 v4, v4, v5
    v_cvt_pk_bf16_f32 v5, v6, v7
    v_mfma_f32_16x16x32_bf16 a[216:219], a[52:55], a[120:123], a[216:219]
    v_cvt_pk_bf16_f32 v6, v36, v37
    v_cvt_pk_bf16_f32 v7, v38, v39
    v_mfma_f32_16x16x32_bf16 a[212:215], a[52:55], a[116:119], a[212:215]
    buffer_store_dwordx4 v[4:7], v155, s[16:19], s98 offen offset:1024 sc0 sc1
    v_mfma_f32_16x16x32_bf16 a[208:211], a[52:55], a[112:115], a[208:211]
    v_cvt_pk_bf16_f32 v8, v8, v9
    v_cvt_pk_bf16_f32 v9, v10, v11
    v_mfma_f32_16x16x32_bf16 a[204:207], a[52:55], a[108:111], a[204:207]
    v_cvt_pk_bf16_f32 v10, v40, v41
    v_cvt_pk_bf16_f32 v11, v42, v43
    v_mfma_f32_16x16x32_bf16 a[200:203], a[52:55], a[104:107], a[200:203]
    buffer_store_dwordx4 v[8:11], v156, s[16:19], s98 offen offset:0 sc0 sc1
    v_mfma_f32_16x16x32_bf16 a[196:199], a[52:55], a[100:103], a[196:199]
    v_cvt_pk_bf16_f32 v12, v12, v13
    v_cvt_pk_bf16_f32 v13, v14, v15
    v_mfma_f32_16x16x32_bf16 a[192:195], a[52:55], a[96:99], a[192:195]
    v_cvt_pk_bf16_f32 v14, v44, v45
    v_cvt_pk_bf16_f32 v15, v46, v47
    v_mfma_f32_16x16x32_bf16 v[224:227], a[56:59], a[96:99], v[224:227]
    buffer_store_dwordx4 v[12:15], v156, s[16:19], s98 offen offset:1024 sc0 sc1
    v_mfma_f32_16x16x32_bf16 v[228:231], a[56:59], a[100:103], v[228:231]
    s_add_u32 s98, s98, 8192
    v_cvt_pk_bf16_f32 v16, v16, v17
    v_cvt_pk_bf16_f32 v17, v18, v19
    v_mfma_f32_16x16x32_bf16 v[232:235], a[56:59], a[104:107], v[232:235]
    v_cvt_pk_bf16_f32 v18, v48, v49
    v_cvt_pk_bf16_f32 v19, v50, v51
    v_mfma_f32_16x16x32_bf16 v[236:239], a[56:59], a[108:111], v[236:239]
    buffer_store_dwordx4 v[16:19], v155, s[16:19], s98 offen offset:0 sc0 sc1
    v_mfma_f32_16x16x32_bf16 v[240:243], a[56:59], a[112:115], v[240:243]
    v_cvt_pk_bf16_f32 v20, v20, v21
    v_cvt_pk_bf16_f32 v21, v22, v23
    v_mfma_f32_16x16x32_bf16 v[244:247], a[56:59], a[116:119], v[244:247]
    v_cvt_pk_bf16_f32 v22, v52, v53
    v_cvt_pk_bf16_f32 v23, v54, v55
    v_mfma_f32_16x16x32_bf16 v[248:251], a[56:59], a[120:123], v[248:251]
    buffer_store_dwordx4 v[20:23], v155, s[16:19], s98 offen offset:1024 sc0 sc1
    v_mfma_f32_16x16x32_bf16 v[252:255], a[56:59], a[124:127], v[252:255]
    v_cvt_pk_bf16_f32 v24, v24, v25
    v_cvt_pk_bf16_f32 v25, v26, v27
    v_mfma_f32_16x16x32_bf16 a[252:255], a[60:63], a[124:127], a[252:255]
    v_cvt_pk_bf16_f32 v26, v56, v57
    v_cvt_pk_bf16_f32 v27, v58, v59
    v_mfma_f32_16x16x32_bf16 a[248:251], a[60:63], a[120:123], a[248:251]
    buffer_store_dwordx4 v[24:27], v156, s[16:19], s98 offen offset:0 sc0 sc1
    v_mfma_f32_16x16x32_bf16 a[244:247], a[60:63], a[116:119], a[244:247]
    v_cvt_pk_bf16_f32 v28, v28, v29
    v_cvt_pk_bf16_f32 v29, v30, v31
    v_mfma_f32_16x16x32_bf16 a[240:243], a[60:63], a[112:115], a[240:243]
    v_cvt_pk_bf16_f32 v30, v60, v61
    v_cvt_pk_bf16_f32 v31, v62, v63
    v_mfma_f32_16x16x32_bf16 a[236:239], a[60:63], a[108:111], a[236:239]
    buffer_store_dwordx4 v[28:31], v156, s[16:19], s98 offen offset:1024 sc0 sc1
    v_mfma_f32_16x16x32_bf16 a[232:235], a[60:63], a[104:107], a[232:235]
    s_add_u32 s98, s98, 8192
    v_cvt_pk_bf16_f32 v64, v64, v65
    v_cvt_pk_bf16_f32 v65, v66, v67
    v_mfma_f32_16x16x32_bf16 a[228:231], a[60:63], a[100:103], a[228:231]
    v_cvt_pk_bf16_f32 v66, v96, v97
    v_cvt_pk_bf16_f32 v67, v98, v99
    v_mfma_f32_16x16x32_bf16 a[224:227], a[60:63], a[96:99], a[224:227]
    buffer_store_dwordx4 v[64:67], v155, s[16:19], s98 offen offset:0 sc0 sc1
    v_cvt_pk_bf16_f32 v68, v68, v69
    v_cvt_pk_bf16_f32 v69, v70, v71
    v_cvt_pk_bf16_f32 v70, v100, v101
    v_cvt_pk_bf16_f32 v71, v102, v103
    buffer_store_dwordx4 v[68:71], v155, s[16:19], s98 offen offset:1024 sc0 sc1
    v_cvt_pk_bf16_f32 v168, v72, v73
    v_cvt_pk_bf16_f32 v169, v74, v75
    v_cvt_pk_bf16_f32 v170, v104, v105
    v_cvt_pk_bf16_f32 v171, v106, v107
    v_cvt_pk_bf16_f32 v172, v76, v77
    v_cvt_pk_bf16_f32 v173, v78, v79
    v_cvt_pk_bf16_f32 v174, v108, v109
    v_cvt_pk_bf16_f32 v175, v110, v111
    v_cvt_pk_bf16_f32 v176, v80, v81
    v_cvt_pk_bf16_f32 v177, v82, v83
    v_cvt_pk_bf16_f32 v178, v112, v113
    v_cvt_pk_bf16_f32 v179, v114, v115
    v_cvt_pk_bf16_f32 v180, v84, v85
    v_cvt_pk_bf16_f32 v181, v86, v87
    v_cvt_pk_bf16_f32 v182, v116, v117
    v_cvt_pk_bf16_f32 v183, v118, v119
    v_cvt_pk_bf16_f32 v184, v88, v89
    v_cvt_pk_bf16_f32 v185, v90, v91
    v_cvt_pk_bf16_f32 v186, v120, v121
    v_cvt_pk_bf16_f32 v187, v122, v123
    v_cvt_pk_bf16_f32 v188, v92, v93
    v_cvt_pk_bf16_f32 v189, v94, v95
    v_cvt_pk_bf16_f32 v190, v124, v125
    v_cvt_pk_bf16_f32 v191, v126, v127
    v_accvgpr_read_b32 v0, a192
    v_accvgpr_read_b32 v1, a193
    v_accvgpr_read_b32 v2, a194
    v_accvgpr_read_b32 v3, a195
    v_cvt_pk_bf16_f32 v192, v192, v193
    v_cvt_pk_bf16_f32 v193, v194, v195
    v_cvt_pk_bf16_f32 v194, v0, v1
    v_cvt_pk_bf16_f32 v195, v2, v3
    v_accvgpr_write_b32 a128, v192
    v_accvgpr_write_b32 a129, v193
    v_accvgpr_write_b32 a130, v194
    v_accvgpr_write_b32 a131, v195
    v_accvgpr_read_b32 v4, a196
    v_accvgpr_read_b32 v5, a197
    v_accvgpr_read_b32 v6, a198
    v_accvgpr_read_b32 v7, a199
    v_cvt_pk_bf16_f32 v196, v196, v197
    v_cvt_pk_bf16_f32 v197, v198, v199
    v_cvt_pk_bf16_f32 v198, v4, v5
    v_cvt_pk_bf16_f32 v199, v6, v7
    v_accvgpr_write_b32 a132, v196
    v_accvgpr_write_b32 a133, v197
    v_accvgpr_write_b32 a134, v198
    v_accvgpr_write_b32 a135, v199
    v_accvgpr_read_b32 v8, a200
    v_accvgpr_read_b32 v9, a201
    v_accvgpr_read_b32 v10, a202
    v_accvgpr_read_b32 v11, a203
    v_cvt_pk_bf16_f32 v200, v200, v201
    v_cvt_pk_bf16_f32 v201, v202, v203
    v_cvt_pk_bf16_f32 v202, v8, v9
    v_cvt_pk_bf16_f32 v203, v10, v11
    v_accvgpr_write_b32 a136, v200
    v_accvgpr_write_b32 a137, v201
    v_accvgpr_write_b32 a138, v202
    v_accvgpr_write_b32 a139, v203
    v_accvgpr_read_b32 v12, a204
    v_accvgpr_read_b32 v13, a205
    v_accvgpr_read_b32 v14, a206
    v_accvgpr_read_b32 v15, a207
    v_cvt_pk_bf16_f32 v204, v204, v205
    v_cvt_pk_bf16_f32 v205, v206, v207
    v_cvt_pk_bf16_f32 v206, v12, v13
    v_cvt_pk_bf16_f32 v207, v14, v15
    v_accvgpr_write_b32 a140, v204
    v_accvgpr_write_b32 a141, v205
    v_accvgpr_write_b32 a142, v206
    v_accvgpr_write_b32 a143, v207
    v_accvgpr_read_b32 v0, a208
    v_accvgpr_read_b32 v1, a209
    v_accvgpr_read_b32 v2, a210
    v_accvgpr_read_b32 v3, a211
    v_cvt_pk_bf16_f32 v208, v208, v209
    v_cvt_pk_bf16_f32 v209, v210, v211
    v_cvt_pk_bf16_f32 v210, v0, v1
    v_cvt_pk_bf16_f32 v211, v2, v3
    v_accvgpr_write_b32 a144, v208
    v_accvgpr_write_b32 a145, v209
    v_accvgpr_write_b32 a146, v210
    v_accvgpr_write_b32 a147, v211
    v_accvgpr_read_b32 v4, a212
    v_accvgpr_read_b32 v5, a213
    v_accvgpr_read_b32 v6, a214
    v_accvgpr_read_b32 v7, a215
    v_cvt_pk_bf16_f32 v212, v212, v213
    v_cvt_pk_bf16_f32 v213, v214, v215
    v_cvt_pk_bf16_f32 v214, v4, v5
    v_cvt_pk_bf16_f32 v215, v6, v7
    v_accvgpr_write_b32 a148, v212
    v_accvgpr_write_b32 a149, v213
    v_accvgpr_write_b32 a150, v214
    v_accvgpr_write_b32 a151, v215
    v_accvgpr_read_b32 v8, a216
    v_accvgpr_read_b32 v9, a217
    v_accvgpr_read_b32 v10, a218
    v_accvgpr_read_b32 v11, a219
    v_cvt_pk_bf16_f32 v216, v216, v217
    v_cvt_pk_bf16_f32 v217, v218, v219
    v_cvt_pk_bf16_f32 v218, v8, v9
    v_cvt_pk_bf16_f32 v219, v10, v11
    v_accvgpr_write_b32 a152, v216
    v_accvgpr_write_b32 a153, v217
    v_accvgpr_write_b32 a154, v218
    v_accvgpr_write_b32 a155, v219
    v_accvgpr_read_b32 v12, a220
    v_accvgpr_read_b32 v13, a221
    v_accvgpr_read_b32 v14, a222
    v_accvgpr_read_b32 v15, a223
    v_cvt_pk_bf16_f32 v220, v220, v221
    v_cvt_pk_bf16_f32 v221, v222, v223
    v_cvt_pk_bf16_f32 v222, v12, v13
    v_cvt_pk_bf16_f32 v223, v14, v15
    v_accvgpr_write_b32 a156, v220
    v_accvgpr_write_b32 a157, v221
    v_accvgpr_write_b32 a158, v222
    v_accvgpr_write_b32 a159, v223
    v_accvgpr_read_b32 v0, a224
    v_accvgpr_read_b32 v1, a225
    v_accvgpr_read_b32 v2, a226
    v_accvgpr_read_b32 v3, a227
    v_cvt_pk_bf16_f32 v224, v224, v225
    v_cvt_pk_bf16_f32 v225, v226, v227
    v_cvt_pk_bf16_f32 v226, v0, v1
    v_cvt_pk_bf16_f32 v227, v2, v3
    v_accvgpr_write_b32 a160, v224
    v_accvgpr_write_b32 a161, v225
    v_accvgpr_write_b32 a162, v226
    v_accvgpr_write_b32 a163, v227
    v_accvgpr_read_b32 v4, a228
    v_accvgpr_read_b32 v5, a229
    v_accvgpr_read_b32 v6, a230
    v_accvgpr_read_b32 v7, a231
    v_cvt_pk_bf16_f32 v228, v228, v229
    v_cvt_pk_bf16_f32 v229, v230, v231
    v_cvt_pk_bf16_f32 v230, v4, v5
    v_cvt_pk_bf16_f32 v231, v6, v7
    v_accvgpr_write_b32 a164, v228
    v_accvgpr_write_b32 a165, v229
    v_accvgpr_write_b32 a166, v230
    v_accvgpr_write_b32 a167, v231
    v_accvgpr_read_b32 v8, a232
    v_accvgpr_read_b32 v9, a233
    v_accvgpr_read_b32 v10, a234
    v_accvgpr_read_b32 v11, a235
    v_cvt_pk_bf16_f32 v232, v232, v233
    v_cvt_pk_bf16_f32 v233, v234, v235
    v_cvt_pk_bf16_f32 v234, v8, v9
    v_cvt_pk_bf16_f32 v235, v10, v11
    v_accvgpr_write_b32 a168, v232
    v_accvgpr_write_b32 a169, v233
    v_accvgpr_write_b32 a170, v234
    v_accvgpr_write_b32 a171, v235
    v_accvgpr_read_b32 v12, a236
    v_accvgpr_read_b32 v13, a237
    v_accvgpr_read_b32 v14, a238
    v_accvgpr_read_b32 v15, a239
    v_cvt_pk_bf16_f32 v236, v236, v237
    v_cvt_pk_bf16_f32 v237, v238, v239
    v_cvt_pk_bf16_f32 v238, v12, v13
    v_cvt_pk_bf16_f32 v239, v14, v15
    v_accvgpr_write_b32 a172, v236
    v_accvgpr_write_b32 a173, v237
    v_accvgpr_write_b32 a174, v238
    v_accvgpr_write_b32 a175, v239
    v_accvgpr_read_b32 v0, a240
    v_accvgpr_read_b32 v1, a241
    v_accvgpr_read_b32 v2, a242
    v_accvgpr_read_b32 v3, a243
    v_cvt_pk_bf16_f32 v240, v240, v241
    v_cvt_pk_bf16_f32 v241, v242, v243
    v_cvt_pk_bf16_f32 v242, v0, v1
    v_cvt_pk_bf16_f32 v243, v2, v3
    v_accvgpr_write_b32 a176, v240
    v_accvgpr_write_b32 a177, v241
    v_accvgpr_write_b32 a178, v242
    v_accvgpr_write_b32 a179, v243
    v_accvgpr_read_b32 v4, a244
    v_accvgpr_read_b32 v5, a245
    v_accvgpr_read_b32 v6, a246
    v_accvgpr_read_b32 v7, a247
    v_cvt_pk_bf16_f32 v244, v244, v245
    v_cvt_pk_bf16_f32 v245, v246, v247
    v_cvt_pk_bf16_f32 v246, v4, v5
    v_cvt_pk_bf16_f32 v247, v6, v7
    v_accvgpr_write_b32 a180, v244
    v_accvgpr_write_b32 a181, v245
    v_accvgpr_write_b32 a182, v246
    v_accvgpr_write_b32 a183, v247
    v_accvgpr_read_b32 v8, a248
    v_accvgpr_read_b32 v9, a249
    v_accvgpr_read_b32 v10, a250
    v_accvgpr_read_b32 v11, a251
    v_cvt_pk_bf16_f32 v248, v248, v249
    v_cvt_pk_bf16_f32 v249, v250, v251
    v_cvt_pk_bf16_f32 v250, v8, v9
    v_cvt_pk_bf16_f32 v251, v10, v11
    v_accvgpr_write_b32 a184, v248
    v_accvgpr_write_b32 a185, v249
    v_accvgpr_write_b32 a186, v250
    v_accvgpr_write_b32 a187, v251
    v_accvgpr_read_b32 v12, a252
    v_accvgpr_read_b32 v13, a253
    v_accvgpr_read_b32 v14, a254
    v_accvgpr_read_b32 v15, a255
    v_cvt_pk_bf16_f32 v252, v252, v253
    v_cvt_pk_bf16_f32 v253, v254, v255
    v_cvt_pk_bf16_f32 v254, v12, v13
    v_cvt_pk_bf16_f32 v255, v14, v15
    v_accvgpr_write_b32 a188, v252
    v_accvgpr_write_b32 a189, v253
    v_accvgpr_write_b32 a190, v254
    v_accvgpr_write_b32 a191, v255
    s_branch L1_job2k
L1_end2v:
    v_mfma_f32_16x16x32_bf16 v[192:195], a[48:51], a[96:99], v[192:195]
    s_barrier
    s_add_u32 m0, s51, 8192
    s_add_u32 s51, s51, 32768
    v_mfma_f32_16x16x32_bf16 v[196:199], a[48:51], a[100:103], v[196:199]
    buffer_load_dwordx4 v128, s[8:11], s47 offen offset:0 sc1 lds
    v_mfma_f32_16x16x32_bf16 v[200:203], a[48:51], a[104:107], v[200:203]
    buffer_load_dwordx4 v129, s[8:11], s47 offen offset:1024 sc1 lds
    v_mfma_f32_16x16x32_bf16 v[204:207], a[48:51], a[108:111], v[204:207]
    buffer_load_dwordx4 v130, s[8:11], s47 offen offset:2048 sc1 lds
    v_mfma_f32_16x16x32_bf16 v[208:211], a[48:51], a[112:115], v[208:211]
    buffer_load_dwordx4 v131, s[8:11], s47 offen offset:3072 sc1 lds
    v_mfma_f32_16x16x32_bf16 v[212:215], a[48:51], a[116:119], v[212:215]
    s_cmp_ge_u32 s51, s79
    s_cselect_b32 s51, s78, s51
    s_mov_b32 s90, s67
    v_mfma_f32_16x16x32_bf16 v[216:219], a[48:51], a[120:123], v[216:219]
    s_add_u32 s91, s67, 4096
    s_add_u32 s92, s67, 32768
    s_add_u32 s93, s67, 36864
    v_mfma_f32_16x16x32_bf16 v[220:223], a[48:51], a[124:127], v[220:223]
    s_mov_b32 s96, s44
    s_mov_b32 s78, s43
    s_waitcnt vmcnt(12)
    v_mfma_f32_16x16x32_bf16 a[220:223], a[52:55], a[124:127], a[220:223]
    buffer_load_dwordx4 a[128:131], v155, s[16:19], s90 offen offset:0 sc0 sc1
    v_mfma_f32_16x16x32_bf16 a[216:219], a[52:55], a[120:123], a[216:219]
    s_bfe_u32 s22, s3, 0x10003
    s_lshl_b32 s23, s59, 1
    s_add_u32 s23, s23, s22
    v_mfma_f32_16x16x32_bf16 a[212:215], a[52:55], a[116:119], a[212:215]
    s_lshr_b32 s25, s3, 4
    s_and_b32 s24, s3, 7
    s_sub_u32 s36, 15, s24
    v_mfma_f32_16x16x32_bf16 a[208:211], a[52:55], a[112:115], a[208:211]
    buffer_load_dwordx4 a[132:135], v155, s[16:19], s90 offen offset:1024 sc0 sc1
    v_mfma_f32_16x16x32_bf16 a[204:207], a[52:55], a[108:111], a[204:207]
    s_and_b32 s4, s3, 0x17
    s_cmp_eq_u32 s4, 23
    s_cselect_b32 s36, 7, s36
    v_mfma_f32_16x16x32_bf16 a[200:203], a[52:55], a[104:107], a[200:203]
    s_lshl_b32 s4, s58, 12
    v_add_u32 v152, s4, v155
    v_mov_b32 v163, 0x80000000
    v_mfma_f32_16x16x32_bf16 a[196:199], a[52:55], a[100:103], a[196:199]
    buffer_load_dwordx4 a[136:139], v155, s[16:19], s90 offen offset:2048 sc0 sc1
    v_mfma_f32_16x16x32_bf16 a[192:195], a[52:55], a[96:99], a[192:195]
    s_add_u32 s45, s4, 65536
    s_add_u32 s46, s45, 98304
    s_mov_b32 s33, 0x47800000
    v_mfma_f32_16x16x32_bf16 v[224:227], a[56:59], a[96:99], v[224:227]
    s_mov_b32 s49, 0xf149f2ca
    s_mov_b32 s41, 2
    s_mov_b32 s21, 0x3f803f80
    v_mfma_f32_16x16x32_bf16 v[228:231], a[56:59], a[100:103], v[228:231]
    buffer_load_dwordx4 a[140:143], v155, s[16:19], s90 offen offset:3072 sc0 sc1
    v_mfma_f32_16x16x32_bf16 v[232:235], a[56:59], a[104:107], v[232:235]
    s_lshl_b32 s4, s24, 2
    s_sub_u32 s5, 28, s4
    s_add_u32 s43, s4, 1
    v_mfma_f32_16x16x32_bf16 v[236:239], a[56:59], a[108:111], v[236:239]
    s_sub_u32 s42, 23, s4
    s_cmp_ge_u32 s24, 6
    s_cselect_b32 s43, 0, s43
    v_mfma_f32_16x16x32_bf16 v[240:243], a[56:59], a[112:115], v[240:243]
    buffer_load_dwordx4 a[144:147], v155, s[16:19], s91 offen offset:0 sc0 sc1
    v_mfma_f32_16x16x32_bf16 v[244:247], a[56:59], a[116:119], v[244:247]
    s_cselect_b32 s42, 25, s42
    s_sub_u32 s6, s5, 10
    s_lshl_b32 s7, s5, 14
    v_mfma_f32_16x16x32_bf16 v[248:251], a[56:59], a[120:123], v[248:251]
    s_sub_u32 s4, 64, s4
    s_cmp_eq_u32 s25, 1
    s_cselect_b32 s26, 0, s7
    v_mfma_f32_16x16x32_bf16 v[252:255], a[56:59], a[124:127], v[252:255]
    buffer_load_dwordx4 a[148:151], v155, s[16:19], s91 offen offset:1024 sc0 sc1
    v_mfma_f32_16x16x32_bf16 a[252:255], a[60:63], a[124:127], a[252:255]
    s_cselect_b32 s38, s5, 36
    s_cselect_b32 s43, 0, s43
    s_cselect_b32 s42, s6, s42
    v_mfma_f32_16x16x32_bf16 a[248:251], a[60:63], a[120:123], a[248:251]
    s_cselect_b32 s39, 0, 1
    s_cselect_b32 s40, 0, 1
    s_cselect_b32 s52, s7, -1
    v_mfma_f32_16x16x32_bf16 a[244:247], a[60:63], a[116:119], a[244:247]
    buffer_load_dwordx4 a[152:155], v155, s[16:19], s91 offen offset:2048 sc0 sc1
    v_mfma_f32_16x16x32_bf16 a[240:243], a[60:63], a[112:115], a[240:243]
    s_cselect_b32 s4, 32, s4
    s_lshl_b32 s14, s4, 14
    s_mov_b32 s10, s14
    v_mfma_f32_16x16x32_bf16 a[236:239], a[60:63], a[108:111], a[236:239]
    s_cmp_eq_u32 s24, 7
    s_cselect_b32 s39, 2, s39
    s_cselect_b32 s40, 1, s40
    v_mfma_f32_16x16x32_bf16 a[232:235], a[60:63], a[104:107], a[232:235]
    buffer_load_dwordx4 a[156:159], v155, s[16:19], s91 offen offset:3072 sc0 sc1
    v_mfma_f32_16x16x32_bf16 a[228:231], a[60:63], a[100:103], a[228:231]
    s_cselect_b32 s52, -1, s52
    s_cmp_eq_u32 s38, 0
    s_cselect_b32 s38, 32, s38
    v_mfma_f32_16x16x32_bf16 a[224:227], a[60:63], a[96:99], a[224:227]
    s_cselect_b32 s42, 21, s42
    s_lshl_b32 s27, s58, 12
    s_add_u32 s27, s27, 32768
    buffer_load_dwordx4 a[160:163], v155, s[16:19], s92 offen offset:0 sc0 sc1
    s_add_u32 s28, s45, 32768
    s_mov_b32 s48, 32768
    s_mov_b32 s29, 131072
    s_mov_b32 s37, s26
    s_mov_b32 s53, s52
    s_add_u32 s26, s26, 49152
    buffer_load_dwordx4 a[164:167], v155, s[16:19], s92 offen offset:1024 sc0 sc1
    s_mov_b32 s47, s26
    s_add_u32 s26, s26, 16384
    s_cmp_eq_u32 s26, s52
    s_cselect_b32 s26, 0, s26
    s_cselect_b32 s52, -1, s52
    s_mov_b32 s12, s62
    buffer_load_dwordx4 a[168:171], v155, s[16:19], s92 offen offset:2048 sc0 sc1
    s_mov_b32 s13, s63
    s_mov_b32 s8, s64
    s_mov_b32 s9, s65
    s_lshl_b32 s4, s23, 3
    s_add_u32 s4, s4, s24
    s_mul_i32 s4, s4, 69632
    buffer_load_dwordx4 a[172:175], v155, s[16:19], s92 offen offset:3072 sc0 sc1
    s_mul_i32 s5, s58, 17408
    s_add_u32 s4, s4, s5
    s_add_u32 s44, s4, 83886080
    v_bfe_u32 v162, v155, 4, 4
    v_lshrrev_b32 v168, 8, v155
    v_lshlrev_b32 v168, 2, v168
    buffer_load_dwordx4 a[176:179], v155, s[16:19], s93 offen offset:0 sc0 sc1
    v_sub_u32 v162, v162, v168
    s_lshl_b32 s4, s58, 4
    v_add_u32 v162, s4, v162
    s_cmp_eq_u32 s39, 1
    s_cselect_b32 s4, 3, 0
    s_cselect_b32 s56, s44, 0x40000000
    buffer_load_dwordx4 a[180:183], v155, s[16:19], s93 offen offset:1024 sc0 sc1
    v_writelane_b32 v165, s4, 23
    s_load_dwordx2 s[84:85], s[0:1], 40
    s_load_dwordx2 s[86:87], s[0:1], 72
    s_load_dwordx2 s[88:89], s[0:1], 88
    v_lshrrev_b32 v182, 4, v155
    v_add_u32 v190, 753664, v155
    buffer_load_dwordx4 a[184:187], v155, s[16:19], s93 offen offset:2048 sc0 sc1
    s_mul_i32 s61, s23, 229376
    s_xor_b32 s4, s23, 1
    s_mul_i32 s63, s4, 229376
    s_lshr_b32 s4, s59, 1
    s_mul_i32 s4, s4, 14
    s_and_b32 s5, s59, 1
    buffer_load_dwordx4 a[188:191], v155, s[16:19], s93 offen offset:3072 sc0 sc1
    s_mul_i32 s5, s5, 7
    s_add_u32 s4, s4, s5
    s_mul_i32 s60, s4, 28672
    s_lshl_b32 s64, s4, 10
    s_and_b32 s6, s23, 1
    s_mul_i32 s6, s6, 448
    s_lshl_b32 s62, s58, 11
    v_lshrrev_b32 v176, 4, v182
    v_and_b32 v177, 15, v182
    s_lshl_b32 s5, s58, 3
    v_add_u32 v178, 0, v176
    v_add_u32 v179, s5, v178
    v_mul_u32_u24 v179, 896, v179
    v_add_u32 v179, s6, v179
    v_lshlrev_b32 v178, 1, v178
    v_xor_b32 v178, v178, v177
    v_cmp_gt_u32 vcc, 12, v178
    v_lshl_add_u32 v179, v178, 4, v179
    v_subrev_u32 v157, 0, v179
    v_cndmask_b32 v188, v163, v157, vcc
    v_add_u32 v178, 4, v176
    v_add_u32 v179, s5, v178
    v_mul_u32_u24 v179, 896, v179
    v_add_u32 v179, s6, v179
    v_lshlrev_b32 v178, 1, v178
    v_xor_b32 v178, v178, v177
    v_cmp_gt_u32 vcc, 12, v178
    v_lshl_add_u32 v179, v178, 4, v179
    v_subrev_u32 v158, 1024, v179
    v_cndmask_b32 v189, v163, v158, vcc
    s_and_b32 s4, s3, 7
    s_lshr_b32 s5, s3, 4
    s_lshl_b32 s5, s5, 3
    s_add_u32 s4, s4, s5
    s_lshl_b32 s4, s4, 2
    s_add_u32 s4, s4, s58
    s_mul_i32 s5, s4, 28
    s_mul_i32 s4, s4, 25
    v_min_u32 v169, 27, v182
    v_min_u32 v170, 24, v182
    v_add_lshl_u32 v169, v169, s5, 7
    v_add_lshl_u32 v170, v170, s4, 7
    s_waitcnt lgkmcnt(0)
    s_mov_b32 s72, s84
    s_mov_b32 s73, s85
    s_mov_b32 s74, 3670016
    s_mov_b32 s75, 0x20000
    s_mov_b32 s68, s86
    s_mov_b32 s69, s87
    s_mov_b32 s70, 1605632
    s_mov_b32 s71, 0x20000
    s_mov_b32 s80, s88
    s_mov_b32 s81, s89
    s_mov_b32 s82, 1835008
    s_mov_b32 s83, 0x20000
    s_lshl_b32 s4, s2, 2
    s_add_u32 s4, s4, s58
    s_lshl_b32 s90, s4, 14
    s_mul_i32 s4, s4, 14336
    s_add_u32 s4, s4, 117440512
    s_xor_b32 s91, s90, 4194304
    s_add_u32 s90, s90, 134217728
    s_add_u32 s91, s91, 134217728
    s_add_u32 s84, s16, s4
    s_addc_u32 s85, s17, 0
    s_mov_b32 s86, 14336
    s_mov_b32 s87, 0x20000
    s_waitcnt lgkmcnt(0)
    s_branch L1_e2v
L1_end2g:
    s_mov_b32 s96, s44
    s_mov_b32 s78, s43
    s_waitcnt vmcnt(12)
    s_bfe_u32 s22, s3, 0x10003
    s_lshl_b32 s23, s59, 1
    s_add_u32 s23, s23, s22
    s_lshr_b32 s25, s3, 4
    s_and_b32 s24, s3, 7
    s_sub_u32 s36, 15, s24
    s_and_b32 s4, s3, 0x17
    s_cmp_eq_u32 s4, 23
    s_cselect_b32 s36, 7, s36
    s_lshl_b32 s4, s58, 12
    v_add_u32 v152, s4, v155
    v_mov_b32 v163, 0x80000000
    s_add_u32 s45, s4, 65536
    s_add_u32 s46, s45, 98304
    s_mov_b32 s33, 0x47800000
    s_mov_b32 s49, 0xf149f2ca
    s_mov_b32 s41, 2
    s_mov_b32 s21, 0x3f803f80
    s_lshl_b32 s4, s24, 2
    s_sub_u32 s5, 28, s4
    s_add_u32 s43, s4, 1
    s_sub_u32 s42, 23, s4
    s_cmp_ge_u32 s24, 6
    s_cselect_b32 s43, 0, s43
    s_cselect_b32 s42, 25, s42
    s_sub_u32 s6, s5, 10
    s_lshl_b32 s7, s5, 14
    s_sub_u32 s4, 64, s4
    s_cmp_eq_u32 s25, 1
    s_cselect_b32 s26, 0, s7
    s_cselect_b32 s38, s5, 36
    s_cselect_b32 s43, 0, s43
    s_cselect_b32 s42, s6, s42
    s_cselect_b32 s39, 0, 1
    s_cselect_b32 s40, 0, 1
    s_cselect_b32 s52, s7, -1
    s_cselect_b32 s4, 32, s4
    s_lshl_b32 s14, s4, 14
    s_mov_b32 s10, s14
    s_cmp_eq_u32 s24, 7
    s_cselect_b32 s39, 2, s39
    s_cselect_b32 s40, 1, s40
    s_cselect_b32 s52, -1, s52
    s_cmp_eq_u32 s38, 0
    s_cselect_b32 s38, 32, s38
    s_cselect_b32 s42, 21, s42
    s_lshl_b32 s27, s58, 12
    s_add_u32 s27, s27, 32768
    s_add_u32 s28, s45, 32768
    s_mov_b32 s48, 32768
    s_mov_b32 s29, 131072
    s_mov_b32 s37, s26
    s_mov_b32 s53, s52
    s_add_u32 s26, s26, 49152
    s_mov_b32 s47, s26
    s_add_u32 s26, s26, 16384
    s_cmp_eq_u32 s26, s52
    s_cselect_b32 s26, 0, s26
    s_cselect_b32 s52, -1, s52
    s_mov_b32 s12, s62
    s_mov_b32 s13, s63
    s_mov_b32 s8, s64
    s_mov_b32 s9, s65
    s_lshl_b32 s4, s23, 3
    s_add_u32 s4, s4, s24
    s_mul_i32 s4, s4, 69632
    s_mul_i32 s5, s58, 17408
    s_add_u32 s4, s4, s5
    s_add_u32 s44, s4, 83886080
    v_bfe_u32 v162, v155, 4, 4
    v_lshrrev_b32 v168, 8, v155
    v_lshlrev_b32 v168, 2, v168
    v_sub_u32 v162, v162, v168
    s_lshl_b32 s4, s58, 4
    v_add_u32 v162, s4, v162
    s_cmp_eq_u32 s39, 1
    s_cselect_b32 s4, 3, 0
    s_cselect_b32 s56, s44, 0x40000000
    v_writelane_b32 v165, s4, 23
    s_load_dwordx2 s[84:85], s[0:1], 40
    s_load_dwordx2 s[86:87], s[0:1], 72
    s_load_dwordx2 s[88:89], s[0:1], 88
    v_lshrrev_b32 v182, 4, v155
    v_add_u32 v190, 753664, v155
    s_mul_i32 s61, s23, 229376
    s_xor_b32 s4, s23, 1
    s_mul_i32 s63, s4, 229376
    s_lshr_b32 s4, s59, 1
    s_mul_i32 s4, s4, 14
    s_and_b32 s5, s59, 1
    s_mul_i32 s5, s5, 7
    s_add_u32 s4, s4, s5
    s_mul_i32 s60, s4, 28672
    s_lshl_b32 s64, s4, 10
    s_and_b32 s6, s23, 1
    s_mul_i32 s6, s6, 448
    s_lshl_b32 s62, s58, 11
    v_lshrrev_b32 v176, 4, v182
    v_and_b32 v177, 15, v182
    s_lshl_b32 s5, s58, 3
    v_add_u32 v178, 0, v176
    v_add_u32 v179, s5, v178
    v_mul_u32_u24 v179, 896, v179
    v_add_u32 v179, s6, v179
    v_lshlrev_b32 v178, 1, v178
    v_xor_b32 v178, v178, v177
    v_cmp_gt_u32 vcc, 12, v178
    v_lshl_add_u32 v179, v178, 4, v179
    v_subrev_u32 v157, 0, v179
    v_cndmask_b32 v188, v163, v157, vcc
    v_add_u32 v178, 4, v176
    v_add_u32 v179, s5, v178
    v_mul_u32_u24 v179, 896, v179
    v_add_u32 v179, s6, v179
    v_lshlrev_b32 v178, 1, v178
    v_xor_b32 v178, v178, v177
    v_cmp_gt_u32 vcc, 12, v178
    v_lshl_add_u32 v179, v178, 4, v179
    v_subrev_u32 v158, 1024, v179
    v_cndmask_b32 v189, v163, v158, vcc
    s_and_b32 s4, s3, 7
    s_lshr_b32 s5, s3, 4
    s_lshl_b32 s5, s5, 3
    s_add_u32 s4, s4, s5
    s_lshl_b32 s4, s4, 2
    s_add_u32 s4, s4, s58
    s_mul_i32 s5, s4, 28
    s_mul_i32 s4, s4, 25
    v_min_u32 v169, 27, v182
    v_min_u32 v170, 24, v182
    v_add_lshl_u32 v169, v169, s5, 7
    v_add_lshl_u32 v170, v170, s4, 7
    s_waitcnt lgkmcnt(0)
    s_mov_b32 s72, s84
    s_mov_b32 s73, s85
    s_mov_b32 s74, 3670016
    s_mov_b32 s75, 0x20000
    s_mov_b32 s68, s86
    s_mov_b32 s69, s87
    s_mov_b32 s70, 1605632
    s_mov_b32 s71, 0x20000
    s_mov_b32 s80, s88
    s_mov_b32 s81, s89
    s_mov_b32 s82, 1835008
    s_mov_b32 s83, 0x20000
    s_lshl_b32 s4, s2, 2
    s_add_u32 s4, s4, s58
    s_lshl_b32 s90, s4, 14
    s_mul_i32 s4, s4, 14336
    s_add_u32 s4, s4, 117440512
    s_xor_b32 s91, s90, 4194304
    s_add_u32 s90, s90, 134217728
    s_add_u32 s91, s91, 134217728
    s_add_u32 s84, s16, s4
    s_addc_u32 s85, s17, 0
    s_mov_b32 s86, 14336
    s_mov_b32 s87, 0x20000
    s_waitcnt lgkmcnt(0)
    s_branch L1_e2g
L1_end2:
    v_mfma_f32_16x16x32_bf16 v[192:195], a[96:99], a[48:51], v[192:195]
    s_barrier
    s_add_u32 m0, s51, 8192
    s_add_u32 s51, s51, 32768
    v_mfma_f32_16x16x32_bf16 a[192:195], a[100:103], a[48:51], a[192:195]
    buffer_load_dwordx4 v128, s[8:11], s47 offen offset:0 sc1 lds
    v_mfma_f32_16x16x32_bf16 v[196:199], a[104:107], a[48:51], v[196:199]
    buffer_load_dwordx4 v129, s[8:11], s47 offen offset:1024 sc1 lds
    v_mfma_f32_16x16x32_bf16 a[196:199], a[108:111], a[48:51], a[196:199]
    buffer_load_dwordx4 v130, s[8:11], s47 offen offset:2048 sc1 lds
    v_mfma_f32_16x16x32_bf16 v[200:203], a[112:115], a[48:51], v[200:203]
    buffer_load_dwordx4 v131, s[8:11], s47 offen offset:3072 sc1 lds
    v_mfma_f32_16x16x32_bf16 a[200:203], a[116:119], a[48:51], a[200:203]
    s_cmp_ge_u32 s51, s79
    s_cselect_b32 s51, s78, s51
    s_mov_b32 s90, s67
    v_mfma_f32_16x16x32_bf16 v[204:207], a[120:123], a[48:51], v[204:207]
    s_add_u32 s91, s67, 4096
    s_add_u32 s92, s67, 32768
    s_add_u32 s93, s67, 36864
    v_mfma_f32_16x16x32_bf16 a[204:207], a[124:127], a[48:51], a[204:207]
    s_mov_b32 s96, s44
    s_mov_b32 s78, s43
    s_waitcnt vmcnt(12)
    v_mfma_f32_16x16x32_bf16 a[220:223], a[124:127], a[52:55], a[220:223]
    buffer_load_dwordx4 a[128:131], v155, s[16:19], s90 offen offset:0 sc0 sc1
    v_mfma_f32_16x16x32_bf16 v[220:223], a[120:123], a[52:55], v[220:223]
    s_bfe_u32 s22, s3, 0x10003
    s_lshl_b32 s23, s59, 1
    s_add_u32 s23, s23, s22
    v_mfma_f32_16x16x32_bf16 a[216:219], a[116:119], a[52:55], a[216:219]
    s_lshr_b32 s25, s3, 4
    s_and_b32 s24, s3, 7
    s_sub_u32 s36, 15, s24
    v_mfma_f32_16x16x32_bf16 v[216:219], a[112:115], a[52:55], v[216:219]
    buffer_load_dwordx4 a[132:135], v155, s[16:19], s90 offen offset:1024 sc0 sc1
    v_mfma_f32_16x16x32_bf16 a[212:215], a[108:111], a[52:55], a[212:215]
    s_and_b32 s4, s3, 0x17
    s_cmp_eq_u32 s4, 23
    s_cselect_b32 s36, 7, s36
    v_mfma_f32_16x16x32_bf16 v[212:215], a[104:107], a[52:55], v[212:215]
    s_lshl_b32 s4, s58, 12
    v_add_u32 v152, s4, v155
    v_mov_b32 v163, 0x80000000
    v_mfma_f32_16x16x32_bf16 a[208:211], a[100:103], a[52:55], a[208:211]
    buffer_load_dwordx4 a[136:139], v155, s[16:19], s90 offen offset:2048 sc0 sc1
    v_mfma_f32_16x16x32_bf16 v[208:211], a[96:99], a[52:55], v[208:211]
    s_add_u32 s45, s4, 65536
    s_add_u32 s46, s45, 98304
    s_mov_b32 s33, 0x47800000
    v_mfma_f32_16x16x32_bf16 v[224:227], a[96:99], a[56:59], v[224:227]
    s_mov_b32 s49, 0xf149f2ca
    s_mov_b32 s41, 2
    s_mov_b32 s21, 0x3f803f80
    v_mfma_f32_16x16x32_bf16 a[224:227], a[100:103], a[56:59], a[224:227]
    buffer_load_dwordx4 a[140:143], v155, s[16:19], s90 offen offset:3072 sc0 sc1
    v_mfma_f32_16x16x32_bf16 v[228:231], a[104:107], a[56:59], v[228:231]
    s_lshl_b32 s4, s24, 2
    s_sub_u32 s5, 28, s4
    s_add_u32 s43, s4, 1
    v_mfma_f32_16x16x32_bf16 a[228:231], a[108:111], a[56:59], a[228:231]
    s_sub_u32 s42, 23, s4
    s_cmp_ge_u32 s24, 6
    s_cselect_b32 s43, 0, s43
    v_mfma_f32_16x16x32_bf16 v[232:235], a[112:115], a[56:59], v[232:235]
    buffer_load_dwordx4 a[144:147], v155, s[16:19], s91 offen offset:0 sc0 sc1
    v_mfma_f32_16x16x32_bf16 a[232:235], a[116:119], a[56:59], a[232:235]
    s_cselect_b32 s42, 25, s42
    s_sub_u32 s6, s5, 10
    s_lshl_b32 s7, s5, 14
    v_mfma_f32_16x16x32_bf16 v[236:239], a[120:123], a[56:59], v[236:239]
    s_sub_u32 s4, 64, s4
    s_cmp_eq_u32 s25, 1
    s_cselect_b32 s26, 0, s7
    v_mfma_f32_16x16x32_bf16 a[236:239], a[124:127], a[56:59], a[236:239]
    buffer_load_dwordx4 a[148:151], v155, s[16:19], s91 offen offset:1024 sc0 sc1
    v_mfma_f32_16x16x32_bf16 a[252:255], a[124:127], a[60:63], a[252:255]
    s_cselect_b32 s38, s5, 36
    s_cselect_b32 s43, 0, s43
    s_cselect_b32 s42, s6, s42
    v_mfma_f32_16x16x32_bf16 v[252:255], a[120:123], a[60:63], v[252:255]
    s_cselect_b32 s39, 0, 1
    s_cselect_b32 s40, 0, 1
    s_cselect_b32 s52, s7, -1
    v_mfma_f32_16x16x32_bf16 a[248:251], a[116:119], a[60:63], a[248:251]
    buffer_load_dwordx4 a[152:155], v155, s[16:19], s91 offen offset:2048 sc0 sc1
    v_mfma_f32_16x16x32_bf16 v[248:251], a[112:115], a[60:63], v[248:251]
    s_cselect_b32 s4, 32, s4
    s_lshl_b32 s14, s4, 14
    s_mov_b32 s10, s14
    v_mfma_f32_16x16x32_bf16 a[244:247], a[108:111], a[60:63], a[244:247]
    s_cmp_eq_u32 s24, 7
    s_cselect_b32 s39, 2, s39
    s_cselect_b32 s40, 1, s40
    v_mfma_f32_16x16x32_bf16 v[244:247], a[104:107], a[60:63], v[244:247]
    buffer_load_dwordx4 a[156:159], v155, s[16:19], s91 offen offset:3072 sc0 sc1
    v_mfma_f32_16x16x32_bf16 a[240:243], a[100:103], a[60:63], a[240:243]
    s_cselect_b32 s52, -1, s52
    s_cmp_eq_u32 s38, 0
    s_cselect_b32 s38, 32, s38
    v_mfma_f32_16x16x32_bf16 v[240:243], a[96:99], a[60:63], v[240:243]
    s_cselect_b32 s42, 21, s42
    s_lshl_b32 s27, s58, 12
    s_add_u32 s27, s27, 32768
    buffer_load_dwordx4 a[160:163], v155, s[16:19], s92 offen offset:0 sc0 sc1
    s_add_u32 s28, s45, 32768
    s_mov_b32 s48, 32768
    s_mov_b32 s29, 131072
    s_mov_b32 s37, s26
    s_mov_b32 s53, s52
    s_add_u32 s26, s26, 49152
    buffer_load_dwordx4 a[164:167], v155, s[16:19], s92 offen offset:1024 sc0 sc1
    s_mov_b32 s47, s26
    s_add_u32 s26, s26, 16384
    s_cmp_eq_u32 s26, s52
    s_cselect_b32 s26, 0, s26
    s_cselect_b32 s52, -1, s52
    s_mov_b32 s12, s62
    buffer_load_dwordx4 a[168:171], v155, s[16:19], s92 offen offset:2048 sc0 sc1
    s_mov_b32 s13, s63
    s_mov_b32 s8, s64
    s_mov_b32 s9, s65
    s_lshl_b32 s4, s23, 3
    s_add_u32 s4, s4, s24
    s_mul_i32 s4, s4, 69632
    buffer_load_dwordx4 a[172:175], v155, s[16:19], s92 offen offset:3072 sc0 sc1
    s_mul_i32 s5, s58, 17408
    s_add_u32 s4, s4, s5
    s_add_u32 s44, s4, 83886080
    v_bfe_u32 v162, v155, 4, 4
    v_lshrrev_b32 v168, 8, v155
    v_lshlrev_b32 v168, 2, v168
    buffer_load_dwordx4 a[176:179], v155, s[16:19], s93 offen offset:0 sc0 sc1
    v_sub_u32 v162, v162, v168
    s_lshl_b32 s4, s58, 4
    v_add_u32 v162, s4, v162
    s_cmp_eq_u32 s39, 1
    s_cselect_b32 s4, 3, 0
    s_cselect_b32 s56, s44, 0x40000000
    buffer_load_dwordx4 a[180:183], v155, s[16:19], s93 offen offset:1024 sc0 sc1
    v_writelane_b32 v165, s4, 23
    s_load_dwordx2 s[84:85], s[0:1], 40
    s_load_dwordx2 s[86:87], s[0:1], 72
    s_load_dwordx2 s[88:89], s[0:1], 88
    v_lshrrev_b32 v182, 4, v155
    v_add_u32 v190, 753664, v155
    buffer_load_dwordx4 a[184:187], v155, s[16:19], s93 offen offset:2048 sc0 sc1
    s_mul_i32 s61, s23, 229376
    s_xor_b32 s4, s23, 1
    s_mul_i32 s63, s4, 229376
    s_lshr_b32 s4, s59, 1
    s_mul_i32 s4, s4, 14
    s_and_b32 s5, s59, 1
    buffer_load_dwordx4 a[188:191], v155, s[16:19], s93 offen offset:3072 sc0 sc1
    s_mul_i32 s5, s5, 7
    s_add_u32 s4, s4, s5
    s_mul_i32 s60, s4, 28672
    s_lshl_b32 s64, s4, 10
    s_and_b32 s6, s23, 1
    s_mul_i32 s6, s6, 448
    s_lshl_b32 s62, s58, 11
    v_lshrrev_b32 v176, 4, v182
    v_and_b32 v177, 15, v182
    s_lshl_b32 s5, s58, 3
    v_add_u32 v178, 0, v176
    v_add_u32 v179, s5, v178
    v_mul_u32_u24 v179, 896, v179
    v_add_u32 v179, s6, v179
    v_lshlrev_b32 v178, 1, v178
    v_xor_b32 v178, v178, v177
    v_cmp_gt_u32 vcc, 12, v178
    v_lshl_add_u32 v179, v178, 4, v179
    v_subrev_u32 v157, 0, v179
    v_cndmask_b32 v188, v163, v157, vcc
    v_add_u32 v178, 4, v176
    v_add_u32 v179, s5, v178
    v_mul_u32_u24 v179, 896, v179
    v_add_u32 v179, s6, v179
    v_lshlrev_b32 v178, 1, v178
    v_xor_b32 v178, v178, v177
    v_cmp_gt_u32 vcc, 12, v178
    v_lshl_add_u32 v179, v178, 4, v179
    v_subrev_u32 v158, 1024, v179
    v_cndmask_b32 v189, v163, v158, vcc
    s_and_b32 s4, s3, 7
    s_lshr_b32 s5, s3, 4
    s_lshl_b32 s5, s5, 3
    s_add_u32 s4, s4, s5
    s_lshl_b32 s4, s4, 2
    s_add_u32 s4, s4, s58
    s_mul_i32 s5, s4, 28
    s_mul_i32 s4, s4, 25
    v_min_u32 v169, 27, v182
    v_min_u32 v170, 24, v182
    v_add_lshl_u32 v169, v169, s5, 7
    v_add_lshl_u32 v170, v170, s4, 7
    s_waitcnt lgkmcnt(0)
    s_mov_b32 s72, s84
    s_mov_b32 s73, s85
    s_mov_b32 s74, 3670016
    s_mov_b32 s75, 0x20000
    s_mov_b32 s68, s86
    s_mov_b32 s69, s87
    s_mov_b32 s70, 1605632
    s_mov_b32 s71, 0x20000
    s_mov_b32 s80, s88
    s_mov_b32 s81, s89
    s_mov_b32 s82, 1835008
    s_mov_b32 s83, 0x20000
    s_lshl_b32 s4, s2, 2
    s_add_u32 s4, s4, s58
    s_lshl_b32 s90, s4, 14
    s_mul_i32 s4, s4, 14336
    s_add_u32 s4, s4, 117440512
    s_xor_b32 s91, s90, 4194304
    s_add_u32 s90, s90, 134217728
    s_add_u32 s91, s91, 134217728
    s_add_u32 s84, s16, s4
    s_addc_u32 s85, s17, 0
    s_mov_b32 s86, 14336
    s_mov_b32 s87, 0x20000
    s_waitcnt lgkmcnt(0)
    s_cmp_eq_u32 s96, 2
    s_cbranch_scc1 L1_e2q
    s_cmp_eq_u32 s96, 3
    s_cbranch_scc1 L1_e2h
    s_lshr_b32 s4, s58, 1
    s_lshl_b32 s4, s4, 16
    s_and_b32 s5, s58, 1
    s_lshl_b32 s5, s5, 11
    s_add_u32 s4, s4, s5
    s_add_u32 s98, s4, s78
    v_add_u32 v156, 4096, v155
    v_cvt_pk_bf16_f32 v0, v0, v1
    v_cvt_pk_bf16_f32 v1, v2, v3
    v_cvt_pk_bf16_f32 v2, v4, v5
    v_cvt_pk_bf16_f32 v3, v6, v7
    buffer_store_dwordx4 v[0:3], v155, s[16:19], s98 offen offset:0 sc0 sc1
    v_cvt_pk_bf16_f32 v8, v8, v9
    v_cvt_pk_bf16_f32 v9, v10, v11
    v_cvt_pk_bf16_f32 v10, v12, v13
    v_cvt_pk_bf16_f32 v11, v14, v15
    buffer_store_dwordx4 v[8:11], v155, s[16:19], s98 offen offset:1024 sc0 sc1
    v_cvt_pk_bf16_f32 v16, v16, v17
    v_cvt_pk_bf16_f32 v17, v18, v19
    v_cvt_pk_bf16_f32 v18, v20, v21
    v_cvt_pk_bf16_f32 v19, v22, v23
    buffer_store_dwordx4 v[16:19], v156, s[16:19], s98 offen offset:0 sc0 sc1
    v_cvt_pk_bf16_f32 v24, v24, v25
    v_cvt_pk_bf16_f32 v25, v26, v27
    v_cvt_pk_bf16_f32 v26, v28, v29
    v_cvt_pk_bf16_f32 v27, v30, v31
    buffer_store_dwordx4 v[24:27], v156, s[16:19], s98 offen offset:1024 sc0 sc1
    s_add_u32 s98, s98, 8192
    v_cvt_pk_bf16_f32 v32, v32, v33
    v_cvt_pk_bf16_f32 v33, v34, v35
    v_cvt_pk_bf16_f32 v34, v36, v37
    v_cvt_pk_bf16_f32 v35, v38, v39
    buffer_store_dwordx4 v[32:35], v155, s[16:19], s98 offen offset:0 sc0 sc1
    v_accvgpr_read_b32 v0, a192
    v_accvgpr_read_b32 v1, a193
    v_accvgpr_read_b32 v2, a194
    v_accvgpr_read_b32 v3, a195
    v_cvt_pk_bf16_f32 v192, v192, v193
    v_cvt_pk_bf16_f32 v193, v194, v195
    v_cvt_pk_bf16_f32 v194, v0, v1
    v_cvt_pk_bf16_f32 v195, v2, v3
    v_accvgpr_read_b32 v4, a196
    v_accvgpr_read_b32 v5, a197
    v_accvgpr_read_b32 v6, a198
    v_cvt_pk_bf16_f32 v40, v40, v41
    v_cvt_pk_bf16_f32 v41, v42, v43
    v_cvt_pk_bf16_f32 v42, v44, v45
    v_cvt_pk_bf16_f32 v43, v46, v47
    buffer_store_dwordx4 v[40:43], v155, s[16:19], s98 offen offset:1024 sc0 sc1
    v_accvgpr_read_b32 v7, a199
    v_cvt_pk_bf16_f32 v196, v196, v197
    v_cvt_pk_bf16_f32 v197, v198, v199
    v_cvt_pk_bf16_f32 v198, v4, v5
    v_cvt_pk_bf16_f32 v199, v6, v7
    v_accvgpr_read_b32 v8, a200
    v_accvgpr_read_b32 v9, a201
    v_accvgpr_read_b32 v10, a202
    v_accvgpr_read_b32 v11, a203
    v_cvt_pk_bf16_f32 v200, v200, v201
    v_cvt_pk_bf16_f32 v201, v202, v203
    v_cvt_pk_bf16_f32 v48, v48, v49
    v_cvt_pk_bf16_f32 v49, v50, v51
    v_cvt_pk_bf16_f32 v50, v52, v53
    v_cvt_pk_bf16_f32 v51, v54, v55
    buffer_store_dwordx4 v[48:51], v156, s[16:19], s98 offen offset:0 sc0 sc1
    v_cvt_pk_bf16_f32 v202, v8, v9
    v_cvt_pk_bf16_f32 v203, v10, v11
    v_accvgpr_read_b32 v12, a204
    v_accvgpr_read_b32 v13, a205
    v_accvgpr_read_b32 v14, a206
    v_accvgpr_read_b32 v15, a207
    v_cvt_pk_bf16_f32 v204, v204, v205
    v_cvt_pk_bf16_f32 v205, v206, v207
    v_cvt_pk_bf16_f32 v206, v12, v13
    v_cvt_pk_bf16_f32 v207, v14, v15
    v_cvt_pk_bf16_f32 v56, v56, v57
    v_cvt_pk_bf16_f32 v57, v58, v59
    v_cvt_pk_bf16_f32 v58, v60, v61
    v_cvt_pk_bf16_f32 v59, v62, v63
    buffer_store_dwordx4 v[56:59], v156, s[16:19], s98 offen offset:1024 sc0 sc1
    s_add_u32 s98, s98, 8192
    v_accvgpr_read_b32 v0, a208
    v_accvgpr_read_b32 v1, a209
    v_accvgpr_read_b32 v2, a210
    v_accvgpr_read_b32 v3, a211
    v_cvt_pk_bf16_f32 v208, v208, v209
    v_cvt_pk_bf16_f32 v209, v210, v211
    v_cvt_pk_bf16_f32 v210, v0, v1
    v_cvt_pk_bf16_f32 v211, v2, v3
    v_accvgpr_read_b32 v4, a212
    v_accvgpr_read_b32 v5, a213
    v_accvgpr_read_b32 v6, a214
    v_cvt_pk_bf16_f32 v64, v64, v65
    v_cvt_pk_bf16_f32 v65, v66, v67
    v_cvt_pk_bf16_f32 v66, v68, v69
    v_cvt_pk_bf16_f32 v67, v70, v71
    buffer_store_dwordx4 v[64:67], v155, s[16:19], s98 offen offset:0 sc0 sc1
    v_accvgpr_read_b32 v7, a215
    v_cvt_pk_bf16_f32 v212, v212, v213
    v_cvt_pk_bf16_f32 v213, v214, v215
    v_cvt_pk_bf16_f32 v214, v4, v5
    v_cvt_pk_bf16_f32 v215, v6, v7
    v_accvgpr_read_b32 v8, a216
    v_accvgpr_read_b32 v9, a217
    v_accvgpr_read_b32 v10, a218
    v_accvgpr_read_b32 v11, a219
    v_cvt_pk_bf16_f32 v216, v216, v217
    v_cvt_pk_bf16_f32 v217, v218, v219
    v_cvt_pk_bf16_f32 v72, v72, v73
    v_cvt_pk_bf16_f32 v73, v74, v75
    v_cvt_pk_bf16_f32 v74, v76, v77
    v_cvt_pk_bf16_f32 v75, v78, v79
    buffer_store_dwordx4 v[72:75], v155, s[16:19], s98 offen offset:1024 sc0 sc1
    v_cvt_pk_bf16_f32 v218, v8, v9
    v_cvt_pk_bf16_f32 v219, v10, v11
    v_accvgpr_read_b32 v12, a220
    v_accvgpr_read_b32 v13, a221
    v_accvgpr_read_b32 v14, a222
    v_accvgpr_read_b32 v15, a223
    v_cvt_pk_bf16_f32 v220, v220, v221
    v_cvt_pk_bf16_f32 v221, v222, v223
    v_cvt_pk_bf16_f32 v222, v12, v13
    v_cvt_pk_bf16_f32 v223, v14, v15
    v_cvt_pk_bf16_f32 v80, v80, v81
    v_cvt_pk_bf16_f32 v81, v82, v83
    v_cvt_pk_bf16_f32 v82, v84, v85
    v_cvt_pk_bf16_f32 v83, v86, v87
    buffer_store_dwordx4 v[80:83], v156, s[16:19], s98 offen offset:0 sc0 sc1
    v_accvgpr_read_b32 v0, a224
    v_accvgpr_read_b32 v1, a225
    v_accvgpr_read_b32 v2, a226
    v_accvgpr_read_b32 v3, a227
    v_cvt_pk_bf16_f32 v224, v224, v225
    v_cvt_pk_bf16_f32 v225, v226, v227
    v_cvt_pk_bf16_f32 v226, v0, v1
    v_cvt_pk_bf16_f32 v227, v2, v3
    v_accvgpr_read_b32 v4, a228
    v_accvgpr_read_b32 v5, a229
    v_accvgpr_read_b32 v6, a230
    v_cvt_pk_bf16_f32 v88, v88, v89
    v_cvt_pk_bf16_f32 v89, v90, v91
    v_cvt_pk_bf16_f32 v90, v92, v93
    v_cvt_pk_bf16_f32 v91, v94, v95
    buffer_store_dwordx4 v[88:91], v156, s[16:19], s98 offen offset:1024 sc0 sc1
    s_add_u32 s98, s98, 8192
    v_accvgpr_read_b32 v7, a231
    v_cvt_pk_bf16_f32 v228, v228, v229
    v_cvt_pk_bf16_f32 v229, v230, v231
    v_cvt_pk_bf16_f32 v230, v4, v5
    v_cvt_pk_bf16_f32 v231, v6, v7
    v_accvgpr_read_b32 v8, a232
    v_accvgpr_read_b32 v9, a233
    v_accvgpr_read_b32 v10, a234
    v_accvgpr_read_b32 v11, a235
    v_cvt_pk_bf16_f32 v232, v232, v233
    v_cvt_pk_bf16_f32 v233, v234, v235
    v_cvt_pk_bf16_f32 v96, v96, v97
    v_cvt_pk_bf16_f32 v97, v98, v99
    v_cvt_pk_bf16_f32 v98, v100, v101
    v_cvt_pk_bf16_f32 v99, v102, v103
    buffer_store_dwordx4 v[96:99], v155, s[16:19], s98 offen offset:0 sc0 sc1
    v_cvt_pk_bf16_f32 v234, v8, v9
    v_cvt_pk_bf16_f32 v235, v10, v11
    v_accvgpr_read_b32 v12, a236
    v_accvgpr_read_b32 v13, a237
    v_accvgpr_read_b32 v14, a238
    v_accvgpr_read_b32 v15, a239
    v_cvt_pk_bf16_f32 v236, v236, v237
    v_cvt_pk_bf16_f32 v237, v238, v239
    v_cvt_pk_bf16_f32 v238, v12, v13
    v_cvt_pk_bf16_f32 v239, v14, v15
    v_cvt_pk_bf16_f32 v104, v104, v105
    v_cvt_pk_bf16_f32 v105, v106, v107
    v_cvt_pk_bf16_f32 v106, v108, v109
    v_cvt_pk_bf16_f32 v107, v110, v111
    buffer_store_dwordx4 v[104:107], v155, s[16:19], s98 offen offset:1024 sc0 sc1
    v_accvgpr_read_b32 v0, a240
    v_accvgpr_read_b32 v1, a241
    v_accvgpr_read_b32 v2, a242
    v_accvgpr_read_b32 v3, a243
    v_cvt_pk_bf16_f32 v240, v240, v241
    v_cvt_pk_bf16_f32 v241, v242, v243
    v_cvt_pk_bf16_f32 v242, v0, v1
    v_cvt_pk_bf16_f32 v243, v2, v3
    v_accvgpr_read_b32 v4, a244
    v_accvgpr_read_b32 v5, a245
    v_accvgpr_read_b32 v6, a246
    v_cvt_pk_bf16_f32 v112, v112, v113
    v_cvt_pk_bf16_f32 v113, v114, v115
    v_cvt_pk_bf16_f32 v114, v116, v117
    v_cvt_pk_bf16_f32 v115, v118, v119
    buffer_store_dwordx4 v[112:115], v156, s[16:19], s98 offen offset:0 sc0 sc1
    v_accvgpr_read_b32 v7, a247
    v_cvt_pk_bf16_f32 v244, v244, v245
    v_cvt_pk_bf16_f32 v245, v246, v247
    v_cvt_pk_bf16_f32 v246, v4, v5
    v_cvt_pk_bf16_f32 v247, v6, v7
    v_accvgpr_read_b32 v8, a248
    v_accvgpr_read_b32 v9, a249
    v_accvgpr_read_b32 v10, a250
    v_accvgpr_read_b32 v11, a251
    v_cvt_pk_bf16_f32 v248, v248, v249
    v_cvt_pk_bf16_f32 v249, v250, v251
    v_cvt_pk_bf16_f32 v120, v120, v121
    v_cvt_pk_bf16_f32 v121, v122, v123
    v_cvt_pk_bf16_f32 v122, v124, v125
    v_cvt_pk_bf16_f32 v123, v126, v127
    buffer_store_dwordx4 v[120:123], v156, s[16:19], s98 offen offset:1024 sc0 sc1
    s_add_u32 s98, s98, 8192
    v_cvt_pk_bf16_f32 v250, v8, v9
    v_cvt_pk_bf16_f32 v251, v10, v11
    v_accvgpr_read_b32 v12, a252
    v_accvgpr_read_b32 v13, a253
    v_accvgpr_read_b32 v14, a254
    v_accvgpr_read_b32 v15, a255
    v_cvt_pk_bf16_f32 v252, v252, v253
    v_cvt_pk_bf16_f32 v253, v254, v255
    v_cvt_pk_bf16_f32 v254, v12, v13
    v_cvt_pk_bf16_f32 v255, v14, v15
    s_waitcnt vmcnt(16)
    s_mov_b32 s35, 8192
    s_branch L2_seg
L1_e2v:
    s_lshr_b32 s4, s58, 1
    s_lshl_b32 s4, s4, 16
    s_and_b32 s5, s58, 1
    s_lshl_b32 s5, s5, 12
    s_add_u32 s4, s4, s5
    s_add_u32 s98, s4, s78
    v_add_u32 v156, 2048, v155
    v_cvt_pk_bf16_f32 v0, v0, v1
    v_cvt_pk_bf16_f32 v1, v2, v3
    v_cvt_pk_bf16_f32 v2, v32, v33
    v_cvt_pk_bf16_f32 v3, v34, v35
    buffer_store_dwordx4 v[0:3], v155, s[16:19], s98 offen offset:0 sc0 sc1
    v_cvt_pk_bf16_f32 v4, v4, v5
    v_cvt_pk_bf16_f32 v5, v6, v7
    v_cvt_pk_bf16_f32 v6, v36, v37
    v_cvt_pk_bf16_f32 v7, v38, v39
    buffer_store_dwordx4 v[4:7], v155, s[16:19], s98 offen offset:1024 sc0 sc1
    v_cvt_pk_bf16_f32 v8, v8, v9
    v_cvt_pk_bf16_f32 v9, v10, v11
    v_cvt_pk_bf16_f32 v10, v40, v41
    v_cvt_pk_bf16_f32 v11, v42, v43
    buffer_store_dwordx4 v[8:11], v156, s[16:19], s98 offen offset:0 sc0 sc1
    v_cvt_pk_bf16_f32 v12, v12, v13
    v_cvt_pk_bf16_f32 v13, v14, v15
    v_cvt_pk_bf16_f32 v14, v44, v45
    v_cvt_pk_bf16_f32 v15, v46, v47
    buffer_store_dwordx4 v[12:15], v156, s[16:19], s98 offen offset:1024 sc0 sc1
    s_add_u32 s98, s98, 8192
    v_cvt_pk_bf16_f32 v16, v16, v17
    v_cvt_pk_bf16_f32 v17, v18, v19
    v_cvt_pk_bf16_f32 v18, v48, v49
    v_cvt_pk_bf16_f32 v19, v50, v51
    buffer_store_dwordx4 v[16:19], v155, s[16:19], s98 offen offset:0 sc0 sc1
    v_accvgpr_read_b32 v0, a192
    v_accvgpr_read_b32 v1, a193
    v_accvgpr_read_b32 v2, a194
    v_accvgpr_read_b32 v3, a195
    v_cvt_pk_bf16_f32 v192, v192, v193
    v_cvt_pk_bf16_f32 v193, v194, v195
    v_cvt_pk_bf16_f32 v194, v0, v1
    v_cvt_pk_bf16_f32 v195, v2, v3
    v_accvgpr_read_b32 v4, a196
    v_accvgpr_read_b32 v5, a197
    v_accvgpr_read_b32 v6, a198
    v_cvt_pk_bf16_f32 v20, v20, v21
    v_cvt_pk_bf16_f32 v21, v22, v23
    v_cvt_pk_bf16_f32 v22, v52, v53
    v_cvt_pk_bf16_f32 v23, v54, v55
    buffer_store_dwordx4 v[20:23], v155, s[16:19], s98 offen offset:1024 sc0 sc1
    v_accvgpr_read_b32 v7, a199
    v_cvt_pk_bf16_f32 v196, v196, v197
    v_cvt_pk_bf16_f32 v197, v198, v199
    v_cvt_pk_bf16_f32 v198, v4, v5
    v_cvt_pk_bf16_f32 v199, v6, v7
    v_accvgpr_read_b32 v8, a200
    v_accvgpr_read_b32 v9, a201
    v_accvgpr_read_b32 v10, a202
    v_accvgpr_read_b32 v11, a203
    v_cvt_pk_bf16_f32 v200, v200, v201
    v_cvt_pk_bf16_f32 v201, v202, v203
    v_cvt_pk_bf16_f32 v24, v24, v25
    v_cvt_pk_bf16_f32 v25, v26, v27
    v_cvt_pk_bf16_f32 v26, v56, v57
    v_cvt_pk_bf16_f32 v27, v58, v59
    buffer_store_dwordx4 v[24:27], v156, s[16:19], s98 offen offset:0 sc0 sc1
    v_cvt_pk_bf16_f32 v202, v8, v9
    v_cvt_pk_bf16_f32 v203, v10, v11
    v_accvgpr_read_b32 v12, a204
    v_accvgpr_read_b32 v13, a205
    v_accvgpr_read_b32 v14, a206
    v_accvgpr_read_b32 v15, a207
    v_cvt_pk_bf16_f32 v204, v204, v205
    v_cvt_pk_bf16_f32 v205, v206, v207
    v_cvt_pk_bf16_f32 v206, v12, v13
    v_cvt_pk_bf16_f32 v207, v14, v15
    v_cvt_pk_bf16_f32 v28, v28, v29
    v_cvt_pk_bf16_f32 v29, v30, v31
    v_cvt_pk_bf16_f32 v30, v60, v61
    v_cvt_pk_bf16_f32 v31, v62, v63
    buffer_store_dwordx4 v[28:31], v156, s[16:19], s98 offen offset:1024 sc0 sc1
    s_add_u32 s98, s98, 8192
    v_accvgpr_read_b32 v0, a208
    v_accvgpr_read_b32 v1, a209
    v_accvgpr_read_b32 v2, a210
    v_accvgpr_read_b32 v3, a211
    v_cvt_pk_bf16_f32 v208, v208, v209
    v_cvt_pk_bf16_f32 v209, v210, v211
    v_cvt_pk_bf16_f32 v210, v0, v1
    v_cvt_pk_bf16_f32 v211, v2, v3
    v_accvgpr_read_b32 v4, a212
    v_accvgpr_read_b32 v5, a213
    v_accvgpr_read_b32 v6, a214
    v_cvt_pk_bf16_f32 v64, v64, v65
    v_cvt_pk_bf16_f32 v65, v66, v67
    v_cvt_pk_bf16_f32 v66, v96, v97
    v_cvt_pk_bf16_f32 v67, v98, v99
    buffer_store_dwordx4 v[64:67], v155, s[16:19], s98 offen offset:0 sc0 sc1
    v_accvgpr_read_b32 v7, a215
    v_cvt_pk_bf16_f32 v212, v212, v213
    v_cvt_pk_bf16_f32 v213, v214, v215
    v_cvt_pk_bf16_f32 v214, v4, v5
    v_cvt_pk_bf16_f32 v215, v6, v7
    v_accvgpr_read_b32 v8, a216
    v_accvgpr_read_b32 v9, a217
    v_accvgpr_read_b32 v10, a218
    v_accvgpr_read_b32 v11, a219
    v_cvt_pk_bf16_f32 v216, v216, v217
    v_cvt_pk_bf16_f32 v217, v218, v219
    v_cvt_pk_bf16_f32 v68, v68, v69
    v_cvt_pk_bf16_f32 v69, v70, v71
    v_cvt_pk_bf16_f32 v70, v100, v101
    v_cvt_pk_bf16_f32 v71, v102, v103
    buffer_store_dwordx4 v[68:71], v155, s[16:19], s98 offen offset:1024 sc0 sc1
    v_cvt_pk_bf16_f32 v218, v8, v9
    v_cvt_pk_bf16_f32 v219, v10, v11
    v_accvgpr_read_b32 v12, a220
    v_accvgpr_read_b32 v13, a221
    v_accvgpr_read_b32 v14, a222
    v_accvgpr_read_b32 v15, a223
    v_cvt_pk_bf16_f32 v220, v220, v221
    v_cvt_pk_bf16_f32 v221, v222, v223
    v_cvt_pk_bf16_f32 v222, v12, v13
    v_cvt_pk_bf16_f32 v223, v14, v15
    v_cvt_pk_bf16_f32 v72, v72, v73
    v_cvt_pk_bf16_f32 v73, v74, v75
    v_cvt_pk_bf16_f32 v74, v104, v105
    v_cvt_pk_bf16_f32 v75, v106, v107
    buffer_store_dwordx4 v[72:75], v156, s[16:19], s98 offen offset:0 sc0 sc1
    v_accvgpr_read_b32 v0, a224
    v_accvgpr_read_b32 v1, a225
    v_accvgpr_read_b32 v2, a226
    v_accvgpr_read_b32 v3, a227
    v_cvt_pk_bf16_f32 v224, v224, v225
    v_cvt_pk_bf16_f32 v225, v226, v227
    v_cvt_pk_bf16_f32 v226, v0, v1
    v_cvt_pk_bf16_f32 v227, v2, v3
    v_accvgpr_read_b32 v4, a228
    v_accvgpr_read_b32 v5, a229
    v_accvgpr_read_b32 v6, a230
    v_cvt_pk_bf16_f32 v76, v76, v77
    v_cvt_pk_bf16_f32 v77, v78, v79
    v_cvt_pk_bf16_f32 v78, v108, v109
    v_cvt_pk_bf16_f32 v79, v110, v111
    buffer_store_dwordx4 v[76:79], v156, s[16:19], s98 offen offset:1024 sc0 sc1
    s_add_u32 s98, s98, 8192
    v_accvgpr_read_b32 v7, a231
    v_cvt_pk_bf16_f32 v228, v228, v229
    v_cvt_pk_bf16_f32 v229, v230, v231
    v_cvt_pk_bf16_f32 v230, v4, v5
    v_cvt_pk_bf16_f32 v231, v6, v7
    v_accvgpr_read_b32 v8, a232
    v_accvgpr_read_b32 v9, a233
    v_accvgpr_read_b32 v10, a234
    v_accvgpr_read_b32 v11, a235
    v_cvt_pk_bf16_f32 v232, v232, v233
    v_cvt_pk_bf16_f32 v233, v234, v235
    v_cvt_pk_bf16_f32 v80, v80, v81
    v_cvt_pk_bf16_f32 v81, v82, v83
    v_cvt_pk_bf16_f32 v82, v112, v113
    v_cvt_pk_bf16_f32 v83, v114, v115
    buffer_store_dwordx4 v[80:83], v155, s[16:19], s98 offen offset:0 sc0 sc1
    v_cvt_pk_bf16_f32 v234, v8, v9
    v_cvt_pk_bf16_f32 v235, v10, v11
    v_accvgpr_read_b32 v12, a236
    v_accvgpr_read_b32 v13, a237
    v_accvgpr_read_b32 v14, a238
    v_accvgpr_read_b32 v15, a239
    v_cvt_pk_bf16_f32 v236, v236, v237
    v_cvt_pk_bf16_f32 v237, v238, v239
    v_cvt_pk_bf16_f32 v238, v12, v13
    v_cvt_pk_bf16_f32 v239, v14, v15
    v_cvt_pk_bf16_f32 v84, v84, v85
    v_cvt_pk_bf16_f32 v85, v86, v87
    v_cvt_pk_bf16_f32 v86, v116, v117
    v_cvt_pk_bf16_f32 v87, v118, v119
    buffer_store_dwordx4 v[84:87], v155, s[16:19], s98 offen offset:1024 sc0 sc1
    v_accvgpr_read_b32 v0, a240
    v_accvgpr_read_b32 v1, a241
    v_accvgpr_read_b32 v2, a242
    v_accvgpr_read_b32 v3, a243
    v_cvt_pk_bf16_f32 v240, v240, v241
    v_cvt_pk_bf16_f32 v241, v242, v243
    v_cvt_pk_bf16_f32 v242, v0, v1
    v_cvt_pk_bf16_f32 v243, v2, v3
    v_accvgpr_read_b32 v4, a244
    v_accvgpr_read_b32 v5, a245
    v_accvgpr_read_b32 v6, a246
    v_cvt_pk_bf16_f32 v88, v88, v89
    v_cvt_pk_bf16_f32 v89, v90, v91
    v_cvt_pk_bf16_f32 v90, v120, v121
    v_cvt_pk_bf16_f32 v91, v122, v123
    buffer_store_dwordx4 v[88:91], v156, s[16:19], s98 offen offset:0 sc0 sc1
    v_accvgpr_read_b32 v7, a247
    v_cvt_pk_bf16_f32 v244, v244, v245
    v_cvt_pk_bf16_f32 v245, v246, v247
    v_cvt_pk_bf16_f32 v246, v4, v5
    v_cvt_pk_bf16_f32 v247, v6, v7
    v_accvgpr_read_b32 v8, a248
    v_accvgpr_read_b32 v9, a249
    v_accvgpr_read_b32 v10, a250
    v_accvgpr_read_b32 v11, a251
    v_cvt_pk_bf16_f32 v248, v248, v249
    v_cvt_pk_bf16_f32 v249, v250, v251
    v_cvt_pk_bf16_f32 v92, v92, v93
    v_cvt_pk_bf16_f32 v93, v94, v95
    v_cvt_pk_bf16_f32 v94, v124, v125
    v_cvt_pk_bf16_f32 v95, v126, v127
    buffer_store_dwordx4 v[92:95], v156, s[16:19], s98 offen offset:1024 sc0 sc1
    s_add_u32 s98, s98, 8192
    v_cvt_pk_bf16_f32 v250, v8, v9
    v_cvt_pk_bf16_f32 v251, v10, v11
    v_accvgpr_read_b32 v12, a252
    v_accvgpr_read_b32 v13, a253
    v_accvgpr_read_b32 v14, a254
    v_accvgpr_read_b32 v15, a255
    v_cvt_pk_bf16_f32 v252, v252, v253
    v_cvt_pk_bf16_f32 v253, v254, v255
    v_cvt_pk_bf16_f32 v254, v12, v13
    v_cvt_pk_bf16_f32 v255, v14, v15
    s_waitcnt vmcnt(16)
    s_mov_b32 s35, 8192
    s_branch L2_seg
L1_e2q:
    s_lshr_b32 s4, s58, 1
    s_lshl_b32 s4, s4, 16
    s_and_b32 s5, s58, 1
    s_lshl_b32 s5, s5, 11
    s_add_u32 s4, s4, s5
    s_add_u32 s98, s4, s78
    v_add_u32 v156, 4096, v155
    v_pk_mul_f32 v[0:1], v[0:1], s[96:97] op_sel:[0,1] op_sel_hi:[1,1]
    v_pk_mul_f32 v[2:3], v[2:3], s[96:97] op_sel:[0,1] op_sel_hi:[1,1]
    v_pk_mul_f32 v[4:5], v[4:5], s[96:97] op_sel:[0,1] op_sel_hi:[1,1]
    v_pk_mul_f32 v[6:7], v[6:7], s[96:97] op_sel:[0,1] op_sel_hi:[1,1]
    v_cvt_pk_bf16_f32 v0, v0, v1
    v_cvt_pk_bf16_f32 v1, v2, v3
    v_cvt_pk_bf16_f32 v2, v4, v5
    v_cvt_pk_bf16_f32 v3, v6, v7
    buffer_store_dwordx4 v[0:3], v155, s[16:19], s98 offen offset:0 sc0 sc1
    v_pk_mul_f32 v[8:9], v[8:9], s[96:97] op_sel:[0,1] op_sel_hi:[1,1]
    v_pk_mul_f32 v[10:11], v[10:11], s[96:97] op_sel:[0,1] op_sel_hi:[1,1]
    v_pk_mul_f32 v[12:13], v[12:13], s[96:97] op_sel:[0,1] op_sel_hi:[1,1]
    v_pk_mul_f32 v[14:15], v[14:15], s[96:97] op_sel:[0,1] op_sel_hi:[1,1]
    v_cvt_pk_bf16_f32 v8, v8, v9
    v_cvt_pk_bf16_f32 v9, v10, v11
    v_cvt_pk_bf16_f32 v10, v12, v13
    v_cvt_pk_bf16_f32 v11, v14, v15
    buffer_store_dwordx4 v[8:11], v155, s[16:19], s98 offen offset:1024 sc0 sc1
    v_pk_mul_f32 v[16:17], v[16:17], s[96:97] op_sel:[0,1] op_sel_hi:[1,1]
    v_pk_mul_f32 v[18:19], v[18:19], s[96:97] op_sel:[0,1] op_sel_hi:[1,1]
    v_pk_mul_f32 v[20:21], v[20:21], s[96:97] op_sel:[0,1] op_sel_hi:[1,1]
    v_pk_mul_f32 v[22:23], v[22:23], s[96:97] op_sel:[0,1] op_sel_hi:[1,1]
    v_cvt_pk_bf16_f32 v16, v16, v17
    v_cvt_pk_bf16_f32 v17, v18, v19
    v_cvt_pk_bf16_f32 v18, v20, v21
    v_cvt_pk_bf16_f32 v19, v22, v23
    buffer_store_dwordx4 v[16:19], v156, s[16:19], s98 offen offset:0 sc0 sc1
    v_pk_mul_f32 v[24:25], v[24:25], s[96:97] op_sel:[0,1] op_sel_hi:[1,1]
    v_pk_mul_f32 v[26:27], v[26:27], s[96:97] op_sel:[0,1] op_sel_hi:[1,1]
    v_pk_mul_f32 v[28:29], v[28:29], s[96:97] op_sel:[0,1] op_sel_hi:[1,1]
    v_pk_mul_f32 v[30:31], v[30:31], s[96:97] op_sel:[0,1] op_sel_hi:[1,1]
    v_cvt_pk_bf16_f32 v24, v24, v25
    v_cvt_pk_bf16_f32 v25, v26, v27
    v_cvt_pk_bf16_f32 v26, v28, v29
    v_cvt_pk_bf16_f32 v27, v30, v31
    buffer_store_dwordx4 v[24:27], v156, s[16:19], s98 offen offset:1024 sc0 sc1
    s_add_u32 s98, s98, 8192
    v_pk_mul_f32 v[32:33], v[32:33], s[96:97] op_sel:[0,1] op_sel_hi:[1,1]
    v_pk_mul_f32 v[34:35], v[34:35], s[96:97] op_sel:[0,1] op_sel_hi:[1,1]
    v_pk_mul_f32 v[36:37], v[36:37], s[96:97] op_sel:[0,1] op_sel_hi:[1,1]
    v_pk_mul_f32 v[38:39], v[38:39], s[96:97] op_sel:[0,1] op_sel_hi:[1,1]
    v_cvt_pk_bf16_f32 v32, v32, v33
    v_cvt_pk_bf16_f32 v33, v34, v35
    v_cvt_pk_bf16_f32 v34, v36, v37
    v_cvt_pk_bf16_f32 v35, v38, v39
    buffer_store_dwordx4 v[32:35], v155, s[16:19], s98 offen offset:0 sc0 sc1
    v_accvgpr_read_b32 v0, a192
    v_accvgpr_read_b32 v1, a193
    v_accvgpr_read_b32 v2, a194
    v_accvgpr_read_b32 v3, a195
    v_pk_mul_f32 v[192:193], v[192:193], s[96:97] op_sel:[0,1] op_sel_hi:[1,1]
    v_pk_mul_f32 v[194:195], v[194:195], s[96:97] op_sel:[0,1] op_sel_hi:[1,1]
    v_pk_mul_f32 v[0:1], v[0:1], s[96:97] op_sel:[0,1] op_sel_hi:[1,1]
    v_pk_mul_f32 v[2:3], v[2:3], s[96:97] op_sel:[0,1] op_sel_hi:[1,1]
    v_cvt_pk_bf16_f32 v192, v192, v193
    v_cvt_pk_bf16_f32 v193, v194, v195
    v_cvt_pk_bf16_f32 v194, v0, v1
    v_cvt_pk_bf16_f32 v195, v2, v3
    v_accvgpr_read_b32 v4, a196
    v_accvgpr_read_b32 v5, a197
    v_accvgpr_read_b32 v6, a198
    v_accvgpr_read_b32 v7, a199
    v_pk_mul_f32 v[40:41], v[40:41], s[96:97] op_sel:[0,1] op_sel_hi:[1,1]
    v_pk_mul_f32 v[42:43], v[42:43], s[96:97] op_sel:[0,1] op_sel_hi:[1,1]
    v_pk_mul_f32 v[44:45], v[44:45], s[96:97] op_sel:[0,1] op_sel_hi:[1,1]
    v_pk_mul_f32 v[46:47], v[46:47], s[96:97] op_sel:[0,1] op_sel_hi:[1,1]
    v_cvt_pk_bf16_f32 v40, v40, v41
    v_cvt_pk_bf16_f32 v41, v42, v43
    v_cvt_pk_bf16_f32 v42, v44, v45
    v_cvt_pk_bf16_f32 v43, v46, v47
    buffer_store_dwordx4 v[40:43], v155, s[16:19], s98 offen offset:1024 sc0 sc1
    v_pk_mul_f32 v[196:197], v[196:197], s[96:97] op_sel:[0,1] op_sel_hi:[1,1]
    v_pk_mul_f32 v[198:199], v[198:199], s[96:97] op_sel:[0,1] op_sel_hi:[1,1]
    v_pk_mul_f32 v[4:5], v[4:5], s[96:97] op_sel:[0,1] op_sel_hi:[1,1]
    v_pk_mul_f32 v[6:7], v[6:7], s[96:97] op_sel:[0,1] op_sel_hi:[1,1]
    v_cvt_pk_bf16_f32 v196, v196, v197
    v_cvt_pk_bf16_f32 v197, v198, v199
    v_cvt_pk_bf16_f32 v198, v4, v5
    v_cvt_pk_bf16_f32 v199, v6, v7
    v_accvgpr_read_b32 v8, a200
    v_accvgpr_read_b32 v9, a201
    v_accvgpr_read_b32 v10, a202
    v_accvgpr_read_b32 v11, a203
    v_pk_mul_f32 v[200:201], v[200:201], s[96:97] op_sel:[0,1] op_sel_hi:[1,1]
    v_pk_mul_f32 v[202:203], v[202:203], s[96:97] op_sel:[0,1] op_sel_hi:[1,1]
    v_pk_mul_f32 v[8:9], v[8:9], s[96:97] op_sel:[0,1] op_sel_hi:[1,1]
    v_pk_mul_f32 v[10:11], v[10:11], s[96:97] op_sel:[0,1] op_sel_hi:[1,1]
    v_pk_mul_f32 v[48:49], v[48:49], s[96:97] op_sel:[0,1] op_sel_hi:[1,1]
    v_pk_mul_f32 v[50:51], v[50:51], s[96:97] op_sel:[0,1] op_sel_hi:[1,1]
    v_pk_mul_f32 v[52:53], v[52:53], s[96:97] op_sel:[0,1] op_sel_hi:[1,1]
    v_pk_mul_f32 v[54:55], v[54:55], s[96:97] op_sel:[0,1] op_sel_hi:[1,1]
    v_cvt_pk_bf16_f32 v48, v48, v49
    v_cvt_pk_bf16_f32 v49, v50, v51
    v_cvt_pk_bf16_f32 v50, v52, v53
    v_cvt_pk_bf16_f32 v51, v54, v55
    buffer_store_dwordx4 v[48:51], v156, s[16:19], s98 offen offset:0 sc0 sc1
    v_cvt_pk_bf16_f32 v200, v200, v201
    v_cvt_pk_bf16_f32 v201, v202, v203
    v_cvt_pk_bf16_f32 v202, v8, v9
    v_cvt_pk_bf16_f32 v203, v10, v11
    v_accvgpr_read_b32 v12, a204
    v_accvgpr_read_b32 v13, a205
    v_accvgpr_read_b32 v14, a206
    v_accvgpr_read_b32 v15, a207
    v_pk_mul_f32 v[204:205], v[204:205], s[96:97] op_sel:[0,1] op_sel_hi:[1,1]
    v_pk_mul_f32 v[206:207], v[206:207], s[96:97] op_sel:[0,1] op_sel_hi:[1,1]
    v_pk_mul_f32 v[12:13], v[12:13], s[96:97] op_sel:[0,1] op_sel_hi:[1,1]
    v_pk_mul_f32 v[14:15], v[14:15], s[96:97] op_sel:[0,1] op_sel_hi:[1,1]
    v_cvt_pk_bf16_f32 v204, v204, v205
    v_cvt_pk_bf16_f32 v205, v206, v207
    v_cvt_pk_bf16_f32 v206, v12, v13
    v_cvt_pk_bf16_f32 v207, v14, v15
    v_pk_mul_f32 v[56:57], v[56:57], s[96:97] op_sel:[0,1] op_sel_hi:[1,1]
    v_pk_mul_f32 v[58:59], v[58:59], s[96:97] op_sel:[0,1] op_sel_hi:[1,1]
    v_pk_mul_f32 v[60:61], v[60:61], s[96:97] op_sel:[0,1] op_sel_hi:[1,1]
    v_pk_mul_f32 v[62:63], v[62:63], s[96:97] op_sel:[0,1] op_sel_hi:[1,1]
    v_cvt_pk_bf16_f32 v56, v56, v57
    v_cvt_pk_bf16_f32 v57, v58, v59
    v_cvt_pk_bf16_f32 v58, v60, v61
    v_cvt_pk_bf16_f32 v59, v62, v63
    buffer_store_dwordx4 v[56:59], v156, s[16:19], s98 offen offset:1024 sc0 sc1
    s_add_u32 s98, s98, 8192
    v_accvgpr_read_b32 v0, a208
    v_accvgpr_read_b32 v1, a209
    v_accvgpr_read_b32 v2, a210
    v_accvgpr_read_b32 v3, a211
    v_pk_mul_f32 v[208:209], v[208:209], s[96:97] op_sel:[0,1] op_sel_hi:[1,1]
    v_pk_mul_f32 v[210:211], v[210:211], s[96:97] op_sel:[0,1] op_sel_hi:[1,1]
    v_pk_mul_f32 v[0:1], v[0:1], s[96:97] op_sel:[0,1] op_sel_hi:[1,1]
    v_pk_mul_f32 v[2:3], v[2:3], s[96:97] op_sel:[0,1] op_sel_hi:[1,1]
    v_cvt_pk_bf16_f32 v208, v208, v209
    v_cvt_pk_bf16_f32 v209, v210, v211
    v_cvt_pk_bf16_f32 v210, v0, v1
    v_cvt_pk_bf16_f32 v211, v2, v3
    v_accvgpr_read_b32 v4, a212
    v_accvgpr_read_b32 v5, a213
    v_accvgpr_read_b32 v6, a214
    v_accvgpr_read_b32 v7, a215
    v_pk_mul_f32 v[64:65], v[64:65], s[96:97] op_sel:[0,1] op_sel_hi:[1,1]
    v_pk_mul_f32 v[66:67], v[66:67], s[96:97] op_sel:[0,1] op_sel_hi:[1,1]
    v_pk_mul_f32 v[68:69], v[68:69], s[96:97] op_sel:[0,1] op_sel_hi:[1,1]
    v_pk_mul_f32 v[70:71], v[70:71], s[96:97] op_sel:[0,1] op_sel_hi:[1,1]
    v_cvt_pk_bf16_f32 v64, v64, v65
    v_cvt_pk_bf16_f32 v65, v66, v67
    v_cvt_pk_bf16_f32 v66, v68, v69
    v_cvt_pk_bf16_f32 v67, v70, v71
    buffer_store_dwordx4 v[64:67], v155, s[16:19], s98 offen offset:0 sc0 sc1
    v_pk_mul_f32 v[212:213], v[212:213], s[96:97] op_sel:[0,1] op_sel_hi:[1,1]
    v_pk_mul_f32 v[214:215], v[214:215], s[96:97] op_sel:[0,1] op_sel_hi:[1,1]
    v_pk_mul_f32 v[4:5], v[4:5], s[96:97] op_sel:[0,1] op_sel_hi:[1,1]
    v_pk_mul_f32 v[6:7], v[6:7], s[96:97] op_sel:[0,1] op_sel_hi:[1,1]
    v_cvt_pk_bf16_f32 v212, v212, v213
    v_cvt_pk_bf16_f32 v213, v214, v215
    v_cvt_pk_bf16_f32 v214, v4, v5
    v_cvt_pk_bf16_f32 v215, v6, v7
    v_accvgpr_read_b32 v8, a216
    v_accvgpr_read_b32 v9, a217
    v_accvgpr_read_b32 v10, a218
    v_accvgpr_read_b32 v11, a219
    v_pk_mul_f32 v[216:217], v[216:217], s[96:97] op_sel:[0,1] op_sel_hi:[1,1]
    v_pk_mul_f32 v[218:219], v[218:219], s[96:97] op_sel:[0,1] op_sel_hi:[1,1]
    v_pk_mul_f32 v[8:9], v[8:9], s[96:97] op_sel:[0,1] op_sel_hi:[1,1]
    v_pk_mul_f32 v[10:11], v[10:11], s[96:97] op_sel:[0,1] op_sel_hi:[1,1]
    v_pk_mul_f32 v[72:73], v[72:73], s[96:97] op_sel:[0,1] op_sel_hi:[1,1]
    v_pk_mul_f32 v[74:75], v[74:75], s[96:97] op_sel:[0,1] op_sel_hi:[1,1]
    v_pk_mul_f32 v[76:77], v[76:77], s[96:97] op_sel:[0,1] op_sel_hi:[1,1]
    v_pk_mul_f32 v[78:79], v[78:79], s[96:97] op_sel:[0,1] op_sel_hi:[1,1]
    v_cvt_pk_bf16_f32 v72, v72, v73
    v_cvt_pk_bf16_f32 v73, v74, v75
    v_cvt_pk_bf16_f32 v74, v76, v77
    v_cvt_pk_bf16_f32 v75, v78, v79
    buffer_store_dwordx4 v[72:75], v155, s[16:19], s98 offen offset:1024 sc0 sc1
    v_cvt_pk_bf16_f32 v216, v216, v217
    v_cvt_pk_bf16_f32 v217, v218, v219
    v_cvt_pk_bf16_f32 v218, v8, v9
    v_cvt_pk_bf16_f32 v219, v10, v11
    v_accvgpr_read_b32 v12, a220
    v_accvgpr_read_b32 v13, a221
    v_accvgpr_read_b32 v14, a222
    v_accvgpr_read_b32 v15, a223
    v_pk_mul_f32 v[220:221], v[220:221], s[96:97] op_sel:[0,1] op_sel_hi:[1,1]
    v_pk_mul_f32 v[222:223], v[222:223], s[96:97] op_sel:[0,1] op_sel_hi:[1,1]
    v_pk_mul_f32 v[12:13], v[12:13], s[96:97] op_sel:[0,1] op_sel_hi:[1,1]
    v_pk_mul_f32 v[14:15], v[14:15], s[96:97] op_sel:[0,1] op_sel_hi:[1,1]
    v_cvt_pk_bf16_f32 v220, v220, v221
    v_cvt_pk_bf16_f32 v221, v222, v223
    v_cvt_pk_bf16_f32 v222, v12, v13
    v_cvt_pk_bf16_f32 v223, v14, v15
    v_pk_mul_f32 v[80:81], v[80:81], s[96:97] op_sel:[0,1] op_sel_hi:[1,1]
    v_pk_mul_f32 v[82:83], v[82:83], s[96:97] op_sel:[0,1] op_sel_hi:[1,1]
    v_pk_mul_f32 v[84:85], v[84:85], s[96:97] op_sel:[0,1] op_sel_hi:[1,1]
    v_pk_mul_f32 v[86:87], v[86:87], s[96:97] op_sel:[0,1] op_sel_hi:[1,1]
    v_cvt_pk_bf16_f32 v80, v80, v81
    v_cvt_pk_bf16_f32 v81, v82, v83
    v_cvt_pk_bf16_f32 v82, v84, v85
    v_cvt_pk_bf16_f32 v83, v86, v87
    buffer_store_dwordx4 v[80:83], v156, s[16:19], s98 offen offset:0 sc0 sc1
    v_accvgpr_read_b32 v0, a224
    v_accvgpr_read_b32 v1, a225
    v_accvgpr_read_b32 v2, a226
    v_accvgpr_read_b32 v3, a227
    v_pk_mul_f32 v[224:225], v[224:225], s[96:97] op_sel:[0,1] op_sel_hi:[1,1]
    v_pk_mul_f32 v[226:227], v[226:227], s[96:97] op_sel:[0,1] op_sel_hi:[1,1]
    v_pk_mul_f32 v[0:1], v[0:1], s[96:97] op_sel:[0,1] op_sel_hi:[1,1]
    v_pk_mul_f32 v[2:3], v[2:3], s[96:97] op_sel:[0,1] op_sel_hi:[1,1]
    v_cvt_pk_bf16_f32 v224, v224, v225
    v_cvt_pk_bf16_f32 v225, v226, v227
    v_cvt_pk_bf16_f32 v226, v0, v1
    v_cvt_pk_bf16_f32 v227, v2, v3
    v_accvgpr_read_b32 v4, a228
    v_accvgpr_read_b32 v5, a229
    v_accvgpr_read_b32 v6, a230
    v_accvgpr_read_b32 v7, a231
    v_pk_mul_f32 v[88:89], v[88:89], s[96:97] op_sel:[0,1] op_sel_hi:[1,1]
    v_pk_mul_f32 v[90:91], v[90:91], s[96:97] op_sel:[0,1] op_sel_hi:[1,1]
    v_pk_mul_f32 v[92:93], v[92:93], s[96:97] op_sel:[0,1] op_sel_hi:[1,1]
    v_pk_mul_f32 v[94:95], v[94:95], s[96:97] op_sel:[0,1] op_sel_hi:[1,1]
    v_cvt_pk_bf16_f32 v88, v88, v89
    v_cvt_pk_bf16_f32 v89, v90, v91
    v_cvt_pk_bf16_f32 v90, v92, v93
    v_cvt_pk_bf16_f32 v91, v94, v95
    buffer_store_dwordx4 v[88:91], v156, s[16:19], s98 offen offset:1024 sc0 sc1
    s_add_u32 s98, s98, 8192
    v_pk_mul_f32 v[228:229], v[228:229], s[96:97] op_sel:[0,1] op_sel_hi:[1,1]
    v_pk_mul_f32 v[230:231], v[230:231], s[96:97] op_sel:[0,1] op_sel_hi:[1,1]
    v_pk_mul_f32 v[4:5], v[4:5], s[96:97] op_sel:[0,1] op_sel_hi:[1,1]
    v_pk_mul_f32 v[6:7], v[6:7], s[96:97] op_sel:[0,1] op_sel_hi:[1,1]
    v_cvt_pk_bf16_f32 v228, v228, v229
    v_cvt_pk_bf16_f32 v229, v230, v231
    v_cvt_pk_bf16_f32 v230, v4, v5
    v_cvt_pk_bf16_f32 v231, v6, v7
    v_accvgpr_read_b32 v8, a232
    v_accvgpr_read_b32 v9, a233
    v_accvgpr_read_b32 v10, a234
    v_accvgpr_read_b32 v11, a235
    v_pk_mul_f32 v[232:233], v[232:233], s[96:97] op_sel:[0,1] op_sel_hi:[1,1]
    v_pk_mul_f32 v[234:235], v[234:235], s[96:97] op_sel:[0,1] op_sel_hi:[1,1]
    v_pk_mul_f32 v[8:9], v[8:9], s[96:97] op_sel:[0,1] op_sel_hi:[1,1]
    v_pk_mul_f32 v[10:11], v[10:11], s[96:97] op_sel:[0,1] op_sel_hi:[1,1]
    v_pk_mul_f32 v[96:97], v[96:97], s[96:97] op_sel:[0,1] op_sel_hi:[1,1]
    v_pk_mul_f32 v[98:99], v[98:99], s[96:97] op_sel:[0,1] op_sel_hi:[1,1]
    v_pk_mul_f32 v[100:101], v[100:101], s[96:97] op_sel:[0,1] op_sel_hi:[1,1]
    v_pk_mul_f32 v[102:103], v[102:103], s[96:97] op_sel:[0,1] op_sel_hi:[1,1]
    v_cvt_pk_bf16_f32 v96, v96, v97
    v_cvt_pk_bf16_f32 v97, v98, v99
    v_cvt_pk_bf16_f32 v98, v100, v101
    v_cvt_pk_bf16_f32 v99, v102, v103
    buffer_store_dwordx4 v[96:99], v155, s[16:19], s98 offen offset:0 sc0 sc1
    v_cvt_pk_bf16_f32 v232, v232, v233
    v_cvt_pk_bf16_f32 v233, v234, v235
    v_cvt_pk_bf16_f32 v234, v8, v9
    v_cvt_pk_bf16_f32 v235, v10, v11
    v_accvgpr_read_b32 v12, a236
    v_accvgpr_read_b32 v13, a237
    v_accvgpr_read_b32 v14, a238
    v_accvgpr_read_b32 v15, a239
    v_pk_mul_f32 v[236:237], v[236:237], s[96:97] op_sel:[0,1] op_sel_hi:[1,1]
    v_pk_mul_f32 v[238:239], v[238:239], s[96:97] op_sel:[0,1] op_sel_hi:[1,1]
    v_pk_mul_f32 v[12:13], v[12:13], s[96:97] op_sel:[0,1] op_sel_hi:[1,1]
    v_pk_mul_f32 v[14:15], v[14:15], s[96:97] op_sel:[0,1] op_sel_hi:[1,1]
    v_cvt_pk_bf16_f32 v236, v236, v237
    v_cvt_pk_bf16_f32 v237, v238, v239
    v_cvt_pk_bf16_f32 v238, v12, v13
    v_cvt_pk_bf16_f32 v239, v14, v15
    v_pk_mul_f32 v[104:105], v[104:105], s[96:97] op_sel:[0,1] op_sel_hi:[1,1]
    v_pk_mul_f32 v[106:107], v[106:107], s[96:97] op_sel:[0,1] op_sel_hi:[1,1]
    v_pk_mul_f32 v[108:109], v[108:109], s[96:97] op_sel:[0,1] op_sel_hi:[1,1]
    v_pk_mul_f32 v[110:111], v[110:111], s[96:97] op_sel:[0,1] op_sel_hi:[1,1]
    v_cvt_pk_bf16_f32 v104, v104, v105
    v_cvt_pk_bf16_f32 v105, v106, v107
    v_cvt_pk_bf16_f32 v106, v108, v109
    v_cvt_pk_bf16_f32 v107, v110, v111
    buffer_store_dwordx4 v[104:107], v155, s[16:19], s98 offen offset:1024 sc0 sc1
    v_accvgpr_read_b32 v0, a240
    v_accvgpr_read_b32 v1, a241
    v_accvgpr_read_b32 v2, a242
    v_accvgpr_read_b32 v3, a243
    v_pk_mul_f32 v[240:241], v[240:241], s[96:97] op_sel:[0,1] op_sel_hi:[1,1]
    v_pk_mul_f32 v[242:243], v[242:243], s[96:97] op_sel:[0,1] op_sel_hi:[1,1]
    v_pk_mul_f32 v[0:1], v[0:1], s[96:97] op_sel:[0,1] op_sel_hi:[1,1]
    v_pk_mul_f32 v[2:3], v[2:3], s[96:97] op_sel:[0,1] op_sel_hi:[1,1]
    v_cvt_pk_bf16_f32 v240, v240, v241
    v_cvt_pk_bf16_f32 v241, v242, v243
    v_cvt_pk_bf16_f32 v242, v0, v1
    v_cvt_pk_bf16_f32 v243, v2, v3
    v_accvgpr_read_b32 v4, a244
    v_accvgpr_read_b32 v5, a245
    v_accvgpr_read_b32 v6, a246
    v_accvgpr_read_b32 v7, a247
    v_pk_mul_f32 v[112:113], v[112:113], s[96:97] op_sel:[0,1] op_sel_hi:[1,1]
    v_pk_mul_f32 v[114:115], v[114:115], s[96:97] op_sel:[0,1] op_sel_hi:[1,1]
    v_pk_mul_f32 v[116:117], v[116:117], s[96:97] op_sel:[0,1] op_sel_hi:[1,1]
    v_pk_mul_f32 v[118:119], v[118:119], s[96:97] op_sel:[0,1] op_sel_hi:[1,1]
    v_cvt_pk_bf16_f32 v112, v112, v113
    v_cvt_pk_bf16_f32 v113, v114, v115
    v_cvt_pk_bf16_f32 v114, v116, v117
    v_cvt_pk_bf16_f32 v115, v118, v119
    buffer_store_dwordx4 v[112:115], v156, s[16:19], s98 offen offset:0 sc0 sc1
    v_pk_mul_f32 v[244:245], v[244:245], s[96:97] op_sel:[0,1] op_sel_hi:[1,1]
    v_pk_mul_f32 v[246:247], v[246:247], s[96:97] op_sel:[0,1] op_sel_hi:[1,1]
    v_pk_mul_f32 v[4:5], v[4:5], s[96:97] op_sel:[0,1] op_sel_hi:[1,1]
    v_pk_mul_f32 v[6:7], v[6:7], s[96:97] op_sel:[0,1] op_sel_hi:[1,1]
    v_cvt_pk_bf16_f32 v244, v244, v245
    v_cvt_pk_bf16_f32 v245, v246, v247
    v_cvt_pk_bf16_f32 v246, v4, v5
    v_cvt_pk_bf16_f32 v247, v6, v7
    v_accvgpr_read_b32 v8, a248
    v_accvgpr_read_b32 v9, a249
    v_accvgpr_read_b32 v10, a250
    v_accvgpr_read_b32 v11, a251
    v_pk_mul_f32 v[248:249], v[248:249], s[96:97] op_sel:[0,1] op_sel_hi:[1,1]
    v_pk_mul_f32 v[250:251], v[250:251], s[96:97] op_sel:[0,1] op_sel_hi:[1,1]
    v_pk_mul_f32 v[8:9], v[8:9], s[96:97] op_sel:[0,1] op_sel_hi:[1,1]
    v_pk_mul_f32 v[10:11], v[10:11], s[96:97] op_sel:[0,1] op_sel_hi:[1,1]
    v_pk_mul_f32 v[120:121], v[120:121], s[96:97] op_sel:[0,1] op_sel_hi:[1,1]
    v_pk_mul_f32 v[122:123], v[122:123], s[96:97] op_sel:[0,1] op_sel_hi:[1,1]
    v_pk_mul_f32 v[124:125], v[124:125], s[96:97] op_sel:[0,1] op_sel_hi:[1,1]
    v_pk_mul_f32 v[126:127], v[126:127], s[96:97] op_sel:[0,1] op_sel_hi:[1,1]
    v_cvt_pk_bf16_f32 v120, v120, v121
    v_cvt_pk_bf16_f32 v121, v122, v123
    v_cvt_pk_bf16_f32 v122, v124, v125
    v_cvt_pk_bf16_f32 v123, v126, v127
    buffer_store_dwordx4 v[120:123], v156, s[16:19], s98 offen offset:1024 sc0 sc1
    s_add_u32 s98, s98, 8192
    v_cvt_pk_bf16_f32 v248, v248, v249
    v_cvt_pk_bf16_f32 v249, v250, v251
    v_cvt_pk_bf16_f32 v250, v8, v9
    v_cvt_pk_bf16_f32 v251, v10, v11
    v_accvgpr_read_b32 v12, a252
    v_accvgpr_read_b32 v13, a253
    v_accvgpr_read_b32 v14, a254
    v_accvgpr_read_b32 v15, a255
    v_pk_mul_f32 v[252:253], v[252:253], s[96:97] op_sel:[0,1] op_sel_hi:[1,1]
    v_pk_mul_f32 v[254:255], v[254:255], s[96:97] op_sel:[0,1] op_sel_hi:[1,1]
    v_pk_mul_f32 v[12:13], v[12:13], s[96:97] op_sel:[0,1] op_sel_hi:[1,1]
    v_pk_mul_f32 v[14:15], v[14:15], s[96:97] op_sel:[0,1] op_sel_hi:[1,1]
    v_cvt_pk_bf16_f32 v252, v252, v253
    v_cvt_pk_bf16_f32 v253, v254, v255
    v_cvt_pk_bf16_f32 v254, v12, v13
    v_cvt_pk_bf16_f32 v255, v14, v15
    s_waitcnt vmcnt(16)
    s_mov_b32 s35, 8192
    s_branch L2_seg
L1_e2h:
    s_lshr_b32 s4, s58, 1
    s_mul_i32 s4, s4, 1507328
    s_and_b32 s5, s58, 1
    s_lshl_b32 s5, s5, 11
    s_add_u32 s4, s4, s5
    s_add_u32 s98, s4, s78
    s_mov_b32 s97, 0xbfb8aa3b
    v_add_u32 v156, 188416, v155
    v_accvgpr_read_b32 v172, a240
    v_accvgpr_read_b32 v173, a241
    v_accvgpr_read_b32 v174, a242
    v_accvgpr_read_b32 v175, a243
    v_pk_mul_f32 v[240:241], v[240:241], s[96:97] op_sel:[0,1] op_sel_hi:[1,1]
    v_pk_mul_f32 v[242:243], v[242:243], s[96:97] op_sel:[0,1] op_sel_hi:[1,1]
    v_pk_mul_f32 v[172:173], v[172:173], s[96:97] op_sel:[0,1] op_sel_hi:[1,1]
    v_pk_mul_f32 v[174:175], v[174:175], s[96:97] op_sel:[0,1] op_sel_hi:[1,1]
    v_exp_f32 v240, v240
    v_exp_f32 v241, v241
    v_exp_f32 v242, v242
    v_exp_f32 v243, v243
    v_exp_f32 v172, v172
    v_exp_f32 v173, v173
    v_exp_f32 v174, v174
    v_exp_f32 v175, v175
    v_accvgpr_read_b32 v176, a248
    v_accvgpr_read_b32 v177, a249
    v_accvgpr_read_b32 v178, a250
    v_accvgpr_read_b32 v179, a251
    v_pk_fma_f32 v[240:241], v[240:241], v[142:143], v[142:143] op_sel:[0,1,1] op_sel_hi:[1,1,1]
    v_pk_fma_f32 v[242:243], v[242:243], v[142:143], v[142:143] op_sel:[0,1,1] op_sel_hi:[1,1,1]
    v_pk_fma_f32 v[172:173], v[172:173], v[142:143], v[142:143] op_sel:[0,1,1] op_sel_hi:[1,1,1]
    v_pk_fma_f32 v[174:175], v[174:175], v[142:143], v[142:143] op_sel:[0,1,1] op_sel_hi:[1,1,1]
    v_rcp_f32 v240, v240
    v_rcp_f32 v241, v241
    v_rcp_f32 v242, v242
    v_rcp_f32 v243, v243
    v_rcp_f32 v172, v172
    v_rcp_f32 v173, v173
    v_rcp_f32 v174, v174
    v_rcp_f32 v175, v175
    v_pk_mul_f32 v[240:241], v[240:241], v[248:249]
    v_pk_mul_f32 v[242:243], v[242:243], v[250:251]
    v_pk_mul_f32 v[172:173], v[172:173], v[176:177]
    v_pk_mul_f32 v[174:175], v[174:175], v[178:179]
    v_cvt_pk_bf16_f32 v248, v240, v241
    v_cvt_pk_bf16_f32 v249, v242, v243
    v_cvt_pk_bf16_f32 v250, v172, v173
    v_cvt_pk_bf16_f32 v251, v174, v175
    v_accvgpr_read_b32 v172, a244
    v_accvgpr_read_b32 v173, a245
    v_accvgpr_read_b32 v174, a246
    v_accvgpr_read_b32 v175, a247
    v_pk_mul_f32 v[244:245], v[244:245], s[96:97] op_sel:[0,1] op_sel_hi:[1,1]
    v_pk_mul_f32 v[246:247], v[246:247], s[96:97] op_sel:[0,1] op_sel_hi:[1,1]
    v_pk_mul_f32 v[172:173], v[172:173], s[96:97] op_sel:[0,1] op_sel_hi:[1,1]
    v_pk_mul_f32 v[174:175], v[174:175], s[96:97] op_sel:[0,1] op_sel_hi:[1,1]
    v_exp_f32 v244, v244
    v_exp_f32 v245, v245
    v_exp_f32 v246, v246
    v_exp_f32 v247, v247
    v_exp_f32 v172, v172
    v_exp_f32 v173, v173
    v_exp_f32 v174, v174
    v_exp_f32 v175, v175
    v_accvgpr_read_b32 v176, a252
    v_accvgpr_read_b32 v177, a253
    v_accvgpr_read_b32 v178, a254
    v_accvgpr_read_b32 v179, a255
    v_pk_fma_f32 v[244:245], v[244:245], v[142:143], v[142:143] op_sel:[0,1,1] op_sel_hi:[1,1,1]
    v_pk_fma_f32 v[246:247], v[246:247], v[142:143], v[142:143] op_sel:[0,1,1] op_sel_hi:[1,1,1]
    v_pk_fma_f32 v[172:173], v[172:173], v[142:143], v[142:143] op_sel:[0,1,1] op_sel_hi:[1,1,1]
    v_pk_fma_f32 v[174:175], v[174:175], v[142:143], v[142:143] op_sel:[0,1,1] op_sel_hi:[1,1,1]
    v_rcp_f32 v244, v244
    v_rcp_f32 v245, v245
    v_rcp_f32 v246, v246
    v_rcp_f32 v247, v247
    v_rcp_f32 v172, v172
    v_rcp_f32 v173, v173
    v_rcp_f32 v174, v174
    v_rcp_f32 v175, v175
    v_pk_mul_f32 v[244:245], v[244:245], v[252:253]
    v_pk_mul_f32 v[246:247], v[246:247], v[254:255]
    v_pk_mul_f32 v[172:173], v[172:173], v[176:177]
    v_pk_mul_f32 v[174:175], v[174:175], v[178:179]
    v_cvt_pk_bf16_f32 v252, v244, v245
    v_cvt_pk_bf16_f32 v253, v246, v247
    v_cvt_pk_bf16_f32 v254, v172, v173
    v_cvt_pk_bf16_f32 v255, v174, v175
    v_accvgpr_read_b32 v172, a224
    v_accvgpr_read_b32 v173, a225
    v_accvgpr_read_b32 v174, a226
    v_accvgpr_read_b32 v175, a227
    v_pk_mul_f32 v[224:225], v[224:225], s[96:97] op_sel:[0,1] op_sel_hi:[1,1]
    v_pk_mul_f32 v[226:227], v[226:227], s[96:97] op_sel:[0,1] op_sel_hi:[1,1]
    v_pk_mul_f32 v[172:173], v[172:173], s[96:97] op_sel:[0,1] op_sel_hi:[1,1]
    v_pk_mul_f32 v[174:175], v[174:175], s[96:97] op_sel:[0,1] op_sel_hi:[1,1]
    v_exp_f32 v224, v224
    v_exp_f32 v225, v225
    v_exp_f32 v226, v226
    v_exp_f32 v227, v227
    v_exp_f32 v172, v172
    v_exp_f32 v173, v173
    v_exp_f32 v174, v174
    v_exp_f32 v175, v175
    v_accvgpr_read_b32 v176, a232
    v_accvgpr_read_b32 v177, a233
    v_accvgpr_read_b32 v178, a234
    v_accvgpr_read_b32 v179, a235
    v_pk_fma_f32 v[224:225], v[224:225], v[142:143], v[142:143] op_sel_hi:[1,0,0]
    v_pk_fma_f32 v[226:227], v[226:227], v[142:143], v[142:143] op_sel_hi:[1,0,0]
    v_pk_fma_f32 v[172:173], v[172:173], v[142:143], v[142:143] op_sel_hi:[1,0,0]
    v_pk_fma_f32 v[174:175], v[174:175], v[142:143], v[142:143] op_sel_hi:[1,0,0]
    v_rcp_f32 v224, v224
    v_rcp_f32 v225, v225
    v_rcp_f32 v226, v226
    v_rcp_f32 v227, v227
    v_rcp_f32 v172, v172
    v_rcp_f32 v173, v173
    v_rcp_f32 v174, v174
    v_rcp_f32 v175, v175
    v_pk_mul_f32 v[224:225], v[224:225], v[232:233]
    v_pk_mul_f32 v[226:227], v[226:227], v[234:235]
    v_pk_mul_f32 v[172:173], v[172:173], v[176:177]
    v_pk_mul_f32 v[174:175], v[174:175], v[178:179]
    v_cvt_pk_bf16_f32 v240, v224, v225
    v_cvt_pk_bf16_f32 v241, v226, v227
    v_cvt_pk_bf16_f32 v242, v172, v173
    v_cvt_pk_bf16_f32 v243, v174, v175
    v_accvgpr_read_b32 v172, a228
    v_accvgpr_read_b32 v173, a229
    v_accvgpr_read_b32 v174, a230
    v_accvgpr_read_b32 v175, a231
    v_pk_mul_f32 v[228:229], v[228:229], s[96:97] op_sel:[0,1] op_sel_hi:[1,1]
    v_pk_mul_f32 v[230:231], v[230:231], s[96:97] op_sel:[0,1] op_sel_hi:[1,1]
    v_pk_mul_f32 v[172:173], v[172:173], s[96:97] op_sel:[0,1] op_sel_hi:[1,1]
    v_pk_mul_f32 v[174:175], v[174:175], s[96:97] op_sel:[0,1] op_sel_hi:[1,1]
    v_exp_f32 v228, v228
    v_exp_f32 v229, v229
    v_exp_f32 v230, v230
    v_exp_f32 v231, v231
    v_exp_f32 v172, v172
    v_exp_f32 v173, v173
    v_exp_f32 v174, v174
    v_exp_f32 v175, v175
    v_accvgpr_read_b32 v176, a236
    v_accvgpr_read_b32 v177, a237
    v_accvgpr_read_b32 v178, a238
    v_accvgpr_read_b32 v179, a239
    v_pk_fma_f32 v[228:229], v[228:229], v[142:143], v[142:143] op_sel_hi:[1,0,0]
    v_pk_fma_f32 v[230:231], v[230:231], v[142:143], v[142:143] op_sel_hi:[1,0,0]
    v_pk_fma_f32 v[172:173], v[172:173], v[142:143], v[142:143] op_sel_hi:[1,0,0]
    v_pk_fma_f32 v[174:175], v[174:175], v[142:143], v[142:143] op_sel_hi:[1,0,0]
    v_rcp_f32 v228, v228
    v_rcp_f32 v229, v229
    v_rcp_f32 v230, v230
    v_rcp_f32 v231, v231
    v_rcp_f32 v172, v172
    v_rcp_f32 v173, v173
    v_rcp_f32 v174, v174
    v_rcp_f32 v175, v175
    v_pk_mul_f32 v[228:229], v[228:229], v[236:237]
    v_pk_mul_f32 v[230:231], v[230:231], v[238:239]
    v_pk_mul_f32 v[172:173], v[172:173], v[176:177]
    v_pk_mul_f32 v[174:175], v[174:175], v[178:179]
    v_cvt_pk_bf16_f32 v244, v228, v229
    v_cvt_pk_bf16_f32 v245, v230, v231
    v_cvt_pk_bf16_f32 v246, v172, v173
    v_cvt_pk_bf16_f32 v247, v174, v175
    v_accvgpr_read_b32 v172, a208
    v_accvgpr_read_b32 v173, a209
    v_accvgpr_read_b32 v174, a210
    v_accvgpr_read_b32 v175, a211
    v_pk_mul_f32 v[208:209], v[208:209], s[96:97] op_sel:[0,1] op_sel_hi:[1,1]
    v_pk_mul_f32 v[210:211], v[210:211], s[96:97] op_sel:[0,1] op_sel_hi:[1,1]
    v_pk_mul_f32 v[172:173], v[172:173], s[96:97] op_sel:[0,1] op_sel_hi:[1,1]
    v_pk_mul_f32 v[174:175], v[174:175], s[96:97] op_sel:[0,1] op_sel_hi:[1,1]
    v_exp_f32 v208, v208
    v_exp_f32 v209, v209
    v_exp_f32 v210, v210
    v_exp_f32 v211, v211
    v_exp_f32 v172, v172
    v_exp_f32 v173, v173
    v_exp_f32 v174, v174
    v_exp_f32 v175, v175
    v_accvgpr_read_b32 v176, a216
    v_accvgpr_read_b32 v177, a217
    v_accvgpr_read_b32 v178, a218
    v_accvgpr_read_b32 v179, a219
    v_pk_fma_f32 v[208:209], v[208:209], v[140:141], v[140:141] op_sel:[0,1,1] op_sel_hi:[1,1,1]
    v_pk_fma_f32 v[210:211], v[210:211], v[140:141], v[140:141] op_sel:[0,1,1] op_sel_hi:[1,1,1]
    v_pk_fma_f32 v[172:173], v[172:173], v[140:141], v[140:141] op_sel:[0,1,1] op_sel_hi:[1,1,1]
    v_pk_fma_f32 v[174:175], v[174:175], v[140:141], v[140:141] op_sel:[0,1,1] op_sel_hi:[1,1,1]
    v_rcp_f32 v208, v208
    v_rcp_f32 v209, v209
    v_rcp_f32 v210, v210
    v_rcp_f32 v211, v211
    v_rcp_f32 v172, v172
    v_rcp_f32 v173, v173
    v_rcp_f32 v174, v174
    v_rcp_f32 v175, v175
    v_pk_mul_f32 v[208:209], v[208:209], v[216:217]
    v_pk_mul_f32 v[210:211], v[210:211], v[218:219]
    v_pk_mul_f32 v[172:173], v[172:173], v[176:177]
    v_pk_mul_f32 v[174:175], v[174:175], v[178:179]
    v_cvt_pk_bf16_f32 v232, v208, v209
    v_cvt_pk_bf16_f32 v233, v210, v211
    v_cvt_pk_bf16_f32 v234, v172, v173
    v_cvt_pk_bf16_f32 v235, v174, v175
    v_accvgpr_read_b32 v172, a212
    v_accvgpr_read_b32 v173, a213
    v_accvgpr_read_b32 v174, a214
    v_accvgpr_read_b32 v175, a215
    v_pk_mul_f32 v[212:213], v[212:213], s[96:97] op_sel:[0,1] op_sel_hi:[1,1]
    v_pk_mul_f32 v[214:215], v[214:215], s[96:97] op_sel:[0,1] op_sel_hi:[1,1]
    v_pk_mul_f32 v[172:173], v[172:173], s[96:97] op_sel:[0,1] op_sel_hi:[1,1]
    v_pk_mul_f32 v[174:175], v[174:175], s[96:97] op_sel:[0,1] op_sel_hi:[1,1]
    v_exp_f32 v212, v212
    v_exp_f32 v213, v213
    v_exp_f32 v214, v214
    v_exp_f32 v215, v215
    v_exp_f32 v172, v172
    v_exp_f32 v173, v173
    v_exp_f32 v174, v174
    v_exp_f32 v175, v175
    v_accvgpr_read_b32 v176, a220
    v_accvgpr_read_b32 v177, a221
    v_accvgpr_read_b32 v178, a222
    v_accvgpr_read_b32 v179, a223
    v_pk_fma_f32 v[212:213], v[212:213], v[140:141], v[140:141] op_sel:[0,1,1] op_sel_hi:[1,1,1]
    v_pk_fma_f32 v[214:215], v[214:215], v[140:141], v[140:141] op_sel:[0,1,1] op_sel_hi:[1,1,1]
    v_pk_fma_f32 v[172:173], v[172:173], v[140:141], v[140:141] op_sel:[0,1,1] op_sel_hi:[1,1,1]
    v_pk_fma_f32 v[174:175], v[174:175], v[140:141], v[140:141] op_sel:[0,1,1] op_sel_hi:[1,1,1]
    v_rcp_f32 v212, v212
    v_rcp_f32 v213, v213
    v_rcp_f32 v214, v214
    v_rcp_f32 v215, v215
    v_rcp_f32 v172, v172
    v_rcp_f32 v173, v173
    v_rcp_f32 v174, v174
    v_rcp_f32 v175, v175
    v_pk_mul_f32 v[212:213], v[212:213], v[220:221]
    v_pk_mul_f32 v[214:215], v[214:215], v[222:223]
    v_pk_mul_f32 v[172:173], v[172:173], v[176:177]
    v_pk_mul_f32 v[174:175], v[174:175], v[178:179]
    v_cvt_pk_bf16_f32 v236, v212, v213
    v_cvt_pk_bf16_f32 v237, v214, v215
    v_cvt_pk_bf16_f32 v238, v172, v173
    v_cvt_pk_bf16_f32 v239, v174, v175
    v_accvgpr_read_b32 v172, a192
    v_accvgpr_read_b32 v173, a193
    v_accvgpr_read_b32 v174, a194
    v_accvgpr_read_b32 v175, a195
    v_pk_mul_f32 v[192:193], v[192:193], s[96:97] op_sel:[0,1] op_sel_hi:[1,1]
    v_pk_mul_f32 v[194:195], v[194:195], s[96:97] op_sel:[0,1] op_sel_hi:[1,1]
    v_pk_mul_f32 v[172:173], v[172:173], s[96:97] op_sel:[0,1] op_sel_hi:[1,1]
    v_pk_mul_f32 v[174:175], v[174:175], s[96:97] op_sel:[0,1] op_sel_hi:[1,1]
    v_exp_f32 v192, v192
    v_exp_f32 v193, v193
    v_exp_f32 v194, v194
    v_exp_f32 v195, v195
    v_exp_f32 v172, v172
    v_exp_f32 v173, v173
    v_exp_f32 v174, v174
    v_exp_f32 v175, v175
    v_accvgpr_read_b32 v176, a200
    v_accvgpr_read_b32 v177, a201
    v_accvgpr_read_b32 v178, a202
    v_accvgpr_read_b32 v179, a203
    v_pk_fma_f32 v[192:193], v[192:193], v[140:141], v[140:141] op_sel_hi:[1,0,0]
    v_pk_fma_f32 v[194:195], v[194:195], v[140:141], v[140:141] op_sel_hi:[1,0,0]
    v_pk_fma_f32 v[172:173], v[172:173], v[140:141], v[140:141] op_sel_hi:[1,0,0]
    v_pk_fma_f32 v[174:175], v[174:175], v[140:141], v[140:141] op_sel_hi:[1,0,0]
    v_rcp_f32 v192, v192
    v_rcp_f32 v193, v193
    v_rcp_f32 v194, v194
    v_rcp_f32 v195, v195
    v_rcp_f32 v172, v172
    v_rcp_f32 v173, v173
    v_rcp_f32 v174, v174
    v_rcp_f32 v175, v175
    v_pk_mul_f32 v[192:193], v[192:193], v[200:201]
    v_pk_mul_f32 v[194:195], v[194:195], v[202:203]
    v_pk_mul_f32 v[172:173], v[172:173], v[176:177]
    v_pk_mul_f32 v[174:175], v[174:175], v[178:179]
    v_cvt_pk_bf16_f32 v224, v192, v193
    v_cvt_pk_bf16_f32 v225, v194, v195
    v_cvt_pk_bf16_f32 v226, v172, v173
    v_cvt_pk_bf16_f32 v227, v174, v175
    v_accvgpr_read_b32 v172, a196
    v_accvgpr_read_b32 v173, a197
    v_accvgpr_read_b32 v174, a198
    v_accvgpr_read_b32 v175, a199
    v_pk_mul_f32 v[196:197], v[196:197], s[96:97] op_sel:[0,1] op_sel_hi:[1,1]
    v_pk_mul_f32 v[198:199], v[198:199], s[96:97] op_sel:[0,1] op_sel_hi:[1,1]
    v_pk_mul_f32 v[172:173], v[172:173], s[96:97] op_sel:[0,1] op_sel_hi:[1,1]
    v_pk_mul_f32 v[174:175], v[174:175], s[96:97] op_sel:[0,1] op_sel_hi:[1,1]
    v_exp_f32 v196, v196
    v_exp_f32 v197, v197
    v_exp_f32 v198, v198
    v_exp_f32 v199, v199
    v_exp_f32 v172, v172
    v_exp_f32 v173, v173
    v_exp_f32 v174, v174
    v_exp_f32 v175, v175
    v_accvgpr_read_b32 v176, a204
    v_accvgpr_read_b32 v177, a205
    v_accvgpr_read_b32 v178, a206
    v_accvgpr_read_b32 v179, a207
    v_pk_fma_f32 v[196:197], v[196:197], v[140:141], v[140:141] op_sel_hi:[1,0,0]
    v_pk_fma_f32 v[198:199], v[198:199], v[140:141], v[140:141] op_sel_hi:[1,0,0]
    v_pk_fma_f32 v[172:173], v[172:173], v[140:141], v[140:141] op_sel_hi:[1,0,0]
    v_pk_fma_f32 v[174:175], v[174:175], v[140:141], v[140:141] op_sel_hi:[1,0,0]
    v_rcp_f32 v196, v196
    v_rcp_f32 v197, v197
    v_rcp_f32 v198, v198
    v_rcp_f32 v199, v199
    v_rcp_f32 v172, v172
    v_rcp_f32 v173, v173
    v_rcp_f32 v174, v174
    v_rcp_f32 v175, v175
    v_pk_mul_f32 v[196:197], v[196:197], v[204:205]
    v_pk_mul_f32 v[198:199], v[198:199], v[206:207]
    v_pk_mul_f32 v[172:173], v[172:173], v[176:177]
    v_pk_mul_f32 v[174:175], v[174:175], v[178:179]
    v_cvt_pk_bf16_f32 v228, v196, v197
    v_cvt_pk_bf16_f32 v229, v198, v199
    v_cvt_pk_bf16_f32 v230, v172, v173
    v_cvt_pk_bf16_f32 v231, v174, v175
    v_pk_mul_f32 v[0:1], v[0:1], s[96:97] op_sel:[0,1] op_sel_hi:[1,1]
    v_pk_mul_f32 v[2:3], v[2:3], s[96:97] op_sel:[0,1] op_sel_hi:[1,1]
    v_pk_mul_f32 v[4:5], v[4:5], s[96:97] op_sel:[0,1] op_sel_hi:[1,1]
    v_pk_mul_f32 v[6:7], v[6:7], s[96:97] op_sel:[0,1] op_sel_hi:[1,1]
    v_exp_f32 v0, v0
    v_exp_f32 v1, v1
    v_exp_f32 v2, v2
    v_exp_f32 v3, v3
    v_exp_f32 v4, v4
    v_exp_f32 v5, v5
    v_exp_f32 v6, v6
    v_exp_f32 v7, v7
    v_pk_fma_f32 v[0:1], v[0:1], v[136:137], v[136:137] op_sel_hi:[1,0,0]
    v_pk_fma_f32 v[2:3], v[2:3], v[136:137], v[136:137] op_sel_hi:[1,0,0]
    v_pk_fma_f32 v[4:5], v[4:5], v[136:137], v[136:137] op_sel_hi:[1,0,0]
    v_pk_fma_f32 v[6:7], v[6:7], v[136:137], v[136:137] op_sel_hi:[1,0,0]
    v_rcp_f32 v0, v0
    v_rcp_f32 v1, v1
    v_rcp_f32 v2, v2
    v_rcp_f32 v3, v3
    v_rcp_f32 v4, v4
    v_rcp_f32 v5, v5
    v_rcp_f32 v6, v6
    v_rcp_f32 v7, v7
    v_pk_mul_f32 v[0:1], v[0:1], v[16:17]
    v_pk_mul_f32 v[2:3], v[2:3], v[18:19]
    v_pk_mul_f32 v[4:5], v[4:5], v[20:21]
    v_pk_mul_f32 v[6:7], v[6:7], v[22:23]
    v_cvt_pk_bf16_f32 v192, v0, v1
    v_cvt_pk_bf16_f32 v193, v2, v3
    v_cvt_pk_bf16_f32 v194, v4, v5
    v_cvt_pk_bf16_f32 v195, v6, v7
    v_pk_mul_f32 v[8:9], v[8:9], s[96:97] op_sel:[0,1] op_sel_hi:[1,1]
    v_pk_mul_f32 v[10:11], v[10:11], s[96:97] op_sel:[0,1] op_sel_hi:[1,1]
    v_pk_mul_f32 v[12:13], v[12:13], s[96:97] op_sel:[0,1] op_sel_hi:[1,1]
    v_pk_mul_f32 v[14:15], v[14:15], s[96:97] op_sel:[0,1] op_sel_hi:[1,1]
    v_exp_f32 v8, v8
    v_exp_f32 v9, v9
    v_exp_f32 v10, v10
    v_exp_f32 v11, v11
    v_exp_f32 v12, v12
    v_exp_f32 v13, v13
    v_exp_f32 v14, v14
    v_exp_f32 v15, v15
    v_pk_fma_f32 v[8:9], v[8:9], v[136:137], v[136:137] op_sel_hi:[1,0,0]
    v_pk_fma_f32 v[10:11], v[10:11], v[136:137], v[136:137] op_sel_hi:[1,0,0]
    v_pk_fma_f32 v[12:13], v[12:13], v[136:137], v[136:137] op_sel_hi:[1,0,0]
    v_pk_fma_f32 v[14:15], v[14:15], v[136:137], v[136:137] op_sel_hi:[1,0,0]
    v_rcp_f32 v8, v8
    v_rcp_f32 v9, v9
    v_rcp_f32 v10, v10
    v_rcp_f32 v11, v11
    v_rcp_f32 v12, v12
    v_rcp_f32 v13, v13
    v_rcp_f32 v14, v14
    v_rcp_f32 v15, v15
    v_pk_mul_f32 v[8:9], v[8:9], v[24:25]
    v_pk_mul_f32 v[10:11], v[10:11], v[26:27]
    v_pk_mul_f32 v[12:13], v[12:13], v[28:29]
    v_pk_mul_f32 v[14:15], v[14:15], v[30:31]
    v_cvt_pk_bf16_f32 v196, v8, v9
    v_cvt_pk_bf16_f32 v197, v10, v11
    v_cvt_pk_bf16_f32 v198, v12, v13
    v_cvt_pk_bf16_f32 v199, v14, v15
    v_pk_mul_f32 v[32:33], v[32:33], s[96:97] op_sel:[0,1] op_sel_hi:[1,1]
    v_pk_mul_f32 v[34:35], v[34:35], s[96:97] op_sel:[0,1] op_sel_hi:[1,1]
    v_pk_mul_f32 v[36:37], v[36:37], s[96:97] op_sel:[0,1] op_sel_hi:[1,1]
    v_pk_mul_f32 v[38:39], v[38:39], s[96:97] op_sel:[0,1] op_sel_hi:[1,1]
    v_exp_f32 v32, v32
    v_exp_f32 v33, v33
    v_exp_f32 v34, v34
    v_exp_f32 v35, v35
    v_exp_f32 v36, v36
    v_exp_f32 v37, v37
    v_exp_f32 v38, v38
    v_exp_f32 v39, v39
    v_pk_fma_f32 v[32:33], v[32:33], v[136:137], v[136:137] op_sel:[0,1,1] op_sel_hi:[1,1,1]
    v_pk_fma_f32 v[34:35], v[34:35], v[136:137], v[136:137] op_sel:[0,1,1] op_sel_hi:[1,1,1]
    v_pk_fma_f32 v[36:37], v[36:37], v[136:137], v[136:137] op_sel:[0,1,1] op_sel_hi:[1,1,1]
    v_pk_fma_f32 v[38:39], v[38:39], v[136:137], v[136:137] op_sel:[0,1,1] op_sel_hi:[1,1,1]
    v_rcp_f32 v32, v32
    v_rcp_f32 v33, v33
    v_rcp_f32 v34, v34
    v_rcp_f32 v35, v35
    v_rcp_f32 v36, v36
    v_rcp_f32 v37, v37
    v_rcp_f32 v38, v38
    v_rcp_f32 v39, v39
    v_pk_mul_f32 v[32:33], v[32:33], v[48:49]
    v_pk_mul_f32 v[34:35], v[34:35], v[50:51]
    v_pk_mul_f32 v[36:37], v[36:37], v[52:53]
    v_pk_mul_f32 v[38:39], v[38:39], v[54:55]
    v_cvt_pk_bf16_f32 v200, v32, v33
    v_cvt_pk_bf16_f32 v201, v34, v35
    v_cvt_pk_bf16_f32 v202, v36, v37
    v_cvt_pk_bf16_f32 v203, v38, v39
    v_pk_mul_f32 v[40:41], v[40:41], s[96:97] op_sel:[0,1] op_sel_hi:[1,1]
    v_pk_mul_f32 v[42:43], v[42:43], s[96:97] op_sel:[0,1] op_sel_hi:[1,1]
    v_pk_mul_f32 v[44:45], v[44:45], s[96:97] op_sel:[0,1] op_sel_hi:[1,1]
    v_pk_mul_f32 v[46:47], v[46:47], s[96:97] op_sel:[0,1] op_sel_hi:[1,1]
    v_exp_f32 v40, v40
    v_exp_f32 v41, v41
    v_exp_f32 v42, v42
    v_exp_f32 v43, v43
    v_exp_f32 v44, v44
    v_exp_f32 v45, v45
    v_exp_f32 v46, v46
    v_exp_f32 v47, v47
    v_pk_fma_f32 v[40:41], v[40:41], v[136:137], v[136:137] op_sel:[0,1,1] op_sel_hi:[1,1,1]
    v_pk_fma_f32 v[42:43], v[42:43], v[136:137], v[136:137] op_sel:[0,1,1] op_sel_hi:[1,1,1]
    v_pk_fma_f32 v[44:45], v[44:45], v[136:137], v[136:137] op_sel:[0,1,1] op_sel_hi:[1,1,1]
    v_pk_fma_f32 v[46:47], v[46:47], v[136:137], v[136:137] op_sel:[0,1,1] op_sel_hi:[1,1,1]
    v_rcp_f32 v40, v40
    v_rcp_f32 v41, v41
    v_rcp_f32 v42, v42
    v_rcp_f32 v43, v43
    v_rcp_f32 v44, v44
    v_rcp_f32 v45, v45
    v_rcp_f32 v46, v46
    v_rcp_f32 v47, v47
    v_pk_mul_f32 v[40:41], v[40:41], v[56:57]
    v_pk_mul_f32 v[42:43], v[42:43], v[58:59]
    v_pk_mul_f32 v[44:45], v[44:45], v[60:61]
    v_pk_mul_f32 v[46:47], v[46:47], v[62:63]
    v_cvt_pk_bf16_f32 v204, v40, v41
    v_cvt_pk_bf16_f32 v205, v42, v43
    v_cvt_pk_bf16_f32 v206, v44, v45
    v_cvt_pk_bf16_f32 v207, v46, v47
    v_pk_mul_f32 v[64:65], v[64:65], s[96:97] op_sel:[0,1] op_sel_hi:[1,1]
    v_pk_mul_f32 v[66:67], v[66:67], s[96:97] op_sel:[0,1] op_sel_hi:[1,1]
    v_pk_mul_f32 v[68:69], v[68:69], s[96:97] op_sel:[0,1] op_sel_hi:[1,1]
    v_pk_mul_f32 v[70:71], v[70:71], s[96:97] op_sel:[0,1] op_sel_hi:[1,1]
    v_exp_f32 v64, v64
    v_exp_f32 v65, v65
    v_exp_f32 v66, v66
    v_exp_f32 v67, v67
    v_exp_f32 v68, v68
    v_exp_f32 v69, v69
    v_exp_f32 v70, v70
    v_exp_f32 v71, v71
    v_pk_fma_f32 v[64:65], v[64:65], v[138:139], v[138:139] op_sel_hi:[1,0,0]
    v_pk_fma_f32 v[66:67], v[66:67], v[138:139], v[138:139] op_sel_hi:[1,0,0]
    v_pk_fma_f32 v[68:69], v[68:69], v[138:139], v[138:139] op_sel_hi:[1,0,0]
    v_pk_fma_f32 v[70:71], v[70:71], v[138:139], v[138:139] op_sel_hi:[1,0,0]
    v_rcp_f32 v64, v64
    v_rcp_f32 v65, v65
    v_rcp_f32 v66, v66
    v_rcp_f32 v67, v67
    v_rcp_f32 v68, v68
    v_rcp_f32 v69, v69
    v_rcp_f32 v70, v70
    v_rcp_f32 v71, v71
    v_pk_mul_f32 v[64:65], v[64:65], v[80:81]
    v_pk_mul_f32 v[66:67], v[66:67], v[82:83]
    v_pk_mul_f32 v[68:69], v[68:69], v[84:85]
    v_pk_mul_f32 v[70:71], v[70:71], v[86:87]
    v_cvt_pk_bf16_f32 v208, v64, v65
    v_cvt_pk_bf16_f32 v209, v66, v67
    v_cvt_pk_bf16_f32 v210, v68, v69
    v_cvt_pk_bf16_f32 v211, v70, v71
    v_pk_mul_f32 v[72:73], v[72:73], s[96:97] op_sel:[0,1] op_sel_hi:[1,1]
    v_pk_mul_f32 v[74:75], v[74:75], s[96:97] op_sel:[0,1] op_sel_hi:[1,1]
    v_pk_mul_f32 v[76:77], v[76:77], s[96:97] op_sel:[0,1] op_sel_hi:[1,1]
    v_pk_mul_f32 v[78:79], v[78:79], s[96:97] op_sel:[0,1] op_sel_hi:[1,1]
    v_exp_f32 v72, v72
    v_exp_f32 v73, v73
    v_exp_f32 v74, v74
    v_exp_f32 v75, v75
    v_exp_f32 v76, v76
    v_exp_f32 v77, v77
    v_exp_f32 v78, v78
    v_exp_f32 v79, v79
    v_pk_fma_f32 v[72:73], v[72:73], v[138:139], v[138:139] op_sel_hi:[1,0,0]
    v_pk_fma_f32 v[74:75], v[74:75], v[138:139], v[138:139] op_sel_hi:[1,0,0]
    v_pk_fma_f32 v[76:77], v[76:77], v[138:139], v[138:139] op_sel_hi:[1,0,0]
    v_pk_fma_f32 v[78:79], v[78:79], v[138:139], v[138:139] op_sel_hi:[1,0,0]
    v_rcp_f32 v72, v72
    v_rcp_f32 v73, v73
    v_rcp_f32 v74, v74
    v_rcp_f32 v75, v75
    v_rcp_f32 v76, v76
    v_rcp_f32 v77, v77
    v_rcp_f32 v78, v78
    v_rcp_f32 v79, v79
    v_pk_mul_f32 v[72:73], v[72:73], v[88:89]
    v_pk_mul_f32 v[74:75], v[74:75], v[90:91]
    v_pk_mul_f32 v[76:77], v[76:77], v[92:93]
    v_pk_mul_f32 v[78:79], v[78:79], v[94:95]
    v_cvt_pk_bf16_f32 v212, v72, v73
    v_cvt_pk_bf16_f32 v213, v74, v75
    v_cvt_pk_bf16_f32 v214, v76, v77
    v_cvt_pk_bf16_f32 v215, v78, v79
    v_pk_mul_f32 v[96:97], v[96:97], s[96:97] op_sel:[0,1] op_sel_hi:[1,1]
    v_pk_mul_f32 v[98:99], v[98:99], s[96:97] op_sel:[0,1] op_sel_hi:[1,1]
    v_pk_mul_f32 v[100:101], v[100:101], s[96:97] op_sel:[0,1] op_sel_hi:[1,1]
    v_pk_mul_f32 v[102:103], v[102:103], s[96:97] op_sel:[0,1] op_sel_hi:[1,1]
    v_exp_f32 v96, v96
    v_exp_f32 v97, v97
    v_exp_f32 v98, v98
    v_exp_f32 v99, v99
    v_exp_f32 v100, v100
    v_exp_f32 v101, v101
    v_exp_f32 v102, v102
    v_exp_f32 v103, v103
    v_pk_fma_f32 v[96:97], v[96:97], v[138:139], v[138:139] op_sel:[0,1,1] op_sel_hi:[1,1,1]
    v_pk_fma_f32 v[98:99], v[98:99], v[138:139], v[138:139] op_sel:[0,1,1] op_sel_hi:[1,1,1]
    v_pk_fma_f32 v[100:101], v[100:101], v[138:139], v[138:139] op_sel:[0,1,1] op_sel_hi:[1,1,1]
    v_pk_fma_f32 v[102:103], v[102:103], v[138:139], v[138:139] op_sel:[0,1,1] op_sel_hi:[1,1,1]
    v_rcp_f32 v96, v96
    v_rcp_f32 v97, v97
    v_rcp_f32 v98, v98
    v_rcp_f32 v99, v99
    v_rcp_f32 v100, v100
    v_rcp_f32 v101, v101
    v_rcp_f32 v102, v102
    v_rcp_f32 v103, v103
    v_pk_mul_f32 v[96:97], v[96:97], v[112:113]
    v_pk_mul_f32 v[98:99], v[98:99], v[114:115]
    v_pk_mul_f32 v[100:101], v[100:101], v[116:117]
    v_pk_mul_f32 v[102:103], v[102:103], v[118:119]
    v_cvt_pk_bf16_f32 v216, v96, v97
    v_cvt_pk_bf16_f32 v217, v98, v99
    v_cvt_pk_bf16_f32 v218, v100, v101
    v_cvt_pk_bf16_f32 v219, v102, v103
    v_pk_mul_f32 v[104:105], v[104:105], s[96:97] op_sel:[0,1] op_sel_hi:[1,1]
    v_pk_mul_f32 v[106:107], v[106:107], s[96:97] op_sel:[0,1] op_sel_hi:[1,1]
    v_pk_mul_f32 v[108:109], v[108:109], s[96:97] op_sel:[0,1] op_sel_hi:[1,1]
    v_pk_mul_f32 v[110:111], v[110:111], s[96:97] op_sel:[0,1] op_sel_hi:[1,1]
    v_exp_f32 v104, v104
    v_exp_f32 v105, v105
    v_exp_f32 v106, v106
    v_exp_f32 v107, v107
    v_exp_f32 v108, v108
    v_exp_f32 v109, v109
    v_exp_f32 v110, v110
    v_exp_f32 v111, v111
    v_pk_fma_f32 v[104:105], v[104:105], v[138:139], v[138:139] op_sel:[0,1,1] op_sel_hi:[1,1,1]
    v_pk_fma_f32 v[106:107], v[106:107], v[138:139], v[138:139] op_sel:[0,1,1] op_sel_hi:[1,1,1]
    v_pk_fma_f32 v[108:109], v[108:109], v[138:139], v[138:139] op_sel:[0,1,1] op_sel_hi:[1,1,1]
    v_pk_fma_f32 v[110:111], v[110:111], v[138:139], v[138:139] op_sel:[0,1,1] op_sel_hi:[1,1,1]
    v_rcp_f32 v104, v104
    v_rcp_f32 v105, v105
    v_rcp_f32 v106, v106
    v_rcp_f32 v107, v107
    v_rcp_f32 v108, v108
    v_rcp_f32 v109, v109
    v_rcp_f32 v110, v110
    v_rcp_f32 v111, v111
    v_pk_mul_f32 v[104:105], v[104:105], v[120:121]
    v_pk_mul_f32 v[106:107], v[106:107], v[122:123]
    v_pk_mul_f32 v[108:109], v[108:109], v[124:125]
    v_pk_mul_f32 v[110:111], v[110:111], v[126:127]
    v_cvt_pk_bf16_f32 v220, v104, v105
    v_cvt_pk_bf16_f32 v221, v106, v107
    v_cvt_pk_bf16_f32 v222, v108, v109
    v_cvt_pk_bf16_f32 v223, v110, v111
    s_waitcnt vmcnt(0)
    s_mov_b32 s35, 376832
    s_branch L2_seg
L1_e2g:
    s_mov_b64 exec, 6295551
    buffer_load_dword v166, v164, s[16:19], 0 offen sc0 sc1
    s_mov_b64 exec, -1
    s_waitcnt vmcnt(0)
    s_mov_b32 s57, 1048576
Lpl4:
    v_cmp_ge_u32 s[50:51], v166, v165
    s_nop 1
    s_and_b32 s50, s50, 6295551
    s_cmp_eq_u32 s50, 6295551
    s_cbranch_scc1 Lpo5
    s_sub_u32 s57, s57, 1
    s_cbranch_scc1 Lpo5
    s_mov_b64 exec, 6295551
    buffer_load_dword v166, v164, s[16:19], 0 offen sc0 sc1
    s_mov_b64 exec, -1
    s_waitcnt vmcnt(0)
    s_branch Lpl4
Lpo5:
    s_mov_b32 s26, s37
    s_mov_b32 s52, s53
    s_mov_b32 s28, s45
    s_mov_b32 m0, s27
    s_nop 0
    buffer_load_dwordx4 v152, s[12:15], s26 offen offset:0 sc1 lds
    buffer_load_dwordx4 v152, s[12:15], s26 offen offset:1024 sc1 lds
    buffer_load_dwordx4 v152, s[12:15], s26 offen offset:2048 sc1 lds
    buffer_load_dwordx4 v152, s[12:15], s26 offen offset:3072 sc1 lds
    s_mov_b32 s47, s26
    s_add_u32 s26, s26, 16384
    s_cmp_eq_u32 s26, s52
    s_cselect_b32 s26, 0, s26
    s_cselect_b32 s52, -1, s52
    s_lshl_b32 s4, s23, 20
    s_lshl_b32 s5, s36, 16
    s_add_u32 s4, s4, s5
    s_lshl_b32 s5, s58, 13
    s_add_u32 s4, s4, s5
    buffer_load_dwordx4 a[128:131], v155, s[16:19], s4 offen offset:0 sc0 sc1
    buffer_load_dwordx4 a[132:135], v155, s[16:19], s4 offen offset:1024 sc0 sc1
    buffer_load_dwordx4 a[136:139], v155, s[16:19], s4 offen offset:2048 sc0 sc1
    buffer_load_dwordx4 a[140:143], v155, s[16:19], s4 offen offset:3072 sc0 sc1
    s_add_u32 s4, s4, 4096
    buffer_load_dwordx4 a[144:147], v155, s[16:19], s4 offen offset:0 sc0 sc1
    buffer_load_dwordx4 a[148:151], v155, s[16:19], s4 offen offset:1024 sc0 sc1
    buffer_load_dwordx4 a[152:155], v155, s[16:19], s4 offen offset:2048 sc0 sc1
    buffer_load_dwordx4 a[156:159], v155, s[16:19], s4 offen offset:3072 sc0 sc1
    s_add_u32 s4, s4, 28672
    buffer_load_dwordx4 a[160:163], v155, s[16:19], s4 offen offset:0 sc0 sc1
    buffer_load_dwordx4 a[164:167], v155, s[16:19], s4 offen offset:1024 sc0 sc1
    buffer_load_dwordx4 a[168:171], v155, s[16:19], s4 offen offset:2048 sc0 sc1
    buffer_load_dwordx4 a[172:175], v155, s[16:19], s4 offen offset:3072 sc0 sc1
    s_add_u32 s4, s4, 4096
    buffer_load_dwordx4 a[176:179], v155, s[16:19], s4 offen offset:0 sc0 sc1
    buffer_load_dwordx4 a[180:183], v155, s[16:19], s4 offen offset:1024 sc0 sc1
    buffer_load_dwordx4 a[184:187], v155, s[16:19], s4 offen offset:2048 sc0 sc1
    buffer_load_dwordx4 a[188:191], v155, s[16:19], s4 offen offset:3072 sc0 sc1
    s_add_u32 m0, s27, 16384
    s_nop 0
    buffer_load_dwordx4 v152, s[12:15], s26 offen offset:0 sc1 lds
    buffer_load_dwordx4 v152, s[12:15], s26 offen offset:1024 sc1 lds
    buffer_load_dwordx4 v152, s[12:15], s26 offen offset:2048 sc1 lds
    buffer_load_dwordx4 v152, s[12:15], s26 offen offset:3072 sc1 lds
    s_xor_b32 s27, s27, 32768
    s_mov_b32 m0, s28
    s_nop 0
    buffer_load_dwordx4 v152, s[8:11], s47 offen offset:0 sc1 lds
    buffer_load_dwordx4 v152, s[8:11], s47 offen offset:1024 sc1 lds
    buffer_load_dwordx4 v152, s[8:11], s47 offen offset:2048 sc1 lds
    buffer_load_dwordx4 v152, s[8:11], s47 offen offset:3072 sc1 lds
    s_mov_b32 s47, s26
    s_add_u32 s26, s26, 16384
    s_cmp_eq_u32 s26, s52
    s_cselect_b32 s26, 0, s26
    s_cselect_b32 s52, -1, s52
    s_mov_b32 m0, s27
    s_nop 0
    buffer_load_dwordx4 v152, s[12:15], s26 offen offset:0 sc1 lds
    buffer_load_dwordx4 v152, s[12:15], s26 offen offset:1024 sc1 lds
    buffer_load_dwordx4 v152, s[12:15], s26 offen offset:2048 sc1 lds
    buffer_load_dwordx4 v152, s[12:15], s26 offen offset:3072 sc1 lds
    s_add_u32 m0, s28, 16384
    s_nop 0
    buffer_load_dwordx4 v152, s[8:11], s47 offen offset:0 sc1 lds
    buffer_load_dwordx4 v152, s[8:11], s47 offen offset:1024 sc1 lds
    buffer_load_dwordx4 v152, s[8:11], s47 offen offset:2048 sc1 lds
    buffer_load_dwordx4 v152, s[8:11], s47 offen offset:3072 sc1 lds
    s_mov_b32 s47, s26
    s_add_u32 s26, s26, 16384
    s_cmp_eq_u32 s26, s52
    s_cselect_b32 s26, 0, s26
    s_cselect_b32 s52, -1, s52
    s_add_u32 s28, s28, 32768
    s_cmp_ge_u32 s28, s46
    s_cselect_b32 s28, s45, s28
    s_add_u32 m0, s27, 16384
    s_nop 0
    buffer_load_dwordx4 v152, s[12:15], s26 offen offset:0 sc1 lds
    buffer_load_dwordx4 v152, s[12:15], s26 offen offset:1024 sc1 lds
    buffer_load_dwordx4 v152, s[12:15], s26 offen offset:2048 sc1 lds
    buffer_load_dwordx4 v152, s[12:15], s26 offen offset:3072 sc1 lds
    s_xor_b32 s27, s27, 32768
    s_mov_b32 m0, s28
    s_nop 0
    buffer_load_dwordx4 v152, s[8:11], s47 offen offset:0 sc1 lds
    buffer_load_dwordx4 v152, s[8:11], s47 offen offset:1024 sc1 lds
    buffer_load_dwordx4 v152, s[8:11], s47 offen offset:2048 sc1 lds
    buffer_load_dwordx4 v152, s[8:11], s47 offen offset:3072 sc1 lds
    s_mov_b32 s47, s26
    s_add_u32 s26, s26, 16384
    s_cmp_eq_u32 s26, s52
    s_cselect_b32 s26, 0, s26
    s_cselect_b32 s52, -1, s52
    s_waitcnt vmcnt(0)
    s_mov_b32 s35, 0
    s_branch L2_seg
L1_gate:
    v_mfma_f32_16x16x32_bf16 v[192:195], a[48:51], a[96:99], v[192:195]
    v_mfma_f32_16x16x32_bf16 v[196:199], a[48:51], a[100:103], v[196:199]
    v_mfma_f32_16x16x32_bf16 v[200:203], a[48:51], a[104:107], v[200:203]
    v_mfma_f32_16x16x32_bf16 v[204:207], a[48:51], a[108:111], v[204:207]
    v_mfma_f32_16x16x32_bf16 v[208:211], a[48:51], a[112:115], v[208:211]
    v_mfma_f32_16x16x32_bf16 v[212:215], a[48:51], a[116:119], v[212:215]
    v_mfma_f32_16x16x32_bf16 v[216:219], a[48:51], a[120:123], v[216:219]
    v_mfma_f32_16x16x32_bf16 v[220:223], a[48:51], a[124:127], v[220:223]
    v_mfma_f32_16x16x32_bf16 a[220:223], a[52:55], a[124:127], a[220:223]
    v_mfma_f32_16x16x32_bf16 a[216:219], a[52:55], a[120:123], a[216:219]
    v_mfma_f32_16x16x32_bf16 a[212:215], a[52:55], a[116:119], a[212:215]
    v_mfma_f32_16x16x32_bf16 a[208:211], a[52:55], a[112:115], a[208:211]
    v_mfma_f32_16x16x32_bf16 a[204:207], a[52:55], a[108:111], a[204:207]
    v_mfma_f32_16x16x32_bf16 a[200:203], a[52:55], a[104:107], a[200:203]
    v_mfma_f32_16x16x32_bf16 a[196:199], a[52:55], a[100:103], a[196:199]
    v_mfma_f32_16x16x32_bf16 a[192:195], a[52:55], a[96:99], a[192:195]
    v_mfma_f32_16x16x32_bf16 v[224:227], a[56:59], a[96:99], v[224:227]
    v_mfma_f32_16x16x32_bf16 v[228:231], a[56:59], a[100:103], v[228:231]
    v_mfma_f32_16x16x32_bf16 v[232:235], a[56:59], a[104:107], v[232:235]
    v_mfma_f32_16x16x32_bf16 v[236:239], a[56:59], a[108:111], v[236:239]
    v_mfma_f32_16x16x32_bf16 v[240:243], a[56:59], a[112:115], v[240:243]
    v_mfma_f32_16x16x32_bf16 v[244:247], a[56:59], a[116:119], v[244:247]
    v_mfma_f32_16x16x32_bf16 v[248:251], a[56:59], a[120:123], v[248:251]
    v_mfma_f32_16x16x32_bf16 v[252:255], a[56:59], a[124:127], v[252:255]
    v_mfma_f32_16x16x32_bf16 a[252:255], a[60:63], a[124:127], a[252:255]
    v_mfma_f32_16x16x32_bf16 a[248:251], a[60:63], a[120:123], a[248:251]
    v_mfma_f32_16x16x32_bf16 a[244:247], a[60:63], a[116:119], a[244:247]
    v_mfma_f32_16x16x32_bf16 a[240:243], a[60:63], a[112:115], a[240:243]
    v_mfma_f32_16x16x32_bf16 a[236:239], a[60:63], a[108:111], a[236:239]
    v_mfma_f32_16x16x32_bf16 a[232:235], a[60:63], a[104:107], a[232:235]
    v_mfma_f32_16x16x32_bf16 a[228:231], a[60:63], a[100:103], a[228:231]
    v_mfma_f32_16x16x32_bf16 a[224:227], a[60:63], a[96:99], a[224:227]
    s_waitcnt lgkmcnt(0)
    s_mov_b32 s8, s60
    s_mov_b32 s9, s61
    s_mov_b32 s10, 1835008
    s_mov_b32 s11, 0x20000
    s_mov_b32 s12, s70
    s_mov_b32 s13, s71
    s_mov_b32 s14, 896
    s_mov_b32 s15, 0x20000
    s_lshl_b32 s4, s59, 1
    s_add_u32 s4, s4, s3
    s_sub_u32 s4, s4, 30
    s_lshl_b32 s5, s4, 7
    s_lshl_b32 s6, s58, 5
    s_add_u32 s5, s5, s6
    s_mul_i32 s55, s5, 896
    v_mov_b32 v130, 0x80000000
    v_cmp_gt_u32 vcc, 896, v155
    v_lshrrev_b32 v128, 4, v155
    v_lshrrev_b32 v129, 1, v128
    v_cndmask_b32 v131, v130, v155, vcc
    v_add_u32 v129, s5, v129
    buffer_load_dwordx4 v[140:143], v131, s[12:15], 0 offen
    buffer_load_dwordx4 a[0:3], v131, s[8:11], s55 offen offset:0
    buffer_load_dwordx4 a[4:7], v131, s[8:11], s55 offen offset:896
    buffer_load_dwordx4 a[8:11], v131, s[8:11], s55 offen offset:1792
    buffer_load_dwordx4 a[12:15], v131, s[8:11], s55 offen offset:2688
    s_add_u32 s55, s55, 3584
    buffer_load_dwordx4 a[16:19], v131, s[8:11], s55 offen offset:0
    buffer_load_dwordx4 a[20:23], v131, s[8:11], s55 offen offset:896
    buffer_load_dwordx4 a[24:27], v131, s[8:11], s55 offen offset:1792
    buffer_load_dwordx4 a[28:31], v131, s[8:11], s55 offen offset:2688
    s_add_u32 s55, s55, 3584
    buffer_load_dwordx4 a[32:35], v131, s[8:11], s55 offen offset:0
    buffer_load_dwordx4 a[36:39], v131, s[8:11], s55 offen offset:896
    buffer_load_dwordx4 a[40:43], v131, s[8:11], s55 offen offset:1792
    buffer_load_dwordx4 a[44:47], v131, s[8:11], s55 offen offset:2688
    s_add_u32 s55, s55, 3584
    buffer_load_dwordx4 a[48:51], v131, s[8:11], s55 offen offset:0
    buffer_load_dwordx4 a[52:55], v131, s[8:11], s55 offen offset:896
    buffer_load_dwordx4 a[56:59], v131, s[8:11], s55 offen offset:1792
    buffer_load_dwordx4 a[60:63], v131, s[8:11], s55 offen offset:2688
    s_add_u32 s55, s55, 3584
    buffer_load_dwordx4 a[64:67], v131, s[8:11], s55 offen offset:0
    buffer_load_dwordx4 a[68:71], v131, s[8:11], s55 offen offset:896
    buffer_load_dwordx4 a[72:75], v131, s[8:11], s55 offen offset:1792
    buffer_load_dwordx4 a[76:79], v131, s[8:11], s55 offen offset:2688
    s_add_u32 s55, s55, 3584
    buffer_load_dwordx4 a[80:83], v131, s[8:11], s55 offen offset:0
    buffer_load_dwordx4 a[84:87], v131, s[8:11], s55 offen offset:896
    buffer_load_dwordx4 a[88:91], v131, s[8:11], s55 offen offset:1792
    buffer_load_dwordx4 a[92:95], v131, s[8:11], s55 offen offset:2688
    s_add_u32 s55, s55, 3584
    buffer_load_dwordx4 a[96:99], v131, s[8:11], s55 offen offset:0
    buffer_load_dwordx4 a[100:103], v131, s[8:11], s55 offen offset:896
    buffer_load_dwordx4 a[104:107], v131, s[8:11], s55 offen offset:1792
    buffer_load_dwordx4 a[108:111], v131, s[8:11], s55 offen offset:2688
    s_add_u32 s55, s55, 3584
    buffer_load_dwordx4 a[112:115], v131, s[8:11], s55 offen offset:0
    buffer_load_dwordx4 a[116:119], v131, s[8:11], s55 offen offset:896
    buffer_load_dwordx4 a[120:123], v131, s[8:11], s55 offen offset:1792
    buffer_load_dwordx4 a[124:127], v131, s[8:11], s55 offen offset:2688
    s_add_u32 s55, s55, 3584
    s_lshr_b32 s4, s58, 1
    s_lshl_b32 s4, s4, 16
    s_and_b32 s5, s58, 1
    s_lshl_b32 s5, s5, 12
    s_add_u32 s4, s4, s5
    s_add_u32 s98, s4, s30
    v_add_u32 v156, 2048, v155
    v_cvt_pk_bf16_f32 v0, v0, v1
    v_cvt_pk_bf16_f32 v1, v2, v3
    v_cvt_pk_bf16_f32 v2, v32, v33
    v_cvt_pk_bf16_f32 v3, v34, v35
    buffer_store_dwordx4 v[0:3], v155, s[16:19], s98 offen offset:0 sc0 sc1
    v_cvt_pk_bf16_f32 v4, v4, v5
    v_cvt_pk_bf16_f32 v5, v6, v7
    v_cvt_pk_bf16_f32 v6, v36, v37
    v_cvt_pk_bf16_f32 v7, v38, v39
    buffer_store_dwordx4 v[4:7], v155, s[16:19], s98 offen offset:1024 sc0 sc1
    v_cvt_pk_bf16_f32 v8, v8, v9
    v_cvt_pk_bf16_f32 v9, v10, v11
    v_cvt_pk_bf16_f32 v10, v40, v41
    v_cvt_pk_bf16_f32 v11, v42, v43
    buffer_store_dwordx4 v[8:11], v156, s[16:19], s98 offen offset:0 sc0 sc1
    v_cvt_pk_bf16_f32 v12, v12, v13
    v_cvt_pk_bf16_f32 v13, v14, v15
    v_cvt_pk_bf16_f32 v14, v44, v45
    v_cvt_pk_bf16_f32 v15, v46, v47
    buffer_store_dwordx4 v[12:15], v156, s[16:19], s98 offen offset:1024 sc0 sc1
    s_add_u32 s98, s98, 8192
    v_cvt_pk_bf16_f32 v16, v16, v17
    v_cvt_pk_bf16_f32 v17, v18, v19
    v_cvt_pk_bf16_f32 v18, v48, v49
    v_cvt_pk_bf16_f32 v19, v50, v51
    buffer_store_dwordx4 v[16:19], v155, s[16:19], s98 offen offset:0 sc0 sc1
    v_cvt_pk_bf16_f32 v20, v20, v21
    v_cvt_pk_bf16_f32 v21, v22, v23
    v_cvt_pk_bf16_f32 v22, v52, v53
    v_cvt_pk_bf16_f32 v23, v54, v55
    buffer_store_dwordx4 v[20:23], v155, s[16:19], s98 offen offset:1024 sc0 sc1
    v_cvt_pk_bf16_f32 v24, v24, v25
    v_cvt_pk_bf16_f32 v25, v26, v27
    v_cvt_pk_bf16_f32 v26, v56, v57
    v_cvt_pk_bf16_f32 v27, v58, v59
    buffer_store_dwordx4 v[24:27], v156, s[16:19], s98 offen offset:0 sc0 sc1
    v_cvt_pk_bf16_f32 v28, v28, v29
    v_cvt_pk_bf16_f32 v29, v30, v31
    v_cvt_pk_bf16_f32 v30, v60, v61
    v_cvt_pk_bf16_f32 v31, v62, v63
    buffer_store_dwordx4 v[28:31], v156, s[16:19], s98 offen offset:1024 sc0 sc1
    s_waitcnt vmcnt(8)
    v_lshlrev_b32 v144, 16, v140
    v_and_b32 v145, 0xffff0000, v140
    v_lshlrev_b32 v146, 16, v141
    v_and_b32 v147, 0xffff0000, v141
    v_lshlrev_b32 v148, 16, v142
    v_and_b32 v149, 0xffff0000, v142
    v_lshlrev_b32 v150, 16, v143
    v_and_b32 v151, 0xffff0000, v143
    v_accvgpr_read_b32 v135, a0
    v_lshlrev_b32 v134, 16, v135
    v_and_b32 v135, 0xffff0000, v135
    v_pk_mul_f32 v[134:135], v[134:135], v[144:145]
    v_cvt_pk_bf16_f32 v134, v134, v135
    v_lshlrev_b32 v132, 16, v134
    v_and_b32 v133, 0xffff0000, v134
    v_accvgpr_read_b32 v135, a1
    v_lshlrev_b32 v134, 16, v135
    v_and_b32 v135, 0xffff0000, v135
    v_pk_mul_f32 v[134:135], v[134:135], v[146:147]
    v_cvt_pk_bf16_f32 v134, v134, v135
    v_lshlrev_b32 v136, 16, v134
    v_and_b32 v137, 0xffff0000, v134
    v_pk_add_f32 v[132:133], v[132:133], v[136:137]
    v_accvgpr_read_b32 v135, a2
    v_lshlrev_b32 v134, 16, v135
    v_and_b32 v135, 0xffff0000, v135
    v_pk_mul_f32 v[134:135], v[134:135], v[148:149]
    v_cvt_pk_bf16_f32 v134, v134, v135
    v_lshlrev_b32 v136, 16, v134
    v_and_b32 v137, 0xffff0000, v134
    v_pk_add_f32 v[132:133], v[132:133], v[136:137]
    v_accvgpr_read_b32 v135, a3
    v_lshlrev_b32 v134, 16, v135
    v_and_b32 v135, 0xffff0000, v135
    v_pk_mul_f32 v[134:135], v[134:135], v[150:151]
    v_cvt_pk_bf16_f32 v134, v134, v135
    v_lshlrev_b32 v136, 16, v134
    v_and_b32 v137, 0xffff0000, v134
    v_pk_add_f32 v[132:133], v[132:133], v[136:137]
    v_add_f32 v132, v132, v133
    v_accvgpr_write_b32 a128, v132
    s_add_u32 s98, s98, 8192
    v_cvt_pk_bf16_f32 v64, v64, v65
    v_cvt_pk_bf16_f32 v65, v66, v67
    v_cvt_pk_bf16_f32 v66, v96, v97
    v_cvt_pk_bf16_f32 v67, v98, v99
    buffer_store_dwordx4 v[64:67], v155, s[16:19], s98 offen offset:0 sc0 sc1
    v_accvgpr_read_b32 v135, a4
    v_lshlrev_b32 v134, 16, v135
    v_and_b32 v135, 0xffff0000, v135
    v_pk_mul_f32 v[134:135], v[134:135], v[144:145]
    v_cvt_pk_bf16_f32 v134, v134, v135
    v_lshlrev_b32 v132, 16, v134
    v_and_b32 v133, 0xffff0000, v134
    v_accvgpr_read_b32 v135, a5
    v_lshlrev_b32 v134, 16, v135
    v_and_b32 v135, 0xffff0000, v135
    v_pk_mul_f32 v[134:135], v[134:135], v[146:147]
    v_cvt_pk_bf16_f32 v134, v134, v135
    v_lshlrev_b32 v136, 16, v134
    v_and_b32 v137, 0xffff0000, v134
    v_pk_add_f32 v[132:133], v[132:133], v[136:137]
    v_accvgpr_read_b32 v135, a6
    v_lshlrev_b32 v134, 16, v135
    v_and_b32 v135, 0xffff0000, v135
    v_pk_mul_f32 v[134:135], v[134:135], v[148:149]
    v_cvt_pk_bf16_f32 v134, v134, v135
    v_lshlrev_b32 v136, 16, v134
    v_and_b32 v137, 0xffff0000, v134
    v_pk_add_f32 v[132:133], v[132:133], v[136:137]
    v_accvgpr_read_b32 v135, a7
    v_lshlrev_b32 v134, 16, v135
    v_and_b32 v135, 0xffff0000, v135
    v_pk_mul_f32 v[134:135], v[134:135], v[150:151]
    v_cvt_pk_bf16_f32 v134, v134, v135
    v_lshlrev_b32 v136, 16, v134
    v_and_b32 v137, 0xffff0000, v134
    v_pk_add_f32 v[132:133], v[132:133], v[136:137]
    v_add_f32 v132, v132, v133
    v_accvgpr_write_b32 a129, v132
    v_cvt_pk_bf16_f32 v68, v68, v69
    v_cvt_pk_bf16_f32 v69, v70, v71
    v_cvt_pk_bf16_f32 v70, v100, v101
    v_cvt_pk_bf16_f32 v71, v102, v103
    buffer_store_dwordx4 v[68:71], v155, s[16:19], s98 offen offset:1024 sc0 sc1
    v_cvt_pk_bf16_f32 v72, v72, v73
    v_accvgpr_read_b32 v135, a8
    v_lshlrev_b32 v134, 16, v135
    v_and_b32 v135, 0xffff0000, v135
    v_pk_mul_f32 v[134:135], v[134:135], v[144:145]
    v_cvt_pk_bf16_f32 v134, v134, v135
    v_lshlrev_b32 v132, 16, v134
    v_and_b32 v133, 0xffff0000, v134
    v_accvgpr_read_b32 v135, a9
    v_lshlrev_b32 v134, 16, v135
    v_and_b32 v135, 0xffff0000, v135
    v_pk_mul_f32 v[134:135], v[134:135], v[146:147]
    v_cvt_pk_bf16_f32 v134, v134, v135
    v_lshlrev_b32 v136, 16, v134
    v_and_b32 v137, 0xffff0000, v134
    v_pk_add_f32 v[132:133], v[132:133], v[136:137]
    v_accvgpr_read_b32 v135, a10
    v_lshlrev_b32 v134, 16, v135
    v_and_b32 v135, 0xffff0000, v135
    v_pk_mul_f32 v[134:135], v[134:135], v[148:149]
    v_cvt_pk_bf16_f32 v134, v134, v135
    v_lshlrev_b32 v136, 16, v134
    v_and_b32 v137, 0xffff0000, v134
    v_pk_add_f32 v[132:133], v[132:133], v[136:137]
    v_accvgpr_read_b32 v135, a11
    v_lshlrev_b32 v134, 16, v135
    v_and_b32 v135, 0xffff0000, v135
    v_pk_mul_f32 v[134:135], v[134:135], v[150:151]
    v_cvt_pk_bf16_f32 v134, v134, v135
    v_lshlrev_b32 v136, 16, v134
    v_and_b32 v137, 0xffff0000, v134
    v_pk_add_f32 v[132:133], v[132:133], v[136:137]
    v_add_f32 v132, v132, v133
    v_accvgpr_write_b32 a130, v132
    v_cvt_pk_bf16_f32 v73, v74, v75
    v_cvt_pk_bf16_f32 v74, v104, v105
    v_cvt_pk_bf16_f32 v75, v106, v107
    buffer_store_dwordx4 v[72:75], v156, s[16:19], s98 offen offset:0 sc0 sc1
    v_cvt_pk_bf16_f32 v76, v76, v77
    v_cvt_pk_bf16_f32 v77, v78, v79
    v_accvgpr_read_b32 v135, a12
    v_lshlrev_b32 v134, 16, v135
    v_and_b32 v135, 0xffff0000, v135
    v_pk_mul_f32 v[134:135], v[134:135], v[144:145]
    v_cvt_pk_bf16_f32 v134, v134, v135
    v_lshlrev_b32 v132, 16, v134
    v_and_b32 v133, 0xffff0000, v134
    v_accvgpr_read_b32 v135, a13
    v_lshlrev_b32 v134, 16, v135
    v_and_b32 v135, 0xffff0000, v135
    v_pk_mul_f32 v[134:135], v[134:135], v[146:147]
    v_cvt_pk_bf16_f32 v134, v134, v135
    v_lshlrev_b32 v136, 16, v134
    v_and_b32 v137, 0xffff0000, v134
    v_pk_add_f32 v[132:133], v[132:133], v[136:137]
    v_accvgpr_read_b32 v135, a14
    v_lshlrev_b32 v134, 16, v135
    v_and_b32 v135, 0xffff0000, v135
    v_pk_mul_f32 v[134:135], v[134:135], v[148:149]
    v_cvt_pk_bf16_f32 v134, v134, v135
    v_lshlrev_b32 v136, 16, v134
    v_and_b32 v137, 0xffff0000, v134
    v_pk_add_f32 v[132:133], v[132:133], v[136:137]
    v_accvgpr_read_b32 v135, a15
    v_lshlrev_b32 v134, 16, v135
    v_and_b32 v135, 0xffff0000, v135
    v_pk_mul_f32 v[134:135], v[134:135], v[150:151]
    v_cvt_pk_bf16_f32 v134, v134, v135
    v_lshlrev_b32 v136, 16, v134
    v_and_b32 v137, 0xffff0000, v134
    v_pk_add_f32 v[132:133], v[132:133], v[136:137]
    v_add_f32 v132, v132, v133
    v_accvgpr_write_b32 a131, v132
    v_cvt_pk_bf16_f32 v78, v108, v109
    v_cvt_pk_bf16_f32 v79, v110, v111
    buffer_store_dwordx4 v[76:79], v156, s[16:19], s98 offen offset:1024 sc0 sc1
    s_add_u32 s98, s98, 8192
    v_cvt_pk_bf16_f32 v80, v80, v81
    v_cvt_pk_bf16_f32 v81, v82, v83
    v_accvgpr_read_b32 v135, a16
    v_lshlrev_b32 v134, 16, v135
    v_and_b32 v135, 0xffff0000, v135
    v_pk_mul_f32 v[134:135], v[134:135], v[144:145]
    v_cvt_pk_bf16_f32 v134, v134, v135
    v_lshlrev_b32 v132, 16, v134
    v_and_b32 v133, 0xffff0000, v134
    v_accvgpr_read_b32 v135, a17
    v_lshlrev_b32 v134, 16, v135
    v_and_b32 v135, 0xffff0000, v135
    v_pk_mul_f32 v[134:135], v[134:135], v[146:147]
    v_cvt_pk_bf16_f32 v134, v134, v135
    v_lshlrev_b32 v136, 16, v134
    v_and_b32 v137, 0xffff0000, v134
    v_pk_add_f32 v[132:133], v[132:133], v[136:137]
    v_accvgpr_read_b32 v135, a18
    v_lshlrev_b32 v134, 16, v135
    v_and_b32 v135, 0xffff0000, v135
    v_pk_mul_f32 v[134:135], v[134:135], v[148:149]
    v_cvt_pk_bf16_f32 v134, v134, v135
    v_lshlrev_b32 v136, 16, v134
    v_and_b32 v137, 0xffff0000, v134
    v_pk_add_f32 v[132:133], v[132:133], v[136:137]
    v_accvgpr_read_b32 v135, a19
    v_lshlrev_b32 v134, 16, v135
    v_and_b32 v135, 0xffff0000, v135
    v_pk_mul_f32 v[134:135], v[134:135], v[150:151]
    v_cvt_pk_bf16_f32 v134, v134, v135
    v_lshlrev_b32 v136, 16, v134
    v_and_b32 v137, 0xffff0000, v134
    v_pk_add_f32 v[132:133], v[132:133], v[136:137]
    v_add_f32 v132, v132, v133
    v_accvgpr_write_b32 a132, v132
    v_cvt_pk_bf16_f32 v82, v112, v113
    v_cvt_pk_bf16_f32 v83, v114, v115
    buffer_store_dwordx4 v[80:83], v155, s[16:19], s98 offen offset:0 sc0 sc1
    v_cvt_pk_bf16_f32 v84, v84, v85
    v_cvt_pk_bf16_f32 v85, v86, v87
    v_cvt_pk_bf16_f32 v86, v116, v117
    v_accvgpr_read_b32 v135, a20
    v_lshlrev_b32 v134, 16, v135
    v_and_b32 v135, 0xffff0000, v135
    v_pk_mul_f32 v[134:135], v[134:135], v[144:145]
    v_cvt_pk_bf16_f32 v134, v134, v135
    v_lshlrev_b32 v132, 16, v134
    v_and_b32 v133, 0xffff0000, v134
    v_accvgpr_read_b32 v135, a21
    v_lshlrev_b32 v134, 16, v135
    v_and_b32 v135, 0xffff0000, v135
    v_pk_mul_f32 v[134:135], v[134:135], v[146:147]
    v_cvt_pk_bf16_f32 v134, v134, v135
    v_lshlrev_b32 v136, 16, v134
    v_and_b32 v137, 0xffff0000, v134
    v_pk_add_f32 v[132:133], v[132:133], v[136:137]
    v_accvgpr_read_b32 v135, a22
    v_lshlrev_b32 v134, 16, v135
    v_and_b32 v135, 0xffff0000, v135
    v_pk_mul_f32 v[134:135], v[134:135], v[148:149]
    v_cvt_pk_bf16_f32 v134, v134, v135
    v_lshlrev_b32 v136, 16, v134
    v_and_b32 v137, 0xffff0000, v134
    v_pk_add_f32 v[132:133], v[132:133], v[136:137]
    v_accvgpr_read_b32 v135, a23
    v_lshlrev_b32 v134, 16, v135
    v_and_b32 v135, 0xffff0000, v135
    v_pk_mul_f32 v[134:135], v[134:135], v[150:151]
    v_cvt_pk_bf16_f32 v134, v134, v135
    v_lshlrev_b32 v136, 16, v134
    v_and_b32 v137, 0xffff0000, v134
    v_pk_add_f32 v[132:133], v[132:133], v[136:137]
    v_add_f32 v132, v132, v133
    v_accvgpr_write_b32 a133, v132
    v_cvt_pk_bf16_f32 v87, v118, v119
    buffer_store_dwordx4 v[84:87], v155, s[16:19], s98 offen offset:1024 sc0 sc1
    v_cvt_pk_bf16_f32 v88, v88, v89
    v_cvt_pk_bf16_f32 v89, v90, v91
    v_cvt_pk_bf16_f32 v90, v120, v121
    v_cvt_pk_bf16_f32 v91, v122, v123
    v_accvgpr_read_b32 v135, a24
    v_lshlrev_b32 v134, 16, v135
    v_and_b32 v135, 0xffff0000, v135
    v_pk_mul_f32 v[134:135], v[134:135], v[144:145]
    v_cvt_pk_bf16_f32 v134, v134, v135
    v_lshlrev_b32 v132, 16, v134
    v_and_b32 v133, 0xffff0000, v134
    v_accvgpr_read_b32 v135, a25
    v_lshlrev_b32 v134, 16, v135
    v_and_b32 v135, 0xffff0000, v135
    v_pk_mul_f32 v[134:135], v[134:135], v[146:147]
    v_cvt_pk_bf16_f32 v134, v134, v135
    v_lshlrev_b32 v136, 16, v134
    v_and_b32 v137, 0xffff0000, v134
    v_pk_add_f32 v[132:133], v[132:133], v[136:137]
    v_accvgpr_read_b32 v135, a26
    v_lshlrev_b32 v134, 16, v135
    v_and_b32 v135, 0xffff0000, v135
    v_pk_mul_f32 v[134:135], v[134:135], v[148:149]
    v_cvt_pk_bf16_f32 v134, v134, v135
    v_lshlrev_b32 v136, 16, v134
    v_and_b32 v137, 0xffff0000, v134
    v_pk_add_f32 v[132:133], v[132:133], v[136:137]
    v_accvgpr_read_b32 v135, a27
    v_lshlrev_b32 v134, 16, v135
    v_and_b32 v135, 0xffff0000, v135
    v_pk_mul_f32 v[134:135], v[134:135], v[150:151]
    v_cvt_pk_bf16_f32 v134, v134, v135
    v_lshlrev_b32 v136, 16, v134
    v_and_b32 v137, 0xffff0000, v134
    v_pk_add_f32 v[132:133], v[132:133], v[136:137]
    v_add_f32 v132, v132, v133
    v_accvgpr_write_b32 a134, v132
    buffer_store_dwordx4 v[88:91], v156, s[16:19], s98 offen offset:0 sc0 sc1
    v_cvt_pk_bf16_f32 v92, v92, v93
    v_cvt_pk_bf16_f32 v93, v94, v95
    v_cvt_pk_bf16_f32 v94, v124, v125
    v_cvt_pk_bf16_f32 v95, v126, v127
    buffer_store_dwordx4 v[92:95], v156, s[16:19], s98 offen offset:1024 sc0 sc1
    v_accvgpr_read_b32 v135, a28
    v_lshlrev_b32 v134, 16, v135
    v_and_b32 v135, 0xffff0000, v135
    v_pk_mul_f32 v[134:135], v[134:135], v[144:145]
    v_cvt_pk_bf16_f32 v134, v134, v135
    v_lshlrev_b32 v132, 16, v134
    v_and_b32 v133, 0xffff0000, v134
    v_accvgpr_read_b32 v135, a29
    v_lshlrev_b32 v134, 16, v135
    v_and_b32 v135, 0xffff0000, v135
    v_pk_mul_f32 v[134:135], v[134:135], v[146:147]
    v_cvt_pk_bf16_f32 v134, v134, v135
    v_lshlrev_b32 v136, 16, v134
    v_and_b32 v137, 0xffff0000, v134
    v_pk_add_f32 v[132:133], v[132:133], v[136:137]
    v_accvgpr_read_b32 v135, a30
    v_lshlrev_b32 v134, 16, v135
    v_and_b32 v135, 0xffff0000, v135
    v_pk_mul_f32 v[134:135], v[134:135], v[148:149]
    v_cvt_pk_bf16_f32 v134, v134, v135
    v_lshlrev_b32 v136, 16, v134
    v_and_b32 v137, 0xffff0000, v134
    v_pk_add_f32 v[132:133], v[132:133], v[136:137]
    v_accvgpr_read_b32 v135, a31
    v_lshlrev_b32 v134, 16, v135
    v_and_b32 v135, 0xffff0000, v135
    v_pk_mul_f32 v[134:135], v[134:135], v[150:151]
    v_cvt_pk_bf16_f32 v134, v134, v135
    v_lshlrev_b32 v136, 16, v134
    v_and_b32 v137, 0xffff0000, v134
    v_pk_add_f32 v[132:133], v[132:133], v[136:137]
    v_add_f32 v132, v132, v133
    v_accvgpr_write_b32 a135, v132
    s_add_u32 s98, s98, 8192
    v_accvgpr_read_b32 v0, a192
    v_accvgpr_read_b32 v1, a193
    v_accvgpr_read_b32 v2, a194
    v_accvgpr_read_b32 v3, a195
    v_cvt_pk_bf16_f32 v192, v192, v193
    v_accvgpr_read_b32 v135, a32
    v_lshlrev_b32 v134, 16, v135
    v_and_b32 v135, 0xffff0000, v135
    v_pk_mul_f32 v[134:135], v[134:135], v[144:145]
    v_cvt_pk_bf16_f32 v134, v134, v135
    v_lshlrev_b32 v132, 16, v134
    v_and_b32 v133, 0xffff0000, v134
    v_accvgpr_read_b32 v135, a33
    v_lshlrev_b32 v134, 16, v135
    v_and_b32 v135, 0xffff0000, v135
    v_pk_mul_f32 v[134:135], v[134:135], v[146:147]
    v_cvt_pk_bf16_f32 v134, v134, v135
    v_lshlrev_b32 v136, 16, v134
    v_and_b32 v137, 0xffff0000, v134
    v_pk_add_f32 v[132:133], v[132:133], v[136:137]
    v_accvgpr_read_b32 v135, a34
    v_lshlrev_b32 v134, 16, v135
    v_and_b32 v135, 0xffff0000, v135
    v_pk_mul_f32 v[134:135], v[134:135], v[148:149]
    v_cvt_pk_bf16_f32 v134, v134, v135
    v_lshlrev_b32 v136, 16, v134
    v_and_b32 v137, 0xffff0000, v134
    v_pk_add_f32 v[132:133], v[132:133], v[136:137]
    v_accvgpr_read_b32 v135, a35
    v_lshlrev_b32 v134, 16, v135
    v_and_b32 v135, 0xffff0000, v135
    v_pk_mul_f32 v[134:135], v[134:135], v[150:151]
    v_cvt_pk_bf16_f32 v134, v134, v135
    v_lshlrev_b32 v136, 16, v134
    v_and_b32 v137, 0xffff0000, v134
    v_pk_add_f32 v[132:133], v[132:133], v[136:137]
    v_add_f32 v132, v132, v133
    v_accvgpr_write_b32 a136, v132
    v_cvt_pk_bf16_f32 v193, v194, v195
    v_cvt_pk_bf16_f32 v194, v0, v1
    v_cvt_pk_bf16_f32 v195, v2, v3
    buffer_store_dwordx4 v[192:195], v155, s[16:19], s98 offen offset:0 sc0 sc1
    v_accvgpr_read_b32 v4, a196
    v_accvgpr_read_b32 v5, a197
    v_accvgpr_read_b32 v135, a36
    v_lshlrev_b32 v134, 16, v135
    v_and_b32 v135, 0xffff0000, v135
    v_pk_mul_f32 v[134:135], v[134:135], v[144:145]
    v_cvt_pk_bf16_f32 v134, v134, v135
    v_lshlrev_b32 v132, 16, v134
    v_and_b32 v133, 0xffff0000, v134
    v_accvgpr_read_b32 v135, a37
    v_lshlrev_b32 v134, 16, v135
    v_and_b32 v135, 0xffff0000, v135
    v_pk_mul_f32 v[134:135], v[134:135], v[146:147]
    v_cvt_pk_bf16_f32 v134, v134, v135
    v_lshlrev_b32 v136, 16, v134
    v_and_b32 v137, 0xffff0000, v134
    v_pk_add_f32 v[132:133], v[132:133], v[136:137]
    v_accvgpr_read_b32 v135, a38
    v_lshlrev_b32 v134, 16, v135
    v_and_b32 v135, 0xffff0000, v135
    v_pk_mul_f32 v[134:135], v[134:135], v[148:149]
    v_cvt_pk_bf16_f32 v134, v134, v135
    v_lshlrev_b32 v136, 16, v134
    v_and_b32 v137, 0xffff0000, v134
    v_pk_add_f32 v[132:133], v[132:133], v[136:137]
    v_accvgpr_read_b32 v135, a39
    v_lshlrev_b32 v134, 16, v135
    v_and_b32 v135, 0xffff0000, v135
    v_pk_mul_f32 v[134:135], v[134:135], v[150:151]
    v_cvt_pk_bf16_f32 v134, v134, v135
    v_lshlrev_b32 v136, 16, v134
    v_and_b32 v137, 0xffff0000, v134
    v_pk_add_f32 v[132:133], v[132:133], v[136:137]
    v_add_f32 v132, v132, v133
    v_accvgpr_write_b32 a137, v132
    v_accvgpr_read_b32 v6, a198
    v_accvgpr_read_b32 v7, a199
    v_cvt_pk_bf16_f32 v196, v196, v197
    v_cvt_pk_bf16_f32 v197, v198, v199
    v_cvt_pk_bf16_f32 v198, v4, v5
    v_cvt_pk_bf16_f32 v199, v6, v7
    v_accvgpr_read_b32 v135, a40
    v_lshlrev_b32 v134, 16, v135
    v_and_b32 v135, 0xffff0000, v135
    v_pk_mul_f32 v[134:135], v[134:135], v[144:145]
    v_cvt_pk_bf16_f32 v134, v134, v135
    v_lshlrev_b32 v132, 16, v134
    v_and_b32 v133, 0xffff0000, v134
    v_accvgpr_read_b32 v135, a41
    v_lshlrev_b32 v134, 16, v135
    v_and_b32 v135, 0xffff0000, v135
    v_pk_mul_f32 v[134:135], v[134:135], v[146:147]
    v_cvt_pk_bf16_f32 v134, v134, v135
    v_lshlrev_b32 v136, 16, v134
    v_and_b32 v137, 0xffff0000, v134
    v_pk_add_f32 v[132:133], v[132:133], v[136:137]
    v_accvgpr_read_b32 v135, a42
    v_lshlrev_b32 v134, 16, v135
    v_and_b32 v135, 0xffff0000, v135
    v_pk_mul_f32 v[134:135], v[134:135], v[148:149]
    v_cvt_pk_bf16_f32 v134, v134, v135
    v_lshlrev_b32 v136, 16, v134
    v_and_b32 v137, 0xffff0000, v134
    v_pk_add_f32 v[132:133], v[132:133], v[136:137]
    v_accvgpr_read_b32 v135, a43
    v_lshlrev_b32 v134, 16, v135
    v_and_b32 v135, 0xffff0000, v135
    v_pk_mul_f32 v[134:135], v[134:135], v[150:151]
    v_cvt_pk_bf16_f32 v134, v134, v135
    v_lshlrev_b32 v136, 16, v134
    v_and_b32 v137, 0xffff0000, v134
    v_pk_add_f32 v[132:133], v[132:133], v[136:137]
    v_add_f32 v132, v132, v133
    v_accvgpr_write_b32 a138, v132
    buffer_store_dwordx4 v[196:199], v155, s[16:19], s98 offen offset:1024 sc0 sc1
    v_accvgpr_read_b32 v8, a200
    v_accvgpr_read_b32 v9, a201
    v_accvgpr_read_b32 v10, a202
    v_accvgpr_read_b32 v11, a203
    v_cvt_pk_bf16_f32 v200, v200, v201
    v_accvgpr_read_b32 v135, a44
    v_lshlrev_b32 v134, 16, v135
    v_and_b32 v135, 0xffff0000, v135
    v_pk_mul_f32 v[134:135], v[134:135], v[144:145]
    v_cvt_pk_bf16_f32 v134, v134, v135
    v_lshlrev_b32 v132, 16, v134
    v_and_b32 v133, 0xffff0000, v134
    v_accvgpr_read_b32 v135, a45
    v_lshlrev_b32 v134, 16, v135
    v_and_b32 v135, 0xffff0000, v135
    v_pk_mul_f32 v[134:135], v[134:135], v[146:147]
    v_cvt_pk_bf16_f32 v134, v134, v135
    v_lshlrev_b32 v136, 16, v134
    v_and_b32 v137, 0xffff0000, v134
    v_pk_add_f32 v[132:133], v[132:133], v[136:137]
    v_accvgpr_read_b32 v135, a46
    v_lshlrev_b32 v134, 16, v135
    v_and_b32 v135, 0xffff0000, v135
    v_pk_mul_f32 v[134:135], v[134:135], v[148:149]
    v_cvt_pk_bf16_f32 v134, v134, v135
    v_lshlrev_b32 v136, 16, v134
    v_and_b32 v137, 0xffff0000, v134
    v_pk_add_f32 v[132:133], v[132:133], v[136:137]
    v_accvgpr_read_b32 v135, a47
    v_lshlrev_b32 v134, 16, v135
    v_and_b32 v135, 0xffff0000, v135
    v_pk_mul_f32 v[134:135], v[134:135], v[150:151]
    v_cvt_pk_bf16_f32 v134, v134, v135
    v_lshlrev_b32 v136, 16, v134
    v_and_b32 v137, 0xffff0000, v134
    v_pk_add_f32 v[132:133], v[132:133], v[136:137]
    v_add_f32 v132, v132, v133
    v_accvgpr_write_b32 a139, v132
    v_cvt_pk_bf16_f32 v201, v202, v203
    v_cvt_pk_bf16_f32 v202, v8, v9
    v_cvt_pk_bf16_f32 v203, v10, v11
    buffer_store_dwordx4 v[200:203], v156, s[16:19], s98 offen offset:0 sc0 sc1
    v_accvgpr_read_b32 v12, a204
    v_accvgpr_read_b32 v13, a205
    v_accvgpr_read_b32 v135, a48
    v_lshlrev_b32 v134, 16, v135
    v_and_b32 v135, 0xffff0000, v135
    v_pk_mul_f32 v[134:135], v[134:135], v[144:145]
    v_cvt_pk_bf16_f32 v134, v134, v135
    v_lshlrev_b32 v132, 16, v134
    v_and_b32 v133, 0xffff0000, v134
    v_accvgpr_read_b32 v135, a49
    v_lshlrev_b32 v134, 16, v135
    v_and_b32 v135, 0xffff0000, v135
    v_pk_mul_f32 v[134:135], v[134:135], v[146:147]
    v_cvt_pk_bf16_f32 v134, v134, v135
    v_lshlrev_b32 v136, 16, v134
    v_and_b32 v137, 0xffff0000, v134
    v_pk_add_f32 v[132:133], v[132:133], v[136:137]
    v_accvgpr_read_b32 v135, a50
    v_lshlrev_b32 v134, 16, v135
    v_and_b32 v135, 0xffff0000, v135
    v_pk_mul_f32 v[134:135], v[134:135], v[148:149]
    v_cvt_pk_bf16_f32 v134, v134, v135
    v_lshlrev_b32 v136, 16, v134
    v_and_b32 v137, 0xffff0000, v134
    v_pk_add_f32 v[132:133], v[132:133], v[136:137]
    v_accvgpr_read_b32 v135, a51
    v_lshlrev_b32 v134, 16, v135
    v_and_b32 v135, 0xffff0000, v135
    v_pk_mul_f32 v[134:135], v[134:135], v[150:151]
    v_cvt_pk_bf16_f32 v134, v134, v135
    v_lshlrev_b32 v136, 16, v134
    v_and_b32 v137, 0xffff0000, v134
    v_pk_add_f32 v[132:133], v[132:133], v[136:137]
    v_add_f32 v132, v132, v133
    v_accvgpr_write_b32 a140, v132
    v_accvgpr_read_b32 v14, a206
    v_accvgpr_read_b32 v15, a207
    v_cvt_pk_bf16_f32 v204, v204, v205
    v_cvt_pk_bf16_f32 v205, v206, v207
    v_cvt_pk_bf16_f32 v206, v12, v13
    v_cvt_pk_bf16_f32 v207, v14, v15
    v_accvgpr_read_b32 v135, a52
    v_lshlrev_b32 v134, 16, v135
    v_and_b32 v135, 0xffff0000, v135
    v_pk_mul_f32 v[134:135], v[134:135], v[144:145]
    v_cvt_pk_bf16_f32 v134, v134, v135
    v_lshlrev_b32 v132, 16, v134
    v_and_b32 v133, 0xffff0000, v134
    v_accvgpr_read_b32 v135, a53
    v_lshlrev_b32 v134, 16, v135
    v_and_b32 v135, 0xffff0000, v135
    v_pk_mul_f32 v[134:135], v[134:135], v[146:147]
    v_cvt_pk_bf16_f32 v134, v134, v135
    v_lshlrev_b32 v136, 16, v134
    v_and_b32 v137, 0xffff0000, v134
    v_pk_add_f32 v[132:133], v[132:133], v[136:137]
    v_accvgpr_read_b32 v135, a54
    v_lshlrev_b32 v134, 16, v135
    v_and_b32 v135, 0xffff0000, v135
    v_pk_mul_f32 v[134:135], v[134:135], v[148:149]
    v_cvt_pk_bf16_f32 v134, v134, v135
    v_lshlrev_b32 v136, 16, v134
    v_and_b32 v137, 0xffff0000, v134
    v_pk_add_f32 v[132:133], v[132:133], v[136:137]
    v_accvgpr_read_b32 v135, a55
    v_lshlrev_b32 v134, 16, v135
    v_and_b32 v135, 0xffff0000, v135
    v_pk_mul_f32 v[134:135], v[134:135], v[150:151]
    v_cvt_pk_bf16_f32 v134, v134, v135
    v_lshlrev_b32 v136, 16, v134
    v_and_b32 v137, 0xffff0000, v134
    v_pk_add_f32 v[132:133], v[132:133], v[136:137]
    v_add_f32 v132, v132, v133
    v_accvgpr_write_b32 a141, v132
    buffer_store_dwordx4 v[204:207], v156, s[16:19], s98 offen offset:1024 sc0 sc1
    s_add_u32 s98, s98, 8192
    v_accvgpr_read_b32 v0, a208
    v_accvgpr_read_b32 v1, a209
    v_accvgpr_read_b32 v2, a210
    v_accvgpr_read_b32 v3, a211
    v_accvgpr_read_b32 v135, a56
    v_lshlrev_b32 v134, 16, v135
    v_and_b32 v135, 0xffff0000, v135
    v_pk_mul_f32 v[134:135], v[134:135], v[144:145]
    v_cvt_pk_bf16_f32 v134, v134, v135
    v_lshlrev_b32 v132, 16, v134
    v_and_b32 v133, 0xffff0000, v134
    v_accvgpr_read_b32 v135, a57
    v_lshlrev_b32 v134, 16, v135
    v_and_b32 v135, 0xffff0000, v135
    v_pk_mul_f32 v[134:135], v[134:135], v[146:147]
    v_cvt_pk_bf16_f32 v134, v134, v135
    v_lshlrev_b32 v136, 16, v134
    v_and_b32 v137, 0xffff0000, v134
    v_pk_add_f32 v[132:133], v[132:133], v[136:137]
    v_accvgpr_read_b32 v135, a58
    v_lshlrev_b32 v134, 16, v135
    v_and_b32 v135, 0xffff0000, v135
    v_pk_mul_f32 v[134:135], v[134:135], v[148:149]
    v_cvt_pk_bf16_f32 v134, v134, v135
    v_lshlrev_b32 v136, 16, v134
    v_and_b32 v137, 0xffff0000, v134
    v_pk_add_f32 v[132:133], v[132:133], v[136:137]
    v_accvgpr_read_b32 v135, a59
    v_lshlrev_b32 v134, 16, v135
    v_and_b32 v135, 0xffff0000, v135
    v_pk_mul_f32 v[134:135], v[134:135], v[150:151]
    v_cvt_pk_bf16_f32 v134, v134, v135
    v_lshlrev_b32 v136, 16, v134
    v_and_b32 v137, 0xffff0000, v134
    v_pk_add_f32 v[132:133], v[132:133], v[136:137]
    v_add_f32 v132, v132, v133
    v_accvgpr_write_b32 a142, v132
    v_cvt_pk_bf16_f32 v208, v208, v209
    v_cvt_pk_bf16_f32 v209, v210, v211
    v_cvt_pk_bf16_f32 v210, v0, v1
    v_cvt_pk_bf16_f32 v211, v2, v3
    buffer_store_dwordx4 v[208:211], v155, s[16:19], s98 offen offset:0 sc0 sc1
    v_accvgpr_read_b32 v4, a212
    v_accvgpr_read_b32 v135, a60
    v_lshlrev_b32 v134, 16, v135
    v_and_b32 v135, 0xffff0000, v135
    v_pk_mul_f32 v[134:135], v[134:135], v[144:145]
    v_cvt_pk_bf16_f32 v134, v134, v135
    v_lshlrev_b32 v132, 16, v134
    v_and_b32 v133, 0xffff0000, v134
    v_accvgpr_read_b32 v135, a61
    v_lshlrev_b32 v134, 16, v135
    v_and_b32 v135, 0xffff0000, v135
    v_pk_mul_f32 v[134:135], v[134:135], v[146:147]
    v_cvt_pk_bf16_f32 v134, v134, v135
    v_lshlrev_b32 v136, 16, v134
    v_and_b32 v137, 0xffff0000, v134
    v_pk_add_f32 v[132:133], v[132:133], v[136:137]
    v_accvgpr_read_b32 v135, a62
    v_lshlrev_b32 v134, 16, v135
    v_and_b32 v135, 0xffff0000, v135
    v_pk_mul_f32 v[134:135], v[134:135], v[148:149]
    v_cvt_pk_bf16_f32 v134, v134, v135
    v_lshlrev_b32 v136, 16, v134
    v_and_b32 v137, 0xffff0000, v134
    v_pk_add_f32 v[132:133], v[132:133], v[136:137]
    v_accvgpr_read_b32 v135, a63
    v_lshlrev_b32 v134, 16, v135
    v_and_b32 v135, 0xffff0000, v135
    v_pk_mul_f32 v[134:135], v[134:135], v[150:151]
    v_cvt_pk_bf16_f32 v134, v134, v135
    v_lshlrev_b32 v136, 16, v134
    v_and_b32 v137, 0xffff0000, v134
    v_pk_add_f32 v[132:133], v[132:133], v[136:137]
    v_add_f32 v132, v132, v133
    v_accvgpr_write_b32 a143, v132
    v_accvgpr_read_b32 v5, a213
    v_accvgpr_read_b32 v6, a214
    v_accvgpr_read_b32 v7, a215
    v_cvt_pk_bf16_f32 v212, v212, v213
    v_cvt_pk_bf16_f32 v213, v214, v215
    v_cvt_pk_bf16_f32 v214, v4, v5
    v_accvgpr_read_b32 v135, a64
    v_lshlrev_b32 v134, 16, v135
    v_and_b32 v135, 0xffff0000, v135
    v_pk_mul_f32 v[134:135], v[134:135], v[144:145]
    v_cvt_pk_bf16_f32 v134, v134, v135
    v_lshlrev_b32 v132, 16, v134
    v_and_b32 v133, 0xffff0000, v134
    v_accvgpr_read_b32 v135, a65
    v_lshlrev_b32 v134, 16, v135
    v_and_b32 v135, 0xffff0000, v135
    v_pk_mul_f32 v[134:135], v[134:135], v[146:147]
    v_cvt_pk_bf16_f32 v134, v134, v135
    v_lshlrev_b32 v136, 16, v134
    v_and_b32 v137, 0xffff0000, v134
    v_pk_add_f32 v[132:133], v[132:133], v[136:137]
    v_accvgpr_read_b32 v135, a66
    v_lshlrev_b32 v134, 16, v135
    v_and_b32 v135, 0xffff0000, v135
    v_pk_mul_f32 v[134:135], v[134:135], v[148:149]
    v_cvt_pk_bf16_f32 v134, v134, v135
    v_lshlrev_b32 v136, 16, v134
    v_and_b32 v137, 0xffff0000, v134
    v_pk_add_f32 v[132:133], v[132:133], v[136:137]
    v_accvgpr_read_b32 v135, a67
    v_lshlrev_b32 v134, 16, v135
    v_and_b32 v135, 0xffff0000, v135
    v_pk_mul_f32 v[134:135], v[134:135], v[150:151]
    v_cvt_pk_bf16_f32 v134, v134, v135
    v_lshlrev_b32 v136, 16, v134
    v_and_b32 v137, 0xffff0000, v134
    v_pk_add_f32 v[132:133], v[132:133], v[136:137]
    v_add_f32 v132, v132, v133
    v_accvgpr_write_b32 a144, v132
    v_cvt_pk_bf16_f32 v215, v6, v7
    buffer_store_dwordx4 v[212:215], v155, s[16:19], s98 offen offset:1024 sc0 sc1
    v_accvgpr_read_b32 v8, a216
    v_accvgpr_read_b32 v9, a217
    v_accvgpr_read_b32 v10, a218
    v_accvgpr_read_b32 v11, a219
    v_accvgpr_read_b32 v135, a68
    v_lshlrev_b32 v134, 16, v135
    v_and_b32 v135, 0xffff0000, v135
    v_pk_mul_f32 v[134:135], v[134:135], v[144:145]
    v_cvt_pk_bf16_f32 v134, v134, v135
    v_lshlrev_b32 v132, 16, v134
    v_and_b32 v133, 0xffff0000, v134
    v_accvgpr_read_b32 v135, a69
    v_lshlrev_b32 v134, 16, v135
    v_and_b32 v135, 0xffff0000, v135
    v_pk_mul_f32 v[134:135], v[134:135], v[146:147]
    v_cvt_pk_bf16_f32 v134, v134, v135
    v_lshlrev_b32 v136, 16, v134
    v_and_b32 v137, 0xffff0000, v134
    v_pk_add_f32 v[132:133], v[132:133], v[136:137]
    v_accvgpr_read_b32 v135, a70
    v_lshlrev_b32 v134, 16, v135
    v_and_b32 v135, 0xffff0000, v135
    v_pk_mul_f32 v[134:135], v[134:135], v[148:149]
    v_cvt_pk_bf16_f32 v134, v134, v135
    v_lshlrev_b32 v136, 16, v134
    v_and_b32 v137, 0xffff0000, v134
    v_pk_add_f32 v[132:133], v[132:133], v[136:137]
    v_accvgpr_read_b32 v135, a71
    v_lshlrev_b32 v134, 16, v135
    v_and_b32 v135, 0xffff0000, v135
    v_pk_mul_f32 v[134:135], v[134:135], v[150:151]
    v_cvt_pk_bf16_f32 v134, v134, v135
    v_lshlrev_b32 v136, 16, v134
    v_and_b32 v137, 0xffff0000, v134
    v_pk_add_f32 v[132:133], v[132:133], v[136:137]
    v_add_f32 v132, v132, v133
    v_accvgpr_write_b32 a145, v132
    v_cvt_pk_bf16_f32 v216, v216, v217
    v_cvt_pk_bf16_f32 v217, v218, v219
    v_cvt_pk_bf16_f32 v218, v8, v9
    v_cvt_pk_bf16_f32 v219, v10, v11
    buffer_store_dwordx4 v[216:219], v156, s[16:19], s98 offen offset:0 sc0 sc1
    v_accvgpr_read_b32 v12, a220
    v_accvgpr_read_b32 v135, a72
    v_lshlrev_b32 v134, 16, v135
    v_and_b32 v135, 0xffff0000, v135
    v_pk_mul_f32 v[134:135], v[134:135], v[144:145]
    v_cvt_pk_bf16_f32 v134, v134, v135
    v_lshlrev_b32 v132, 16, v134
    v_and_b32 v133, 0xffff0000, v134
    v_accvgpr_read_b32 v135, a73
    v_lshlrev_b32 v134, 16, v135
    v_and_b32 v135, 0xffff0000, v135
    v_pk_mul_f32 v[134:135], v[134:135], v[146:147]
    v_cvt_pk_bf16_f32 v134, v134, v135
    v_lshlrev_b32 v136, 16, v134
    v_and_b32 v137, 0xffff0000, v134
    v_pk_add_f32 v[132:133], v[132:133], v[136:137]
    v_accvgpr_read_b32 v135, a74
    v_lshlrev_b32 v134, 16, v135
    v_and_b32 v135, 0xffff0000, v135
    v_pk_mul_f32 v[134:135], v[134:135], v[148:149]
    v_cvt_pk_bf16_f32 v134, v134, v135
    v_lshlrev_b32 v136, 16, v134
    v_and_b32 v137, 0xffff0000, v134
    v_pk_add_f32 v[132:133], v[132:133], v[136:137]
    v_accvgpr_read_b32 v135, a75
    v_lshlrev_b32 v134, 16, v135
    v_and_b32 v135, 0xffff0000, v135
    v_pk_mul_f32 v[134:135], v[134:135], v[150:151]
    v_cvt_pk_bf16_f32 v134, v134, v135
    v_lshlrev_b32 v136, 16, v134
    v_and_b32 v137, 0xffff0000, v134
    v_pk_add_f32 v[132:133], v[132:133], v[136:137]
    v_add_f32 v132, v132, v133
    v_accvgpr_write_b32 a146, v132
    v_accvgpr_read_b32 v13, a221
    v_accvgpr_read_b32 v14, a222
    v_accvgpr_read_b32 v15, a223
    v_cvt_pk_bf16_f32 v220, v220, v221
    v_cvt_pk_bf16_f32 v221, v222, v223
    v_cvt_pk_bf16_f32 v222, v12, v13
    v_accvgpr_read_b32 v135, a76
    v_lshlrev_b32 v134, 16, v135
    v_and_b32 v135, 0xffff0000, v135
    v_pk_mul_f32 v[134:135], v[134:135], v[144:145]
    v_cvt_pk_bf16_f32 v134, v134, v135
    v_lshlrev_b32 v132, 16, v134
    v_and_b32 v133, 0xffff0000, v134
    v_accvgpr_read_b32 v135, a77
    v_lshlrev_b32 v134, 16, v135
    v_and_b32 v135, 0xffff0000, v135
    v_pk_mul_f32 v[134:135], v[134:135], v[146:147]
    v_cvt_pk_bf16_f32 v134, v134, v135
    v_lshlrev_b32 v136, 16, v134
    v_and_b32 v137, 0xffff0000, v134
    v_pk_add_f32 v[132:133], v[132:133], v[136:137]
    v_accvgpr_read_b32 v135, a78
    v_lshlrev_b32 v134, 16, v135
    v_and_b32 v135, 0xffff0000, v135
    v_pk_mul_f32 v[134:135], v[134:135], v[148:149]
    v_cvt_pk_bf16_f32 v134, v134, v135
    v_lshlrev_b32 v136, 16, v134
    v_and_b32 v137, 0xffff0000, v134
    v_pk_add_f32 v[132:133], v[132:133], v[136:137]
    v_accvgpr_read_b32 v135, a79
    v_lshlrev_b32 v134, 16, v135
    v_and_b32 v135, 0xffff0000, v135
    v_pk_mul_f32 v[134:135], v[134:135], v[150:151]
    v_cvt_pk_bf16_f32 v134, v134, v135
    v_lshlrev_b32 v136, 16, v134
    v_and_b32 v137, 0xffff0000, v134
    v_pk_add_f32 v[132:133], v[132:133], v[136:137]
    v_add_f32 v132, v132, v133
    v_accvgpr_write_b32 a147, v132
    v_cvt_pk_bf16_f32 v223, v14, v15
    buffer_store_dwordx4 v[220:223], v156, s[16:19], s98 offen offset:1024 sc0 sc1
    s_add_u32 s98, s98, 8192
    v_accvgpr_read_b32 v0, a224
    v_accvgpr_read_b32 v1, a225
    v_accvgpr_read_b32 v2, a226
    v_accvgpr_read_b32 v135, a80
    v_lshlrev_b32 v134, 16, v135
    v_and_b32 v135, 0xffff0000, v135
    v_pk_mul_f32 v[134:135], v[134:135], v[144:145]
    v_cvt_pk_bf16_f32 v134, v134, v135
    v_lshlrev_b32 v132, 16, v134
    v_and_b32 v133, 0xffff0000, v134
    v_accvgpr_read_b32 v135, a81
    v_lshlrev_b32 v134, 16, v135
    v_and_b32 v135, 0xffff0000, v135
    v_pk_mul_f32 v[134:135], v[134:135], v[146:147]
    v_cvt_pk_bf16_f32 v134, v134, v135
    v_lshlrev_b32 v136, 16, v134
    v_and_b32 v137, 0xffff0000, v134
    v_pk_add_f32 v[132:133], v[132:133], v[136:137]
    v_accvgpr_read_b32 v135, a82
    v_lshlrev_b32 v134, 16, v135
    v_and_b32 v135, 0xffff0000, v135
    v_pk_mul_f32 v[134:135], v[134:135], v[148:149]
    v_cvt_pk_bf16_f32 v134, v134, v135
    v_lshlrev_b32 v136, 16, v134
    v_and_b32 v137, 0xffff0000, v134
    v_pk_add_f32 v[132:133], v[132:133], v[136:137]
    v_accvgpr_read_b32 v135, a83
    v_lshlrev_b32 v134, 16, v135
    v_and_b32 v135, 0xffff0000, v135
    v_pk_mul_f32 v[134:135], v[134:135], v[150:151]
    v_cvt_pk_bf16_f32 v134, v134, v135
    v_lshlrev_b32 v136, 16, v134
    v_and_b32 v137, 0xffff0000, v134
    v_pk_add_f32 v[132:133], v[132:133], v[136:137]
    v_add_f32 v132, v132, v133
    v_accvgpr_write_b32 a148, v132
    v_accvgpr_read_b32 v3, a227
    v_cvt_pk_bf16_f32 v224, v224, v225
    v_cvt_pk_bf16_f32 v225, v226, v227
    v_cvt_pk_bf16_f32 v226, v0, v1
    v_cvt_pk_bf16_f32 v227, v2, v3
    buffer_store_dwordx4 v[224:227], v155, s[16:19], s98 offen offset:0 sc0 sc1
    v_accvgpr_read_b32 v135, a84
    v_lshlrev_b32 v134, 16, v135
    v_and_b32 v135, 0xffff0000, v135
    v_pk_mul_f32 v[134:135], v[134:135], v[144:145]
    v_cvt_pk_bf16_f32 v134, v134, v135
    v_lshlrev_b32 v132, 16, v134
    v_and_b32 v133, 0xffff0000, v134
    v_accvgpr_read_b32 v135, a85
    v_lshlrev_b32 v134, 16, v135
    v_and_b32 v135, 0xffff0000, v135
    v_pk_mul_f32 v[134:135], v[134:135], v[146:147]
    v_cvt_pk_bf16_f32 v134, v134, v135
    v_lshlrev_b32 v136, 16, v134
    v_and_b32 v137, 0xffff0000, v134
    v_pk_add_f32 v[132:133], v[132:133], v[136:137]
    v_accvgpr_read_b32 v135, a86
    v_lshlrev_b32 v134, 16, v135
    v_and_b32 v135, 0xffff0000, v135
    v_pk_mul_f32 v[134:135], v[134:135], v[148:149]
    v_cvt_pk_bf16_f32 v134, v134, v135
    v_lshlrev_b32 v136, 16, v134
    v_and_b32 v137, 0xffff0000, v134
    v_pk_add_f32 v[132:133], v[132:133], v[136:137]
    v_accvgpr_read_b32 v135, a87
    v_lshlrev_b32 v134, 16, v135
    v_and_b32 v135, 0xffff0000, v135
    v_pk_mul_f32 v[134:135], v[134:135], v[150:151]
    v_cvt_pk_bf16_f32 v134, v134, v135
    v_lshlrev_b32 v136, 16, v134
    v_and_b32 v137, 0xffff0000, v134
    v_pk_add_f32 v[132:133], v[132:133], v[136:137]
    v_add_f32 v132, v132, v133
    v_accvgpr_write_b32 a149, v132
    v_accvgpr_read_b32 v4, a228
    v_accvgpr_read_b32 v5, a229
    v_accvgpr_read_b32 v6, a230
    v_accvgpr_read_b32 v7, a231
    v_cvt_pk_bf16_f32 v228, v228, v229
    v_cvt_pk_bf16_f32 v229, v230, v231
    v_accvgpr_read_b32 v135, a88
    v_lshlrev_b32 v134, 16, v135
    v_and_b32 v135, 0xffff0000, v135
    v_pk_mul_f32 v[134:135], v[134:135], v[144:145]
    v_cvt_pk_bf16_f32 v134, v134, v135
    v_lshlrev_b32 v132, 16, v134
    v_and_b32 v133, 0xffff0000, v134
    v_accvgpr_read_b32 v135, a89
    v_lshlrev_b32 v134, 16, v135
    v_and_b32 v135, 0xffff0000, v135
    v_pk_mul_f32 v[134:135], v[134:135], v[146:147]
    v_cvt_pk_bf16_f32 v134, v134, v135
    v_lshlrev_b32 v136, 16, v134
    v_and_b32 v137, 0xffff0000, v134
    v_pk_add_f32 v[132:133], v[132:133], v[136:137]
    v_accvgpr_read_b32 v135, a90
    v_lshlrev_b32 v134, 16, v135
    v_and_b32 v135, 0xffff0000, v135
    v_pk_mul_f32 v[134:135], v[134:135], v[148:149]
    v_cvt_pk_bf16_f32 v134, v134, v135
    v_lshlrev_b32 v136, 16, v134
    v_and_b32 v137, 0xffff0000, v134
    v_pk_add_f32 v[132:133], v[132:133], v[136:137]
    v_accvgpr_read_b32 v135, a91
    v_lshlrev_b32 v134, 16, v135
    v_and_b32 v135, 0xffff0000, v135
    v_pk_mul_f32 v[134:135], v[134:135], v[150:151]
    v_cvt_pk_bf16_f32 v134, v134, v135
    v_lshlrev_b32 v136, 16, v134
    v_and_b32 v137, 0xffff0000, v134
    v_pk_add_f32 v[132:133], v[132:133], v[136:137]
    v_add_f32 v132, v132, v133
    v_accvgpr_write_b32 a150, v132
    v_cvt_pk_bf16_f32 v230, v4, v5
    v_cvt_pk_bf16_f32 v231, v6, v7
    buffer_store_dwordx4 v[228:231], v155, s[16:19], s98 offen offset:1024 sc0 sc1
    v_accvgpr_read_b32 v8, a232
    v_accvgpr_read_b32 v9, a233
    v_accvgpr_read_b32 v10, a234
    v_accvgpr_read_b32 v135, a92
    v_lshlrev_b32 v134, 16, v135
    v_and_b32 v135, 0xffff0000, v135
    v_pk_mul_f32 v[134:135], v[134:135], v[144:145]
    v_cvt_pk_bf16_f32 v134, v134, v135
    v_lshlrev_b32 v132, 16, v134
    v_and_b32 v133, 0xffff0000, v134
    v_accvgpr_read_b32 v135, a93
    v_lshlrev_b32 v134, 16, v135
    v_and_b32 v135, 0xffff0000, v135
    v_pk_mul_f32 v[134:135], v[134:135], v[146:147]
    v_cvt_pk_bf16_f32 v134, v134, v135
    v_lshlrev_b32 v136, 16, v134
    v_and_b32 v137, 0xffff0000, v134
    v_pk_add_f32 v[132:133], v[132:133], v[136:137]
    v_accvgpr_read_b32 v135, a94
    v_lshlrev_b32 v134, 16, v135
    v_and_b32 v135, 0xffff0000, v135
    v_pk_mul_f32 v[134:135], v[134:135], v[148:149]
    v_cvt_pk_bf16_f32 v134, v134, v135
    v_lshlrev_b32 v136, 16, v134
    v_and_b32 v137, 0xffff0000, v134
    v_pk_add_f32 v[132:133], v[132:133], v[136:137]
    v_accvgpr_read_b32 v135, a95
    v_lshlrev_b32 v134, 16, v135
    v_and_b32 v135, 0xffff0000, v135
    v_pk_mul_f32 v[134:135], v[134:135], v[150:151]
    v_cvt_pk_bf16_f32 v134, v134, v135
    v_lshlrev_b32 v136, 16, v134
    v_and_b32 v137, 0xffff0000, v134
    v_pk_add_f32 v[132:133], v[132:133], v[136:137]
    v_add_f32 v132, v132, v133
    v_accvgpr_write_b32 a151, v132
    v_accvgpr_read_b32 v11, a235
    v_cvt_pk_bf16_f32 v232, v232, v233
    v_cvt_pk_bf16_f32 v233, v234, v235
    v_cvt_pk_bf16_f32 v234, v8, v9
    v_cvt_pk_bf16_f32 v235, v10, v11
    buffer_store_dwordx4 v[232:235], v156, s[16:19], s98 offen offset:0 sc0 sc1
    v_accvgpr_read_b32 v135, a96
    v_lshlrev_b32 v134, 16, v135
    v_and_b32 v135, 0xffff0000, v135
    v_pk_mul_f32 v[134:135], v[134:135], v[144:145]
    v_cvt_pk_bf16_f32 v134, v134, v135
    v_lshlrev_b32 v132, 16, v134
    v_and_b32 v133, 0xffff0000, v134
    v_accvgpr_read_b32 v135, a97
    v_lshlrev_b32 v134, 16, v135
    v_and_b32 v135, 0xffff0000, v135
    v_pk_mul_f32 v[134:135], v[134:135], v[146:147]
    v_cvt_pk_bf16_f32 v134, v134, v135
    v_lshlrev_b32 v136, 16, v134
    v_and_b32 v137, 0xffff0000, v134
    v_pk_add_f32 v[132:133], v[132:133], v[136:137]
    v_accvgpr_read_b32 v135, a98
    v_lshlrev_b32 v134, 16, v135
    v_and_b32 v135, 0xffff0000, v135
    v_pk_mul_f32 v[134:135], v[134:135], v[148:149]
    v_cvt_pk_bf16_f32 v134, v134, v135
    v_lshlrev_b32 v136, 16, v134
    v_and_b32 v137, 0xffff0000, v134
    v_pk_add_f32 v[132:133], v[132:133], v[136:137]
    v_accvgpr_read_b32 v135, a99
    v_lshlrev_b32 v134, 16, v135
    v_and_b32 v135, 0xffff0000, v135
    v_pk_mul_f32 v[134:135], v[134:135], v[150:151]
    v_cvt_pk_bf16_f32 v134, v134, v135
    v_lshlrev_b32 v136, 16, v134
    v_and_b32 v137, 0xffff0000, v134
    v_pk_add_f32 v[132:133], v[132:133], v[136:137]
    v_add_f32 v132, v132, v133
    v_accvgpr_write_b32 a152, v132
    v_accvgpr_read_b32 v12, a236
    v_accvgpr_read_b32 v13, a237
    v_accvgpr_read_b32 v14, a238
    v_accvgpr_read_b32 v15, a239
    v_cvt_pk_bf16_f32 v236, v236, v237
    v_cvt_pk_bf16_f32 v237, v238, v239
    v_accvgpr_read_b32 v135, a100
    v_lshlrev_b32 v134, 16, v135
    v_and_b32 v135, 0xffff0000, v135
    v_pk_mul_f32 v[134:135], v[134:135], v[144:145]
    v_cvt_pk_bf16_f32 v134, v134, v135
    v_lshlrev_b32 v132, 16, v134
    v_and_b32 v133, 0xffff0000, v134
    v_accvgpr_read_b32 v135, a101
    v_lshlrev_b32 v134, 16, v135
    v_and_b32 v135, 0xffff0000, v135
    v_pk_mul_f32 v[134:135], v[134:135], v[146:147]
    v_cvt_pk_bf16_f32 v134, v134, v135
    v_lshlrev_b32 v136, 16, v134
    v_and_b32 v137, 0xffff0000, v134
    v_pk_add_f32 v[132:133], v[132:133], v[136:137]
    v_accvgpr_read_b32 v135, a102
    v_lshlrev_b32 v134, 16, v135
    v_and_b32 v135, 0xffff0000, v135
    v_pk_mul_f32 v[134:135], v[134:135], v[148:149]
    v_cvt_pk_bf16_f32 v134, v134, v135
    v_lshlrev_b32 v136, 16, v134
    v_and_b32 v137, 0xffff0000, v134
    v_pk_add_f32 v[132:133], v[132:133], v[136:137]
    v_accvgpr_read_b32 v135, a103
    v_lshlrev_b32 v134, 16, v135
    v_and_b32 v135, 0xffff0000, v135
    v_pk_mul_f32 v[134:135], v[134:135], v[150:151]
    v_cvt_pk_bf16_f32 v134, v134, v135
    v_lshlrev_b32 v136, 16, v134
    v_and_b32 v137, 0xffff0000, v134
    v_pk_add_f32 v[132:133], v[132:133], v[136:137]
    v_add_f32 v132, v132, v133
    v_accvgpr_write_b32 a153, v132
    v_cvt_pk_bf16_f32 v238, v12, v13
    v_cvt_pk_bf16_f32 v239, v14, v15
    buffer_store_dwordx4 v[236:239], v156, s[16:19], s98 offen offset:1024 sc0 sc1
    s_add_u32 s98, s98, 8192
    v_accvgpr_read_b32 v0, a240
    v_accvgpr_read_b32 v1, a241
    v_accvgpr_read_b32 v135, a104
    v_lshlrev_b32 v134, 16, v135
    v_and_b32 v135, 0xffff0000, v135
    v_pk_mul_f32 v[134:135], v[134:135], v[144:145]
    v_cvt_pk_bf16_f32 v134, v134, v135
    v_lshlrev_b32 v132, 16, v134
    v_and_b32 v133, 0xffff0000, v134
    v_accvgpr_read_b32 v135, a105
    v_lshlrev_b32 v134, 16, v135
    v_and_b32 v135, 0xffff0000, v135
    v_pk_mul_f32 v[134:135], v[134:135], v[146:147]
    v_cvt_pk_bf16_f32 v134, v134, v135
    v_lshlrev_b32 v136, 16, v134
    v_and_b32 v137, 0xffff0000, v134
    v_pk_add_f32 v[132:133], v[132:133], v[136:137]
    v_accvgpr_read_b32 v135, a106
    v_lshlrev_b32 v134, 16, v135
    v_and_b32 v135, 0xffff0000, v135
    v_pk_mul_f32 v[134:135], v[134:135], v[148:149]
    v_cvt_pk_bf16_f32 v134, v134, v135
    v_lshlrev_b32 v136, 16, v134
    v_and_b32 v137, 0xffff0000, v134
    v_pk_add_f32 v[132:133], v[132:133], v[136:137]
    v_accvgpr_read_b32 v135, a107
    v_lshlrev_b32 v134, 16, v135
    v_and_b32 v135, 0xffff0000, v135
    v_pk_mul_f32 v[134:135], v[134:135], v[150:151]
    v_cvt_pk_bf16_f32 v134, v134, v135
    v_lshlrev_b32 v136, 16, v134
    v_and_b32 v137, 0xffff0000, v134
    v_pk_add_f32 v[132:133], v[132:133], v[136:137]
    v_add_f32 v132, v132, v133
    v_accvgpr_write_b32 a154, v132
    v_accvgpr_read_b32 v2, a242
    v_accvgpr_read_b32 v3, a243
    v_cvt_pk_bf16_f32 v240, v240, v241
    v_cvt_pk_bf16_f32 v241, v242, v243
    v_cvt_pk_bf16_f32 v242, v0, v1
    v_cvt_pk_bf16_f32 v243, v2, v3
    v_accvgpr_read_b32 v135, a108
    v_lshlrev_b32 v134, 16, v135
    v_and_b32 v135, 0xffff0000, v135
    v_pk_mul_f32 v[134:135], v[134:135], v[144:145]
    v_cvt_pk_bf16_f32 v134, v134, v135
    v_lshlrev_b32 v132, 16, v134
    v_and_b32 v133, 0xffff0000, v134
    v_accvgpr_read_b32 v135, a109
    v_lshlrev_b32 v134, 16, v135
    v_and_b32 v135, 0xffff0000, v135
    v_pk_mul_f32 v[134:135], v[134:135], v[146:147]
    v_cvt_pk_bf16_f32 v134, v134, v135
    v_lshlrev_b32 v136, 16, v134
    v_and_b32 v137, 0xffff0000, v134
    v_pk_add_f32 v[132:133], v[132:133], v[136:137]
    v_accvgpr_read_b32 v135, a110
    v_lshlrev_b32 v134, 16, v135
    v_and_b32 v135, 0xffff0000, v135
    v_pk_mul_f32 v[134:135], v[134:135], v[148:149]
    v_cvt_pk_bf16_f32 v134, v134, v135
    v_lshlrev_b32 v136, 16, v134
    v_and_b32 v137, 0xffff0000, v134
    v_pk_add_f32 v[132:133], v[132:133], v[136:137]
    v_accvgpr_read_b32 v135, a111
    v_lshlrev_b32 v134, 16, v135
    v_and_b32 v135, 0xffff0000, v135
    v_pk_mul_f32 v[134:135], v[134:135], v[150:151]
    v_cvt_pk_bf16_f32 v134, v134, v135
    v_lshlrev_b32 v136, 16, v134
    v_and_b32 v137, 0xffff0000, v134
    v_pk_add_f32 v[132:133], v[132:133], v[136:137]
    v_add_f32 v132, v132, v133
    v_accvgpr_write_b32 a155, v132
    buffer_store_dwordx4 v[240:243], v155, s[16:19], s98 offen offset:0 sc0 sc1
    v_accvgpr_read_b32 v4, a244
    v_accvgpr_read_b32 v5, a245
    v_accvgpr_read_b32 v6, a246
    v_accvgpr_read_b32 v7, a247
    v_cvt_pk_bf16_f32 v244, v244, v245
    v_accvgpr_read_b32 v135, a112
    v_lshlrev_b32 v134, 16, v135
    v_and_b32 v135, 0xffff0000, v135
    v_pk_mul_f32 v[134:135], v[134:135], v[144:145]
    v_cvt_pk_bf16_f32 v134, v134, v135
    v_lshlrev_b32 v132, 16, v134
    v_and_b32 v133, 0xffff0000, v134
    v_accvgpr_read_b32 v135, a113
    v_lshlrev_b32 v134, 16, v135
    v_and_b32 v135, 0xffff0000, v135
    v_pk_mul_f32 v[134:135], v[134:135], v[146:147]
    v_cvt_pk_bf16_f32 v134, v134, v135
    v_lshlrev_b32 v136, 16, v134
    v_and_b32 v137, 0xffff0000, v134
    v_pk_add_f32 v[132:133], v[132:133], v[136:137]
    v_accvgpr_read_b32 v135, a114
    v_lshlrev_b32 v134, 16, v135
    v_and_b32 v135, 0xffff0000, v135
    v_pk_mul_f32 v[134:135], v[134:135], v[148:149]
    v_cvt_pk_bf16_f32 v134, v134, v135
    v_lshlrev_b32 v136, 16, v134
    v_and_b32 v137, 0xffff0000, v134
    v_pk_add_f32 v[132:133], v[132:133], v[136:137]
    v_accvgpr_read_b32 v135, a115
    v_lshlrev_b32 v134, 16, v135
    v_and_b32 v135, 0xffff0000, v135
    v_pk_mul_f32 v[134:135], v[134:135], v[150:151]
    v_cvt_pk_bf16_f32 v134, v134, v135
    v_lshlrev_b32 v136, 16, v134
    v_and_b32 v137, 0xffff0000, v134
    v_pk_add_f32 v[132:133], v[132:133], v[136:137]
    v_add_f32 v132, v132, v133
    v_accvgpr_write_b32 a156, v132
    v_cvt_pk_bf16_f32 v245, v246, v247
    v_cvt_pk_bf16_f32 v246, v4, v5
    v_cvt_pk_bf16_f32 v247, v6, v7
    buffer_store_dwordx4 v[244:247], v155, s[16:19], s98 offen offset:1024 sc0 sc1
    v_accvgpr_read_b32 v8, a248
    v_accvgpr_read_b32 v9, a249
    v_accvgpr_read_b32 v135, a116
    v_lshlrev_b32 v134, 16, v135
    v_and_b32 v135, 0xffff0000, v135
    v_pk_mul_f32 v[134:135], v[134:135], v[144:145]
    v_cvt_pk_bf16_f32 v134, v134, v135
    v_lshlrev_b32 v132, 16, v134
    v_and_b32 v133, 0xffff0000, v134
    v_accvgpr_read_b32 v135, a117
    v_lshlrev_b32 v134, 16, v135
    v_and_b32 v135, 0xffff0000, v135
    v_pk_mul_f32 v[134:135], v[134:135], v[146:147]
    v_cvt_pk_bf16_f32 v134, v134, v135
    v_lshlrev_b32 v136, 16, v134
    v_and_b32 v137, 0xffff0000, v134
    v_pk_add_f32 v[132:133], v[132:133], v[136:137]
    v_accvgpr_read_b32 v135, a118
    v_lshlrev_b32 v134, 16, v135
    v_and_b32 v135, 0xffff0000, v135
    v_pk_mul_f32 v[134:135], v[134:135], v[148:149]
    v_cvt_pk_bf16_f32 v134, v134, v135
    v_lshlrev_b32 v136, 16, v134
    v_and_b32 v137, 0xffff0000, v134
    v_pk_add_f32 v[132:133], v[132:133], v[136:137]
    v_accvgpr_read_b32 v135, a119
    v_lshlrev_b32 v134, 16, v135
    v_and_b32 v135, 0xffff0000, v135
    v_pk_mul_f32 v[134:135], v[134:135], v[150:151]
    v_cvt_pk_bf16_f32 v134, v134, v135
    v_lshlrev_b32 v136, 16, v134
    v_and_b32 v137, 0xffff0000, v134
    v_pk_add_f32 v[132:133], v[132:133], v[136:137]
    v_add_f32 v132, v132, v133
    v_accvgpr_write_b32 a157, v132
    v_accvgpr_read_b32 v10, a250
    v_accvgpr_read_b32 v11, a251
    v_cvt_pk_bf16_f32 v248, v248, v249
    v_cvt_pk_bf16_f32 v249, v250, v251
    v_cvt_pk_bf16_f32 v250, v8, v9
    v_cvt_pk_bf16_f32 v251, v10, v11
    v_accvgpr_read_b32 v135, a120
    v_lshlrev_b32 v134, 16, v135
    v_and_b32 v135, 0xffff0000, v135
    v_pk_mul_f32 v[134:135], v[134:135], v[144:145]
    v_cvt_pk_bf16_f32 v134, v134, v135
    v_lshlrev_b32 v132, 16, v134
    v_and_b32 v133, 0xffff0000, v134
    v_accvgpr_read_b32 v135, a121
    v_lshlrev_b32 v134, 16, v135
    v_and_b32 v135, 0xffff0000, v135
    v_pk_mul_f32 v[134:135], v[134:135], v[146:147]
    v_cvt_pk_bf16_f32 v134, v134, v135
    v_lshlrev_b32 v136, 16, v134
    v_and_b32 v137, 0xffff0000, v134
    v_pk_add_f32 v[132:133], v[132:133], v[136:137]
    v_accvgpr_read_b32 v135, a122
    v_lshlrev_b32 v134, 16, v135
    v_and_b32 v135, 0xffff0000, v135
    v_pk_mul_f32 v[134:135], v[134:135], v[148:149]
    v_cvt_pk_bf16_f32 v134, v134, v135
    v_lshlrev_b32 v136, 16, v134
    v_and_b32 v137, 0xffff0000, v134
    v_pk_add_f32 v[132:133], v[132:133], v[136:137]
    v_accvgpr_read_b32 v135, a123
    v_lshlrev_b32 v134, 16, v135
    v_and_b32 v135, 0xffff0000, v135
    v_pk_mul_f32 v[134:135], v[134:135], v[150:151]
    v_cvt_pk_bf16_f32 v134, v134, v135
    v_lshlrev_b32 v136, 16, v134
    v_and_b32 v137, 0xffff0000, v134
    v_pk_add_f32 v[132:133], v[132:133], v[136:137]
    v_add_f32 v132, v132, v133
    v_accvgpr_write_b32 a158, v132
    buffer_store_dwordx4 v[248:251], v156, s[16:19], s98 offen offset:0 sc0 sc1
    v_accvgpr_read_b32 v12, a252
    v_accvgpr_read_b32 v13, a253
    v_accvgpr_read_b32 v14, a254
    v_accvgpr_read_b32 v15, a255
    v_cvt_pk_bf16_f32 v252, v252, v253
    v_accvgpr_read_b32 v135, a124
    v_lshlrev_b32 v134, 16, v135
    v_and_b32 v135, 0xffff0000, v135
    v_pk_mul_f32 v[134:135], v[134:135], v[144:145]
    v_cvt_pk_bf16_f32 v134, v134, v135
    v_lshlrev_b32 v132, 16, v134
    v_and_b32 v133, 0xffff0000, v134
    v_accvgpr_read_b32 v135, a125
    v_lshlrev_b32 v134, 16, v135
    v_and_b32 v135, 0xffff0000, v135
    v_pk_mul_f32 v[134:135], v[134:135], v[146:147]
    v_cvt_pk_bf16_f32 v134, v134, v135
    v_lshlrev_b32 v136, 16, v134
    v_and_b32 v137, 0xffff0000, v134
    v_pk_add_f32 v[132:133], v[132:133], v[136:137]
    v_accvgpr_read_b32 v135, a126
    v_lshlrev_b32 v134, 16, v135
    v_and_b32 v135, 0xffff0000, v135
    v_pk_mul_f32 v[134:135], v[134:135], v[148:149]
    v_cvt_pk_bf16_f32 v134, v134, v135
    v_lshlrev_b32 v136, 16, v134
    v_and_b32 v137, 0xffff0000, v134
    v_pk_add_f32 v[132:133], v[132:133], v[136:137]
    v_accvgpr_read_b32 v135, a127
    v_lshlrev_b32 v134, 16, v135
    v_and_b32 v135, 0xffff0000, v135
    v_pk_mul_f32 v[134:135], v[134:135], v[150:151]
    v_cvt_pk_bf16_f32 v134, v134, v135
    v_lshlrev_b32 v136, 16, v134
    v_and_b32 v137, 0xffff0000, v134
    v_pk_add_f32 v[132:133], v[132:133], v[136:137]
    v_add_f32 v132, v132, v133
    v_accvgpr_write_b32 a159, v132
    v_cvt_pk_bf16_f32 v253, v254, v255
    v_cvt_pk_bf16_f32 v254, v12, v13
    v_cvt_pk_bf16_f32 v255, v14, v15
    buffer_store_dwordx4 v[252:255], v156, s[16:19], s98 offen offset:1024 sc0 sc1
    s_add_u32 s98, s98, 8192
    s_nop 1
    v_accvgpr_read_b32 v0, a128
    v_accvgpr_read_b32 v1, a129
    v_accvgpr_read_b32 v2, a130
    v_accvgpr_read_b32 v3, a131
    v_accvgpr_read_b32 v4, a132
    v_accvgpr_read_b32 v5, a133
    v_accvgpr_read_b32 v6, a134
    v_accvgpr_read_b32 v7, a135
    v_accvgpr_read_b32 v8, a136
    v_accvgpr_read_b32 v9, a137
    v_accvgpr_read_b32 v10, a138
    v_accvgpr_read_b32 v11, a139
    v_accvgpr_read_b32 v12, a140
    v_accvgpr_read_b32 v13, a141
    v_accvgpr_read_b32 v14, a142
    v_accvgpr_read_b32 v15, a143
    v_accvgpr_read_b32 v16, a144
    v_accvgpr_read_b32 v17, a145
    v_accvgpr_read_b32 v18, a146
    v_accvgpr_read_b32 v19, a147
    v_accvgpr_read_b32 v20, a148
    v_accvgpr_read_b32 v21, a149
    v_accvgpr_read_b32 v22, a150
    v_accvgpr_read_b32 v23, a151
    v_accvgpr_read_b32 v24, a152
    v_accvgpr_read_b32 v25, a153
    v_accvgpr_read_b32 v26, a154
    v_accvgpr_read_b32 v27, a155
    v_accvgpr_read_b32 v28, a156
    v_accvgpr_read_b32 v29, a157
    v_accvgpr_read_b32 v30, a158
    v_accvgpr_read_b32 v31, a159
    s_nop 1
    v_permlane32_swap_b32 v0, v16
    v_permlane32_swap_b32 v1, v17
    v_permlane32_swap_b32 v2, v18
    v_permlane32_swap_b32 v3, v19
    v_permlane32_swap_b32 v4, v20
    v_permlane32_swap_b32 v5, v21
    v_permlane32_swap_b32 v6, v22
    v_permlane32_swap_b32 v7, v23
    v_permlane32_swap_b32 v8, v24
    v_permlane32_swap_b32 v9, v25
    v_permlane32_swap_b32 v10, v26
    v_permlane32_swap_b32 v11, v27
    v_permlane32_swap_b32 v12, v28
    v_permlane32_swap_b32 v13, v29
    v_permlane32_swap_b32 v14, v30
    v_permlane32_swap_b32 v15, v31
    v_add_f32 v0, v0, v16
    v_add_f32 v1, v1, v17
    v_add_f32 v2, v2, v18
    v_add_f32 v3, v3, v19
    v_add_f32 v4, v4, v20
    v_add_f32 v5, v5, v21
    v_add_f32 v6, v6, v22
    v_add_f32 v7, v7, v23
    v_add_f32 v8, v8, v24
    v_add_f32 v9, v9, v25
    v_add_f32 v10, v10, v26
    v_add_f32 v11, v11, v27
    v_add_f32 v12, v12, v28
    v_add_f32 v13, v13, v29
    v_add_f32 v14, v14, v30
    v_add_f32 v15, v15, v31
    s_nop 1
    v_permlane16_swap_b32 v0, v8
    v_permlane16_swap_b32 v1, v9
    v_permlane16_swap_b32 v2, v10
    v_permlane16_swap_b32 v3, v11
    v_permlane16_swap_b32 v4, v12
    v_permlane16_swap_b32 v5, v13
    v_permlane16_swap_b32 v6, v14
    v_permlane16_swap_b32 v7, v15
    v_add_f32 v0, v0, v8
    v_add_f32 v1, v1, v9
    v_add_f32 v2, v2, v10
    v_add_f32 v3, v3, v11
    v_add_f32 v4, v4, v12
    v_add_f32 v5, v5, v13
    v_add_f32 v6, v6, v14
    v_add_f32 v7, v7, v15
    s_nop 1
    v_and_b32 v130, 8, v128
    v_cmp_ne_u32 vcc, 0, v130
    s_nop 1
    v_cndmask_b32 v32, v0, v4, vcc
    v_cndmask_b32 v40, v4, v0, vcc
    v_cndmask_b32 v33, v1, v5, vcc
    v_cndmask_b32 v41, v5, v1, vcc
    v_cndmask_b32 v34, v2, v6, vcc
    v_cndmask_b32 v42, v6, v2, vcc
    v_cndmask_b32 v35, v3, v7, vcc
    v_cndmask_b32 v43, v7, v3, vcc
    s_nop 1
    v_add_f32_dpp v0, v40, v32 row_ror:8 row_mask:0xf bank_mask:0xf
    v_add_f32_dpp v1, v41, v33 row_ror:8 row_mask:0xf bank_mask:0xf
    v_add_f32_dpp v2, v42, v34 row_ror:8 row_mask:0xf bank_mask:0xf
    v_add_f32_dpp v3, v43, v35 row_ror:8 row_mask:0xf bank_mask:0xf
    s_nop 1
    v_and_b32 v130, 4, v128
    v_cmp_ne_u32 vcc, 0, v130
    s_nop 1
    v_cndmask_b32 v32, v0, v2, vcc
    v_cndmask_b32 v40, v2, v0, vcc
    v_cndmask_b32 v33, v1, v3, vcc
    v_cndmask_b32 v41, v3, v1, vcc
    s_nop 1
    v_add_f32_dpp v0, v40, v32 row_half_mirror row_mask:0xf bank_mask:0xf
    v_add_f32_dpp v1, v41, v33 row_half_mirror row_mask:0xf bank_mask:0xf
    s_nop 1
    v_and_b32 v130, 2, v128
    v_cmp_ne_u32 vcc, 0, v130
    s_nop 1
    v_cndmask_b32 v32, v0, v1, vcc
    v_cndmask_b32 v40, v1, v0, vcc
    s_nop 1
    v_add_f32_dpp v0, v40, v32 quad_perm:[2,3,0,1] row_mask:0xf bank_mask:0xf
    s_nop 1
    v_add_f32_dpp v132, v0, v0 quad_perm:[1,0,3,2] row_mask:0xf bank_mask:0xf
    s_nop 1
    v_cvt_pk_bf16_f32 v132, v132, v132
    v_and_b32 v132, 0xffff0000, v132
    v_mul_f32 v132, 0xbfb8aa3b, v132
    v_exp_f32 v132, v132
    s_nop 0
    v_add_f32 v132, 1.0, v132
    v_rcp_f32 v132, v132
    s_nop 0
    v_cvt_pk_bf16_f32 v132, v132, v132
    v_and_b32 v132, 0xffff0000, v132
    v_sub_f32 v133, 1.0, v132
    v_cvt_pk_bf16_f32 v133, v133, v133
    v_and_b32 v133, 0xffff0000, v133
    v_rcp_f32 v133, v133
    s_nop 0
    v_min_f32 v133, 0x71800000, v133
    v_and_b32 v130, 1, v128
    v_cmp_eq_u32 vcc, 1, v130
    s_nop 1
    v_cndmask_b32 v132, v132, v133, vcc
    v_lshlrev_b32 v130, 13, v130
    v_lshlrev_b32 v129, 2, v129
    v_add_u32 v129, v129, v130
    s_mov_b32 s6, 75497472
    buffer_store_dword v132, v129, s[16:19], s6 offen sc0 sc1
    v_lshrrev_b32 v162, 4, v155
    v_and_b32 v162, 7, v162
    v_lshlrev_b32 v162, 5, v162
    buffer_load_dword v160, v162, s[80:83], 0 offen sc0 sc1
    s_waitcnt vmcnt(0)
    s_barrier
    s_cmp_lg_u32 s58, 0
    s_cbranch_scc1 Lpub6
    v_mov_b32 v161, 2
    s_mov_b64 exec, 1
    buffer_store_dword v161, off, s[16:19], s99 sc0 sc1
    s_mov_b64 exec, -1
Lpub6:
    s_waitcnt vmcnt(1)
    s_mov_b32 s57, 1048576
Lpl7:
    v_cmp_le_u32 s[50:51], 32, v160
    s_nop 1
    s_cmp_eq_u64 s[50:51], -1
    s_cbranch_scc1 Lpo8
    s_sub_u32 s57, s57, 1
    s_cbranch_scc1 Lpo8
    buffer_load_dword v160, v162, s[80:83], 0 offen sc0 sc1
    s_waitcnt vmcnt(0)
    s_branch Lpl7
Lpo8:
    s_branch L1_end2g
L1_sw1:
    s_call_b64 s[100:101], L1_switchw
    s_branch L1_swr1
L1_sw2:
    s_call_b64 s[100:101], L1_switchx
    s_branch L1_swr2
L1_sw3:
    s_call_b64 s[100:101], L1_switchw
    s_branch L1_swr3
L1_sw4:
    s_call_b64 s[100:101], L1_switchx
    s_branch L1_swr4
L1_sw5:
    s_call_b64 s[100:101], L1_switchw
    s_branch L1_swr5
L1_sw6:
    s_call_b64 s[100:101], L1_switchx
    s_branch L1_swr6
L1_sw7:
    s_call_b64 s[100:101], L1_switchw
    s_branch L1_swr7
L1_sw8:
    s_call_b64 s[100:101], L1_switchx
    s_branch L1_swr8
L1_sw9:
    s_call_b64 s[100:101], L1_switchw
    s_branch L1_swr9
L1_sw10:
    s_call_b64 s[100:101], L1_switchx
    s_branch L1_swr10
L1_sw11:
    s_call_b64 s[100:101], L1_switchw
    s_branch L1_swr11
L1_sw12:
    s_call_b64 s[100:101], L1_switchx
    s_branch L1_swr12
L1_sw13:
    s_call_b64 s[100:101], L1_switchw
    s_branch L1_swr13
L1_sw14:
    s_call_b64 s[100:101], L1_switchx
    s_branch L1_swr14
L1_sw15:
    s_call_b64 s[100:101], L1_switchw
    s_branch L1_swr15
L1_sw16:
    s_call_b64 s[100:101], L1_switchx
    s_branch L1_swr16
L1_sw17:
    s_call_b64 s[100:101], L1_switchw
    s_branch L1_swr17
L1_sw18:
    s_call_b64 s[100:101], L1_switchx
    s_branch L1_swr18
L1_sw19:
    s_call_b64 s[100:101], L1_switchw
    s_branch L1_swr19
L1_sw20:
    s_call_b64 s[100:101], L1_switchx
    s_branch L1_swr20
L1_sw21:
    s_call_b64 s[100:101], L1_switchw
    s_branch L1_swr21
L1_sw22:
    s_call_b64 s[100:101], L1_switchx
    s_branch L1_swr22
L1_sw23:
    s_call_b64 s[100:101], L1_switchw
    s_branch L1_swr23
L1_sw24:
    s_call_b64 s[100:101], L1_switchx
    s_branch L1_swr24
L1_switchx:
    s_mov_b32 s8, s33
    s_mov_b32 s9, s34
    s_mov_b32 s10, s35
    s_mov_b32 s46, s36
    s_lshl_b32 s50, s37, 6
    s_mov_b32 s35, 0
    s_sub_u32 s56, s45, 1
    v_mov_b32 v128, v136
    v_mov_b32 v129, v137
    v_mov_b32 v130, v138
    v_mov_b32 v131, v139
    global_load_dword v158, v167, s[76:77]
    s_cmp_eq_u32 s96, 0
    s_cbranch_scc1 L1_swx_r
    s_waitcnt vmcnt(30)
    s_mov_b32 s92, 1048576
Lpl9:
    v_cmp_le_u32 s[90:91], 32, v160
    s_nop 1
    s_cmp_eq_u64 s[90:91], -1
    s_cbranch_scc1 Lpo10
    s_sub_u32 s92, s92, 1
    s_cbranch_scc1 Lpo10
    buffer_load_dword v160, v162, s[80:83], 0 offen sc0 sc1
    s_waitcnt vmcnt(0)
    s_branch Lpl9
Lpo10:
    s_mov_b64 exec, 6295551
    buffer_load_dword v166, v164, s[16:19], 0 offen sc0 sc1
    s_mov_b64 exec, -1
L1_swx_r:
    s_setpc_b64 s[100:101]
L1_switchw:
    s_cmp_eq_u32 s96, 0
    s_cbranch_scc1 L1_sww0
    s_mov_b32 s12, s62
    s_mov_b32 s13, s63
    s_mov_b32 s14, 1048576
    s_mov_b32 s48, s66
    s_mov_b32 s49, 16384
    s_mov_b32 s8, s64
    s_mov_b32 s9, s65
    s_mov_b32 s10, 1048576
    s_mov_b32 s46, s66
    s_mov_b32 s50, 8192
    s_mov_b32 s47, 0x80000000
    s_mov_b32 s68, 32768
    s_mov_b32 s57, 100
    s_mov_b32 s84, s16
    s_mov_b32 s85, s17
    s_mov_b32 s86, 16777216
    s_mov_b32 s88, s67
    s_mov_b32 s89, 32768
    s_lshl_b32 s4, s58, 12
    s_sub_u32 s5, s78, 65536
    v_lshlrev_b32 v157, 3, v155
    v_add_u32 v132, s4, v155
    v_add_u32 v128, s5, v155
    v_add_u32 v133, s4, v155
    v_add_u32 v129, s5, v155
    v_add_u32 v134, s4, v155
    v_add_u32 v130, s5, v155
    v_add_u32 v135, s4, v155
    v_add_u32 v131, s5, v155
    s_waitcnt vmcnt(4)
    s_mov_b32 s92, 1048576
Lpl11:
    v_cmp_ge_u32 s[90:91], v166, v165
    s_nop 1
    s_and_b32 s90, s90, 6295551
    s_cmp_eq_u32 s90, 6295551
    s_cbranch_scc1 Lpo12
    s_sub_u32 s92, s92, 1
    s_cbranch_scc1 Lpo12
    s_mov_b64 exec, 6295551
    buffer_load_dword v166, v164, s[16:19], 0 offen sc0 sc1
    s_mov_b64 exec, -1
    s_waitcnt vmcnt(0)
    s_branch Lpl11
Lpo12:
    s_cmp_lg_u32 s44, 3
    s_cbranch_scc1 L1_sww1
    v_bfe_u32 v161, v155, 2, 6
    buffer_load_dword v136, v161, s[16:19], s69 offen offset:0 sc0 sc1
    buffer_load_dword v137, v161, s[16:19], s69 offen offset:64 sc0 sc1
    buffer_load_dword v138, v161, s[16:19], s69 offen offset:128 sc0 sc1
    buffer_load_dword v139, v161, s[16:19], s69 offen offset:192 sc0 sc1
    buffer_load_dword v140, v161, s[16:19], s69 offen offset:256 sc0 sc1
    buffer_load_dword v141, v161, s[16:19], s69 offen offset:320 sc0 sc1
    buffer_load_dword v142, v161, s[16:19], s69 offen offset:384 sc0 sc1
    buffer_load_dword v143, v161, s[16:19], s69 offen offset:448 sc0 sc1
L1_sww1:
    s_setpc_b64 s[100:101]
L1_sww0:
    s_mov_b32 s12, s38
    s_mov_b32 s13, s39
    s_mov_b32 s14, s40
    s_mov_b32 s48, s41
    s_lshl_b32 s49, s42, 5
    s_mov_b32 s40, 0
    s_sub_u32 s57, s45, 1
    v_mov_b32 v132, v140
    v_mov_b32 v133, v141
    v_mov_b32 v134, v142
    v_mov_b32 v135, v143
    s_setpc_b64 s[100:101]
L2_seg:
    v_mov_b32 v128, 0
    v_mov_b32 v129, 0
    v_mov_b32 v130, 0
    v_mov_b32 v131, 0
    v_mov_b32 v132, 0
    v_mov_b32 v133, 0
    v_mov_b32 v134, 0
    v_mov_b32 v135, 0
    v_mov_b32 v136, 0
    v_mov_b32 v137, 0
    v_mov_b32 v138, 0
    v_mov_b32 v139, 0
    v_mov_b32 v140, 0
    v_mov_b32 v141, 0
    v_mov_b32 v142, 0
    v_mov_b32 v143, 0
    v_mov_b32 v146, 0
    v_mov_b32 v144, 0
    v_mov_b32 v147, 0
    v_mov_b32 v145, 0
    v_add_u32 v150, s48, v155
    s_sub_u32 s31, s38, 4
    s_mov_b32 s32, 0
    s_cmp_eq_u32 s40, 0
    s_cselect_b32 s31, 0x7fffffff, s31
    s_lshr_b32 s30, s38, 1
    s_sub_u32 s30, s30, 1
    s_cmp_eq_u32 s35, 0
    s_cselect_b32 s34, 2, 6
    s_cselect_b32 s98, 0x40000000, s98
    s_mov_b32 s20, s35
    s_mov_b32 s35, 0
    s_barrier
    ds_read_b128 v[0:3], v150 offset:0
    ds_read_b128 v[4:7], v150 offset:1024
    ds_read_b128 v[8:11], v150 offset:2048
    ds_read_b128 v[12:15], v150 offset:3072
    ds_read_b128 v[16:19], v150 offset:4096
    ds_read_b128 v[20:23], v150 offset:5120
    ds_read_b128 v[24:27], v150 offset:6144
    ds_read_b128 v[28:31], v150 offset:7168
    ds_read_b128 v[32:35], v150 offset:8192
    ds_read_b128 v[36:39], v150 offset:9216
    ds_read_b128 v[40:43], v150 offset:10240
    ds_read_b128 v[44:47], v150 offset:11264
    s_sub_u32 s31, s31, 1
    s_cbranch_scc1 L2_hk1
L2_hkr1:
    s_waitcnt lgkmcnt(8)
    v_mfma_f32_16x16x32_bf16 v[64:67], v[0:3], a[128:131], v[128:131]
    v_mfma_f32_16x16x32_bf16 v[64:67], v[4:7], a[132:135], v[64:67]
    ds_read_b128 v[48:51], v150 offset:12288
    v_mfma_f32_16x16x32_bf16 v[64:67], v[8:11], a[136:139], v[64:67]
    v_mfma_f32_16x16x32_bf16 v[64:67], v[12:15], a[140:143], v[64:67]
    ds_read_b128 v[52:55], v150 offset:13312
    v_mfma_f32_16x16x32_bf16 v[72:75], v[12:15], a[172:175], v[136:139]
    buffer_store_dwordx4 v[192:195], v155, s[16:19], s98 offen offset:0 sc0 sc1
    v_mfma_f32_16x16x32_bf16 v[72:75], v[8:11], a[168:171], v[72:75]
    ds_read_b128 v[56:59], v150 offset:14336
    v_mfma_f32_16x16x32_bf16 v[72:75], v[4:7], a[164:167], v[72:75]
    v_mfma_f32_16x16x32_bf16 v[72:75], v[0:3], a[160:163], v[72:75]
    ds_read_b128 v[60:63], v150 offset:15360
    s_waitcnt lgkmcnt(8)
    v_mfma_f32_16x16x32_bf16 v[72:75], v[16:19], a[176:179], v[72:75]
    v_mfma_f32_16x16x32_bf16 v[72:75], v[20:23], a[180:183], v[72:75]
    ds_read_b128 v[0:3], v150 offset:16384
    v_mfma_f32_16x16x32_bf16 v[72:75], v[24:27], a[184:187], v[72:75]
    v_mfma_f32_16x16x32_bf16 v[72:75], v[28:31], a[188:191], v[72:75]
    ds_read_b128 v[4:7], v150 offset:17408
    v_mfma_f32_16x16x32_bf16 v[64:67], v[28:31], a[156:159], v[64:67]
    buffer_store_dwordx4 v[196:199], v155, s[16:19], s98 offen offset:1024 sc0 sc1
    v_mfma_f32_16x16x32_bf16 v[64:67], v[24:27], a[152:155], v[64:67]
    ds_read_b128 v[8:11], v150 offset:18432
    v_mfma_f32_16x16x32_bf16 v[64:67], v[20:23], a[148:151], v[64:67]
    v_mfma_f32_16x16x32_bf16 v[64:67], v[16:19], a[144:147], v[64:67]
    ds_read_b128 v[12:15], v150 offset:19456
    s_waitcnt lgkmcnt(8)
    v_mfma_f32_16x16x32_bf16 v[68:71], v[32:35], a[128:131], v[132:135]
    v_mfma_f32_16x16x32_bf16 v[68:71], v[36:39], a[132:135], v[68:71]
    ds_read_b128 v[16:19], v150 offset:20480
    v_mfma_f32_16x16x32_bf16 v[68:71], v[40:43], a[136:139], v[68:71]
    v_mfma_f32_16x16x32_bf16 v[68:71], v[44:47], a[140:143], v[68:71]
    ds_read_b128 v[20:23], v150 offset:21504
    v_mfma_f32_16x16x32_bf16 v[76:79], v[44:47], a[172:175], v[140:143]
    buffer_store_dwordx4 v[200:203], v156, s[16:19], s98 offen offset:0 sc0 sc1
    v_mfma_f32_16x16x32_bf16 v[76:79], v[40:43], a[168:171], v[76:79]
    ds_read_b128 v[24:27], v150 offset:22528
    v_mfma_f32_16x16x32_bf16 v[76:79], v[36:39], a[164:167], v[76:79]
    v_mfma_f32_16x16x32_bf16 v[76:79], v[32:35], a[160:163], v[76:79]
    ds_read_b128 v[28:31], v150 offset:23552
    s_waitcnt lgkmcnt(8)
    v_mfma_f32_16x16x32_bf16 v[76:79], v[48:51], a[176:179], v[76:79]
    v_mfma_f32_16x16x32_bf16 v[76:79], v[52:55], a[180:183], v[76:79]
    ds_read_b128 v[32:35], v150 offset:24576
    v_mfma_f32_16x16x32_bf16 v[76:79], v[56:59], a[184:187], v[76:79]
    v_mfma_f32_16x16x32_bf16 v[76:79], v[60:63], a[188:191], v[76:79]
    ds_read_b128 v[36:39], v150 offset:25600
    v_mfma_f32_16x16x32_bf16 v[68:71], v[60:63], a[156:159], v[68:71]
    buffer_store_dwordx4 v[204:207], v156, s[16:19], s98 offen offset:1024 sc0 sc1
    s_add_u32 s98, s98, s20
    v_mfma_f32_16x16x32_bf16 v[68:71], v[56:59], a[152:155], v[68:71]
    ds_read_b128 v[40:43], v150 offset:26624
    v_mfma_f32_16x16x32_bf16 v[68:71], v[52:55], a[148:151], v[68:71]
    v_mfma_f32_16x16x32_bf16 v[68:71], v[48:51], a[144:147], v[68:71]
    ds_read_b128 v[44:47], v150 offset:27648
    s_waitcnt lgkmcnt(8)
    s_sub_u32 s31, s31, 1
    s_cbranch_scc1 L2_hk2
L2_hkr2:
    v_mfma_f32_16x16x32_bf16 v[80:83], v[0:3], a[128:131], v[128:131]
    v_mfma_f32_16x16x32_bf16 v[80:83], v[4:7], a[132:135], v[80:83]
    ds_read_b128 v[48:51], v150 offset:28672
    v_mfma_f32_16x16x32_bf16 v[80:83], v[8:11], a[136:139], v[80:83]
    v_mfma_f32_16x16x32_bf16 v[80:83], v[12:15], a[140:143], v[80:83]
    ds_read_b128 v[52:55], v150 offset:29696
    v_mfma_f32_16x16x32_bf16 v[88:91], v[12:15], a[172:175], v[136:139]
    v_mfma_f32_16x16x32_bf16 v[88:91], v[8:11], a[168:171], v[88:91]
    ds_read_b128 v[56:59], v150 offset:30720
    v_mfma_f32_16x16x32_bf16 v[88:91], v[4:7], a[164:167], v[88:91]
    v_max3_f32 v148, v64, v65, v66
    v_max3_f32 v148, v148, v67, v68
    v_mfma_f32_16x16x32_bf16 v[88:91], v[0:3], a[160:163], v[88:91]
    ds_read_b128 v[60:63], v150 offset:31744
    v_max3_f32 v148, v148, v69, v70
    s_waitcnt lgkmcnt(8)
    s_xor_b32 s48, s48, 32768
    v_add_u32 v150, s48, v155
    s_barrier
    v_mfma_f32_16x16x32_bf16 v[88:91], v[16:19], a[176:179], v[88:91]
    v_max_f32 v148, v148, v71
    v_max3_f32 v149, v72, v73, v74
    v_mfma_f32_16x16x32_bf16 v[88:91], v[20:23], a[180:183], v[88:91]
    ds_read_b128 v[0:3], v150 offset:0
    v_max3_f32 v149, v149, v75, v76
    v_mfma_f32_16x16x32_bf16 v[88:91], v[24:27], a[184:187], v[88:91]
    s_mov_b32 m0, s27
    s_nop 0
    buffer_load_dwordx4 v152, s[12:15], s26 offen offset:0 sc1 lds
    v_mfma_f32_16x16x32_bf16 v[88:91], v[28:31], a[188:191], v[88:91]
    ds_read_b128 v[4:7], v150 offset:1024
    v_max3_f32 v149, v149, v77, v78
    v_mfma_f32_16x16x32_bf16 v[80:83], v[28:31], a[156:159], v[80:83]
    buffer_load_dwordx4 v152, s[12:15], s26 offen offset:1024 sc1 lds
    v_mfma_f32_16x16x32_bf16 v[80:83], v[24:27], a[152:155], v[80:83]
    ds_read_b128 v[8:11], v150 offset:2048
    v_max_f32 v149, v149, v79
    v_mfma_f32_16x16x32_bf16 v[80:83], v[20:23], a[148:151], v[80:83]
    buffer_load_dwordx4 v152, s[12:15], s26 offen offset:2048 sc1 lds
    v_mfma_f32_16x16x32_bf16 v[80:83], v[16:19], a[144:147], v[80:83]
    ds_read_b128 v[12:15], v150 offset:3072
    v_mov_b32 v172, v148
    s_waitcnt lgkmcnt(8)
    v_mfma_f32_16x16x32_bf16 v[84:87], v[32:35], a[128:131], v[132:135]
    buffer_load_dwordx4 v152, s[12:15], s26 offen offset:3072 sc1 lds
    v_mfma_f32_16x16x32_bf16 v[84:87], v[36:39], a[132:135], v[84:87]
    ds_read_b128 v[16:19], v150 offset:4096
    v_mov_b32 v174, v149
    v_mfma_f32_16x16x32_bf16 v[84:87], v[40:43], a[136:139], v[84:87]
    s_nop 0
    v_permlane32_swap_b32 v148, v172
    v_permlane32_swap_b32 v149, v174
    v_mfma_f32_16x16x32_bf16 v[84:87], v[44:47], a[140:143], v[84:87]
    ds_read_b128 v[20:23], v150 offset:5120
    s_nop 0
    v_mfma_f32_16x16x32_bf16 v[92:95], v[44:47], a[172:175], v[140:143]
    s_add_u32 m0, s28, 16384
    s_nop 0
    buffer_load_dwordx4 v152, s[8:11], s47 offen offset:0 sc1 lds
    v_mfma_f32_16x16x32_bf16 v[92:95], v[40:43], a[168:171], v[92:95]
    ds_read_b128 v[24:27], v150 offset:6144
    v_max_f32 v148, v148, v172
    v_mfma_f32_16x16x32_bf16 v[92:95], v[36:39], a[164:167], v[92:95]
    buffer_load_dwordx4 v152, s[8:11], s47 offen offset:1024 sc1 lds
    v_mfma_f32_16x16x32_bf16 v[92:95], v[32:35], a[160:163], v[92:95]
    ds_read_b128 v[28:31], v150 offset:7168
    v_max_f32 v149, v149, v174
    s_waitcnt lgkmcnt(8)
    v_mfma_f32_16x16x32_bf16 v[92:95], v[48:51], a[176:179], v[92:95]
    buffer_load_dwordx4 v152, s[8:11], s47 offen offset:2048 sc1 lds
    v_mfma_f32_16x16x32_bf16 v[92:95], v[52:55], a[180:183], v[92:95]
    ds_read_b128 v[32:35], v150 offset:8192
    v_mov_b32 v172, v148
    v_mfma_f32_16x16x32_bf16 v[92:95], v[56:59], a[184:187], v[92:95]
    buffer_load_dwordx4 v152, s[8:11], s47 offen offset:3072 sc1 lds
    s_mov_b32 s47, s26
    s_add_u32 s26, s26, 16384
    s_cmp_eq_u32 s26, s52
    s_cselect_b32 s26, 0, s26
    s_cselect_b32 s52, -1, s52
    s_add_u32 s28, s28, 32768
    s_cmp_ge_u32 s28, s46
    s_cselect_b32 s28, s45, s28
    v_mfma_f32_16x16x32_bf16 v[92:95], v[60:63], a[188:191], v[92:95]
    ds_read_b128 v[36:39], v150 offset:9216
    v_mov_b32 v174, v149
    v_mfma_f32_16x16x32_bf16 v[84:87], v[60:63], a[156:159], v[84:87]
    s_nop 0
    v_permlane16_swap_b32 v148, v172
    v_permlane16_swap_b32 v149, v174
    v_mfma_f32_16x16x32_bf16 v[84:87], v[56:59], a[152:155], v[84:87]
    ds_read_b128 v[40:43], v150 offset:10240
    s_nop 0
    v_mfma_f32_16x16x32_bf16 v[84:87], v[52:55], a[148:151], v[84:87]
    v_max_f32 v148, v148, v172
    v_max_f32 v149, v149, v174
    v_mfma_f32_16x16x32_bf16 v[84:87], v[48:51], a[144:147], v[84:87]
    ds_read_b128 v[44:47], v150 offset:11264
    v_sub_f32 v64, v64, v148
    v_sub_f32 v65, v65, v148
    v_sub_f32 v66, v66, v148
    v_sub_f32 v67, v67, v148
    v_sub_f32 v68, v68, v148
    v_sub_f32 v69, v69, v148
    v_sub_f32 v70, v70, v148
    v_sub_f32 v71, v71, v148
    v_sub_f32 v72, v72, v149
    v_sub_f32 v73, v73, v149
    v_sub_f32 v74, v74, v149
    v_sub_f32 v75, v75, v149
    v_sub_f32 v76, v76, v149
    v_sub_f32 v77, v77, v149
    v_sub_f32 v78, v78, v149
    v_sub_f32 v79, v79, v149
    v_exp_f32 v112, v64
    v_exp_f32 v113, v65
    v_exp_f32 v114, v66
    v_cvt_pk_bf16_f32 v96, v112, v113
    v_add_f32 v144, v112, v113
    v_exp_f32 v115, v67
    v_exp_f32 v116, v68
    v_cvt_pk_bf16_f32 v97, v114, v115
    v_add_f32 v144, v144, v114
    v_add_f32 v144, v144, v115
    v_exp_f32 v117, v69
    v_exp_f32 v118, v70
    v_cvt_pk_bf16_f32 v98, v116, v117
    v_add_f32 v144, v144, v116
    v_add_f32 v144, v144, v117
    v_exp_f32 v119, v71
    v_exp_f32 v120, v72
    v_cvt_pk_bf16_f32 v99, v118, v119
    v_add_f32 v144, v144, v118
    v_add_f32 v144, v144, v119
    v_exp_f32 v121, v73
    v_exp_f32 v122, v74
    v_cvt_pk_bf16_f32 v100, v120, v121
    v_add_f32 v145, v120, v121
    v_exp_f32 v123, v75
    v_exp_f32 v124, v76
    v_cvt_pk_bf16_f32 v101, v122, v123
    v_add_f32 v145, v145, v122
    v_add_f32 v145, v145, v123
    v_exp_f32 v125, v77
    v_exp_f32 v126, v78
    v_cvt_pk_bf16_f32 v102, v124, v125
    v_add_f32 v145, v145, v124
    v_add_f32 v145, v145, v125
    v_exp_f32 v127, v79
    s_nop 0
    v_cvt_pk_bf16_f32 v103, v126, v127
    v_add_f32 v145, v145, v126
    v_add_f32 v145, v145, v127
    v_max_f32 v172, v144, v145
    v_cmp_lt_f32 vcc, s33, v172
    v_sub_f32 v128, v128, v148
    v_sub_f32 v129, v129, v148
    v_sub_f32 v130, v130, v148
    v_sub_f32 v131, v131, v148
    v_sub_f32 v132, v132, v148
    v_sub_f32 v133, v133, v148
    v_sub_f32 v134, v134, v148
    v_sub_f32 v135, v135, v148
    v_sub_f32 v136, v136, v149
    v_sub_f32 v137, v137, v149
    v_sub_f32 v138, v138, v149
    v_sub_f32 v139, v139, v149
    v_sub_f32 v140, v140, v149
    v_sub_f32 v141, v141, v149
    v_sub_f32 v142, v142, v149
    v_sub_f32 v143, v143, v149
    v_sub_f32 v80, v80, v148
    v_sub_f32 v81, v81, v148
    v_sub_f32 v82, v82, v148
    v_sub_f32 v83, v83, v148
    v_sub_f32 v84, v84, v148
    v_sub_f32 v85, v85, v148
    v_sub_f32 v86, v86, v148
    v_sub_f32 v87, v87, v148
    v_sub_f32 v88, v88, v149
    v_sub_f32 v89, v89, v149
    v_sub_f32 v90, v90, v149
    v_sub_f32 v91, v91, v149
    v_sub_f32 v92, v92, v149
    v_sub_f32 v93, v93, v149
    v_sub_f32 v94, v94, v149
    v_sub_f32 v95, v95, v149
    s_barrier
    s_add_u32 m0, s27, 16384
    s_nop 0
    buffer_load_dwordx4 v152, s[12:15], s26 offen offset:0 sc1 lds
    buffer_load_dwordx4 v152, s[12:15], s26 offen offset:1024 sc1 lds
    buffer_load_dwordx4 v152, s[12:15], s26 offen offset:2048 sc1 lds
    buffer_load_dwordx4 v152, s[12:15], s26 offen offset:3072 sc1 lds
    s_xor_b32 s27, s27, 32768
    s_sub_u32 s31, s31, 1
    s_cbranch_scc1 L2_hk3
L2_hkr3:
    s_sub_u32 s34, s34, 1
    s_cbranch_scc1 L2_hk4
L2_hkr4:
    s_cbranch_vccnz L2_sl5
L2_slr5:
    s_waitcnt lgkmcnt(8)
    s_cmp_eq_u32 s30, s40
    s_cbranch_scc1 L2_short
    v_mfma_f32_16x16x32_bf16 v[64:67], v[0:3], a[128:131], v[128:131]
    s_add_u32 s29, s29, 32768
    s_cmp_ge_u32 s29, 163840
    s_cselect_b32 s29, 65536, s29
    v_mfma_f32_16x16x32_bf16 v[64:67], v[4:7], a[132:135], v[64:67]
    ds_read_b128 v[48:51], v150 offset:12288
    v_add_f32 v146, v146, v144
    v_mfma_f32_16x16x32_bf16 v[64:67], v[8:11], a[136:139], v[64:67]
    s_mov_b32 m0, s28
    v_exp_f32 v112, v80
    v_mfma_f32_16x16x32_bf16 v[64:67], v[12:15], a[140:143], v[64:67]
    ds_read_b128 v[52:55], v150 offset:13312
    v_add_u32 v151, s29, v155
    v_mfma_f32_16x16x32_bf16 v[72:75], v[12:15], a[172:175], v[136:139]
    buffer_load_dwordx4 v152, s[8:11], s47 offen offset:0 sc1 lds
    v_mfma_f32_16x16x32_bf16 v[72:75], v[8:11], a[168:171], v[72:75]
    ds_read_b128 v[56:59], v150 offset:14336
    v_add_f32 v147, v147, v145
    buffer_store_dwordx4 v[208:211], v155, s[16:19], s98 offen offset:0 sc0 sc1
    v_mfma_f32_16x16x32_bf16 v[72:75], v[4:7], a[164:167], v[72:75]
    s_waitcnt lgkmcnt(7)
    v_exp_f32 v113, v81
    v_mfma_f32_16x16x32_bf16 v[72:75], v[0:3], a[160:163], v[72:75]
    ds_read_b128 v[60:63], v150 offset:15360
    v_cvt_pk_bf16_f32 v104, v112, v113
    v_mfma_f32_16x16x32_bf16 v[72:75], v[16:19], a[176:179], v[72:75]
    v_exp_f32 v114, v82
    v_mfma_f32_16x16x32_bf16 v[72:75], v[20:23], a[180:183], v[72:75]
    ds_read_b128 v[0:3], v151 offset:0
    v_add_f32 v144, v112, v113
    v_mfma_f32_16x16x32_bf16 v[72:75], v[24:27], a[184:187], v[72:75]
    v_exp_f32 v115, v83
    v_mfma_f32_16x16x32_bf16 v[72:75], v[28:31], a[188:191], v[72:75]
    ds_read_b128 v[4:7], v151 offset:1024
    v_cvt_pk_bf16_f32 v105, v114, v115
    v_mfma_f32_16x16x32_bf16 v[64:67], v[28:31], a[156:159], v[64:67]
    buffer_load_dwordx4 v152, s[8:11], s47 offen offset:1024 sc1 lds
    v_mfma_f32_16x16x32_bf16 v[64:67], v[24:27], a[152:155], v[64:67]
    ds_read_b128 v[8:11], v151 offset:2048
    v_add_f32 v144, v144, v114
    buffer_store_dwordx4 v[212:215], v155, s[16:19], s98 offen offset:1024 sc0 sc1
    v_mfma_f32_16x16x32_bf16 v[64:67], v[20:23], a[148:151], v[64:67]
    s_waitcnt lgkmcnt(7)
    v_exp_f32 v116, v84
    v_mfma_f32_16x16x32_bf16 v[64:67], v[16:19], a[144:147], v[64:67]
    ds_read_b128 v[12:15], v151 offset:3072
    v_add_f32 v144, v144, v115
    v_mfma_f32_16x16x32_bf16 v[68:71], v[32:35], a[128:131], v[132:135]
    v_exp_f32 v117, v85
    v_mfma_f32_16x16x32_bf16 v[68:71], v[36:39], a[132:135], v[68:71]
    ds_read_b128 v[16:19], v151 offset:4096
    v_cvt_pk_bf16_f32 v106, v116, v117
    v_mfma_f32_16x16x32_bf16 v[68:71], v[40:43], a[136:139], v[68:71]
    v_exp_f32 v118, v86
    v_mfma_f32_16x16x32_bf16 v[68:71], v[44:47], a[140:143], v[68:71]
    ds_read_b128 v[20:23], v151 offset:5120
    v_add_f32 v144, v144, v116
    v_mfma_f32_16x16x32_bf16 v[76:79], v[44:47], a[172:175], v[140:143]
    buffer_load_dwordx4 v152, s[8:11], s47 offen offset:2048 sc1 lds
    v_mfma_f32_16x16x32_bf16 v[76:79], v[40:43], a[168:171], v[76:79]
    ds_read_b128 v[24:27], v151 offset:6144
    v_add_f32 v144, v144, v117
    buffer_store_dwordx4 v[216:219], v156, s[16:19], s98 offen offset:0 sc0 sc1
    v_mfma_f32_16x16x32_bf16 v[76:79], v[36:39], a[164:167], v[76:79]
    s_waitcnt lgkmcnt(7)
    v_exp_f32 v119, v87
    v_mfma_f32_16x16x32_bf16 v[76:79], v[32:35], a[160:163], v[76:79]
    ds_read_b128 v[28:31], v151 offset:7168
    v_cvt_pk_bf16_f32 v107, v118, v119
    v_mfma_f32_16x16x32_bf16 v[76:79], v[48:51], a[176:179], v[76:79]
    v_exp_f32 v120, v88
    v_mfma_f32_16x16x32_bf16 v[76:79], v[52:55], a[180:183], v[76:79]
    ds_read_b128 v[32:35], v151 offset:8192
    v_add_f32 v144, v144, v118
    v_mfma_f32_16x16x32_bf16 v[76:79], v[56:59], a[184:187], v[76:79]
    v_exp_f32 v121, v89
    v_mfma_f32_16x16x32_bf16 v[76:79], v[60:63], a[188:191], v[76:79]
    ds_read_b128 v[36:39], v151 offset:9216
    v_add_f32 v144, v144, v119
    v_mfma_f32_16x16x32_bf16 v[68:71], v[60:63], a[156:159], v[68:71]
    buffer_load_dwordx4 v152, s[8:11], s47 offen offset:3072 sc1 lds
    v_mfma_f32_16x16x32_bf16 v[68:71], v[56:59], a[152:155], v[68:71]
    ds_read_b128 v[40:43], v151 offset:10240
    v_cvt_pk_bf16_f32 v108, v120, v121
    buffer_store_dwordx4 v[220:223], v156, s[16:19], s98 offen offset:1024 sc0 sc1
    s_add_u32 s98, s98, s20
    v_mfma_f32_16x16x32_bf16 v[68:71], v[52:55], a[148:151], v[68:71]
    s_waitcnt lgkmcnt(7)
    v_exp_f32 v122, v90
    v_mfma_f32_16x16x32_bf16 v[68:71], v[48:51], a[144:147], v[68:71]
    ds_read_b128 v[44:47], v151 offset:11264
    v_add_f32 v145, v120, v121
    v_mfma_f32_16x16x32_bf16 a[0:3], v[0:3], v[96:99], 0
    s_mov_b32 s47, s26
    v_exp_f32 v123, v91
    v_mfma_f32_16x16x32_bf16 a[4:7], v[0:3], v[100:103], 0
    ds_read_b128 v[48:51], v151 offset:12288
    v_cvt_pk_bf16_f32 v109, v122, v123
    v_mfma_f32_16x16x32_bf16 a[12:15], v[4:7], v[100:103], 0
    s_add_u32 s26, s26, 16384
    v_exp_f32 v124, v92
    v_mfma_f32_16x16x32_bf16 a[8:11], v[4:7], v[96:99], 0
    ds_read_b128 v[52:55], v151 offset:13312
    v_add_f32 v145, v145, v122
    v_mfma_f32_16x16x32_bf16 a[16:19], v[8:11], v[96:99], 0
    s_cmp_eq_u32 s26, s52
    v_exp_f32 v125, v93
    v_mfma_f32_16x16x32_bf16 a[20:23], v[8:11], v[100:103], 0
    ds_read_b128 v[56:59], v151 offset:14336
    v_add_f32 v145, v145, v123
    v_mfma_f32_16x16x32_bf16 a[28:31], v[12:15], v[100:103], 0
    s_waitcnt lgkmcnt(7)
    v_exp_f32 v126, v94
    v_mfma_f32_16x16x32_bf16 a[24:27], v[12:15], v[96:99], 0
    ds_read_b128 v[60:63], v151 offset:15360
    v_cvt_pk_bf16_f32 v110, v124, v125
    v_mfma_f32_16x16x32_bf16 a[32:35], v[16:19], v[96:99], 0
    s_waitcnt vmcnt(30)
    s_barrier
    s_cselect_b32 s26, 0, s26
    v_mfma_f32_16x16x32_bf16 a[36:39], v[16:19], v[100:103], 0
    ds_read_b128 v[0:3], v150 offset:16384
    s_cselect_b32 s52, -1, s52
    v_mfma_f32_16x16x32_bf16 a[44:47], v[20:23], v[100:103], 0
    s_mov_b32 m0, s27
    v_exp_f32 v127, v95
    v_mfma_f32_16x16x32_bf16 a[40:43], v[20:23], v[96:99], 0
    ds_read_b128 v[4:7], v150 offset:17408
    v_add_f32 v145, v145, v124
    v_mfma_f32_16x16x32_bf16 a[48:51], v[24:27], v[96:99], 0
    buffer_load_dwordx4 v152, s[12:15], s26 offen offset:0 sc1 lds
    v_mfma_f32_16x16x32_bf16 a[52:55], v[24:27], v[100:103], 0
    ds_read_b128 v[8:11], v150 offset:18432
    v_add_f32 v145, v145, v125
    v_mfma_f32_16x16x32_bf16 a[60:63], v[28:31], v[100:103], 0
    s_waitcnt lgkmcnt(7)
    v_cvt_pk_bf16_f32 v111, v126, v127
    v_add_f32 v145, v145, v126
    v_mfma_f32_16x16x32_bf16 a[56:59], v[28:31], v[96:99], 0
    ds_read_b128 v[12:15], v150 offset:19456
    v_add_f32 v145, v145, v127
    buffer_store_dwordx4 v[224:227], v155, s[16:19], s98 offen offset:0 sc0 sc1
    v_mfma_f32_16x16x32_bf16 a[64:67], v[32:35], v[96:99], 0
    s_sub_u32 s30, s30, 1
    v_max_f32 v172, v144, v145
    v_cmp_lt_f32 vcc, s33, v172
    v_mfma_f32_16x16x32_bf16 a[68:71], v[32:35], v[100:103], 0
    ds_read_b128 v[16:19], v150 offset:20480
    v_mfma_f32_16x16x32_bf16 a[76:79], v[36:39], v[100:103], 0
    buffer_load_dwordx4 v152, s[12:15], s26 offen offset:1024 sc1 lds
    v_mfma_f32_16x16x32_bf16 a[72:75], v[36:39], v[96:99], 0
    ds_read_b128 v[20:23], v150 offset:21504
    v_mfma_f32_16x16x32_bf16 a[80:83], v[40:43], v[96:99], 0
    s_sub_u32 s31, s31, 1
    s_cbranch_scc1 L2_hk6
L2_hkr6:
    v_mfma_f32_16x16x32_bf16 a[84:87], v[40:43], v[100:103], 0
    ds_read_b128 v[24:27], v150 offset:22528
    v_mfma_f32_16x16x32_bf16 a[92:95], v[44:47], v[100:103], 0
    s_waitcnt lgkmcnt(7)
    v_mfma_f32_16x16x32_bf16 a[88:91], v[44:47], v[96:99], 0
    ds_read_b128 v[28:31], v150 offset:23552
    v_mfma_f32_16x16x32_bf16 a[96:99], v[48:51], v[96:99], 0
    buffer_load_dwordx4 v152, s[12:15], s26 offen offset:2048 sc1 lds
    v_mfma_f32_16x16x32_bf16 a[100:103], v[48:51], v[100:103], 0
    ds_read_b128 v[32:35], v150 offset:24576
    buffer_store_dwordx4 v[228:231], v155, s[16:19], s98 offen offset:1024 sc0 sc1
    v_mfma_f32_16x16x32_bf16 a[108:111], v[52:55], v[100:103], 0
    s_sub_u32 s34, s34, 1
    s_cbranch_scc1 L2_hk7
L2_hkr7:
    v_mfma_f32_16x16x32_bf16 a[104:107], v[52:55], v[96:99], 0
    ds_read_b128 v[36:39], v150 offset:25600
    v_mfma_f32_16x16x32_bf16 a[112:115], v[56:59], v[96:99], 0
    buffer_load_dwordx4 v152, s[12:15], s26 offen offset:3072 sc1 lds
    v_mfma_f32_16x16x32_bf16 a[116:119], v[56:59], v[100:103], 0
    ds_read_b128 v[40:43], v150 offset:26624
    v_mfma_f32_16x16x32_bf16 a[124:127], v[60:63], v[100:103], 0
    s_waitcnt lgkmcnt(7)
    v_mfma_f32_16x16x32_bf16 a[120:123], v[60:63], v[96:99], 0
    ds_read_b128 v[44:47], v150 offset:27648
    s_cbranch_vccnz L2_sl8
L2_slr8:
    v_mfma_f32_16x16x32_bf16 v[80:83], v[0:3], a[128:131], v[128:131]
    v_exp_f32 v112, v64
    v_mfma_f32_16x16x32_bf16 v[80:83], v[4:7], a[132:135], v[80:83]
    ds_read_b128 v[48:51], v150 offset:28672
    v_add_f32 v146, v146, v144
    v_mfma_f32_16x16x32_bf16 v[80:83], v[8:11], a[136:139], v[80:83]
    s_add_u32 m0, s28, 16384
    v_exp_f32 v113, v65
    v_mfma_f32_16x16x32_bf16 v[80:83], v[12:15], a[140:143], v[80:83]
    ds_read_b128 v[52:55], v150 offset:29696
    v_add_f32 v147, v147, v145
    v_mfma_f32_16x16x32_bf16 v[88:91], v[12:15], a[172:175], v[136:139]
    buffer_load_dwordx4 v152, s[8:11], s47 offen offset:0 sc1 lds
    v_mfma_f32_16x16x32_bf16 v[88:91], v[8:11], a[168:171], v[88:91]
    ds_read_b128 v[56:59], v150 offset:30720
    v_cvt_pk_bf16_f32 v96, v112, v113
    buffer_store_dwordx4 v[232:235], v156, s[16:19], s98 offen offset:0 sc0 sc1
    v_mfma_f32_16x16x32_bf16 v[88:91], v[4:7], a[164:167], v[88:91]
    s_waitcnt lgkmcnt(7)
    v_exp_f32 v114, v66
    v_mfma_f32_16x16x32_bf16 v[88:91], v[0:3], a[160:163], v[88:91]
    ds_read_b128 v[60:63], v150 offset:31744
    v_add_f32 v144, v112, v113
    v_mfma_f32_16x16x32_bf16 v[88:91], v[16:19], a[176:179], v[88:91]
    s_xor_b32 s48, s48, 32768
    v_exp_f32 v115, v67
    v_mfma_f32_16x16x32_bf16 v[88:91], v[20:23], a[180:183], v[88:91]
    ds_read_b128 v[0:3], v151 offset:16384
    v_cvt_pk_bf16_f32 v97, v114, v115
    v_mfma_f32_16x16x32_bf16 v[88:91], v[24:27], a[184:187], v[88:91]
    s_add_u32 s4, s29, 32768
    v_exp_f32 v116, v68
    v_mfma_f32_16x16x32_bf16 v[88:91], v[28:31], a[188:191], v[88:91]
    ds_read_b128 v[4:7], v151 offset:17408
    v_add_f32 v144, v144, v114
    v_mfma_f32_16x16x32_bf16 v[80:83], v[28:31], a[156:159], v[80:83]
    buffer_load_dwordx4 v152, s[8:11], s47 offen offset:1024 sc1 lds
    v_mfma_f32_16x16x32_bf16 v[80:83], v[24:27], a[152:155], v[80:83]
    ds_read_b128 v[8:11], v151 offset:18432
    v_add_f32 v144, v144, v115
    buffer_store_dwordx4 v[236:239], v156, s[16:19], s98 offen offset:1024 sc0 sc1
    s_add_u32 s98, s98, s20
    v_mfma_f32_16x16x32_bf16 v[80:83], v[20:23], a[148:151], v[80:83]
    s_waitcnt lgkmcnt(7)
    v_exp_f32 v117, v69
    v_mfma_f32_16x16x32_bf16 v[80:83], v[16:19], a[144:147], v[80:83]
    ds_read_b128 v[12:15], v151 offset:19456
    v_cvt_pk_bf16_f32 v98, v116, v117
    v_mfma_f32_16x16x32_bf16 v[84:87], v[32:35], a[128:131], v[132:135]
    s_cmp_ge_u32 s4, 163840
    v_exp_f32 v118, v70
    v_mfma_f32_16x16x32_bf16 v[84:87], v[36:39], a[132:135], v[84:87]
    ds_read_b128 v[16:19], v151 offset:20480
    v_add_f32 v144, v144, v116
    v_mfma_f32_16x16x32_bf16 v[84:87], v[40:43], a[136:139], v[84:87]
    s_cselect_b32 s4, 65536, s4
    v_exp_f32 v119, v71
    v_mfma_f32_16x16x32_bf16 v[84:87], v[44:47], a[140:143], v[84:87]
    ds_read_b128 v[20:23], v151 offset:21504
    v_add_f32 v144, v144, v117
    v_mfma_f32_16x16x32_bf16 v[92:95], v[44:47], a[172:175], v[140:143]
    buffer_load_dwordx4 v152, s[8:11], s47 offen offset:2048 sc1 lds
    v_mfma_f32_16x16x32_bf16 v[92:95], v[40:43], a[168:171], v[92:95]
    ds_read_b128 v[24:27], v151 offset:22528
    v_cvt_pk_bf16_f32 v99, v118, v119
    buffer_store_dwordx4 v[240:243], v155, s[16:19], s98 offen offset:0 sc0 sc1
    v_mfma_f32_16x16x32_bf16 v[92:95], v[36:39], a[164:167], v[92:95]
    s_waitcnt lgkmcnt(7)
    v_exp_f32 v120, v72
    v_mfma_f32_16x16x32_bf16 v[92:95], v[32:35], a[160:163], v[92:95]
    ds_read_b128 v[28:31], v151 offset:23552
    v_add_f32 v144, v144, v118
    v_mfma_f32_16x16x32_bf16 v[92:95], v[48:51], a[176:179], v[92:95]
    s_cmp_eq_u32 s30, 0
    v_exp_f32 v121, v73
    v_mfma_f32_16x16x32_bf16 v[92:95], v[52:55], a[180:183], v[92:95]
    ds_read_b128 v[32:35], v151 offset:24576
    v_add_f32 v144, v144, v119
    v_mfma_f32_16x16x32_bf16 v[92:95], v[56:59], a[184:187], v[92:95]
    s_cselect_b32 s4, s4, s48
    v_exp_f32 v122, v74
    v_mfma_f32_16x16x32_bf16 v[92:95], v[60:63], a[188:191], v[92:95]
    ds_read_b128 v[36:39], v151 offset:25600
    v_cvt_pk_bf16_f32 v100, v120, v121
    v_mfma_f32_16x16x32_bf16 v[84:87], v[60:63], a[156:159], v[84:87]
    buffer_load_dwordx4 v152, s[8:11], s47 offen offset:3072 sc1 lds
    v_mfma_f32_16x16x32_bf16 v[84:87], v[56:59], a[152:155], v[84:87]
    ds_read_b128 v[40:43], v151 offset:26624
    v_add_u32 v150, s4, v155
    buffer_store_dwordx4 v[244:247], v155, s[16:19], s98 offen offset:1024 sc0 sc1
    v_mfma_f32_16x16x32_bf16 v[84:87], v[52:55], a[148:151], v[84:87]
    s_waitcnt lgkmcnt(7)
    v_exp_f32 v123, v75
    v_mfma_f32_16x16x32_bf16 v[84:87], v[48:51], a[144:147], v[84:87]
    ds_read_b128 v[44:47], v151 offset:27648
    v_add_f32 v145, v120, v121
    v_mfma_f32_16x16x32_bf16 a[0:3], v[0:3], v[104:107], a[0:3]
    s_mov_b32 s47, s26
    v_exp_f32 v124, v76
    v_mfma_f32_16x16x32_bf16 a[4:7], v[0:3], v[108:111], a[4:7]
    ds_read_b128 v[48:51], v151 offset:28672
    v_cvt_pk_bf16_f32 v101, v122, v123
    v_mfma_f32_16x16x32_bf16 a[12:15], v[4:7], v[108:111], a[12:15]
    s_add_u32 s26, s26, 16384
    v_exp_f32 v125, v77
    v_mfma_f32_16x16x32_bf16 a[8:11], v[4:7], v[104:107], a[8:11]
    ds_read_b128 v[52:55], v151 offset:29696
    v_add_f32 v145, v145, v122
    v_mfma_f32_16x16x32_bf16 a[16:19], v[8:11], v[104:107], a[16:19]
    s_cmp_eq_u32 s26, s52
    v_exp_f32 v126, v78
    v_mfma_f32_16x16x32_bf16 a[20:23], v[8:11], v[108:111], a[20:23]
    ds_read_b128 v[56:59], v151 offset:30720
    v_add_f32 v145, v145, v123
    v_mfma_f32_16x16x32_bf16 a[28:31], v[12:15], v[108:111], a[28:31]
    s_waitcnt lgkmcnt(7)
    v_exp_f32 v127, v79
    v_mfma_f32_16x16x32_bf16 a[24:27], v[12:15], v[104:107], a[24:27]
    ds_read_b128 v[60:63], v151 offset:31744
    v_cvt_pk_bf16_f32 v102, v124, v125
    v_mfma_f32_16x16x32_bf16 a[32:35], v[16:19], v[104:107], a[32:35]
    s_waitcnt vmcnt(30)
    s_barrier
    s_cselect_b32 s26, 0, s26
    v_mfma_f32_16x16x32_bf16 a[36:39], v[16:19], v[108:111], a[36:39]
    ds_read_b128 v[0:3], v150 offset:0
    s_cselect_b32 s52, -1, s52
    v_mfma_f32_16x16x32_bf16 a[44:47], v[20:23], v[108:111], a[44:47]
    s_add_u32 m0, s27, 16384
    v_add_f32 v145, v145, v124
    v_add_f32 v145, v145, v125
    v_mfma_f32_16x16x32_bf16 a[40:43], v[20:23], v[104:107], a[40:43]
    ds_read_b128 v[4:7], v150 offset:1024
    v_cvt_pk_bf16_f32 v103, v126, v127
    v_mfma_f32_16x16x32_bf16 a[48:51], v[24:27], v[104:107], a[48:51]
    buffer_load_dwordx4 v152, s[12:15], s26 offen offset:0 sc1 lds
    v_mfma_f32_16x16x32_bf16 a[52:55], v[24:27], v[108:111], a[52:55]
    ds_read_b128 v[8:11], v150 offset:2048
    v_add_f32 v145, v145, v126
    v_mfma_f32_16x16x32_bf16 a[60:63], v[28:31], v[108:111], a[60:63]
    s_waitcnt lgkmcnt(7)
    v_add_f32 v145, v145, v127
    v_max_f32 v172, v144, v145
    v_mfma_f32_16x16x32_bf16 a[56:59], v[28:31], v[104:107], a[56:59]
    ds_read_b128 v[12:15], v150 offset:3072
    v_cmp_lt_f32 vcc, s33, v172
    buffer_store_dwordx4 v[248:251], v156, s[16:19], s98 offen offset:0 sc0 sc1
    v_mfma_f32_16x16x32_bf16 a[64:67], v[32:35], v[104:107], a[64:67]
    v_mfma_f32_16x16x32_bf16 a[68:71], v[32:35], v[108:111], a[68:71]
    ds_read_b128 v[16:19], v150 offset:4096
    v_mfma_f32_16x16x32_bf16 a[76:79], v[36:39], v[108:111], a[76:79]
    buffer_load_dwordx4 v152, s[12:15], s26 offen offset:1024 sc1 lds
    v_mfma_f32_16x16x32_bf16 a[72:75], v[36:39], v[104:107], a[72:75]
    ds_read_b128 v[20:23], v150 offset:5120
    s_add_u32 s28, s28, 32768
    v_mfma_f32_16x16x32_bf16 a[80:83], v[40:43], v[104:107], a[80:83]
    s_sub_u32 s31, s31, 1
    s_cbranch_scc1 L2_hk9
L2_hkr9:
    v_mfma_f32_16x16x32_bf16 a[84:87], v[40:43], v[108:111], a[84:87]
    ds_read_b128 v[24:27], v150 offset:6144
    v_mfma_f32_16x16x32_bf16 a[92:95], v[44:47], v[108:111], a[92:95]
    s_waitcnt lgkmcnt(7)
    s_cmp_ge_u32 s28, s46
    s_cselect_b32 s28, s45, s28
    v_mfma_f32_16x16x32_bf16 a[88:91], v[44:47], v[104:107], a[88:91]
    ds_read_b128 v[28:31], v150 offset:7168
    v_mfma_f32_16x16x32_bf16 a[96:99], v[48:51], v[104:107], a[96:99]
    buffer_load_dwordx4 v152, s[12:15], s26 offen offset:2048 sc1 lds
    v_mfma_f32_16x16x32_bf16 a[100:103], v[48:51], v[108:111], a[100:103]
    ds_read_b128 v[32:35], v150 offset:8192
    buffer_store_dwordx4 v[252:255], v156, s[16:19], s98 offen offset:1024 sc0 sc1
    s_add_u32 s98, s98, s20
    v_mfma_f32_16x16x32_bf16 a[108:111], v[52:55], v[108:111], a[108:111]
    s_sub_u32 s34, s34, 1
    s_cbranch_scc1 L2_hk10
L2_hkr10:
    v_mfma_f32_16x16x32_bf16 a[104:107], v[52:55], v[104:107], a[104:107]
    ds_read_b128 v[36:39], v150 offset:9216
    v_mfma_f32_16x16x32_bf16 a[112:115], v[56:59], v[104:107], a[112:115]
    buffer_load_dwordx4 v152, s[12:15], s26 offen offset:3072 sc1 lds
    v_mfma_f32_16x16x32_bf16 a[116:119], v[56:59], v[108:111], a[116:119]
    ds_read_b128 v[40:43], v150 offset:10240
    v_mfma_f32_16x16x32_bf16 a[124:127], v[60:63], v[108:111], a[124:127]
    s_waitcnt lgkmcnt(7)
    s_xor_b32 s27, s27, 32768
    s_cmp_lg_u32 s30, s40
    v_mfma_f32_16x16x32_bf16 a[120:123], v[60:63], v[104:107], a[120:123]
    ds_read_b128 v[44:47], v150 offset:11264
    s_cbranch_vccnz L2_sl11
L2_slr11:
    s_cbranch_scc0 L2_last
L2_loop:
    v_mfma_f32_16x16x32_bf16 v[64:67], v[0:3], a[128:131], v[128:131]
    s_add_u32 s29, s29, 32768
    s_cmp_ge_u32 s29, 163840
    s_cselect_b32 s29, 65536, s29
    v_mfma_f32_16x16x32_bf16 v[64:67], v[4:7], a[132:135], v[64:67]
    ds_read_b128 v[48:51], v150 offset:12288
    v_add_f32 v146, v146, v144
    v_mfma_f32_16x16x32_bf16 v[64:67], v[8:11], a[136:139], v[64:67]
    s_mov_b32 m0, s28
    v_exp_f32 v112, v80
    v_mfma_f32_16x16x32_bf16 v[64:67], v[12:15], a[140:143], v[64:67]
    ds_read_b128 v[52:55], v150 offset:13312
    v_add_u32 v151, s29, v155
    v_mfma_f32_16x16x32_bf16 v[72:75], v[12:15], a[172:175], v[136:139]
    buffer_load_dwordx4 v152, s[8:11], s47 offen offset:0 sc1 lds
    v_mfma_f32_16x16x32_bf16 v[72:75], v[8:11], a[168:171], v[72:75]
    ds_read_b128 v[56:59], v150 offset:14336
    v_add_f32 v147, v147, v145
    v_mfma_f32_16x16x32_bf16 v[72:75], v[4:7], a[164:167], v[72:75]
    s_waitcnt lgkmcnt(7)
    v_exp_f32 v113, v81
    v_mfma_f32_16x16x32_bf16 v[72:75], v[0:3], a[160:163], v[72:75]
    ds_read_b128 v[60:63], v150 offset:15360
    v_cvt_pk_bf16_f32 v104, v112, v113
    v_mfma_f32_16x16x32_bf16 v[72:75], v[16:19], a[176:179], v[72:75]
    v_exp_f32 v114, v82
    v_mfma_f32_16x16x32_bf16 v[72:75], v[20:23], a[180:183], v[72:75]
    ds_read_b128 v[0:3], v151 offset:0
    v_add_f32 v144, v112, v113
    v_mfma_f32_16x16x32_bf16 v[72:75], v[24:27], a[184:187], v[72:75]
    v_exp_f32 v115, v83
    v_mfma_f32_16x16x32_bf16 v[72:75], v[28:31], a[188:191], v[72:75]
    ds_read_b128 v[4:7], v151 offset:1024
    v_cvt_pk_bf16_f32 v105, v114, v115
    v_mfma_f32_16x16x32_bf16 v[64:67], v[28:31], a[156:159], v[64:67]
    buffer_load_dwordx4 v152, s[8:11], s47 offen offset:1024 sc1 lds
    v_mfma_f32_16x16x32_bf16 v[64:67], v[24:27], a[152:155], v[64:67]
    ds_read_b128 v[8:11], v151 offset:2048
    v_add_f32 v144, v144, v114
    v_mfma_f32_16x16x32_bf16 v[64:67], v[20:23], a[148:151], v[64:67]
    s_waitcnt lgkmcnt(7)
    v_exp_f32 v116, v84
    v_mfma_f32_16x16x32_bf16 v[64:67], v[16:19], a[144:147], v[64:67]
    ds_read_b128 v[12:15], v151 offset:3072
    v_add_f32 v144, v144, v115
    v_mfma_f32_16x16x32_bf16 v[68:71], v[32:35], a[128:131], v[132:135]
    v_exp_f32 v117, v85
    v_mfma_f32_16x16x32_bf16 v[68:71], v[36:39], a[132:135], v[68:71]
    ds_read_b128 v[16:19], v151 offset:4096
    v_cvt_pk_bf16_f32 v106, v116, v117
    v_mfma_f32_16x16x32_bf16 v[68:71], v[40:43], a[136:139], v[68:71]
    v_exp_f32 v118, v86
    v_mfma_f32_16x16x32_bf16 v[68:71], v[44:47], a[140:143], v[68:71]
    ds_read_b128 v[20:23], v151 offset:5120
    v_add_f32 v144, v144, v116
    v_mfma_f32_16x16x32_bf16 v[76:79], v[44:47], a[172:175], v[140:143]
    buffer_load_dwordx4 v152, s[8:11], s47 offen offset:2048 sc1 lds
    v_mfma_f32_16x16x32_bf16 v[76:79], v[40:43], a[168:171], v[76:79]
    ds_read_b128 v[24:27], v151 offset:6144
    v_add_f32 v144, v144, v117
    v_mfma_f32_16x16x32_bf16 v[76:79], v[36:39], a[164:167], v[76:79]
    s_waitcnt lgkmcnt(7)
    v_exp_f32 v119, v87
    v_mfma_f32_16x16x32_bf16 v[76:79], v[32:35], a[160:163], v[76:79]
    ds_read_b128 v[28:31], v151 offset:7168
    v_cvt_pk_bf16_f32 v107, v118, v119
    v_mfma_f32_16x16x32_bf16 v[76:79], v[48:51], a[176:179], v[76:79]
    v_exp_f32 v120, v88
    v_mfma_f32_16x16x32_bf16 v[76:79], v[52:55], a[180:183], v[76:79]
    ds_read_b128 v[32:35], v151 offset:8192
    v_add_f32 v144, v144, v118
    v_mfma_f32_16x16x32_bf16 v[76:79], v[56:59], a[184:187], v[76:79]
    v_exp_f32 v121, v89
    v_mfma_f32_16x16x32_bf16 v[76:79], v[60:63], a[188:191], v[76:79]
    ds_read_b128 v[36:39], v151 offset:9216
    v_add_f32 v144, v144, v119
    v_mfma_f32_16x16x32_bf16 v[68:71], v[60:63], a[156:159], v[68:71]
    buffer_load_dwordx4 v152, s[8:11], s47 offen offset:3072 sc1 lds
    v_mfma_f32_16x16x32_bf16 v[68:71], v[56:59], a[152:155], v[68:71]
    ds_read_b128 v[40:43], v151 offset:10240
    v_cvt_pk_bf16_f32 v108, v120, v121
    v_mfma_f32_16x16x32_bf16 v[68:71], v[52:55], a[148:151], v[68:71]
    s_waitcnt lgkmcnt(7)
    v_exp_f32 v122, v90
    v_mfma_f32_16x16x32_bf16 v[68:71], v[48:51], a[144:147], v[68:71]
    ds_read_b128 v[44:47], v151 offset:11264
    v_add_f32 v145, v120, v121
    v_mfma_f32_16x16x32_bf16 a[0:3], v[0:3], v[96:99], a[0:3]
    s_mov_b32 s47, s26
    v_exp_f32 v123, v91
    v_mfma_f32_16x16x32_bf16 a[4:7], v[0:3], v[100:103], a[4:7]
    ds_read_b128 v[48:51], v151 offset:12288
    v_cvt_pk_bf16_f32 v109, v122, v123
    v_mfma_f32_16x16x32_bf16 a[12:15], v[4:7], v[100:103], a[12:15]
    s_add_u32 s26, s26, 16384
    v_exp_f32 v124, v92
    v_mfma_f32_16x16x32_bf16 a[8:11], v[4:7], v[96:99], a[8:11]
    ds_read_b128 v[52:55], v151 offset:13312
    v_add_f32 v145, v145, v122
    v_mfma_f32_16x16x32_bf16 a[16:19], v[8:11], v[96:99], a[16:19]
    s_cmp_eq_u32 s26, s52
    v_exp_f32 v125, v93
    v_mfma_f32_16x16x32_bf16 a[20:23], v[8:11], v[100:103], a[20:23]
    ds_read_b128 v[56:59], v151 offset:14336
    v_add_f32 v145, v145, v123
    v_mfma_f32_16x16x32_bf16 a[28:31], v[12:15], v[100:103], a[28:31]
    s_waitcnt lgkmcnt(7)
    v_exp_f32 v126, v94
    v_mfma_f32_16x16x32_bf16 a[24:27], v[12:15], v[96:99], a[24:27]
    ds_read_b128 v[60:63], v151 offset:15360
    v_cvt_pk_bf16_f32 v110, v124, v125
    v_mfma_f32_16x16x32_bf16 a[32:35], v[16:19], v[96:99], a[32:35]
    s_waitcnt vmcnt(20)
    s_barrier
    s_cselect_b32 s26, 0, s26
    v_mfma_f32_16x16x32_bf16 a[36:39], v[16:19], v[100:103], a[36:39]
    ds_read_b128 v[0:3], v150 offset:16384
    s_cselect_b32 s52, -1, s52
    v_mfma_f32_16x16x32_bf16 a[44:47], v[20:23], v[100:103], a[44:47]
    s_mov_b32 m0, s27
    v_exp_f32 v127, v95
    v_mfma_f32_16x16x32_bf16 a[40:43], v[20:23], v[96:99], a[40:43]
    ds_read_b128 v[4:7], v150 offset:17408
    v_add_f32 v145, v145, v124
    v_mfma_f32_16x16x32_bf16 a[48:51], v[24:27], v[96:99], a[48:51]
    buffer_load_dwordx4 v152, s[12:15], s26 offen offset:0 sc1 lds
    v_mfma_f32_16x16x32_bf16 a[52:55], v[24:27], v[100:103], a[52:55]
    ds_read_b128 v[8:11], v150 offset:18432
    v_add_f32 v145, v145, v125
    v_mfma_f32_16x16x32_bf16 a[60:63], v[28:31], v[100:103], a[60:63]
    s_waitcnt lgkmcnt(7)
    v_cvt_pk_bf16_f32 v111, v126, v127
    v_add_f32 v145, v145, v126
    v_mfma_f32_16x16x32_bf16 a[56:59], v[28:31], v[96:99], a[56:59]
    ds_read_b128 v[12:15], v150 offset:19456
    v_add_f32 v145, v145, v127
    v_mfma_f32_16x16x32_bf16 a[64:67], v[32:35], v[96:99], a[64:67]
    s_sub_u32 s30, s30, 1
    v_max_f32 v172, v144, v145
    v_cmp_lt_f32 vcc, s33, v172
    v_mfma_f32_16x16x32_bf16 a[68:71], v[32:35], v[100:103], a[68:71]
    ds_read_b128 v[16:19], v150 offset:20480
    v_mfma_f32_16x16x32_bf16 a[76:79], v[36:39], v[100:103], a[76:79]
    buffer_load_dwordx4 v152, s[12:15], s26 offen offset:1024 sc1 lds
    v_mfma_f32_16x16x32_bf16 a[72:75], v[36:39], v[96:99], a[72:75]
    ds_read_b128 v[20:23], v150 offset:21504
    v_mfma_f32_16x16x32_bf16 a[80:83], v[40:43], v[96:99], a[80:83]
    s_sub_u32 s31, s31, 1
    s_cbranch_scc1 L2_hk12
L2_hkr12:
    v_mfma_f32_16x16x32_bf16 a[84:87], v[40:43], v[100:103], a[84:87]
    ds_read_b128 v[24:27], v150 offset:22528
    v_mfma_f32_16x16x32_bf16 a[92:95], v[44:47], v[100:103], a[92:95]
    s_waitcnt lgkmcnt(7)
    v_mfma_f32_16x16x32_bf16 a[88:91], v[44:47], v[96:99], a[88:91]
    ds_read_b128 v[28:31], v150 offset:23552
    v_mfma_f32_16x16x32_bf16 a[96:99], v[48:51], v[96:99], a[96:99]
    buffer_load_dwordx4 v152, s[12:15], s26 offen offset:2048 sc1 lds
    v_mfma_f32_16x16x32_bf16 a[100:103], v[48:51], v[100:103], a[100:103]
    ds_read_b128 v[32:35], v150 offset:24576
    v_mfma_f32_16x16x32_bf16 a[108:111], v[52:55], v[100:103], a[108:111]
    s_sub_u32 s34, s34, 1
    s_cbranch_scc1 L2_hk13
L2_hkr13:
    v_mfma_f32_16x16x32_bf16 a[104:107], v[52:55], v[96:99], a[104:107]
    ds_read_b128 v[36:39], v150 offset:25600
    v_mfma_f32_16x16x32_bf16 a[112:115], v[56:59], v[96:99], a[112:115]
    buffer_load_dwordx4 v152, s[12:15], s26 offen offset:3072 sc1 lds
    v_mfma_f32_16x16x32_bf16 a[116:119], v[56:59], v[100:103], a[116:119]
    ds_read_b128 v[40:43], v150 offset:26624
    v_mfma_f32_16x16x32_bf16 a[124:127], v[60:63], v[100:103], a[124:127]
    s_waitcnt lgkmcnt(7)
    v_mfma_f32_16x16x32_bf16 a[120:123], v[60:63], v[96:99], a[120:123]
    ds_read_b128 v[44:47], v150 offset:27648
    s_cbranch_vccnz L2_sl14
L2_slr14:
    v_mfma_f32_16x16x32_bf16 v[80:83], v[0:3], a[128:131], v[128:131]
    v_exp_f32 v112, v64
    v_mfma_f32_16x16x32_bf16 v[80:83], v[4:7], a[132:135], v[80:83]
    ds_read_b128 v[48:51], v150 offset:28672
    v_add_f32 v146, v146, v144
    v_mfma_f32_16x16x32_bf16 v[80:83], v[8:11], a[136:139], v[80:83]
    s_add_u32 m0, s28, 16384
    v_exp_f32 v113, v65
    v_mfma_f32_16x16x32_bf16 v[80:83], v[12:15], a[140:143], v[80:83]
    ds_read_b128 v[52:55], v150 offset:29696
    v_add_f32 v147, v147, v145
    v_mfma_f32_16x16x32_bf16 v[88:91], v[12:15], a[172:175], v[136:139]
    buffer_load_dwordx4 v152, s[8:11], s47 offen offset:0 sc1 lds
    v_mfma_f32_16x16x32_bf16 v[88:91], v[8:11], a[168:171], v[88:91]
    ds_read_b128 v[56:59], v150 offset:30720
    v_cvt_pk_bf16_f32 v96, v112, v113
    v_mfma_f32_16x16x32_bf16 v[88:91], v[4:7], a[164:167], v[88:91]
    s_waitcnt lgkmcnt(7)
    v_exp_f32 v114, v66
    v_mfma_f32_16x16x32_bf16 v[88:91], v[0:3], a[160:163], v[88:91]
    ds_read_b128 v[60:63], v150 offset:31744
    v_add_f32 v144, v112, v113
    v_mfma_f32_16x16x32_bf16 v[88:91], v[16:19], a[176:179], v[88:91]
    s_xor_b32 s48, s48, 32768
    v_exp_f32 v115, v67
    v_mfma_f32_16x16x32_bf16 v[88:91], v[20:23], a[180:183], v[88:91]
    ds_read_b128 v[0:3], v151 offset:16384
    v_cvt_pk_bf16_f32 v97, v114, v115
    v_mfma_f32_16x16x32_bf16 v[88:91], v[24:27], a[184:187], v[88:91]
    s_add_u32 s4, s29, 32768
    v_exp_f32 v116, v68
    v_mfma_f32_16x16x32_bf16 v[88:91], v[28:31], a[188:191], v[88:91]
    ds_read_b128 v[4:7], v151 offset:17408
    v_add_f32 v144, v144, v114
    v_mfma_f32_16x16x32_bf16 v[80:83], v[28:31], a[156:159], v[80:83]
    buffer_load_dwordx4 v152, s[8:11], s47 offen offset:1024 sc1 lds
    v_mfma_f32_16x16x32_bf16 v[80:83], v[24:27], a[152:155], v[80:83]
    ds_read_b128 v[8:11], v151 offset:18432
    v_add_f32 v144, v144, v115
    v_mfma_f32_16x16x32_bf16 v[80:83], v[20:23], a[148:151], v[80:83]
    s_waitcnt lgkmcnt(7)
    v_exp_f32 v117, v69
    v_mfma_f32_16x16x32_bf16 v[80:83], v[16:19], a[144:147], v[80:83]
    ds_read_b128 v[12:15], v151 offset:19456
    v_cvt_pk_bf16_f32 v98, v116, v117
    v_mfma_f32_16x16x32_bf16 v[84:87], v[32:35], a[128:131], v[132:135]
    s_cmp_ge_u32 s4, 163840
    v_exp_f32 v118, v70
    v_mfma_f32_16x16x32_bf16 v[84:87], v[36:39], a[132:135], v[84:87]
    ds_read_b128 v[16:19], v151 offset:20480
    v_add_f32 v144, v144, v116
    v_mfma_f32_16x16x32_bf16 v[84:87], v[40:43], a[136:139], v[84:87]
    s_cselect_b32 s4, 65536, s4
    v_exp_f32 v119, v71
    v_mfma_f32_16x16x32_bf16 v[84:87], v[44:47], a[140:143], v[84:87]
    ds_read_b128 v[20:23], v151 offset:21504
    v_add_f32 v144, v144, v117
    v_mfma_f32_16x16x32_bf16 v[92:95], v[44:47], a[172:175], v[140:143]
    buffer_load_dwordx4 v152, s[8:11], s47 offen offset:2048 sc1 lds
    v_mfma_f32_16x16x32_bf16 v[92:95], v[40:43], a[168:171], v[92:95]
    ds_read_b128 v[24:27], v151 offset:22528
    v_cvt_pk_bf16_f32 v99, v118, v119
    v_mfma_f32_16x16x32_bf16 v[92:95], v[36:39], a[164:167], v[92:95]
    s_waitcnt lgkmcnt(7)
    v_exp_f32 v120, v72
    v_mfma_f32_16x16x32_bf16 v[92:95], v[32:35], a[160:163], v[92:95]
    ds_read_b128 v[28:31], v151 offset:23552
    v_add_f32 v144, v144, v118
    v_mfma_f32_16x16x32_bf16 v[92:95], v[48:51], a[176:179], v[92:95]
    s_cmp_eq_u32 s30, 0
    v_exp_f32 v121, v73
    v_mfma_f32_16x16x32_bf16 v[92:95], v[52:55], a[180:183], v[92:95]
    ds_read_b128 v[32:35], v151 offset:24576
    v_add_f32 v144, v144, v119
    v_mfma_f32_16x16x32_bf16 v[92:95], v[56:59], a[184:187], v[92:95]
    s_cselect_b32 s4, s4, s48
    v_exp_f32 v122, v74
    v_mfma_f32_16x16x32_bf16 v[92:95], v[60:63], a[188:191], v[92:95]
    ds_read_b128 v[36:39], v151 offset:25600
    v_cvt_pk_bf16_f32 v100, v120, v121
    v_mfma_f32_16x16x32_bf16 v[84:87], v[60:63], a[156:159], v[84:87]
    buffer_load_dwordx4 v152, s[8:11], s47 offen offset:3072 sc1 lds
    v_mfma_f32_16x16x32_bf16 v[84:87], v[56:59], a[152:155], v[84:87]
    ds_read_b128 v[40:43], v151 offset:26624
    v_add_u32 v150, s4, v155
    v_mfma_f32_16x16x32_bf16 v[84:87], v[52:55], a[148:151], v[84:87]
    s_waitcnt lgkmcnt(7)
    v_exp_f32 v123, v75
    v_mfma_f32_16x16x32_bf16 v[84:87], v[48:51], a[144:147], v[84:87]
    ds_read_b128 v[44:47], v151 offset:27648
    v_add_f32 v145, v120, v121
    v_mfma_f32_16x16x32_bf16 a[0:3], v[0:3], v[104:107], a[0:3]
    s_mov_b32 s47, s26
    v_exp_f32 v124, v76
    v_mfma_f32_16x16x32_bf16 a[4:7], v[0:3], v[108:111], a[4:7]
    ds_read_b128 v[48:51], v151 offset:28672
    v_cvt_pk_bf16_f32 v101, v122, v123
    v_mfma_f32_16x16x32_bf16 a[12:15], v[4:7], v[108:111], a[12:15]
    s_add_u32 s26, s26, 16384
    v_exp_f32 v125, v77
    v_mfma_f32_16x16x32_bf16 a[8:11], v[4:7], v[104:107], a[8:11]
    ds_read_b128 v[52:55], v151 offset:29696
    v_add_f32 v145, v145, v122
    v_mfma_f32_16x16x32_bf16 a[16:19], v[8:11], v[104:107], a[16:19]
    s_cmp_eq_u32 s26, s52
    v_exp_f32 v126, v78
    v_mfma_f32_16x16x32_bf16 a[20:23], v[8:11], v[108:111], a[20:23]
    ds_read_b128 v[56:59], v151 offset:30720
    v_add_f32 v145, v145, v123
    v_mfma_f32_16x16x32_bf16 a[28:31], v[12:15], v[108:111], a[28:31]
    s_waitcnt lgkmcnt(7)
    v_exp_f32 v127, v79
    v_mfma_f32_16x16x32_bf16 a[24:27], v[12:15], v[104:107], a[24:27]
    ds_read_b128 v[60:63], v151 offset:31744
    v_cvt_pk_bf16_f32 v102, v124, v125
    v_mfma_f32_16x16x32_bf16 a[32:35], v[16:19], v[104:107], a[32:35]
    s_waitcnt vmcnt(20)
    s_barrier
    s_cselect_b32 s26, 0, s26
    v_mfma_f32_16x16x32_bf16 a[36:39], v[16:19], v[108:111], a[36:39]
    ds_read_b128 v[0:3], v150 offset:0
    s_cselect_b32 s52, -1, s52
    v_mfma_f32_16x16x32_bf16 a[44:47], v[20:23], v[108:111], a[44:47]
    s_add_u32 m0, s27, 16384
    v_add_f32 v145, v145, v124
    v_add_f32 v145, v145, v125
    v_mfma_f32_16x16x32_bf16 a[40:43], v[20:23], v[104:107], a[40:43]
    ds_read_b128 v[4:7], v150 offset:1024
    v_cvt_pk_bf16_f32 v103, v126, v127
    v_mfma_f32_16x16x32_bf16 a[48:51], v[24:27], v[104:107], a[48:51]
    buffer_load_dwordx4 v152, s[12:15], s26 offen offset:0 sc1 lds
    v_mfma_f32_16x16x32_bf16 a[52:55], v[24:27], v[108:111], a[52:55]
    ds_read_b128 v[8:11], v150 offset:2048
    v_add_f32 v145, v145, v126
    v_mfma_f32_16x16x32_bf16 a[60:63], v[28:31], v[108:111], a[60:63]
    s_waitcnt lgkmcnt(7)
    v_add_f32 v145, v145, v127
    v_max_f32 v172, v144, v145
    v_mfma_f32_16x16x32_bf16 a[56:59], v[28:31], v[104:107], a[56:59]
    ds_read_b128 v[12:15], v150 offset:3072
    v_cmp_lt_f32 vcc, s33, v172
    v_mfma_f32_16x16x32_bf16 a[64:67], v[32:35], v[104:107], a[64:67]
    v_mfma_f32_16x16x32_bf16 a[68:71], v[32:35], v[108:111], a[68:71]
    ds_read_b128 v[16:19], v150 offset:4096
    v_mfma_f32_16x16x32_bf16 a[76:79], v[36:39], v[108:111], a[76:79]
    buffer_load_dwordx4 v152, s[12:15], s26 offen offset:1024 sc1 lds
    v_mfma_f32_16x16x32_bf16 a[72:75], v[36:39], v[104:107], a[72:75]
    ds_read_b128 v[20:23], v150 offset:5120
    s_add_u32 s28, s28, 32768
    v_mfma_f32_16x16x32_bf16 a[80:83], v[40:43], v[104:107], a[80:83]
    s_sub_u32 s31, s31, 1
    s_cbranch_scc1 L2_hk15
L2_hkr15:
    v_mfma_f32_16x16x32_bf16 a[84:87], v[40:43], v[108:111], a[84:87]
    ds_read_b128 v[24:27], v150 offset:6144
    v_mfma_f32_16x16x32_bf16 a[92:95], v[44:47], v[108:111], a[92:95]
    s_waitcnt lgkmcnt(7)
    s_cmp_ge_u32 s28, s46
    s_cselect_b32 s28, s45, s28
    v_mfma_f32_16x16x32_bf16 a[88:91], v[44:47], v[104:107], a[88:91]
    ds_read_b128 v[28:31], v150 offset:7168
    v_mfma_f32_16x16x32_bf16 a[96:99], v[48:51], v[104:107], a[96:99]
    buffer_load_dwordx4 v152, s[12:15], s26 offen offset:2048 sc1 lds
    v_mfma_f32_16x16x32_bf16 a[100:103], v[48:51], v[108:111], a[100:103]
    ds_read_b128 v[32:35], v150 offset:8192
    v_mfma_f32_16x16x32_bf16 a[108:111], v[52:55], v[108:111], a[108:111]
    s_sub_u32 s34, s34, 1
    s_cbranch_scc1 L2_hk16
L2_hkr16:
    v_mfma_f32_16x16x32_bf16 a[104:107], v[52:55], v[104:107], a[104:107]
    ds_read_b128 v[36:39], v150 offset:9216
    v_mfma_f32_16x16x32_bf16 a[112:115], v[56:59], v[104:107], a[112:115]
    buffer_load_dwordx4 v152, s[12:15], s26 offen offset:3072 sc1 lds
    v_mfma_f32_16x16x32_bf16 a[116:119], v[56:59], v[108:111], a[116:119]
    ds_read_b128 v[40:43], v150 offset:10240
    v_mfma_f32_16x16x32_bf16 a[124:127], v[60:63], v[108:111], a[124:127]
    s_waitcnt lgkmcnt(7)
    s_xor_b32 s27, s27, 32768
    s_cmp_lg_u32 s30, s40
    v_mfma_f32_16x16x32_bf16 a[120:123], v[60:63], v[104:107], a[120:123]
    ds_read_b128 v[44:47], v150 offset:11264
    s_cbranch_vccnz L2_sl17
L2_slr17:
    s_cbranch_scc1 L2_loop
L2_last:
    s_cmp_lg_u32 s39, 0
    s_cbranch_scc1 L2_dt0
    s_waitcnt lgkmcnt(8)
    v_mfma_f32_16x16x32_bf16 a[0:3], v[0:3], v[96:99], a[0:3]
    v_add_f32 v146, v146, v144
    v_add_f32 v147, v147, v145
    v_mfma_f32_16x16x32_bf16 a[4:7], v[0:3], v[100:103], a[4:7]
    ds_read_b128 v[48:51], v150 offset:12288
    v_mfma_f32_16x16x32_bf16 a[12:15], v[4:7], v[100:103], a[12:15]
    v_exp_f32 v112, v80
    v_mfma_f32_16x16x32_bf16 a[8:11], v[4:7], v[96:99], a[8:11]
    ds_read_b128 v[52:55], v150 offset:13312
    v_mfma_f32_16x16x32_bf16 a[16:19], v[8:11], v[96:99], a[16:19]
    v_exp_f32 v113, v81
    v_mfma_f32_16x16x32_bf16 a[20:23], v[8:11], v[100:103], a[20:23]
    ds_read_b128 v[56:59], v150 offset:14336
    v_mfma_f32_16x16x32_bf16 a[28:31], v[12:15], v[100:103], a[28:31]
    v_exp_f32 v114, v82
    v_mfma_f32_16x16x32_bf16 a[24:27], v[12:15], v[96:99], a[24:27]
    ds_read_b128 v[60:63], v150 offset:15360
    s_waitcnt lgkmcnt(8)
    s_cmp_lg_u32 s35, 0
    s_cbranch_scc1 L2_np15
    s_waitcnt vmcnt(0)
    s_barrier
    s_cmp_lg_u32 s58, 0
    s_cbranch_scc1 Lpub17
    v_mov_b32 v161, s41
    s_mov_b64 exec, 1
    buffer_store_dword v161, off, s[16:19], s99 sc0 sc1
    s_mov_b64 exec, -1
Lpub17:
    s_branch L2_nq16
L2_np15:
    s_waitcnt vmcnt(20)
    s_barrier
L2_nq16:
    s_waitcnt vmcnt(8)
    s_mov_b32 s57, 1048576
Lpl18:
    v_cmp_ge_u32 s[50:51], v166, v165
    s_nop 1
    s_and_b32 s50, s50, 16777216
    s_cmp_eq_u32 s50, 16777216
    s_cbranch_scc1 Lpo19
    s_sub_u32 s57, s57, 1
    s_cbranch_scc1 Lpo19
    s_mov_b64 exec, 16777216
    buffer_load_dword v166, v164, s[16:19], 0 offen sc0 sc1
    s_mov_b64 exec, -1
    s_waitcnt vmcnt(0)
    s_branch Lpl18
Lpo19:
    v_mfma_f32_16x16x32_bf16 a[32:35], v[16:19], v[96:99], a[32:35]
    v_cvt_pk_bf16_f32 v104, v112, v113
    v_add_f32 v144, v112, v113
    v_mfma_f32_16x16x32_bf16 a[36:39], v[16:19], v[100:103], a[36:39]
    ds_read_b128 v[0:3], v150 offset:16384
    v_mfma_f32_16x16x32_bf16 a[44:47], v[20:23], v[100:103], a[44:47]
    s_mov_b32 m0, s28
    s_nop 0
    buffer_load_dwordx4 v152, s[8:11], s47 offen offset:0 sc1 lds
    v_exp_f32 v115, v83
    v_mfma_f32_16x16x32_bf16 a[40:43], v[20:23], v[96:99], a[40:43]
    ds_read_b128 v[4:7], v150 offset:17408
    v_mfma_f32_16x16x32_bf16 a[48:51], v[24:27], v[96:99], a[48:51]
    buffer_load_dwordx4 v152, s[8:11], s47 offen offset:1024 sc1 lds
    v_exp_f32 v116, v84
    v_mfma_f32_16x16x32_bf16 a[52:55], v[24:27], v[100:103], a[52:55]
    ds_read_b128 v[8:11], v150 offset:18432
    v_cvt_pk_bf16_f32 v105, v114, v115
    v_mfma_f32_16x16x32_bf16 a[60:63], v[28:31], v[100:103], a[60:63]
    v_add_f32 v144, v144, v114
    v_add_f32 v144, v144, v115
    v_mfma_f32_16x16x32_bf16 a[56:59], v[28:31], v[96:99], a[56:59]
    ds_read_b128 v[12:15], v150 offset:19456
    buffer_load_dwordx4 v152, s[8:11], s47 offen offset:2048 sc1 lds
    s_waitcnt lgkmcnt(8)
    v_mfma_f32_16x16x32_bf16 a[64:67], v[32:35], v[96:99], a[64:67]
    v_exp_f32 v117, v85
    v_mfma_f32_16x16x32_bf16 a[68:71], v[32:35], v[100:103], a[68:71]
    ds_read_b128 v[16:19], v150 offset:20480
    v_mfma_f32_16x16x32_bf16 a[76:79], v[36:39], v[100:103], a[76:79]
    buffer_load_dwordx4 v152, s[8:11], s47 offen offset:3072 sc1 lds
    s_mov_b32 s47, s26
    s_add_u32 s26, s26, 16384
    s_cmp_eq_u32 s26, s52
    s_cselect_b32 s26, 0, s26
    s_cselect_b32 s52, -1, s52
    v_exp_f32 v118, v86
    v_mfma_f32_16x16x32_bf16 a[72:75], v[36:39], v[96:99], a[72:75]
    ds_read_b128 v[20:23], v150 offset:21504
    v_cvt_pk_bf16_f32 v106, v116, v117
    v_mfma_f32_16x16x32_bf16 a[80:83], v[40:43], v[96:99], a[80:83]
    s_lshl_b32 s4, s23, 20
    s_lshl_b32 s5, s24, 16
    s_add_u32 s4, s4, s5
    s_lshl_b32 s5, s58, 13
    s_add_u32 s4, s4, s5
    buffer_load_dwordx4 a[128:131], v155, s[16:19], s4 offen offset:0 sc0 sc1
    v_add_f32 v144, v144, v116
    v_add_f32 v144, v144, v117
    v_mfma_f32_16x16x32_bf16 a[84:87], v[40:43], v[100:103], a[84:87]
    ds_read_b128 v[24:27], v150 offset:22528
    v_mfma_f32_16x16x32_bf16 a[92:95], v[44:47], v[100:103], a[92:95]
    v_exp_f32 v119, v87
    v_mfma_f32_16x16x32_bf16 a[88:91], v[44:47], v[96:99], a[88:91]
    ds_read_b128 v[28:31], v150 offset:23552
    buffer_load_dwordx4 a[132:135], v155, s[16:19], s4 offen offset:1024 sc0 sc1
    s_waitcnt lgkmcnt(8)
    v_mfma_f32_16x16x32_bf16 a[96:99], v[48:51], v[96:99], a[96:99]
    v_exp_f32 v120, v88
    v_mfma_f32_16x16x32_bf16 a[100:103], v[48:51], v[100:103], a[100:103]
    ds_read_b128 v[32:35], v150 offset:24576
    v_cvt_pk_bf16_f32 v107, v118, v119
    v_mfma_f32_16x16x32_bf16 a[108:111], v[52:55], v[100:103], a[108:111]
    buffer_load_dwordx4 a[136:139], v155, s[16:19], s4 offen offset:2048 sc0 sc1
    v_add_f32 v144, v144, v118
    v_add_f32 v144, v144, v119
    v_mfma_f32_16x16x32_bf16 a[104:107], v[52:55], v[96:99], a[104:107]
    ds_read_b128 v[36:39], v150 offset:25600
    v_mfma_f32_16x16x32_bf16 a[112:115], v[56:59], v[96:99], a[112:115]
    buffer_load_dwordx4 a[140:143], v155, s[16:19], s4 offen offset:3072 sc0 sc1
    v_exp_f32 v121, v89
    v_mfma_f32_16x16x32_bf16 a[116:119], v[56:59], v[100:103], a[116:119]
    ds_read_b128 v[40:43], v150 offset:26624
    v_mfma_f32_16x16x32_bf16 a[124:127], v[60:63], v[100:103], a[124:127]
    v_exp_f32 v122, v90
    v_mfma_f32_16x16x32_bf16 a[120:123], v[60:63], v[96:99], a[120:123]
    ds_read_b128 v[44:47], v150 offset:27648
    v_cvt_pk_bf16_f32 v108, v120, v121
    v_add_f32 v145, v120, v121
    v_exp_f32 v123, v91
    v_exp_f32 v124, v92
    v_cvt_pk_bf16_f32 v109, v122, v123
    v_add_f32 v145, v145, v122
    v_add_f32 v145, v145, v123
    v_exp_f32 v125, v93
    v_exp_f32 v126, v94
    v_cvt_pk_bf16_f32 v110, v124, v125
    v_add_f32 v145, v145, v124
    v_add_f32 v145, v145, v125
    v_exp_f32 v127, v95
    s_nop 0
    v_cvt_pk_bf16_f32 v111, v126, v127
    v_add_f32 v145, v145, v126
    v_add_f32 v145, v145, v127
    v_max_f32 v172, v144, v145
    v_cmp_lt_f32 vcc, s33, v172
    s_add_u32 s4, s4, 4096
    buffer_load_dwordx4 a[144:147], v155, s[16:19], s4 offen offset:0 sc0 sc1
    s_cbranch_vccnz L2_sl18
L2_slr18:
    v_add_f32 v146, v146, v144
    v_add_f32 v147, v147, v145
    s_waitcnt lgkmcnt(8)
    v_mfma_f32_16x16x32_bf16 a[0:3], v[0:3], v[104:107], a[0:3]
    v_mfma_f32_16x16x32_bf16 a[4:7], v[0:3], v[108:111], a[4:7]
    ds_read_b128 v[48:51], v150 offset:28672
    v_mfma_f32_16x16x32_bf16 a[12:15], v[4:7], v[108:111], a[12:15]
    buffer_load_dwordx4 a[148:151], v155, s[16:19], s4 offen offset:1024 sc0 sc1
    v_mfma_f32_16x16x32_bf16 a[8:11], v[4:7], v[104:107], a[8:11]
    ds_read_b128 v[52:55], v150 offset:29696
    v_mfma_f32_16x16x32_bf16 a[16:19], v[8:11], v[104:107], a[16:19]
    v_mfma_f32_16x16x32_bf16 a[20:23], v[8:11], v[108:111], a[20:23]
    ds_read_b128 v[56:59], v150 offset:30720
    buffer_load_dwordx4 a[152:155], v155, s[16:19], s4 offen offset:2048 sc0 sc1
    v_mfma_f32_16x16x32_bf16 a[28:31], v[12:15], v[108:111], a[28:31]
    v_mfma_f32_16x16x32_bf16 a[24:27], v[12:15], v[104:107], a[24:27]
    ds_read_b128 v[60:63], v150 offset:31744
    buffer_load_dwordx4 a[156:159], v155, s[16:19], s4 offen offset:3072 sc0 sc1
    s_waitcnt lgkmcnt(8)
    v_mfma_f32_16x16x32_bf16 a[32:35], v[16:19], v[104:107], a[32:35]
    v_mfma_f32_16x16x32_bf16 a[36:39], v[16:19], v[108:111], a[36:39]
    v_mfma_f32_16x16x32_bf16 a[44:47], v[20:23], v[108:111], a[44:47]
    s_add_u32 s4, s4, 28672
    buffer_load_dwordx4 a[160:163], v155, s[16:19], s4 offen offset:0 sc0 sc1
    v_mfma_f32_16x16x32_bf16 a[40:43], v[20:23], v[104:107], a[40:43]
    v_mfma_f32_16x16x32_bf16 a[48:51], v[24:27], v[104:107], a[48:51]
    v_mfma_f32_16x16x32_bf16 a[52:55], v[24:27], v[108:111], a[52:55]
    buffer_load_dwordx4 a[164:167], v155, s[16:19], s4 offen offset:1024 sc0 sc1
    v_mfma_f32_16x16x32_bf16 a[60:63], v[28:31], v[108:111], a[60:63]
    v_mfma_f32_16x16x32_bf16 a[56:59], v[28:31], v[104:107], a[56:59]
    buffer_load_dwordx4 a[168:171], v155, s[16:19], s4 offen offset:2048 sc0 sc1
    s_waitcnt lgkmcnt(4)
    v_mfma_f32_16x16x32_bf16 a[64:67], v[32:35], v[104:107], a[64:67]
    v_mfma_f32_16x16x32_bf16 a[68:71], v[32:35], v[108:111], a[68:71]
    v_mfma_f32_16x16x32_bf16 a[76:79], v[36:39], v[108:111], a[76:79]
    buffer_load_dwordx4 a[172:175], v155, s[16:19], s4 offen offset:3072 sc0 sc1
    v_mfma_f32_16x16x32_bf16 a[72:75], v[36:39], v[104:107], a[72:75]
    v_mfma_f32_16x16x32_bf16 a[80:83], v[40:43], v[104:107], a[80:83]
    v_mfma_f32_16x16x32_bf16 a[84:87], v[40:43], v[108:111], a[84:87]
    s_add_u32 s4, s4, 4096
    buffer_load_dwordx4 a[176:179], v155, s[16:19], s4 offen offset:0 sc0 sc1
    v_mfma_f32_16x16x32_bf16 a[92:95], v[44:47], v[108:111], a[92:95]
    v_mfma_f32_16x16x32_bf16 a[88:91], v[44:47], v[104:107], a[88:91]
    buffer_load_dwordx4 a[180:183], v155, s[16:19], s4 offen offset:1024 sc0 sc1
    s_waitcnt lgkmcnt(0)
    v_mfma_f32_16x16x32_bf16 a[96:99], v[48:51], v[104:107], a[96:99]
    v_mfma_f32_16x16x32_bf16 a[100:103], v[48:51], v[108:111], a[100:103]
    v_mfma_f32_16x16x32_bf16 a[108:111], v[52:55], v[108:111], a[108:111]
    buffer_load_dwordx4 a[184:187], v155, s[16:19], s4 offen offset:2048 sc0 sc1
    v_mfma_f32_16x16x32_bf16 a[104:107], v[52:55], v[104:107], a[104:107]
    v_mfma_f32_16x16x32_bf16 a[112:115], v[56:59], v[104:107], a[112:115]
    v_mfma_f32_16x16x32_bf16 a[116:119], v[56:59], v[108:111], a[116:119]
    buffer_load_dwordx4 a[188:191], v155, s[16:19], s4 offen offset:3072 sc0 sc1
    v_mfma_f32_16x16x32_bf16 a[124:127], v[60:63], v[108:111], a[124:127]
    v_mfma_f32_16x16x32_bf16 a[120:123], v[60:63], v[104:107], a[120:123]
    v_mov_b32 v172, v146
    s_nop 1
    v_permlane32_swap_b32 v146, v172
    s_nop 1
    v_add_f32 v146, v146, v172
    v_mov_b32 v172, v146
    s_nop 1
    v_permlane16_swap_b32 v146, v172
    s_nop 1
    v_add_f32 v146, v146, v172
    v_mov_b32 v172, v147
    s_nop 1
    v_permlane32_swap_b32 v147, v172
    s_nop 1
    v_add_f32 v147, v147, v172
    v_mov_b32 v172, v147
    s_nop 1
    v_permlane16_swap_b32 v147, v172
    s_nop 1
    v_add_f32 v147, v147, v172
    s_mov_b32 s36, s24
    s_lshl_b32 s38, s24, 2
    s_add_u32 s38, s38, 4
    s_sub_u32 s42, s38, 7
    s_lshl_b32 s14, s38, 14
    s_mov_b32 s10, s14
    s_mov_b32 s39, 2
    s_mov_b32 s40, 1
    s_mov_b32 s35, 0
    s_mov_b32 s41, 3
    s_add_u32 s29, s29, 32768
    s_cmp_ge_u32 s29, 163840
    s_cselect_b32 s29, 65536, s29
    s_add_u32 s4, s44, 16384
    buffer_store_dwordx4 v[146:149], v155, s[16:19], s4 offen sc0 sc1
    s_mov_b32 s98, s44
    s_mov_b32 s35, 4096
    s_sub_u32 s42, s38, 11
    v_add_u32 v156, 2048, v155
    v_accvgpr_read_b32 v0, a0
    v_accvgpr_read_b32 v1, a1
    v_accvgpr_read_b32 v2, a2
    v_accvgpr_read_b32 v3, a3
    v_accvgpr_read_b32 v4, a8
    v_accvgpr_read_b32 v5, a9
    v_accvgpr_read_b32 v6, a10
    v_accvgpr_read_b32 v7, a11
    v_cvt_pk_bf16_f32 v192, v0, v1
    v_cvt_pk_bf16_f32 v193, v2, v3
    v_cvt_pk_bf16_f32 v194, v4, v5
    v_cvt_pk_bf16_f32 v195, v6, v7
    v_accvgpr_read_b32 v8, a4
    v_accvgpr_read_b32 v9, a5
    v_accvgpr_read_b32 v10, a6
    v_accvgpr_read_b32 v11, a7
    v_accvgpr_read_b32 v12, a12
    v_accvgpr_read_b32 v13, a13
    v_accvgpr_read_b32 v14, a14
    v_accvgpr_read_b32 v15, a15
    v_cvt_pk_bf16_f32 v196, v8, v9
    v_cvt_pk_bf16_f32 v197, v10, v11
    v_cvt_pk_bf16_f32 v198, v12, v13
    v_cvt_pk_bf16_f32 v199, v14, v15
    v_accvgpr_read_b32 v16, a16
    v_accvgpr_read_b32 v17, a17
    v_accvgpr_read_b32 v18, a18
    v_accvgpr_read_b32 v19, a19
    v_accvgpr_read_b32 v20, a24
    v_accvgpr_read_b32 v21, a25
    v_accvgpr_read_b32 v22, a26
    v_accvgpr_read_b32 v23, a27
    v_cvt_pk_bf16_f32 v200, v16, v17
    v_cvt_pk_bf16_f32 v201, v18, v19
    v_cvt_pk_bf16_f32 v202, v20, v21
    v_cvt_pk_bf16_f32 v203, v22, v23
    v_accvgpr_read_b32 v24, a20
    v_accvgpr_read_b32 v25, a21
    v_accvgpr_read_b32 v26, a22
    v_accvgpr_read_b32 v27, a23
    v_accvgpr_read_b32 v28, a28
    v_accvgpr_read_b32 v29, a29
    v_accvgpr_read_b32 v30, a30
    v_accvgpr_read_b32 v31, a31
    v_cvt_pk_bf16_f32 v204, v24, v25
    v_cvt_pk_bf16_f32 v205, v26, v27
    v_cvt_pk_bf16_f32 v206, v28, v29
    v_cvt_pk_bf16_f32 v207, v30, v31
    v_accvgpr_read_b32 v32, a32
    v_accvgpr_read_b32 v33, a33
    v_accvgpr_read_b32 v34, a34
    v_accvgpr_read_b32 v35, a35
    v_accvgpr_read_b32 v36, a40
    v_accvgpr_read_b32 v37, a41
    v_accvgpr_read_b32 v38, a42
    v_accvgpr_read_b32 v39, a43
    v_cvt_pk_bf16_f32 v208, v32, v33
    v_cvt_pk_bf16_f32 v209, v34, v35
    v_cvt_pk_bf16_f32 v210, v36, v37
    v_cvt_pk_bf16_f32 v211, v38, v39
    v_accvgpr_read_b32 v40, a36
    v_accvgpr_read_b32 v41, a37
    v_accvgpr_read_b32 v42, a38
    v_accvgpr_read_b32 v43, a39
    v_accvgpr_read_b32 v44, a44
    v_accvgpr_read_b32 v45, a45
    v_accvgpr_read_b32 v46, a46
    v_accvgpr_read_b32 v47, a47
    v_cvt_pk_bf16_f32 v212, v40, v41
    v_cvt_pk_bf16_f32 v213, v42, v43
    v_cvt_pk_bf16_f32 v214, v44, v45
    v_cvt_pk_bf16_f32 v215, v46, v47
    v_accvgpr_read_b32 v48, a48
    v_accvgpr_read_b32 v49, a49
    v_accvgpr_read_b32 v50, a50
    v_accvgpr_read_b32 v51, a51
    v_accvgpr_read_b32 v52, a56
    v_accvgpr_read_b32 v53, a57
    v_accvgpr_read_b32 v54, a58
    v_accvgpr_read_b32 v55, a59
    v_cvt_pk_bf16_f32 v216, v48, v49
    v_cvt_pk_bf16_f32 v217, v50, v51
    v_cvt_pk_bf16_f32 v218, v52, v53
    v_cvt_pk_bf16_f32 v219, v54, v55
    v_accvgpr_read_b32 v56, a52
    v_accvgpr_read_b32 v57, a53
    v_accvgpr_read_b32 v58, a54
    v_accvgpr_read_b32 v59, a55
    v_accvgpr_read_b32 v60, a60
    v_accvgpr_read_b32 v61, a61
    v_accvgpr_read_b32 v62, a62
    v_accvgpr_read_b32 v63, a63
    v_cvt_pk_bf16_f32 v220, v56, v57
    v_cvt_pk_bf16_f32 v221, v58, v59
    v_cvt_pk_bf16_f32 v222, v60, v61
    v_cvt_pk_bf16_f32 v223, v62, v63
    v_accvgpr_read_b32 v0, a64
    v_accvgpr_read_b32 v1, a65
    v_accvgpr_read_b32 v2, a66
    v_accvgpr_read_b32 v3, a67
    v_accvgpr_read_b32 v4, a72
    v_accvgpr_read_b32 v5, a73
    v_accvgpr_read_b32 v6, a74
    v_accvgpr_read_b32 v7, a75
    v_cvt_pk_bf16_f32 v224, v0, v1
    v_cvt_pk_bf16_f32 v225, v2, v3
    v_cvt_pk_bf16_f32 v226, v4, v5
    v_cvt_pk_bf16_f32 v227, v6, v7
    v_accvgpr_read_b32 v8, a68
    v_accvgpr_read_b32 v9, a69
    v_accvgpr_read_b32 v10, a70
    v_accvgpr_read_b32 v11, a71
    v_accvgpr_read_b32 v12, a76
    v_accvgpr_read_b32 v13, a77
    v_accvgpr_read_b32 v14, a78
    v_accvgpr_read_b32 v15, a79
    v_cvt_pk_bf16_f32 v228, v8, v9
    v_cvt_pk_bf16_f32 v229, v10, v11
    v_cvt_pk_bf16_f32 v230, v12, v13
    v_cvt_pk_bf16_f32 v231, v14, v15
    v_accvgpr_read_b32 v16, a80
    v_accvgpr_read_b32 v17, a81
    v_accvgpr_read_b32 v18, a82
    v_accvgpr_read_b32 v19, a83
    v_accvgpr_read_b32 v20, a88
    v_accvgpr_read_b32 v21, a89
    v_accvgpr_read_b32 v22, a90
    v_accvgpr_read_b32 v23, a91
    v_cvt_pk_bf16_f32 v232, v16, v17
    v_cvt_pk_bf16_f32 v233, v18, v19
    v_cvt_pk_bf16_f32 v234, v20, v21
    v_cvt_pk_bf16_f32 v235, v22, v23
    v_accvgpr_read_b32 v24, a84
    v_accvgpr_read_b32 v25, a85
    v_accvgpr_read_b32 v26, a86
    v_accvgpr_read_b32 v27, a87
    v_accvgpr_read_b32 v28, a92
    v_accvgpr_read_b32 v29, a93
    v_accvgpr_read_b32 v30, a94
    v_accvgpr_read_b32 v31, a95
    v_cvt_pk_bf16_f32 v236, v24, v25
    v_cvt_pk_bf16_f32 v237, v26, v27
    v_cvt_pk_bf16_f32 v238, v28, v29
    v_cvt_pk_bf16_f32 v239, v30, v31
    v_accvgpr_read_b32 v32, a96
    v_accvgpr_read_b32 v33, a97
    v_accvgpr_read_b32 v34, a98
    v_accvgpr_read_b32 v35, a99
    v_accvgpr_read_b32 v36, a104
    v_accvgpr_read_b32 v37, a105
    v_accvgpr_read_b32 v38, a106
    v_accvgpr_read_b32 v39, a107
    v_cvt_pk_bf16_f32 v240, v32, v33
    v_cvt_pk_bf16_f32 v241, v34, v35
    v_cvt_pk_bf16_f32 v242, v36, v37
    v_cvt_pk_bf16_f32 v243, v38, v39
    v_accvgpr_read_b32 v40, a100
    v_accvgpr_read_b32 v41, a101
    v_accvgpr_read_b32 v42, a102
    v_accvgpr_read_b32 v43, a103
    v_accvgpr_read_b32 v44, a108
    v_accvgpr_read_b32 v45, a109
    v_accvgpr_read_b32 v46, a110
    v_accvgpr_read_b32 v47, a111
    v_cvt_pk_bf16_f32 v244, v40, v41
    v_cvt_pk_bf16_f32 v245, v42, v43
    v_cvt_pk_bf16_f32 v246, v44, v45
    v_cvt_pk_bf16_f32 v247, v46, v47
    v_accvgpr_read_b32 v48, a112
    v_accvgpr_read_b32 v49, a113
    v_accvgpr_read_b32 v50, a114
    v_accvgpr_read_b32 v51, a115
    v_accvgpr_read_b32 v52, a120
    v_accvgpr_read_b32 v53, a121
    v_accvgpr_read_b32 v54, a122
    v_accvgpr_read_b32 v55, a123
    v_cvt_pk_bf16_f32 v248, v48, v49
    v_cvt_pk_bf16_f32 v249, v50, v51
    v_cvt_pk_bf16_f32 v250, v52, v53
    v_cvt_pk_bf16_f32 v251, v54, v55
    v_accvgpr_read_b32 v56, a116
    v_accvgpr_read_b32 v57, a117
    v_accvgpr_read_b32 v58, a118
    v_accvgpr_read_b32 v59, a119
    v_accvgpr_read_b32 v60, a124
    v_accvgpr_read_b32 v61, a125
    v_accvgpr_read_b32 v62, a126
    v_accvgpr_read_b32 v63, a127
    v_cvt_pk_bf16_f32 v252, v56, v57
    v_cvt_pk_bf16_f32 v253, v58, v59
    v_cvt_pk_bf16_f32 v254, v60, v61
    v_cvt_pk_bf16_f32 v255, v62, v63
    s_waitcnt vmcnt(1)
    s_branch L2_seg
L2_short:
    buffer_store_dwordx4 v[208:211], v155, s[16:19], s98 offen offset:0 sc0 sc1
    v_accvgpr_write_b32 a0, 0
    v_accvgpr_write_b32 a1, 0
    v_accvgpr_write_b32 a2, 0
    v_accvgpr_write_b32 a3, 0
    v_accvgpr_write_b32 a4, 0
    v_accvgpr_write_b32 a5, 0
    v_accvgpr_write_b32 a6, 0
    v_accvgpr_write_b32 a7, 0
    v_accvgpr_write_b32 a8, 0
    v_accvgpr_write_b32 a9, 0
    v_accvgpr_write_b32 a10, 0
    buffer_store_dwordx4 v[212:215], v155, s[16:19], s98 offen offset:1024 sc0 sc1
    v_accvgpr_write_b32 a11, 0
    v_accvgpr_write_b32 a12, 0
    v_accvgpr_write_b32 a13, 0
    v_accvgpr_write_b32 a14, 0
    v_accvgpr_write_b32 a15, 0
    v_accvgpr_write_b32 a16, 0
    v_accvgpr_write_b32 a17, 0
    v_accvgpr_write_b32 a18, 0
    v_accvgpr_write_b32 a19, 0
    v_accvgpr_write_b32 a20, 0
    v_accvgpr_write_b32 a21, 0
    buffer_store_dwordx4 v[216:219], v156, s[16:19], s98 offen offset:0 sc0 sc1
    v_accvgpr_write_b32 a22, 0
    v_accvgpr_write_b32 a23, 0
    v_accvgpr_write_b32 a24, 0
    v_accvgpr_write_b32 a25, 0
    v_accvgpr_write_b32 a26, 0
    v_accvgpr_write_b32 a27, 0
    v_accvgpr_write_b32 a28, 0
    v_accvgpr_write_b32 a29, 0
    v_accvgpr_write_b32 a30, 0
    v_accvgpr_write_b32 a31, 0
    buffer_store_dwordx4 v[220:223], v156, s[16:19], s98 offen offset:1024 sc0 sc1
    s_add_u32 s98, s98, s20
    v_accvgpr_write_b32 a32, 0
    v_accvgpr_write_b32 a33, 0
    v_accvgpr_write_b32 a34, 0
    v_accvgpr_write_b32 a35, 0
    v_accvgpr_write_b32 a36, 0
    v_accvgpr_write_b32 a37, 0
    v_accvgpr_write_b32 a38, 0
    v_accvgpr_write_b32 a39, 0
    v_accvgpr_write_b32 a40, 0
    v_accvgpr_write_b32 a41, 0
    v_accvgpr_write_b32 a42, 0
    buffer_store_dwordx4 v[224:227], v155, s[16:19], s98 offen offset:0 sc0 sc1
    v_accvgpr_write_b32 a43, 0
    v_accvgpr_write_b32 a44, 0
    v_accvgpr_write_b32 a45, 0
    v_accvgpr_write_b32 a46, 0
    v_accvgpr_write_b32 a47, 0
    v_accvgpr_write_b32 a48, 0
    v_accvgpr_write_b32 a49, 0
    v_accvgpr_write_b32 a50, 0
    v_accvgpr_write_b32 a51, 0
    v_accvgpr_write_b32 a52, 0
    v_accvgpr_write_b32 a53, 0
    buffer_store_dwordx4 v[228:231], v155, s[16:19], s98 offen offset:1024 sc0 sc1
    v_accvgpr_write_b32 a54, 0
    v_accvgpr_write_b32 a55, 0
    v_accvgpr_write_b32 a56, 0
    v_accvgpr_write_b32 a57, 0
    v_accvgpr_write_b32 a58, 0
    v_accvgpr_write_b32 a59, 0
    v_accvgpr_write_b32 a60, 0
    v_accvgpr_write_b32 a61, 0
    v_accvgpr_write_b32 a62, 0
    v_accvgpr_write_b32 a63, 0
    buffer_store_dwordx4 v[232:235], v156, s[16:19], s98 offen offset:0 sc0 sc1
    v_accvgpr_write_b32 a64, 0
    v_accvgpr_write_b32 a65, 0
    v_accvgpr_write_b32 a66, 0
    v_accvgpr_write_b32 a67, 0
    v_accvgpr_write_b32 a68, 0
    v_accvgpr_write_b32 a69, 0
    v_accvgpr_write_b32 a70, 0
    v_accvgpr_write_b32 a71, 0
    v_accvgpr_write_b32 a72, 0
    v_accvgpr_write_b32 a73, 0
    v_accvgpr_write_b32 a74, 0
    buffer_store_dwordx4 v[236:239], v156, s[16:19], s98 offen offset:1024 sc0 sc1
    s_add_u32 s98, s98, s20
    v_accvgpr_write_b32 a75, 0
    v_accvgpr_write_b32 a76, 0
    v_accvgpr_write_b32 a77, 0
    v_accvgpr_write_b32 a78, 0
    v_accvgpr_write_b32 a79, 0
    v_accvgpr_write_b32 a80, 0
    v_accvgpr_write_b32 a81, 0
    v_accvgpr_write_b32 a82, 0
    v_accvgpr_write_b32 a83, 0
    v_accvgpr_write_b32 a84, 0
    v_accvgpr_write_b32 a85, 0
    buffer_store_dwordx4 v[240:243], v155, s[16:19], s98 offen offset:0 sc0 sc1
    v_accvgpr_write_b32 a86, 0
    v_accvgpr_write_b32 a87, 0
    v_accvgpr_write_b32 a88, 0
    v_accvgpr_write_b32 a89, 0
    v_accvgpr_write_b32 a90, 0
    v_accvgpr_write_b32 a91, 0
    v_accvgpr_write_b32 a92, 0
    v_accvgpr_write_b32 a93, 0
    v_accvgpr_write_b32 a94, 0
    v_accvgpr_write_b32 a95, 0
    buffer_store_dwordx4 v[244:247], v155, s[16:19], s98 offen offset:1024 sc0 sc1
    v_accvgpr_write_b32 a96, 0
    v_accvgpr_write_b32 a97, 0
    v_accvgpr_write_b32 a98, 0
    v_accvgpr_write_b32 a99, 0
    v_accvgpr_write_b32 a100, 0
    v_accvgpr_write_b32 a101, 0
    v_accvgpr_write_b32 a102, 0
    v_accvgpr_write_b32 a103, 0
    v_accvgpr_write_b32 a104, 0
    v_accvgpr_write_b32 a105, 0
    v_accvgpr_write_b32 a106, 0
    buffer_store_dwordx4 v[248:251], v156, s[16:19], s98 offen offset:0 sc0 sc1
    v_accvgpr_write_b32 a107, 0
    v_accvgpr_write_b32 a108, 0
    v_accvgpr_write_b32 a109, 0
    v_accvgpr_write_b32 a110, 0
    v_accvgpr_write_b32 a111, 0
    v_accvgpr_write_b32 a112, 0
    v_accvgpr_write_b32 a113, 0
    v_accvgpr_write_b32 a114, 0
    v_accvgpr_write_b32 a115, 0
    v_accvgpr_write_b32 a116, 0
    v_accvgpr_write_b32 a117, 0
    buffer_store_dwordx4 v[252:255], v156, s[16:19], s98 offen offset:1024 sc0 sc1
    s_add_u32 s98, s98, s20
    v_accvgpr_write_b32 a118, 0
    v_accvgpr_write_b32 a119, 0
    v_accvgpr_write_b32 a120, 0
    v_accvgpr_write_b32 a121, 0
    v_accvgpr_write_b32 a122, 0
    v_accvgpr_write_b32 a123, 0
    v_accvgpr_write_b32 a124, 0
    v_accvgpr_write_b32 a125, 0
    v_accvgpr_write_b32 a126, 0
    v_accvgpr_write_b32 a127, 0
    s_mov_b64 exec, 43782144
    buffer_load_dword v166, v164, s[16:19], 0 offen sc0 sc1
    s_mov_b64 exec, -1
    s_add_u32 s29, s29, 32768
    s_cmp_ge_u32 s29, 163840
    s_cselect_b32 s29, 65536, s29
    v_add_u32 v151, s29, v155
    v_mov_b32 v175, s49
    v_cmp_gt_i32 s[50:51], 0, v162
    v_cmp_gt_i32 s[54:55], 1, v162
    s_nop 0
    v_cndmask_b32 v136, v136, v175, s[50:51]
    v_cndmask_b32 v137, v137, v175, s[54:55]
    v_cmp_gt_i32 s[50:51], 2, v162
    v_cmp_gt_i32 s[54:55], 3, v162
    s_nop 0
    v_cndmask_b32 v138, v138, v175, s[50:51]
    v_cndmask_b32 v139, v139, v175, s[54:55]
    v_cmp_gt_i32 s[50:51], 16, v162
    v_cmp_gt_i32 s[54:55], 17, v162
    s_nop 0
    v_cndmask_b32 v140, v140, v175, s[50:51]
    v_cndmask_b32 v141, v141, v175, s[54:55]
    v_cmp_gt_i32 s[50:51], 18, v162
    v_cmp_gt_i32 s[54:55], 19, v162
    s_nop 0
    v_cndmask_b32 v142, v142, v175, s[50:51]
    v_cndmask_b32 v143, v143, v175, s[54:55]
    s_branch L2_dt
L2_dt0:
    s_mov_b64 exec, 43782144
    buffer_load_dword v166, v164, s[16:19], 0 offen sc0 sc1
    s_mov_b64 exec, -1
    s_add_u32 s29, s29, 32768
    s_cmp_ge_u32 s29, 163840
    s_cselect_b32 s29, 65536, s29
    v_add_u32 v151, s29, v155
    v_mov_b32 v175, s49
    v_cmp_gt_i32 s[50:51], 0, v162
    v_cmp_gt_i32 s[54:55], 1, v162
    s_nop 0
    v_cndmask_b32 v136, v136, v175, s[50:51]
    v_cndmask_b32 v137, v137, v175, s[54:55]
    v_cmp_gt_i32 s[50:51], 2, v162
    v_cmp_gt_i32 s[54:55], 3, v162
    s_nop 0
    v_cndmask_b32 v138, v138, v175, s[50:51]
    v_cndmask_b32 v139, v139, v175, s[54:55]
    v_cmp_gt_i32 s[50:51], 16, v162
    v_cmp_gt_i32 s[54:55], 17, v162
    s_nop 0
    v_cndmask_b32 v140, v140, v175, s[50:51]
    v_cndmask_b32 v141, v141, v175, s[54:55]
    v_cmp_gt_i32 s[50:51], 18, v162
    v_cmp_gt_i32 s[54:55], 19, v162
    s_nop 0
    v_cndmask_b32 v142, v142, v175, s[50:51]
    v_cndmask_b32 v143, v143, v175, s[54:55]
L2_dt:
    s_waitcnt lgkmcnt(8)
    v_mfma_f32_16x16x32_bf16 v[72:75], v[0:3], a[160:163], v[136:139]
    ds_read_b128 v[48:51], v150 offset:12288
    v_add_f32 v146, v146, v144
    v_mfma_f32_16x16x32_bf16 v[72:75], v[4:7], a[164:167], v[72:75]
    ds_read_b128 v[52:55], v150 offset:13312
    v_add_f32 v147, v147, v145
    v_mfma_f32_16x16x32_bf16 v[72:75], v[8:11], a[168:171], v[72:75]
    ds_read_b128 v[56:59], v150 offset:14336
    v_exp_f32 v112, v80
    v_mfma_f32_16x16x32_bf16 v[72:75], v[12:15], a[172:175], v[72:75]
    ds_read_b128 v[60:63], v150 offset:15360
    v_exp_f32 v113, v81
    s_waitcnt lgkmcnt(8)
    v_mfma_f32_16x16x32_bf16 v[72:75], v[16:19], a[176:179], v[72:75]
    ds_read_b128 v[0:3], v151 offset:0
    v_cvt_pk_bf16_f32 v104, v112, v113
    v_mfma_f32_16x16x32_bf16 v[72:75], v[20:23], a[180:183], v[72:75]
    ds_read_b128 v[4:7], v151 offset:1024
    v_add_f32 v144, v112, v113
    v_mfma_f32_16x16x32_bf16 v[72:75], v[24:27], a[184:187], v[72:75]
    ds_read_b128 v[8:11], v151 offset:2048
    v_exp_f32 v114, v82
    v_mfma_f32_16x16x32_bf16 v[72:75], v[28:31], a[188:191], v[72:75]
    ds_read_b128 v[12:15], v151 offset:3072
    v_exp_f32 v115, v83
    s_waitcnt lgkmcnt(8)
    v_mfma_f32_16x16x32_bf16 v[76:79], v[32:35], a[160:163], v[140:143]
    ds_read_b128 v[16:19], v151 offset:4096
    v_cvt_pk_bf16_f32 v105, v114, v115
    v_mfma_f32_16x16x32_bf16 v[76:79], v[36:39], a[164:167], v[76:79]
    ds_read_b128 v[20:23], v151 offset:5120
    v_add_f32 v144, v144, v114
    v_mfma_f32_16x16x32_bf16 v[76:79], v[40:43], a[168:171], v[76:79]
    ds_read_b128 v[24:27], v151 offset:6144
    v_add_f32 v144, v144, v115
    v_mfma_f32_16x16x32_bf16 v[76:79], v[44:47], a[172:175], v[76:79]
    ds_read_b128 v[28:31], v151 offset:7168
    v_exp_f32 v116, v84
    s_waitcnt lgkmcnt(8)
    v_mfma_f32_16x16x32_bf16 v[76:79], v[48:51], a[176:179], v[76:79]
    ds_read_b128 v[32:35], v151 offset:8192
    v_exp_f32 v117, v85
    v_mfma_f32_16x16x32_bf16 v[76:79], v[52:55], a[180:183], v[76:79]
    ds_read_b128 v[36:39], v151 offset:9216
    v_cvt_pk_bf16_f32 v106, v116, v117
    v_mfma_f32_16x16x32_bf16 v[76:79], v[56:59], a[184:187], v[76:79]
    ds_read_b128 v[40:43], v151 offset:10240
    v_add_f32 v144, v144, v116
    v_mfma_f32_16x16x32_bf16 v[76:79], v[60:63], a[188:191], v[76:79]
    ds_read_b128 v[44:47], v151 offset:11264
    v_add_f32 v144, v144, v117
    s_waitcnt lgkmcnt(8)
    v_mfma_f32_16x16x32_bf16 a[0:3], v[0:3], v[96:99], a[0:3]
    v_exp_f32 v118, v86
    v_mfma_f32_16x16x32_bf16 a[4:7], v[0:3], v[100:103], a[4:7]
    ds_read_b128 v[48:51], v151 offset:12288
    v_mfma_f32_16x16x32_bf16 a[12:15], v[4:7], v[100:103], a[12:15]
    v_exp_f32 v119, v87
    v_mfma_f32_16x16x32_bf16 a[8:11], v[4:7], v[96:99], a[8:11]
    ds_read_b128 v[52:55], v151 offset:13312
    v_cvt_pk_bf16_f32 v107, v118, v119
    v_mfma_f32_16x16x32_bf16 a[16:19], v[8:11], v[96:99], a[16:19]
    v_exp_f32 v120, v88
    v_mfma_f32_16x16x32_bf16 a[20:23], v[8:11], v[100:103], a[20:23]
    ds_read_b128 v[56:59], v151 offset:14336
    v_add_f32 v144, v144, v118
    v_mfma_f32_16x16x32_bf16 a[28:31], v[12:15], v[100:103], a[28:31]
    v_exp_f32 v121, v89
    v_mfma_f32_16x16x32_bf16 a[24:27], v[12:15], v[96:99], a[24:27]
    ds_read_b128 v[60:63], v151 offset:15360
    v_add_f32 v144, v144, v119
    s_waitcnt lgkmcnt(8)
    s_cmp_lg_u32 s35, 0
    s_cbranch_scc1 L2_np20
    s_waitcnt vmcnt(0)
    s_barrier
    s_cmp_lg_u32 s58, 0
    s_cbranch_scc1 Lpub22
    v_mov_b32 v161, s41
    s_mov_b64 exec, 1
    buffer_store_dword v161, off, s[16:19], s99 sc0 sc1
    s_mov_b64 exec, -1
Lpub22:
    s_branch L2_nq21
L2_np20:
    s_waitcnt vmcnt(17)
    s_barrier
L2_nq21:
    v_mfma_f32_16x16x32_bf16 a[32:35], v[16:19], v[96:99], a[32:35]
    v_exp_f32 v122, v90
    v_mfma_f32_16x16x32_bf16 a[36:39], v[16:19], v[100:103], a[36:39]
    ds_read_b128 v[0:3], v150 offset:16384
    v_cvt_pk_bf16_f32 v108, v120, v121
    v_mfma_f32_16x16x32_bf16 a[44:47], v[20:23], v[100:103], a[44:47]
    v_exp_f32 v123, v91
    v_mfma_f32_16x16x32_bf16 a[40:43], v[20:23], v[96:99], a[40:43]
    ds_read_b128 v[4:7], v150 offset:17408
    v_add_f32 v145, v120, v121
    v_mfma_f32_16x16x32_bf16 a[48:51], v[24:27], v[96:99], a[48:51]
    v_exp_f32 v124, v92
    v_mfma_f32_16x16x32_bf16 a[52:55], v[24:27], v[100:103], a[52:55]
    ds_read_b128 v[8:11], v150 offset:18432
    v_cvt_pk_bf16_f32 v109, v122, v123
    v_mfma_f32_16x16x32_bf16 a[60:63], v[28:31], v[100:103], a[60:63]
    v_exp_f32 v125, v93
    v_mfma_f32_16x16x32_bf16 a[56:59], v[28:31], v[96:99], a[56:59]
    ds_read_b128 v[12:15], v150 offset:19456
    v_add_f32 v145, v145, v122
    s_waitcnt lgkmcnt(8)
    v_mfma_f32_16x16x32_bf16 a[64:67], v[32:35], v[96:99], a[64:67]
    v_exp_f32 v126, v94
    v_mfma_f32_16x16x32_bf16 a[68:71], v[32:35], v[100:103], a[68:71]
    ds_read_b128 v[16:19], v150 offset:20480
    v_add_f32 v145, v145, v123
    v_mfma_f32_16x16x32_bf16 a[76:79], v[36:39], v[100:103], a[76:79]
    v_exp_f32 v127, v95
    v_mfma_f32_16x16x32_bf16 a[72:75], v[36:39], v[96:99], a[72:75]
    ds_read_b128 v[20:23], v150 offset:21504
    v_cvt_pk_bf16_f32 v110, v124, v125
    v_mfma_f32_16x16x32_bf16 a[80:83], v[40:43], v[96:99], a[80:83]
    v_add_f32 v145, v145, v124
    v_add_f32 v145, v145, v125
    v_mfma_f32_16x16x32_bf16 a[84:87], v[40:43], v[100:103], a[84:87]
    ds_read_b128 v[24:27], v150 offset:22528
    v_cvt_pk_bf16_f32 v111, v126, v127
    v_mfma_f32_16x16x32_bf16 a[92:95], v[44:47], v[100:103], a[92:95]
    v_add_f32 v145, v145, v126
    v_add_f32 v145, v145, v127
    v_mfma_f32_16x16x32_bf16 a[88:91], v[44:47], v[96:99], a[88:91]
    ds_read_b128 v[28:31], v150 offset:23552
    v_cmp_gt_i32 s[50:51], 32, v162
    s_waitcnt lgkmcnt(8)
    v_mfma_f32_16x16x32_bf16 a[96:99], v[48:51], v[96:99], a[96:99]
    v_cmp_gt_i32 s[54:55], 33, v162
    v_cndmask_b32 v136, v136, v175, s[50:51]
    v_mfma_f32_16x16x32_bf16 a[100:103], v[48:51], v[100:103], a[100:103]
    ds_read_b128 v[32:35], v150 offset:24576
    v_cndmask_b32 v137, v137, v175, s[54:55]
    v_mfma_f32_16x16x32_bf16 a[108:111], v[52:55], v[100:103], a[108:111]
    v_cmp_gt_i32 s[50:51], 34, v162
    v_cmp_gt_i32 s[54:55], 35, v162
    v_mfma_f32_16x16x32_bf16 a[104:107], v[52:55], v[96:99], a[104:107]
    ds_read_b128 v[36:39], v150 offset:25600
    v_cndmask_b32 v138, v138, v175, s[50:51]
    v_mfma_f32_16x16x32_bf16 a[112:115], v[56:59], v[96:99], a[112:115]
    v_cndmask_b32 v139, v139, v175, s[54:55]
    v_cmp_gt_i32 s[50:51], 48, v162
    v_mfma_f32_16x16x32_bf16 a[116:119], v[56:59], v[100:103], a[116:119]
    ds_read_b128 v[40:43], v150 offset:26624
    v_cmp_gt_i32 s[54:55], 49, v162
    v_mfma_f32_16x16x32_bf16 a[124:127], v[60:63], v[100:103], a[124:127]
    v_cndmask_b32 v140, v140, v175, s[50:51]
    v_cndmask_b32 v141, v141, v175, s[54:55]
    v_mfma_f32_16x16x32_bf16 a[120:123], v[60:63], v[96:99], a[120:123]
    ds_read_b128 v[44:47], v150 offset:27648
    v_cmp_gt_i32 s[50:51], 50, v162
    v_cmp_gt_i32 s[54:55], 51, v162
    s_nop 0
    v_cndmask_b32 v142, v142, v175, s[50:51]
    v_cndmask_b32 v143, v143, v175, s[54:55]
    v_max_f32 v172, v144, v145
    v_cmp_lt_f32 vcc, s33, v172
    s_cbranch_vccnz L2_sl19
L2_slr19:
    s_waitcnt vmcnt(0)
    s_mov_b32 s57, 1048576
Lpl23:
    v_cmp_ge_u32 s[50:51], v166, v165
    s_nop 1
    s_and_b32 s50, s50, 43782144
    s_cmp_eq_u32 s50, 43782144
    s_cbranch_scc1 Lpo24
    s_sub_u32 s57, s57, 1
    s_cbranch_scc1 Lpo24
    s_mov_b64 exec, 43782144
    buffer_load_dword v166, v164, s[16:19], 0 offen sc0 sc1
    s_mov_b64 exec, -1
    s_waitcnt vmcnt(0)
    s_branch Lpl23
Lpo24:
    s_add_u32 s6, s29, 32768
    s_cmp_ge_u32 s6, 163840
    s_cselect_b32 s6, 65536, s6
    s_waitcnt lgkmcnt(8)
    v_mfma_f32_16x16x32_bf16 v[88:91], v[0:3], a[160:163], v[136:139]
    ds_read_b128 v[48:51], v150 offset:28672
    s_lshl_b32 s4, s36, 9
    s_lshl_b32 s5, s58, 6
    s_add_u32 s4, s4, s5
    s_add_u32 s4, s4, 75497472
    v_lshrrev_b32 v168, 2, v155
    v_and_b32 v168, 63, v168
    buffer_load_dword v153, v168, s[16:19], s4 offen sc0 sc1
    v_mfma_f32_16x16x32_bf16 v[88:91], v[4:7], a[164:167], v[88:91]
    ds_read_b128 v[52:55], v150 offset:29696
    v_add_f32 v146, v146, v144
    v_mfma_f32_16x16x32_bf16 v[88:91], v[8:11], a[168:171], v[88:91]
    ds_read_b128 v[56:59], v150 offset:30720
    buffer_load_dword v154, v168, s[16:19], s4 offen offset:256 sc0 sc1
    v_mfma_f32_16x16x32_bf16 v[88:91], v[12:15], a[172:175], v[88:91]
    ds_read_b128 v[60:63], v150 offset:31744
    v_add_f32 v147, v147, v145
    s_waitcnt lgkmcnt(8)
    v_mfma_f32_16x16x32_bf16 v[88:91], v[16:19], a[176:179], v[88:91]
    ds_read_b128 v[0:3], v151 offset:16384
    v_exp_f32 v120, v72
    v_add_u32 v150, s6, v155
    v_mfma_f32_16x16x32_bf16 v[88:91], v[20:23], a[180:183], v[88:91]
    ds_read_b128 v[4:7], v151 offset:17408
    s_add_u32 s4, s56, 16384
    buffer_load_dwordx4 a[240:243], v155, s[16:19], s4 offen sc0 sc1
    v_mfma_f32_16x16x32_bf16 v[88:91], v[24:27], a[184:187], v[88:91]
    ds_read_b128 v[8:11], v151 offset:18432
    v_exp_f32 v121, v73
    v_mfma_f32_16x16x32_bf16 v[88:91], v[28:31], a[188:191], v[88:91]
    ds_read_b128 v[12:15], v151 offset:19456
    s_mov_b32 s4, s56
    buffer_load_dwordx4 v[192:195], v155, s[16:19], s4 offen offset:0 sc0 sc1
    s_waitcnt lgkmcnt(8)
    v_mfma_f32_16x16x32_bf16 v[92:95], v[32:35], a[160:163], v[140:143]
    ds_read_b128 v[16:19], v151 offset:20480
    v_cvt_pk_bf16_f32 v100, v120, v121
    v_mfma_f32_16x16x32_bf16 v[92:95], v[36:39], a[164:167], v[92:95]
    ds_read_b128 v[20:23], v151 offset:21504
    v_add_f32 v145, v120, v121
    v_mfma_f32_16x16x32_bf16 v[92:95], v[40:43], a[168:171], v[92:95]
    ds_read_b128 v[24:27], v151 offset:22528
    buffer_load_dwordx4 v[196:199], v155, s[16:19], s4 offen offset:1024 sc0 sc1
    v_mfma_f32_16x16x32_bf16 v[92:95], v[44:47], a[172:175], v[92:95]
    ds_read_b128 v[28:31], v151 offset:23552
    v_exp_f32 v122, v74
    s_waitcnt lgkmcnt(8)
    v_mfma_f32_16x16x32_bf16 v[92:95], v[48:51], a[176:179], v[92:95]
    ds_read_b128 v[32:35], v151 offset:24576
    buffer_load_dwordx4 v[200:203], v155, s[16:19], s4 offen offset:2048 sc0 sc1
    v_mfma_f32_16x16x32_bf16 v[92:95], v[52:55], a[180:183], v[92:95]
    ds_read_b128 v[36:39], v151 offset:25600
    v_exp_f32 v123, v75
    v_mfma_f32_16x16x32_bf16 v[92:95], v[56:59], a[184:187], v[92:95]
    ds_read_b128 v[40:43], v151 offset:26624
    v_cvt_pk_bf16_f32 v101, v122, v123
    v_mfma_f32_16x16x32_bf16 v[92:95], v[60:63], a[188:191], v[92:95]
    ds_read_b128 v[44:47], v151 offset:27648
    buffer_load_dwordx4 v[204:207], v155, s[16:19], s4 offen offset:3072 sc0 sc1
    s_waitcnt lgkmcnt(8)
    v_mfma_f32_16x16x32_bf16 a[0:3], v[0:3], v[104:107], a[0:3]
    v_exp_f32 v124, v76
    v_mfma_f32_16x16x32_bf16 a[4:7], v[0:3], v[108:111], a[4:7]
    ds_read_b128 v[48:51], v151 offset:28672
    s_add_u32 s4, s4, 4096
    buffer_load_dwordx4 v[208:211], v155, s[16:19], s4 offen offset:0 sc0 sc1
    v_mfma_f32_16x16x32_bf16 a[12:15], v[4:7], v[108:111], a[12:15]
    v_exp_f32 v125, v77
    v_mfma_f32_16x16x32_bf16 a[8:11], v[4:7], v[104:107], a[8:11]
    ds_read_b128 v[52:55], v151 offset:29696
    v_add_f32 v145, v145, v122
    v_mfma_f32_16x16x32_bf16 a[16:19], v[8:11], v[104:107], a[16:19]
    buffer_load_dwordx4 v[212:215], v155, s[16:19], s4 offen offset:1024 sc0 sc1
    v_mfma_f32_16x16x32_bf16 a[20:23], v[8:11], v[108:111], a[20:23]
    ds_read_b128 v[56:59], v151 offset:30720
    v_add_f32 v145, v145, v123
    v_mfma_f32_16x16x32_bf16 a[28:31], v[12:15], v[108:111], a[28:31]
    buffer_load_dwordx4 v[216:219], v155, s[16:19], s4 offen offset:2048 sc0 sc1
    v_mfma_f32_16x16x32_bf16 a[24:27], v[12:15], v[104:107], a[24:27]
    ds_read_b128 v[60:63], v151 offset:31744
    v_cvt_pk_bf16_f32 v102, v124, v125
    s_waitcnt lgkmcnt(8)
    s_barrier
    v_mfma_f32_16x16x32_bf16 a[32:35], v[16:19], v[104:107], a[32:35]
    v_exp_f32 v126, v78
    v_mfma_f32_16x16x32_bf16 a[36:39], v[16:19], v[108:111], a[36:39]
    ds_read_b128 v[0:3], v150 offset:0
    buffer_load_dwordx4 v[220:223], v155, s[16:19], s4 offen offset:3072 sc0 sc1
    v_mfma_f32_16x16x32_bf16 a[44:47], v[20:23], v[108:111], a[44:47]
    v_exp_f32 v127, v79
    v_mfma_f32_16x16x32_bf16 a[40:43], v[20:23], v[104:107], a[40:43]
    ds_read_b128 v[4:7], v150 offset:1024
    s_add_u32 s4, s4, 4096
    buffer_load_dwordx4 v[224:227], v155, s[16:19], s4 offen offset:0 sc0 sc1
    v_mfma_f32_16x16x32_bf16 a[48:51], v[24:27], v[104:107], a[48:51]
    v_add_f32 v145, v145, v124
    v_add_f32 v145, v145, v125
    v_mfma_f32_16x16x32_bf16 a[52:55], v[24:27], v[108:111], a[52:55]
    ds_read_b128 v[8:11], v150 offset:2048
    v_cvt_pk_bf16_f32 v103, v126, v127
    v_mfma_f32_16x16x32_bf16 a[60:63], v[28:31], v[108:111], a[60:63]
    buffer_load_dwordx4 v[228:231], v155, s[16:19], s4 offen offset:1024 sc0 sc1
    v_mfma_f32_16x16x32_bf16 a[56:59], v[28:31], v[104:107], a[56:59]
    ds_read_b128 v[12:15], v150 offset:3072
    v_add_f32 v145, v145, v126
    s_waitcnt lgkmcnt(8)
    v_mfma_f32_16x16x32_bf16 a[64:67], v[32:35], v[104:107], a[64:67]
    buffer_load_dwordx4 v[232:235], v155, s[16:19], s4 offen offset:2048 sc0 sc1
    v_mfma_f32_16x16x32_bf16 a[68:71], v[32:35], v[108:111], a[68:71]
    ds_read_b128 v[16:19], v150 offset:4096
    v_add_f32 v145, v145, v127
    v_mfma_f32_16x16x32_bf16 a[76:79], v[36:39], v[108:111], a[76:79]
    v_cmp_lt_f32 vcc, s33, v145
    v_mfma_f32_16x16x32_bf16 a[72:75], v[36:39], v[104:107], a[72:75]
    ds_read_b128 v[20:23], v150 offset:5120
    buffer_load_dwordx4 v[236:239], v155, s[16:19], s4 offen offset:3072 sc0 sc1
    v_mfma_f32_16x16x32_bf16 a[80:83], v[40:43], v[104:107], a[80:83]
    v_mfma_f32_16x16x32_bf16 a[84:87], v[40:43], v[108:111], a[84:87]
    ds_read_b128 v[24:27], v150 offset:6144
    s_add_u32 s4, s4, 4096
    buffer_load_dwordx4 v[240:243], v155, s[16:19], s4 offen offset:0 sc0 sc1
    v_mfma_f32_16x16x32_bf16 a[92:95], v[44:47], v[108:111], a[92:95]
    v_mfma_f32_16x16x32_bf16 a[88:91], v[44:47], v[104:107], a[88:91]
    ds_read_b128 v[28:31], v150 offset:7168
    s_waitcnt lgkmcnt(8)
    v_mfma_f32_16x16x32_bf16 a[96:99], v[48:51], v[104:107], a[96:99]
    buffer_load_dwordx4 v[244:247], v155, s[16:19], s4 offen offset:1024 sc0 sc1
    v_mfma_f32_16x16x32_bf16 a[100:103], v[48:51], v[108:111], a[100:103]
    ds_read_b128 v[32:35], v150 offset:8192
    v_mfma_f32_16x16x32_bf16 a[108:111], v[52:55], v[108:111], a[108:111]
    buffer_load_dwordx4 v[248:251], v155, s[16:19], s4 offen offset:2048 sc0 sc1
    v_mfma_f32_16x16x32_bf16 a[104:107], v[52:55], v[104:107], a[104:107]
    ds_read_b128 v[36:39], v150 offset:9216
    v_mfma_f32_16x16x32_bf16 a[112:115], v[56:59], v[104:107], a[112:115]
    v_mfma_f32_16x16x32_bf16 a[116:119], v[56:59], v[108:111], a[116:119]
    ds_read_b128 v[40:43], v150 offset:10240
    buffer_load_dwordx4 v[252:255], v155, s[16:19], s4 offen offset:3072 sc0 sc1
    s_add_u32 s4, s4, 4096
    v_mfma_f32_16x16x32_bf16 a[124:127], v[60:63], v[108:111], a[124:127]
    v_mfma_f32_16x16x32_bf16 a[120:123], v[60:63], v[104:107], a[120:123]
    ds_read_b128 v[44:47], v150 offset:11264
    s_cbranch_vccnz L2_sl20
L2_slr20:
    s_waitcnt lgkmcnt(8)
    v_mfma_f32_16x16x32_bf16 a[4:7], v[0:3], v[100:103], a[4:7]
    ds_read_b128 v[48:51], v150 offset:12288
    s_lshl_b32 s5, s36, 3
    s_add_u32 s5, s5, s58
    s_mul_i32 s5, s5, 188416
    s_add_u32 s5, s5, 50462720
    s_add_u32 s64, s64, s5
    s_add_u32 s65, s64, 4096
    s_add_u32 s92, s64, 8192
    buffer_load_dwordx4 a[192:195], v155, s[16:19], s64 offen offset:0 sc0 sc1
    v_mfma_f32_16x16x32_bf16 a[12:15], v[4:7], v[100:103], a[12:15]
    ds_read_b128 v[52:55], v150 offset:13312
    v_add_f32 v147, v147, v145
    v_mfma_f32_16x16x32_bf16 a[20:23], v[8:11], v[100:103], a[20:23]
    ds_read_b128 v[56:59], v150 offset:14336
    v_exp_f32 v120, v88
    v_mfma_f32_16x16x32_bf16 a[28:31], v[12:15], v[100:103], a[28:31]
    ds_read_b128 v[60:63], v150 offset:15360
    v_exp_f32 v121, v89
    s_waitcnt lgkmcnt(8)
    v_mfma_f32_16x16x32_bf16 a[36:39], v[16:19], v[100:103], a[36:39]
    ds_read_b128 v[0:3], v150 offset:16384
    v_cvt_pk_bf16_f32 v108, v120, v121
    v_mfma_f32_16x16x32_bf16 a[44:47], v[20:23], v[100:103], a[44:47]
    ds_read_b128 v[4:7], v150 offset:17408
    v_add_f32 v145, v120, v121
    v_mfma_f32_16x16x32_bf16 a[52:55], v[24:27], v[100:103], a[52:55]
    ds_read_b128 v[8:11], v150 offset:18432
    v_exp_f32 v122, v90
    v_mfma_f32_16x16x32_bf16 a[60:63], v[28:31], v[100:103], a[60:63]
    ds_read_b128 v[12:15], v150 offset:19456
    buffer_load_dwordx4 a[196:199], v190, s[16:19], s64 offen offset:0 sc0 sc1
    s_waitcnt lgkmcnt(8)
    v_mfma_f32_16x16x32_bf16 a[68:71], v[32:35], v[100:103], a[68:71]
    ds_read_b128 v[16:19], v150 offset:20480
    v_exp_f32 v123, v91
    v_mfma_f32_16x16x32_bf16 a[76:79], v[36:39], v[100:103], a[76:79]
    ds_read_b128 v[20:23], v150 offset:21504
    v_cvt_pk_bf16_f32 v109, v122, v123
    v_mfma_f32_16x16x32_bf16 a[84:87], v[40:43], v[100:103], a[84:87]
    ds_read_b128 v[24:27], v150 offset:22528
    v_add_f32 v145, v145, v122
    v_mfma_f32_16x16x32_bf16 a[92:95], v[44:47], v[100:103], a[92:95]
    ds_read_b128 v[28:31], v150 offset:23552
    v_add_f32 v145, v145, v123
    s_waitcnt lgkmcnt(8)
    v_mfma_f32_16x16x32_bf16 a[100:103], v[48:51], v[100:103], a[100:103]
    ds_read_b128 v[32:35], v150 offset:24576
    v_exp_f32 v124, v92
    v_mfma_f32_16x16x32_bf16 a[108:111], v[52:55], v[100:103], a[108:111]
    ds_read_b128 v[36:39], v150 offset:25600
    v_exp_f32 v125, v93
    v_mfma_f32_16x16x32_bf16 a[116:119], v[56:59], v[100:103], a[116:119]
    ds_read_b128 v[40:43], v150 offset:26624
    v_cvt_pk_bf16_f32 v110, v124, v125
    v_mfma_f32_16x16x32_bf16 a[124:127], v[60:63], v[100:103], a[124:127]
    ds_read_b128 v[44:47], v150 offset:27648
    v_add_f32 v145, v145, v124
    v_exp_f32 v126, v94
    v_exp_f32 v127, v95
    v_add_f32 v145, v145, v125
    v_cvt_pk_bf16_f32 v111, v126, v127
    v_add_f32 v145, v145, v126
    v_add_f32 v145, v145, v127
    v_cmp_lt_f32 vcc, s33, v145
    s_cbranch_vccnz L2_sl21
L2_slr21:
    v_add_f32 v147, v147, v145
    s_waitcnt lgkmcnt(8)
    v_mfma_f32_16x16x32_bf16 a[4:7], v[0:3], v[108:111], a[4:7]
    ds_read_b128 v[48:51], v150 offset:28672
    buffer_load_dwordx4 a[200:203], v155, s[16:19], s64 offen offset:1024 sc0 sc1
    v_mfma_f32_16x16x32_bf16 a[12:15], v[4:7], v[108:111], a[12:15]
    ds_read_b128 v[52:55], v150 offset:29696
    v_mfma_f32_16x16x32_bf16 a[20:23], v[8:11], v[108:111], a[20:23]
    ds_read_b128 v[56:59], v150 offset:30720
    buffer_load_dwordx4 a[204:207], v190, s[16:19], s64 offen offset:1024 sc0 sc1
    v_mfma_f32_16x16x32_bf16 a[28:31], v[12:15], v[108:111], a[28:31]
    ds_read_b128 v[60:63], v150 offset:31744
    s_waitcnt lgkmcnt(8)
    v_mfma_f32_16x16x32_bf16 a[36:39], v[16:19], v[108:111], a[36:39]
    v_mfma_f32_16x16x32_bf16 a[44:47], v[20:23], v[108:111], a[44:47]
    buffer_load_dwordx4 a[208:211], v155, s[16:19], s64 offen offset:2048 sc0 sc1
    v_mfma_f32_16x16x32_bf16 a[52:55], v[24:27], v[108:111], a[52:55]
    v_mfma_f32_16x16x32_bf16 a[60:63], v[28:31], v[108:111], a[60:63]
    buffer_load_dwordx4 a[212:215], v190, s[16:19], s64 offen offset:2048 sc0 sc1
    s_waitcnt lgkmcnt(4)
    v_mfma_f32_16x16x32_bf16 a[68:71], v[32:35], v[108:111], a[68:71]
    v_mfma_f32_16x16x32_bf16 a[76:79], v[36:39], v[108:111], a[76:79]
    v_mfma_f32_16x16x32_bf16 a[84:87], v[40:43], v[108:111], a[84:87]
    buffer_load_dwordx4 a[216:219], v155, s[16:19], s64 offen offset:3072 sc0 sc1
    v_mfma_f32_16x16x32_bf16 a[92:95], v[44:47], v[108:111], a[92:95]
    s_waitcnt lgkmcnt(0)
    v_mfma_f32_16x16x32_bf16 a[100:103], v[48:51], v[108:111], a[100:103]
    v_mfma_f32_16x16x32_bf16 a[108:111], v[52:55], v[108:111], a[108:111]
    buffer_load_dwordx4 a[220:223], v190, s[16:19], s64 offen offset:3072 sc0 sc1
    v_mfma_f32_16x16x32_bf16 a[116:119], v[56:59], v[108:111], a[116:119]
    v_mfma_f32_16x16x32_bf16 a[124:127], v[60:63], v[108:111], a[124:127]
    v_mov_b32 v172, v146
    s_nop 1
    v_permlane32_swap_b32 v146, v172
    s_nop 1
    v_add_f32 v146, v146, v172
    v_mov_b32 v172, v146
    s_nop 1
    v_permlane16_swap_b32 v146, v172
    s_nop 1
    v_add_f32 v146, v146, v172
    v_mov_b32 v172, v147
    s_nop 1
    v_permlane32_swap_b32 v147, v172
    s_nop 1
    v_add_f32 v147, v147, v172
    v_mov_b32 v172, v147
    s_nop 1
    v_permlane16_swap_b32 v147, v172
    s_nop 1
    v_add_f32 v147, v147, v172
    s_waitcnt vmcnt(8)
    s_cmp_eq_u32 s39, 1
    s_cbranch_scc1 L2_lf1
    v_rcp_f32 v174, v146
    s_nop 0
    v_mul_f32 v174, v174, v153
    v_rcp_f32 v175, v147
    s_nop 0
    v_mul_f32 v175, v175, v154
    v_accvgpr_read_b32 v0, a0
    v_accvgpr_read_b32 v1, a1
    v_accvgpr_read_b32 v2, a2
    v_accvgpr_read_b32 v3, a3
    v_accvgpr_read_b32 v4, a8
    v_accvgpr_read_b32 v5, a9
    v_accvgpr_read_b32 v6, a10
    v_accvgpr_read_b32 v7, a11
    s_add_u32 m0, s62, 0
    s_add_u32 s7, s61, 0
    buffer_load_dwordx4 v157, s[72:75], s7 offen offset:0 lds
    buffer_load_dwordx4 v158, s[72:75], s7 offen offset:1024 lds
    v_pk_mul_f32 v[0:1], v[0:1], v[174:175] op_sel_hi:[1,0]
    v_pk_mul_f32 v[2:3], v[2:3], v[174:175] op_sel_hi:[1,0]
    v_pk_mul_f32 v[4:5], v[4:5], v[174:175] op_sel_hi:[1,0]
    v_pk_mul_f32 v[6:7], v[6:7], v[174:175] op_sel_hi:[1,0]
    v_cvt_pk_bf16_f32 v192, v0, v1
    v_cvt_pk_bf16_f32 v193, v2, v3
    v_cvt_pk_bf16_f32 v194, v4, v5
    v_cvt_pk_bf16_f32 v195, v6, v7
    buffer_store_dwordx4 v[192:195], v155, s[16:19], s90 offen offset:0 sc0 sc1
    v_accvgpr_read_b32 v12, a4
    v_accvgpr_read_b32 v13, a5
    v_accvgpr_read_b32 v14, a6
    v_accvgpr_read_b32 v15, a7
    v_accvgpr_read_b32 v16, a12
    v_accvgpr_read_b32 v17, a13
    v_accvgpr_read_b32 v18, a14
    v_accvgpr_read_b32 v19, a15
    s_add_u32 m0, s62, 8192
    s_add_u32 s7, s61, 28672
    buffer_load_dwordx4 v157, s[72:75], s7 offen offset:0 lds
    buffer_load_dwordx4 v158, s[72:75], s7 offen offset:1024 lds
    v_pk_mul_f32 v[12:13], v[12:13], v[174:175] op_sel:[0,1] op_sel_hi:[1,1]
    v_pk_mul_f32 v[14:15], v[14:15], v[174:175] op_sel:[0,1] op_sel_hi:[1,1]
    v_pk_mul_f32 v[16:17], v[16:17], v[174:175] op_sel:[0,1] op_sel_hi:[1,1]
    v_pk_mul_f32 v[18:19], v[18:19], v[174:175] op_sel:[0,1] op_sel_hi:[1,1]
    v_cvt_pk_bf16_f32 v196, v12, v13
    v_cvt_pk_bf16_f32 v197, v14, v15
    v_cvt_pk_bf16_f32 v198, v16, v17
    v_cvt_pk_bf16_f32 v199, v18, v19
    v_accvgpr_read_b32 v24, a16
    v_accvgpr_read_b32 v25, a17
    v_accvgpr_read_b32 v26, a18
    v_accvgpr_read_b32 v27, a19
    v_accvgpr_read_b32 v28, a24
    v_accvgpr_read_b32 v29, a25
    v_accvgpr_read_b32 v30, a26
    v_accvgpr_read_b32 v31, a27
    s_add_u32 m0, s62, 16384
    s_add_u32 s7, s61, 256
    buffer_load_dwordx4 v188, s[72:75], s7 offen offset:0 lds
    buffer_load_dwordx4 v189, s[72:75], s7 offen offset:1024 lds
    v_pk_mul_f32 v[24:25], v[24:25], v[174:175] op_sel_hi:[1,0]
    v_pk_mul_f32 v[26:27], v[26:27], v[174:175] op_sel_hi:[1,0]
    v_pk_mul_f32 v[28:29], v[28:29], v[174:175] op_sel_hi:[1,0]
    v_pk_mul_f32 v[30:31], v[30:31], v[174:175] op_sel_hi:[1,0]
    v_cvt_pk_bf16_f32 v200, v24, v25
    v_cvt_pk_bf16_f32 v201, v26, v27
    v_cvt_pk_bf16_f32 v202, v28, v29
    v_cvt_pk_bf16_f32 v203, v30, v31
    v_accvgpr_read_b32 v36, a20
    v_accvgpr_read_b32 v37, a21
    v_accvgpr_read_b32 v38, a22
    v_accvgpr_read_b32 v39, a23
    v_accvgpr_read_b32 v40, a28
    v_accvgpr_read_b32 v41, a29
    v_accvgpr_read_b32 v42, a30
    v_accvgpr_read_b32 v43, a31
    s_add_u32 m0, s62, 24576
    s_add_u32 s7, s61, 28928
    buffer_load_dwordx4 v188, s[72:75], s7 offen offset:0 lds
    buffer_load_dwordx4 v189, s[72:75], s7 offen offset:1024 lds
    v_pk_mul_f32 v[36:37], v[36:37], v[174:175] op_sel:[0,1] op_sel_hi:[1,1]
    v_pk_mul_f32 v[38:39], v[38:39], v[174:175] op_sel:[0,1] op_sel_hi:[1,1]
    v_pk_mul_f32 v[40:41], v[40:41], v[174:175] op_sel:[0,1] op_sel_hi:[1,1]
    v_pk_mul_f32 v[42:43], v[42:43], v[174:175] op_sel:[0,1] op_sel_hi:[1,1]
    v_cvt_pk_bf16_f32 v204, v36, v37
    v_cvt_pk_bf16_f32 v205, v38, v39
    v_cvt_pk_bf16_f32 v206, v40, v41
    v_cvt_pk_bf16_f32 v207, v42, v43
    buffer_store_dwordx4 v[196:199], v155, s[16:19], s90 offen offset:1024 sc0 sc1
    v_accvgpr_read_b32 v48, a32
    v_accvgpr_read_b32 v49, a33
    v_accvgpr_read_b32 v50, a34
    v_accvgpr_read_b32 v51, a35
    v_accvgpr_read_b32 v52, a40
    v_accvgpr_read_b32 v53, a41
    v_accvgpr_read_b32 v54, a42
    v_accvgpr_read_b32 v55, a43
    s_add_u32 m0, s62, 32768
    s_add_u32 s7, s61, 57344
    buffer_load_dwordx4 v157, s[72:75], s7 offen offset:0 lds
    v_pk_mul_f32 v[48:49], v[48:49], v[174:175] op_sel_hi:[1,0]
    v_pk_mul_f32 v[50:51], v[50:51], v[174:175] op_sel_hi:[1,0]
    v_pk_mul_f32 v[52:53], v[52:53], v[174:175] op_sel_hi:[1,0]
    v_pk_mul_f32 v[54:55], v[54:55], v[174:175] op_sel_hi:[1,0]
    v_cvt_pk_bf16_f32 v208, v48, v49
    v_cvt_pk_bf16_f32 v209, v50, v51
    v_cvt_pk_bf16_f32 v210, v52, v53
    v_cvt_pk_bf16_f32 v211, v54, v55
    v_accvgpr_read_b32 v60, a36
    v_accvgpr_read_b32 v61, a37
    v_accvgpr_read_b32 v62, a38
    v_accvgpr_read_b32 v63, a39
    v_accvgpr_read_b32 v64, a44
    v_accvgpr_read_b32 v65, a45
    v_accvgpr_read_b32 v66, a46
    v_accvgpr_read_b32 v67, a47
    buffer_load_dwordx4 v158, s[72:75], s7 offen offset:1024 lds
    v_pk_mul_f32 v[60:61], v[60:61], v[174:175] op_sel:[0,1] op_sel_hi:[1,1]
    v_pk_mul_f32 v[62:63], v[62:63], v[174:175] op_sel:[0,1] op_sel_hi:[1,1]
    v_pk_mul_f32 v[64:65], v[64:65], v[174:175] op_sel:[0,1] op_sel_hi:[1,1]
    v_pk_mul_f32 v[66:67], v[66:67], v[174:175] op_sel:[0,1] op_sel_hi:[1,1]
    v_cvt_pk_bf16_f32 v212, v60, v61
    v_cvt_pk_bf16_f32 v213, v62, v63
    v_cvt_pk_bf16_f32 v214, v64, v65
    v_cvt_pk_bf16_f32 v215, v66, v67
    v_accvgpr_read_b32 v72, a48
    v_accvgpr_read_b32 v73, a49
    v_accvgpr_read_b32 v74, a50
    v_accvgpr_read_b32 v75, a51
    v_accvgpr_read_b32 v76, a56
    v_accvgpr_read_b32 v77, a57
    v_accvgpr_read_b32 v78, a58
    v_accvgpr_read_b32 v79, a59
    s_add_u32 m0, s62, 40960
    s_add_u32 s7, s61, 86016
    buffer_load_dwordx4 v157, s[72:75], s7 offen offset:0 lds
    v_pk_mul_f32 v[72:73], v[72:73], v[174:175] op_sel_hi:[1,0]
    v_pk_mul_f32 v[74:75], v[74:75], v[174:175] op_sel_hi:[1,0]
    v_pk_mul_f32 v[76:77], v[76:77], v[174:175] op_sel_hi:[1,0]
    v_pk_mul_f32 v[78:79], v[78:79], v[174:175] op_sel_hi:[1,0]
    v_cvt_pk_bf16_f32 v216, v72, v73
    v_cvt_pk_bf16_f32 v217, v74, v75
    v_cvt_pk_bf16_f32 v218, v76, v77
    v_cvt_pk_bf16_f32 v219, v78, v79
    buffer_store_dwordx4 v[200:203], v155, s[16:19], s90 offen offset:2048 sc0 sc1
    v_accvgpr_read_b32 v84, a52
    v_accvgpr_read_b32 v85, a53
    v_accvgpr_read_b32 v86, a54
    v_accvgpr_read_b32 v87, a55
    v_accvgpr_read_b32 v88, a60
    v_accvgpr_read_b32 v89, a61
    v_accvgpr_read_b32 v90, a62
    v_accvgpr_read_b32 v91, a63
    buffer_load_dwordx4 v158, s[72:75], s7 offen offset:1024 lds
    v_pk_mul_f32 v[84:85], v[84:85], v[174:175] op_sel:[0,1] op_sel_hi:[1,1]
    v_pk_mul_f32 v[86:87], v[86:87], v[174:175] op_sel:[0,1] op_sel_hi:[1,1]
    v_pk_mul_f32 v[88:89], v[88:89], v[174:175] op_sel:[0,1] op_sel_hi:[1,1]
    v_pk_mul_f32 v[90:91], v[90:91], v[174:175] op_sel:[0,1] op_sel_hi:[1,1]
    v_cvt_pk_bf16_f32 v220, v84, v85
    v_cvt_pk_bf16_f32 v221, v86, v87
    v_cvt_pk_bf16_f32 v222, v88, v89
    v_cvt_pk_bf16_f32 v223, v90, v91
    v_accvgpr_read_b32 v0, a64
    v_accvgpr_read_b32 v1, a65
    v_accvgpr_read_b32 v2, a66
    v_accvgpr_read_b32 v3, a67
    v_accvgpr_read_b32 v4, a72
    v_accvgpr_read_b32 v5, a73
    v_accvgpr_read_b32 v6, a74
    v_accvgpr_read_b32 v7, a75
    s_add_u32 m0, s62, 49152
    s_add_u32 s7, s61, 57600
    buffer_load_dwordx4 v188, s[72:75], s7 offen offset:0 lds
    v_pk_mul_f32 v[0:1], v[0:1], v[174:175] op_sel_hi:[1,0]
    v_pk_mul_f32 v[2:3], v[2:3], v[174:175] op_sel_hi:[1,0]
    v_pk_mul_f32 v[4:5], v[4:5], v[174:175] op_sel_hi:[1,0]
    v_pk_mul_f32 v[6:7], v[6:7], v[174:175] op_sel_hi:[1,0]
    v_cvt_pk_bf16_f32 v224, v0, v1
    v_cvt_pk_bf16_f32 v225, v2, v3
    v_cvt_pk_bf16_f32 v226, v4, v5
    v_cvt_pk_bf16_f32 v227, v6, v7
    v_accvgpr_read_b32 v12, a68
    v_accvgpr_read_b32 v13, a69
    v_accvgpr_read_b32 v14, a70
    v_accvgpr_read_b32 v15, a71
    v_accvgpr_read_b32 v16, a76
    v_accvgpr_read_b32 v17, a77
    v_accvgpr_read_b32 v18, a78
    v_accvgpr_read_b32 v19, a79
    buffer_load_dwordx4 v189, s[72:75], s7 offen offset:1024 lds
    v_pk_mul_f32 v[12:13], v[12:13], v[174:175] op_sel:[0,1] op_sel_hi:[1,1]
    v_pk_mul_f32 v[14:15], v[14:15], v[174:175] op_sel:[0,1] op_sel_hi:[1,1]
    v_pk_mul_f32 v[16:17], v[16:17], v[174:175] op_sel:[0,1] op_sel_hi:[1,1]
    v_pk_mul_f32 v[18:19], v[18:19], v[174:175] op_sel:[0,1] op_sel_hi:[1,1]
    v_cvt_pk_bf16_f32 v228, v12, v13
    v_cvt_pk_bf16_f32 v229, v14, v15
    v_cvt_pk_bf16_f32 v230, v16, v17
    v_cvt_pk_bf16_f32 v231, v18, v19
    buffer_store_dwordx4 v[204:207], v155, s[16:19], s90 offen offset:3072 sc0 sc1
    v_accvgpr_read_b32 v24, a80
    v_accvgpr_read_b32 v25, a81
    v_accvgpr_read_b32 v26, a82
    v_accvgpr_read_b32 v27, a83
    v_accvgpr_read_b32 v28, a88
    v_accvgpr_read_b32 v29, a89
    v_accvgpr_read_b32 v30, a90
    v_accvgpr_read_b32 v31, a91
    s_add_u32 m0, s62, 57344
    s_add_u32 s7, s61, 86272
    buffer_load_dwordx4 v188, s[72:75], s7 offen offset:0 lds
    v_pk_mul_f32 v[24:25], v[24:25], v[174:175] op_sel_hi:[1,0]
    v_pk_mul_f32 v[26:27], v[26:27], v[174:175] op_sel_hi:[1,0]
    v_pk_mul_f32 v[28:29], v[28:29], v[174:175] op_sel_hi:[1,0]
    v_pk_mul_f32 v[30:31], v[30:31], v[174:175] op_sel_hi:[1,0]
    v_cvt_pk_bf16_f32 v232, v24, v25
    v_cvt_pk_bf16_f32 v233, v26, v27
    v_cvt_pk_bf16_f32 v234, v28, v29
    v_cvt_pk_bf16_f32 v235, v30, v31
    v_accvgpr_read_b32 v36, a84
    v_accvgpr_read_b32 v37, a85
    v_accvgpr_read_b32 v38, a86
    v_accvgpr_read_b32 v39, a87
    v_accvgpr_read_b32 v40, a92
    v_accvgpr_read_b32 v41, a93
    v_accvgpr_read_b32 v42, a94
    v_accvgpr_read_b32 v43, a95
    buffer_load_dwordx4 v189, s[72:75], s7 offen offset:1024 lds
    v_pk_mul_f32 v[36:37], v[36:37], v[174:175] op_sel:[0,1] op_sel_hi:[1,1]
    v_pk_mul_f32 v[38:39], v[38:39], v[174:175] op_sel:[0,1] op_sel_hi:[1,1]
    v_pk_mul_f32 v[40:41], v[40:41], v[174:175] op_sel:[0,1] op_sel_hi:[1,1]
    v_pk_mul_f32 v[42:43], v[42:43], v[174:175] op_sel:[0,1] op_sel_hi:[1,1]
    v_cvt_pk_bf16_f32 v236, v36, v37
    v_cvt_pk_bf16_f32 v237, v38, v39
    v_cvt_pk_bf16_f32 v238, v40, v41
    v_cvt_pk_bf16_f32 v239, v42, v43
    v_accvgpr_read_b32 v48, a96
    v_accvgpr_read_b32 v49, a97
    v_accvgpr_read_b32 v50, a98
    v_accvgpr_read_b32 v51, a99
    v_accvgpr_read_b32 v52, a104
    v_accvgpr_read_b32 v53, a105
    v_accvgpr_read_b32 v54, a106
    v_accvgpr_read_b32 v55, a107
    v_pk_mul_f32 v[48:49], v[48:49], v[174:175] op_sel_hi:[1,0]
    v_pk_mul_f32 v[50:51], v[50:51], v[174:175] op_sel_hi:[1,0]
    v_pk_mul_f32 v[52:53], v[52:53], v[174:175] op_sel_hi:[1,0]
    v_pk_mul_f32 v[54:55], v[54:55], v[174:175] op_sel_hi:[1,0]
    v_cvt_pk_bf16_f32 v240, v48, v49
    v_cvt_pk_bf16_f32 v241, v50, v51
    v_cvt_pk_bf16_f32 v242, v52, v53
    v_cvt_pk_bf16_f32 v243, v54, v55
    s_add_u32 s90, s90, 4096
    buffer_store_dwordx4 v[208:211], v155, s[16:19], s90 offen offset:0 sc0 sc1
    v_accvgpr_read_b32 v60, a100
    v_accvgpr_read_b32 v61, a101
    v_accvgpr_read_b32 v62, a102
    v_accvgpr_read_b32 v63, a103
    v_accvgpr_read_b32 v64, a108
    v_accvgpr_read_b32 v65, a109
    v_accvgpr_read_b32 v66, a110
    v_accvgpr_read_b32 v67, a111
    v_pk_mul_f32 v[60:61], v[60:61], v[174:175] op_sel:[0,1] op_sel_hi:[1,1]
    v_pk_mul_f32 v[62:63], v[62:63], v[174:175] op_sel:[0,1] op_sel_hi:[1,1]
    v_pk_mul_f32 v[64:65], v[64:65], v[174:175] op_sel:[0,1] op_sel_hi:[1,1]
    v_pk_mul_f32 v[66:67], v[66:67], v[174:175] op_sel:[0,1] op_sel_hi:[1,1]
    v_cvt_pk_bf16_f32 v244, v60, v61
    v_cvt_pk_bf16_f32 v245, v62, v63
    v_cvt_pk_bf16_f32 v246, v64, v65
    v_cvt_pk_bf16_f32 v247, v66, v67
    v_accvgpr_read_b32 v72, a112
    v_accvgpr_read_b32 v73, a113
    v_accvgpr_read_b32 v74, a114
    v_accvgpr_read_b32 v75, a115
    v_accvgpr_read_b32 v76, a120
    v_accvgpr_read_b32 v77, a121
    v_accvgpr_read_b32 v78, a122
    v_accvgpr_read_b32 v79, a123
    v_pk_mul_f32 v[72:73], v[72:73], v[174:175] op_sel_hi:[1,0]
    v_pk_mul_f32 v[74:75], v[74:75], v[174:175] op_sel_hi:[1,0]
    v_pk_mul_f32 v[76:77], v[76:77], v[174:175] op_sel_hi:[1,0]
    v_pk_mul_f32 v[78:79], v[78:79], v[174:175] op_sel_hi:[1,0]
    v_cvt_pk_bf16_f32 v248, v72, v73
    v_cvt_pk_bf16_f32 v249, v74, v75
    v_cvt_pk_bf16_f32 v250, v76, v77
    v_cvt_pk_bf16_f32 v251, v78, v79
    v_accvgpr_read_b32 v84, a116
    v_accvgpr_read_b32 v85, a117
    v_accvgpr_read_b32 v86, a118
    v_accvgpr_read_b32 v87, a119
    v_accvgpr_read_b32 v88, a124
    v_accvgpr_read_b32 v89, a125
    v_accvgpr_read_b32 v90, a126
    v_accvgpr_read_b32 v91, a127
    v_pk_mul_f32 v[84:85], v[84:85], v[174:175] op_sel:[0,1] op_sel_hi:[1,1]
    v_pk_mul_f32 v[86:87], v[86:87], v[174:175] op_sel:[0,1] op_sel_hi:[1,1]
    v_pk_mul_f32 v[88:89], v[88:89], v[174:175] op_sel:[0,1] op_sel_hi:[1,1]
    v_pk_mul_f32 v[90:91], v[90:91], v[174:175] op_sel:[0,1] op_sel_hi:[1,1]
    v_cvt_pk_bf16_f32 v252, v84, v85
    v_cvt_pk_bf16_f32 v253, v86, v87
    v_cvt_pk_bf16_f32 v254, v88, v89
    v_cvt_pk_bf16_f32 v255, v90, v91
    buffer_store_dwordx4 v[212:215], v155, s[16:19], s90 offen offset:1024 sc0 sc1
    s_branch L3_go
L2_lf1:
    v_accvgpr_read_b32 v180, a240
    v_accvgpr_read_b32 v181, a241
    v_accvgpr_read_b32 v182, a242
    v_accvgpr_read_b32 v183, a243
    v_max_f32 v178, v148, v182
    v_sub_f32 v174, v148, v178
    v_sub_f32 v176, v182, v178
    v_exp_f32 v174, v174
    v_exp_f32 v176, v176
    s_nop 0
    v_mul_f32 v178, v146, v174
    v_fmac_f32 v178, v180, v176
    v_rcp_f32 v178, v178
    s_nop 0
    v_mul_f32 v178, v178, v153
    v_mul_f32 v174, v174, v178
    v_mul_f32 v176, v176, v178
    v_max_f32 v178, v149, v183
    v_sub_f32 v175, v149, v178
    v_sub_f32 v177, v183, v178
    v_exp_f32 v175, v175
    v_exp_f32 v177, v177
    s_nop 0
    v_mul_f32 v178, v147, v175
    v_fmac_f32 v178, v181, v177
    v_rcp_f32 v178, v178
    s_nop 0
    v_mul_f32 v178, v178, v154
    v_mul_f32 v175, v175, v178
    v_mul_f32 v177, v177, v178
    v_accvgpr_read_b32 v0, a0
    v_accvgpr_read_b32 v1, a1
    v_accvgpr_read_b32 v2, a2
    v_accvgpr_read_b32 v3, a3
    v_accvgpr_read_b32 v4, a8
    v_accvgpr_read_b32 v5, a9
    v_accvgpr_read_b32 v6, a10
    v_accvgpr_read_b32 v7, a11
    s_add_u32 m0, s62, 0
    s_add_u32 s7, s61, 0
    buffer_load_dwordx4 v157, s[72:75], s7 offen offset:0 lds
    v_pk_mul_f32 v[0:1], v[0:1], v[174:175] op_sel_hi:[1,0]
    v_pk_mul_f32 v[2:3], v[2:3], v[174:175] op_sel_hi:[1,0]
    v_pk_mul_f32 v[4:5], v[4:5], v[174:175] op_sel_hi:[1,0]
    v_pk_mul_f32 v[6:7], v[6:7], v[174:175] op_sel_hi:[1,0]
    v_lshlrev_b32 v96, 16, v192
    v_and_b32 v97, 0xffff0000, v192
    v_lshlrev_b32 v98, 16, v193
    v_and_b32 v99, 0xffff0000, v193
    v_lshlrev_b32 v100, 16, v194
    v_and_b32 v101, 0xffff0000, v194
    v_lshlrev_b32 v102, 16, v195
    v_and_b32 v103, 0xffff0000, v195
    buffer_load_dwordx4 v158, s[72:75], s7 offen offset:1024 lds
    v_pk_fma_f32 v[0:1], v[96:97], v[176:177], v[0:1] op_sel_hi:[1,0,1]
    v_pk_fma_f32 v[2:3], v[98:99], v[176:177], v[2:3] op_sel_hi:[1,0,1]
    v_pk_fma_f32 v[4:5], v[100:101], v[176:177], v[4:5] op_sel_hi:[1,0,1]
    v_pk_fma_f32 v[6:7], v[102:103], v[176:177], v[6:7] op_sel_hi:[1,0,1]
    v_cvt_pk_bf16_f32 v192, v0, v1
    v_cvt_pk_bf16_f32 v193, v2, v3
    v_cvt_pk_bf16_f32 v194, v4, v5
    v_cvt_pk_bf16_f32 v195, v6, v7
    buffer_store_dwordx4 v[192:195], v155, s[16:19], s90 offen offset:0 sc0 sc1
    v_accvgpr_read_b32 v12, a4
    v_accvgpr_read_b32 v13, a5
    v_accvgpr_read_b32 v14, a6
    v_accvgpr_read_b32 v15, a7
    v_accvgpr_read_b32 v16, a12
    v_accvgpr_read_b32 v17, a13
    v_accvgpr_read_b32 v18, a14
    v_accvgpr_read_b32 v19, a15
    s_add_u32 m0, s62, 8192
    s_add_u32 s7, s61, 28672
    buffer_load_dwordx4 v157, s[72:75], s7 offen offset:0 lds
    v_pk_mul_f32 v[12:13], v[12:13], v[174:175] op_sel:[0,1] op_sel_hi:[1,1]
    v_pk_mul_f32 v[14:15], v[14:15], v[174:175] op_sel:[0,1] op_sel_hi:[1,1]
    v_pk_mul_f32 v[16:17], v[16:17], v[174:175] op_sel:[0,1] op_sel_hi:[1,1]
    v_pk_mul_f32 v[18:19], v[18:19], v[174:175] op_sel:[0,1] op_sel_hi:[1,1]
    v_lshlrev_b32 v104, 16, v196
    v_and_b32 v105, 0xffff0000, v196
    v_lshlrev_b32 v106, 16, v197
    v_and_b32 v107, 0xffff0000, v197
    v_lshlrev_b32 v108, 16, v198
    v_and_b32 v109, 0xffff0000, v198
    v_lshlrev_b32 v110, 16, v199
    v_and_b32 v111, 0xffff0000, v199
    buffer_load_dwordx4 v158, s[72:75], s7 offen offset:1024 lds
    v_pk_fma_f32 v[12:13], v[104:105], v[176:177], v[12:13] op_sel:[0,1,0] op_sel_hi:[1,1,1]
    v_pk_fma_f32 v[14:15], v[106:107], v[176:177], v[14:15] op_sel:[0,1,0] op_sel_hi:[1,1,1]
    v_pk_fma_f32 v[16:17], v[108:109], v[176:177], v[16:17] op_sel:[0,1,0] op_sel_hi:[1,1,1]
    v_pk_fma_f32 v[18:19], v[110:111], v[176:177], v[18:19] op_sel:[0,1,0] op_sel_hi:[1,1,1]
    v_cvt_pk_bf16_f32 v196, v12, v13
    v_cvt_pk_bf16_f32 v197, v14, v15
    v_cvt_pk_bf16_f32 v198, v16, v17
    v_cvt_pk_bf16_f32 v199, v18, v19
    v_accvgpr_read_b32 v24, a16
    v_accvgpr_read_b32 v25, a17
    v_accvgpr_read_b32 v26, a18
    v_accvgpr_read_b32 v27, a19
    v_accvgpr_read_b32 v28, a24
    v_accvgpr_read_b32 v29, a25
    v_accvgpr_read_b32 v30, a26
    v_accvgpr_read_b32 v31, a27
    s_add_u32 m0, s62, 16384
    s_add_u32 s7, s61, 256
    buffer_load_dwordx4 v188, s[72:75], s7 offen offset:0 lds
    v_pk_mul_f32 v[24:25], v[24:25], v[174:175] op_sel_hi:[1,0]
    v_pk_mul_f32 v[26:27], v[26:27], v[174:175] op_sel_hi:[1,0]
    v_pk_mul_f32 v[28:29], v[28:29], v[174:175] op_sel_hi:[1,0]
    v_pk_mul_f32 v[30:31], v[30:31], v[174:175] op_sel_hi:[1,0]
    v_lshlrev_b32 v96, 16, v200
    v_and_b32 v97, 0xffff0000, v200
    v_lshlrev_b32 v98, 16, v201
    v_and_b32 v99, 0xffff0000, v201
    v_lshlrev_b32 v100, 16, v202
    v_and_b32 v101, 0xffff0000, v202
    v_lshlrev_b32 v102, 16, v203
    v_and_b32 v103, 0xffff0000, v203
    buffer_load_dwordx4 v189, s[72:75], s7 offen offset:1024 lds
    v_pk_fma_f32 v[24:25], v[96:97], v[176:177], v[24:25] op_sel_hi:[1,0,1]
    v_pk_fma_f32 v[26:27], v[98:99], v[176:177], v[26:27] op_sel_hi:[1,0,1]
    v_pk_fma_f32 v[28:29], v[100:101], v[176:177], v[28:29] op_sel_hi:[1,0,1]
    v_pk_fma_f32 v[30:31], v[102:103], v[176:177], v[30:31] op_sel_hi:[1,0,1]
    v_cvt_pk_bf16_f32 v200, v24, v25
    v_cvt_pk_bf16_f32 v201, v26, v27
    v_cvt_pk_bf16_f32 v202, v28, v29
    v_cvt_pk_bf16_f32 v203, v30, v31
    v_accvgpr_read_b32 v36, a20
    v_accvgpr_read_b32 v37, a21
    v_accvgpr_read_b32 v38, a22
    v_accvgpr_read_b32 v39, a23
    v_accvgpr_read_b32 v40, a28
    v_accvgpr_read_b32 v41, a29
    v_accvgpr_read_b32 v42, a30
    v_accvgpr_read_b32 v43, a31
    s_add_u32 m0, s62, 24576
    s_add_u32 s7, s61, 28928
    buffer_load_dwordx4 v188, s[72:75], s7 offen offset:0 lds
    v_pk_mul_f32 v[36:37], v[36:37], v[174:175] op_sel:[0,1] op_sel_hi:[1,1]
    v_pk_mul_f32 v[38:39], v[38:39], v[174:175] op_sel:[0,1] op_sel_hi:[1,1]
    v_pk_mul_f32 v[40:41], v[40:41], v[174:175] op_sel:[0,1] op_sel_hi:[1,1]
    v_pk_mul_f32 v[42:43], v[42:43], v[174:175] op_sel:[0,1] op_sel_hi:[1,1]
    v_lshlrev_b32 v104, 16, v204
    v_and_b32 v105, 0xffff0000, v204
    v_lshlrev_b32 v106, 16, v205
    v_and_b32 v107, 0xffff0000, v205
    v_lshlrev_b32 v108, 16, v206
    v_and_b32 v109, 0xffff0000, v206
    v_lshlrev_b32 v110, 16, v207
    v_and_b32 v111, 0xffff0000, v207
    buffer_load_dwordx4 v189, s[72:75], s7 offen offset:1024 lds
    v_pk_fma_f32 v[36:37], v[104:105], v[176:177], v[36:37] op_sel:[0,1,0] op_sel_hi:[1,1,1]
    v_pk_fma_f32 v[38:39], v[106:107], v[176:177], v[38:39] op_sel:[0,1,0] op_sel_hi:[1,1,1]
    v_pk_fma_f32 v[40:41], v[108:109], v[176:177], v[40:41] op_sel:[0,1,0] op_sel_hi:[1,1,1]
    v_pk_fma_f32 v[42:43], v[110:111], v[176:177], v[42:43] op_sel:[0,1,0] op_sel_hi:[1,1,1]
    v_cvt_pk_bf16_f32 v204, v36, v37
    v_cvt_pk_bf16_f32 v205, v38, v39
    v_cvt_pk_bf16_f32 v206, v40, v41
    v_cvt_pk_bf16_f32 v207, v42, v43
    buffer_store_dwordx4 v[196:199], v155, s[16:19], s90 offen offset:1024 sc0 sc1
    v_accvgpr_read_b32 v48, a32
    v_accvgpr_read_b32 v49, a33
    v_accvgpr_read_b32 v50, a34
    v_accvgpr_read_b32 v51, a35
    v_accvgpr_read_b32 v52, a40
    v_accvgpr_read_b32 v53, a41
    v_accvgpr_read_b32 v54, a42
    v_accvgpr_read_b32 v55, a43
    s_add_u32 m0, s62, 32768
    s_add_u32 s7, s61, 57344
    buffer_load_dwordx4 v157, s[72:75], s7 offen offset:0 lds
    v_pk_mul_f32 v[48:49], v[48:49], v[174:175] op_sel_hi:[1,0]
    v_pk_mul_f32 v[50:51], v[50:51], v[174:175] op_sel_hi:[1,0]
    v_pk_mul_f32 v[52:53], v[52:53], v[174:175] op_sel_hi:[1,0]
    v_pk_mul_f32 v[54:55], v[54:55], v[174:175] op_sel_hi:[1,0]
    v_lshlrev_b32 v96, 16, v208
    v_and_b32 v97, 0xffff0000, v208
    v_lshlrev_b32 v98, 16, v209
    v_and_b32 v99, 0xffff0000, v209
    v_lshlrev_b32 v100, 16, v210
    v_and_b32 v101, 0xffff0000, v210
    v_lshlrev_b32 v102, 16, v211
    v_and_b32 v103, 0xffff0000, v211
    buffer_load_dwordx4 v158, s[72:75], s7 offen offset:1024 lds
    v_pk_fma_f32 v[48:49], v[96:97], v[176:177], v[48:49] op_sel_hi:[1,0,1]
    v_pk_fma_f32 v[50:51], v[98:99], v[176:177], v[50:51] op_sel_hi:[1,0,1]
    v_pk_fma_f32 v[52:53], v[100:101], v[176:177], v[52:53] op_sel_hi:[1,0,1]
    v_pk_fma_f32 v[54:55], v[102:103], v[176:177], v[54:55] op_sel_hi:[1,0,1]
    v_cvt_pk_bf16_f32 v208, v48, v49
    v_cvt_pk_bf16_f32 v209, v50, v51
    v_cvt_pk_bf16_f32 v210, v52, v53
    v_cvt_pk_bf16_f32 v211, v54, v55
    v_accvgpr_read_b32 v60, a36
    v_accvgpr_read_b32 v61, a37
    v_accvgpr_read_b32 v62, a38
    v_accvgpr_read_b32 v63, a39
    v_accvgpr_read_b32 v64, a44
    v_accvgpr_read_b32 v65, a45
    v_accvgpr_read_b32 v66, a46
    v_accvgpr_read_b32 v67, a47
    s_add_u32 m0, s62, 40960
    s_add_u32 s7, s61, 86016
    buffer_load_dwordx4 v157, s[72:75], s7 offen offset:0 lds
    v_pk_mul_f32 v[60:61], v[60:61], v[174:175] op_sel:[0,1] op_sel_hi:[1,1]
    v_pk_mul_f32 v[62:63], v[62:63], v[174:175] op_sel:[0,1] op_sel_hi:[1,1]
    v_pk_mul_f32 v[64:65], v[64:65], v[174:175] op_sel:[0,1] op_sel_hi:[1,1]
    v_pk_mul_f32 v[66:67], v[66:67], v[174:175] op_sel:[0,1] op_sel_hi:[1,1]
    v_lshlrev_b32 v104, 16, v212
    v_and_b32 v105, 0xffff0000, v212
    v_lshlrev_b32 v106, 16, v213
    v_and_b32 v107, 0xffff0000, v213
    v_lshlrev_b32 v108, 16, v214
    v_and_b32 v109, 0xffff0000, v214
    v_lshlrev_b32 v110, 16, v215
    v_and_b32 v111, 0xffff0000, v215
    buffer_load_dwordx4 v158, s[72:75], s7 offen offset:1024 lds
    v_pk_fma_f32 v[60:61], v[104:105], v[176:177], v[60:61] op_sel:[0,1,0] op_sel_hi:[1,1,1]
    v_pk_fma_f32 v[62:63], v[106:107], v[176:177], v[62:63] op_sel:[0,1,0] op_sel_hi:[1,1,1]
    v_pk_fma_f32 v[64:65], v[108:109], v[176:177], v[64:65] op_sel:[0,1,0] op_sel_hi:[1,1,1]
    v_pk_fma_f32 v[66:67], v[110:111], v[176:177], v[66:67] op_sel:[0,1,0] op_sel_hi:[1,1,1]
    v_cvt_pk_bf16_f32 v212, v60, v61
    v_cvt_pk_bf16_f32 v213, v62, v63
    v_cvt_pk_bf16_f32 v214, v64, v65
    v_cvt_pk_bf16_f32 v215, v66, v67
    v_accvgpr_read_b32 v72, a48
    v_accvgpr_read_b32 v73, a49
    v_accvgpr_read_b32 v74, a50
    v_accvgpr_read_b32 v75, a51
    v_accvgpr_read_b32 v76, a56
    v_accvgpr_read_b32 v77, a57
    v_accvgpr_read_b32 v78, a58
    v_accvgpr_read_b32 v79, a59
    s_add_u32 m0, s62, 49152
    s_add_u32 s7, s61, 57600
    buffer_load_dwordx4 v188, s[72:75], s7 offen offset:0 lds
    v_pk_mul_f32 v[72:73], v[72:73], v[174:175] op_sel_hi:[1,0]
    v_pk_mul_f32 v[74:75], v[74:75], v[174:175] op_sel_hi:[1,0]
    v_pk_mul_f32 v[76:77], v[76:77], v[174:175] op_sel_hi:[1,0]
    v_pk_mul_f32 v[78:79], v[78:79], v[174:175] op_sel_hi:[1,0]
    v_lshlrev_b32 v96, 16, v216
    v_and_b32 v97, 0xffff0000, v216
    v_lshlrev_b32 v98, 16, v217
    v_and_b32 v99, 0xffff0000, v217
    v_lshlrev_b32 v100, 16, v218
    v_and_b32 v101, 0xffff0000, v218
    v_lshlrev_b32 v102, 16, v219
    v_and_b32 v103, 0xffff0000, v219
    buffer_load_dwordx4 v189, s[72:75], s7 offen offset:1024 lds
    v_pk_fma_f32 v[72:73], v[96:97], v[176:177], v[72:73] op_sel_hi:[1,0,1]
    v_pk_fma_f32 v[74:75], v[98:99], v[176:177], v[74:75] op_sel_hi:[1,0,1]
    v_pk_fma_f32 v[76:77], v[100:101], v[176:177], v[76:77] op_sel_hi:[1,0,1]
    v_pk_fma_f32 v[78:79], v[102:103], v[176:177], v[78:79] op_sel_hi:[1,0,1]
    v_cvt_pk_bf16_f32 v216, v72, v73
    v_cvt_pk_bf16_f32 v217, v74, v75
    v_cvt_pk_bf16_f32 v218, v76, v77
    v_cvt_pk_bf16_f32 v219, v78, v79
    buffer_store_dwordx4 v[200:203], v155, s[16:19], s90 offen offset:2048 sc0 sc1
    v_accvgpr_read_b32 v84, a52
    v_accvgpr_read_b32 v85, a53
    v_accvgpr_read_b32 v86, a54
    v_accvgpr_read_b32 v87, a55
    v_accvgpr_read_b32 v88, a60
    v_accvgpr_read_b32 v89, a61
    v_accvgpr_read_b32 v90, a62
    v_accvgpr_read_b32 v91, a63
    s_add_u32 m0, s62, 57344
    s_add_u32 s7, s61, 86272
    buffer_load_dwordx4 v188, s[72:75], s7 offen offset:0 lds
    v_pk_mul_f32 v[84:85], v[84:85], v[174:175] op_sel:[0,1] op_sel_hi:[1,1]
    v_pk_mul_f32 v[86:87], v[86:87], v[174:175] op_sel:[0,1] op_sel_hi:[1,1]
    v_pk_mul_f32 v[88:89], v[88:89], v[174:175] op_sel:[0,1] op_sel_hi:[1,1]
    v_pk_mul_f32 v[90:91], v[90:91], v[174:175] op_sel:[0,1] op_sel_hi:[1,1]
    v_lshlrev_b32 v104, 16, v220
    v_and_b32 v105, 0xffff0000, v220
    v_lshlrev_b32 v106, 16, v221
    v_and_b32 v107, 0xffff0000, v221
    v_lshlrev_b32 v108, 16, v222
    v_and_b32 v109, 0xffff0000, v222
    v_lshlrev_b32 v110, 16, v223
    v_and_b32 v111, 0xffff0000, v223
    buffer_load_dwordx4 v189, s[72:75], s7 offen offset:1024 lds
    v_pk_fma_f32 v[84:85], v[104:105], v[176:177], v[84:85] op_sel:[0,1,0] op_sel_hi:[1,1,1]
    v_pk_fma_f32 v[86:87], v[106:107], v[176:177], v[86:87] op_sel:[0,1,0] op_sel_hi:[1,1,1]
    v_pk_fma_f32 v[88:89], v[108:109], v[176:177], v[88:89] op_sel:[0,1,0] op_sel_hi:[1,1,1]
    v_pk_fma_f32 v[90:91], v[110:111], v[176:177], v[90:91] op_sel:[0,1,0] op_sel_hi:[1,1,1]
    v_cvt_pk_bf16_f32 v220, v84, v85
    v_cvt_pk_bf16_f32 v221, v86, v87
    v_cvt_pk_bf16_f32 v222, v88, v89
    v_cvt_pk_bf16_f32 v223, v90, v91
    v_accvgpr_read_b32 v0, a64
    v_accvgpr_read_b32 v1, a65
    v_accvgpr_read_b32 v2, a66
    v_accvgpr_read_b32 v3, a67
    v_accvgpr_read_b32 v4, a72
    v_accvgpr_read_b32 v5, a73
    v_accvgpr_read_b32 v6, a74
    v_accvgpr_read_b32 v7, a75
    v_pk_mul_f32 v[0:1], v[0:1], v[174:175] op_sel_hi:[1,0]
    v_pk_mul_f32 v[2:3], v[2:3], v[174:175] op_sel_hi:[1,0]
    v_pk_mul_f32 v[4:5], v[4:5], v[174:175] op_sel_hi:[1,0]
    v_pk_mul_f32 v[6:7], v[6:7], v[174:175] op_sel_hi:[1,0]
    v_lshlrev_b32 v96, 16, v224
    v_and_b32 v97, 0xffff0000, v224
    v_lshlrev_b32 v98, 16, v225
    v_and_b32 v99, 0xffff0000, v225
    v_lshlrev_b32 v100, 16, v226
    v_and_b32 v101, 0xffff0000, v226
    v_lshlrev_b32 v102, 16, v227
    v_and_b32 v103, 0xffff0000, v227
    v_pk_fma_f32 v[0:1], v[96:97], v[176:177], v[0:1] op_sel_hi:[1,0,1]
    v_pk_fma_f32 v[2:3], v[98:99], v[176:177], v[2:3] op_sel_hi:[1,0,1]
    v_pk_fma_f32 v[4:5], v[100:101], v[176:177], v[4:5] op_sel_hi:[1,0,1]
    v_pk_fma_f32 v[6:7], v[102:103], v[176:177], v[6:7] op_sel_hi:[1,0,1]
    v_cvt_pk_bf16_f32 v224, v0, v1
    v_cvt_pk_bf16_f32 v225, v2, v3
    v_cvt_pk_bf16_f32 v226, v4, v5
    v_cvt_pk_bf16_f32 v227, v6, v7
    v_accvgpr_read_b32 v12, a68
    v_accvgpr_read_b32 v13, a69
    v_accvgpr_read_b32 v14, a70
    v_accvgpr_read_b32 v15, a71
    v_accvgpr_read_b32 v16, a76
    v_accvgpr_read_b32 v17, a77
    v_accvgpr_read_b32 v18, a78
    v_accvgpr_read_b32 v19, a79
    v_pk_mul_f32 v[12:13], v[12:13], v[174:175] op_sel:[0,1] op_sel_hi:[1,1]
    v_pk_mul_f32 v[14:15], v[14:15], v[174:175] op_sel:[0,1] op_sel_hi:[1,1]
    v_pk_mul_f32 v[16:17], v[16:17], v[174:175] op_sel:[0,1] op_sel_hi:[1,1]
    v_pk_mul_f32 v[18:19], v[18:19], v[174:175] op_sel:[0,1] op_sel_hi:[1,1]
    v_lshlrev_b32 v104, 16, v228
    v_and_b32 v105, 0xffff0000, v228
    v_lshlrev_b32 v106, 16, v229
    v_and_b32 v107, 0xffff0000, v229
    v_lshlrev_b32 v108, 16, v230
    v_and_b32 v109, 0xffff0000, v230
    v_lshlrev_b32 v110, 16, v231
    v_and_b32 v111, 0xffff0000, v231
    v_pk_fma_f32 v[12:13], v[104:105], v[176:177], v[12:13] op_sel:[0,1,0] op_sel_hi:[1,1,1]
    v_pk_fma_f32 v[14:15], v[106:107], v[176:177], v[14:15] op_sel:[0,1,0] op_sel_hi:[1,1,1]
    v_pk_fma_f32 v[16:17], v[108:109], v[176:177], v[16:17] op_sel:[0,1,0] op_sel_hi:[1,1,1]
    v_pk_fma_f32 v[18:19], v[110:111], v[176:177], v[18:19] op_sel:[0,1,0] op_sel_hi:[1,1,1]
    v_cvt_pk_bf16_f32 v228, v12, v13
    v_cvt_pk_bf16_f32 v229, v14, v15
    v_cvt_pk_bf16_f32 v230, v16, v17
    v_cvt_pk_bf16_f32 v231, v18, v19
    buffer_store_dwordx4 v[204:207], v155, s[16:19], s90 offen offset:3072 sc0 sc1
    v_accvgpr_read_b32 v24, a80
    v_accvgpr_read_b32 v25, a81
    v_accvgpr_read_b32 v26, a82
    v_accvgpr_read_b32 v27, a83
    v_accvgpr_read_b32 v28, a88
    v_accvgpr_read_b32 v29, a89
    v_accvgpr_read_b32 v30, a90
    v_accvgpr_read_b32 v31, a91
    v_pk_mul_f32 v[24:25], v[24:25], v[174:175] op_sel_hi:[1,0]
    v_pk_mul_f32 v[26:27], v[26:27], v[174:175] op_sel_hi:[1,0]
    v_pk_mul_f32 v[28:29], v[28:29], v[174:175] op_sel_hi:[1,0]
    v_pk_mul_f32 v[30:31], v[30:31], v[174:175] op_sel_hi:[1,0]
    v_lshlrev_b32 v96, 16, v232
    v_and_b32 v97, 0xffff0000, v232
    v_lshlrev_b32 v98, 16, v233
    v_and_b32 v99, 0xffff0000, v233
    v_lshlrev_b32 v100, 16, v234
    v_and_b32 v101, 0xffff0000, v234
    v_lshlrev_b32 v102, 16, v235
    v_and_b32 v103, 0xffff0000, v235
    v_pk_fma_f32 v[24:25], v[96:97], v[176:177], v[24:25] op_sel_hi:[1,0,1]
    v_pk_fma_f32 v[26:27], v[98:99], v[176:177], v[26:27] op_sel_hi:[1,0,1]
    v_pk_fma_f32 v[28:29], v[100:101], v[176:177], v[28:29] op_sel_hi:[1,0,1]
    v_pk_fma_f32 v[30:31], v[102:103], v[176:177], v[30:31] op_sel_hi:[1,0,1]
    v_cvt_pk_bf16_f32 v232, v24, v25
    v_cvt_pk_bf16_f32 v233, v26, v27
    v_cvt_pk_bf16_f32 v234, v28, v29
    v_cvt_pk_bf16_f32 v235, v30, v31
    v_accvgpr_read_b32 v36, a84
    v_accvgpr_read_b32 v37, a85
    v_accvgpr_read_b32 v38, a86
    v_accvgpr_read_b32 v39, a87
    v_accvgpr_read_b32 v40, a92
    v_accvgpr_read_b32 v41, a93
    v_accvgpr_read_b32 v42, a94
    v_accvgpr_read_b32 v43, a95
    v_pk_mul_f32 v[36:37], v[36:37], v[174:175] op_sel:[0,1] op_sel_hi:[1,1]
    v_pk_mul_f32 v[38:39], v[38:39], v[174:175] op_sel:[0,1] op_sel_hi:[1,1]
    v_pk_mul_f32 v[40:41], v[40:41], v[174:175] op_sel:[0,1] op_sel_hi:[1,1]
    v_pk_mul_f32 v[42:43], v[42:43], v[174:175] op_sel:[0,1] op_sel_hi:[1,1]
    v_lshlrev_b32 v104, 16, v236
    v_and_b32 v105, 0xffff0000, v236
    v_lshlrev_b32 v106, 16, v237
    v_and_b32 v107, 0xffff0000, v237
    v_lshlrev_b32 v108, 16, v238
    v_and_b32 v109, 0xffff0000, v238
    v_lshlrev_b32 v110, 16, v239
    v_and_b32 v111, 0xffff0000, v239
    v_pk_fma_f32 v[36:37], v[104:105], v[176:177], v[36:37] op_sel:[0,1,0] op_sel_hi:[1,1,1]
    v_pk_fma_f32 v[38:39], v[106:107], v[176:177], v[38:39] op_sel:[0,1,0] op_sel_hi:[1,1,1]
    v_pk_fma_f32 v[40:41], v[108:109], v[176:177], v[40:41] op_sel:[0,1,0] op_sel_hi:[1,1,1]
    v_pk_fma_f32 v[42:43], v[110:111], v[176:177], v[42:43] op_sel:[0,1,0] op_sel_hi:[1,1,1]
    v_cvt_pk_bf16_f32 v236, v36, v37
    v_cvt_pk_bf16_f32 v237, v38, v39
    v_cvt_pk_bf16_f32 v238, v40, v41
    v_cvt_pk_bf16_f32 v239, v42, v43
    v_accvgpr_read_b32 v48, a96
    v_accvgpr_read_b32 v49, a97
    v_accvgpr_read_b32 v50, a98
    v_accvgpr_read_b32 v51, a99
    v_accvgpr_read_b32 v52, a104
    v_accvgpr_read_b32 v53, a105
    v_accvgpr_read_b32 v54, a106
    v_accvgpr_read_b32 v55, a107
    v_pk_mul_f32 v[48:49], v[48:49], v[174:175] op_sel_hi:[1,0]
    v_pk_mul_f32 v[50:51], v[50:51], v[174:175] op_sel_hi:[1,0]
    v_pk_mul_f32 v[52:53], v[52:53], v[174:175] op_sel_hi:[1,0]
    v_pk_mul_f32 v[54:55], v[54:55], v[174:175] op_sel_hi:[1,0]
    v_lshlrev_b32 v96, 16, v240
    v_and_b32 v97, 0xffff0000, v240
    v_lshlrev_b32 v98, 16, v241
    v_and_b32 v99, 0xffff0000, v241
    v_lshlrev_b32 v100, 16, v242
    v_and_b32 v101, 0xffff0000, v242
    v_lshlrev_b32 v102, 16, v243
    v_and_b32 v103, 0xffff0000, v243
    v_pk_fma_f32 v[48:49], v[96:97], v[176:177], v[48:49] op_sel_hi:[1,0,1]
    v_pk_fma_f32 v[50:51], v[98:99], v[176:177], v[50:51] op_sel_hi:[1,0,1]
    v_pk_fma_f32 v[52:53], v[100:101], v[176:177], v[52:53] op_sel_hi:[1,0,1]
    v_pk_fma_f32 v[54:55], v[102:103], v[176:177], v[54:55] op_sel_hi:[1,0,1]
    v_cvt_pk_bf16_f32 v240, v48, v49
    v_cvt_pk_bf16_f32 v241, v50, v51
    v_cvt_pk_bf16_f32 v242, v52, v53
    v_cvt_pk_bf16_f32 v243, v54, v55
    s_add_u32 s90, s90, 4096
    buffer_store_dwordx4 v[208:211], v155, s[16:19], s90 offen offset:0 sc0 sc1
    v_accvgpr_read_b32 v60, a100
    v_accvgpr_read_b32 v61, a101
    v_accvgpr_read_b32 v62, a102
    v_accvgpr_read_b32 v63, a103
    v_accvgpr_read_b32 v64, a108
    v_accvgpr_read_b32 v65, a109
    v_accvgpr_read_b32 v66, a110
    v_accvgpr_read_b32 v67, a111
    v_pk_mul_f32 v[60:61], v[60:61], v[174:175] op_sel:[0,1] op_sel_hi:[1,1]
    v_pk_mul_f32 v[62:63], v[62:63], v[174:175] op_sel:[0,1] op_sel_hi:[1,1]
    v_pk_mul_f32 v[64:65], v[64:65], v[174:175] op_sel:[0,1] op_sel_hi:[1,1]
    v_pk_mul_f32 v[66:67], v[66:67], v[174:175] op_sel:[0,1] op_sel_hi:[1,1]
    v_lshlrev_b32 v104, 16, v244
    v_and_b32 v105, 0xffff0000, v244
    v_lshlrev_b32 v106, 16, v245
    v_and_b32 v107, 0xffff0000, v245
    v_lshlrev_b32 v108, 16, v246
    v_and_b32 v109, 0xffff0000, v246
    v_lshlrev_b32 v110, 16, v247
    v_and_b32 v111, 0xffff0000, v247
    v_pk_fma_f32 v[60:61], v[104:105], v[176:177], v[60:61] op_sel:[0,1,0] op_sel_hi:[1,1,1]
    v_pk_fma_f32 v[62:63], v[106:107], v[176:177], v[62:63] op_sel:[0,1,0] op_sel_hi:[1,1,1]
    v_pk_fma_f32 v[64:65], v[108:109], v[176:177], v[64:65] op_sel:[0,1,0] op_sel_hi:[1,1,1]
    v_pk_fma_f32 v[66:67], v[110:111], v[176:177], v[66:67] op_sel:[0,1,0] op_sel_hi:[1,1,1]
    v_cvt_pk_bf16_f32 v244, v60, v61
    v_cvt_pk_bf16_f32 v245, v62, v63
    v_cvt_pk_bf16_f32 v246, v64, v65
    v_cvt_pk_bf16_f32 v247, v66, v67
    v_accvgpr_read_b32 v72, a112
    v_accvgpr_read_b32 v73, a113
    v_accvgpr_read_b32 v74, a114
    v_accvgpr_read_b32 v75, a115
    v_accvgpr_read_b32 v76, a120
    v_accvgpr_read_b32 v77, a121
    v_accvgpr_read_b32 v78, a122
    v_accvgpr_read_b32 v79, a123
    v_pk_mul_f32 v[72:73], v[72:73], v[174:175] op_sel_hi:[1,0]
    v_pk_mul_f32 v[74:75], v[74:75], v[174:175] op_sel_hi:[1,0]
    v_pk_mul_f32 v[76:77], v[76:77], v[174:175] op_sel_hi:[1,0]
    v_pk_mul_f32 v[78:79], v[78:79], v[174:175] op_sel_hi:[1,0]
    v_lshlrev_b32 v96, 16, v248
    v_and_b32 v97, 0xffff0000, v248
    v_lshlrev_b32 v98, 16, v249
    v_and_b32 v99, 0xffff0000, v249
    v_lshlrev_b32 v100, 16, v250
    v_and_b32 v101, 0xffff0000, v250
    v_lshlrev_b32 v102, 16, v251
    v_and_b32 v103, 0xffff0000, v251
    v_pk_fma_f32 v[72:73], v[96:97], v[176:177], v[72:73] op_sel_hi:[1,0,1]
    v_pk_fma_f32 v[74:75], v[98:99], v[176:177], v[74:75] op_sel_hi:[1,0,1]
    v_pk_fma_f32 v[76:77], v[100:101], v[176:177], v[76:77] op_sel_hi:[1,0,1]
    v_pk_fma_f32 v[78:79], v[102:103], v[176:177], v[78:79] op_sel_hi:[1,0,1]
    v_cvt_pk_bf16_f32 v248, v72, v73
    v_cvt_pk_bf16_f32 v249, v74, v75
    v_cvt_pk_bf16_f32 v250, v76, v77
    v_cvt_pk_bf16_f32 v251, v78, v79
    v_accvgpr_read_b32 v84, a116
    v_accvgpr_read_b32 v85, a117
    v_accvgpr_read_b32 v86, a118
    v_accvgpr_read_b32 v87, a119
    v_accvgpr_read_b32 v88, a124
    v_accvgpr_read_b32 v89, a125
    v_accvgpr_read_b32 v90, a126
    v_accvgpr_read_b32 v91, a127
    v_pk_mul_f32 v[84:85], v[84:85], v[174:175] op_sel:[0,1] op_sel_hi:[1,1]
    v_pk_mul_f32 v[86:87], v[86:87], v[174:175] op_sel:[0,1] op_sel_hi:[1,1]
    v_pk_mul_f32 v[88:89], v[88:89], v[174:175] op_sel:[0,1] op_sel_hi:[1,1]
    v_pk_mul_f32 v[90:91], v[90:91], v[174:175] op_sel:[0,1] op_sel_hi:[1,1]
    v_lshlrev_b32 v104, 16, v252
    v_and_b32 v105, 0xffff0000, v252
    v_lshlrev_b32 v106, 16, v253
    v_and_b32 v107, 0xffff0000, v253
    v_lshlrev_b32 v108, 16, v254
    v_and_b32 v109, 0xffff0000, v254
    v_lshlrev_b32 v110, 16, v255
    v_and_b32 v111, 0xffff0000, v255
    v_pk_fma_f32 v[84:85], v[104:105], v[176:177], v[84:85] op_sel:[0,1,0] op_sel_hi:[1,1,1]
    v_pk_fma_f32 v[86:87], v[106:107], v[176:177], v[86:87] op_sel:[0,1,0] op_sel_hi:[1,1,1]
    v_pk_fma_f32 v[88:89], v[108:109], v[176:177], v[88:89] op_sel:[0,1,0] op_sel_hi:[1,1,1]
    v_pk_fma_f32 v[90:91], v[110:111], v[176:177], v[90:91] op_sel:[0,1,0] op_sel_hi:[1,1,1]
    v_cvt_pk_bf16_f32 v252, v84, v85
    v_cvt_pk_bf16_f32 v253, v86, v87
    v_cvt_pk_bf16_f32 v254, v88, v89
    v_cvt_pk_bf16_f32 v255, v90, v91
    buffer_store_dwordx4 v[212:215], v155, s[16:19], s90 offen offset:1024 sc0 sc1
L3_go:
    v_lshrrev_b32 v182, 4, v155
    v_lshrrev_b32 v176, 4, v182
    v_bfe_u32 v178, v182, 2, 2
    v_lshlrev_b32 v179, 2, v176
    v_add_u32 v179, v179, v178
    v_and_b32 v180, 7, v179
    v_lshlrev_b32 v179, 8, v179
    v_and_b32 v178, 3, v182
    v_lshl_add_u32 v179, v178, 3, v179
    v_xor_b32 v178, 0, v180
    v_lshl_add_u32 v128, v178, 5, v179
    v_xor_b32 v178, 1, v180
    v_lshl_add_u32 v129, v178, 5, v179
    v_xor_b32 v178, 2, v180
    v_lshl_add_u32 v130, v178, 5, v179
    v_xor_b32 v178, 3, v180
    v_lshl_add_u32 v131, v178, 5, v179
    v_xor_b32 v178, 4, v180
    v_lshl_add_u32 v132, v178, 5, v179
    v_xor_b32 v178, 5, v180
    v_lshl_add_u32 v133, v178, 5, v179
    v_xor_b32 v178, 6, v180
    v_lshl_add_u32 v134, v178, 5, v179
    v_xor_b32 v178, 7, v180
    v_lshl_add_u32 v135, v178, 5, v179
    s_waitcnt vmcnt(8)
    s_barrier
    ds_read_b64_tr_b16 a[128:129], v128 offset:0
    ds_read_b64_tr_b16 a[130:131], v128 offset:4096
    ds_read_b64_tr_b16 a[132:133], v128 offset:8192
    ds_read_b64_tr_b16 a[134:135], v128 offset:12288
    ds_read_b64_tr_b16 a[136:137], v129 offset:0
    ds_read_b64_tr_b16 a[138:139], v129 offset:4096
    ds_read_b64_tr_b16 a[140:141], v129 offset:8192
    ds_read_b64_tr_b16 a[142:143], v129 offset:12288
    ds_read_b64_tr_b16 a[144:145], v130 offset:0
    ds_read_b64_tr_b16 a[146:147], v130 offset:4096
    ds_read_b64_tr_b16 a[148:149], v130 offset:8192
    ds_read_b64_tr_b16 a[150:151], v130 offset:12288
    ds_read_b64_tr_b16 a[152:153], v131 offset:0
    ds_read_b64_tr_b16 a[154:155], v131 offset:4096
    s_waitcnt lgkmcnt(10)
    v_mfma_f32_16x16x32_bf16 v[0:3], a[128:131], v[192:195], 0
    ds_read_b64_tr_b16 a[156:157], v131 offset:8192
    s_add_u32 m0, s62, 65536
    v_mfma_f32_16x16x32_bf16 v[0:3], a[132:135], v[200:203], v[0:3]
    ds_read_b64_tr_b16 a[158:159], v131 offset:12288
    s_add_u32 s7, s61, 114688
    v_mfma_f32_16x16x32_bf16 v[4:7], a[132:135], v[204:207], 0
    ds_read_b64_tr_b16 a[160:161], v132 offset:0
    v_mfma_f32_16x16x32_bf16 v[4:7], a[128:131], v[196:199], v[4:7]
    ds_read_b64_tr_b16 a[162:163], v132 offset:4096
    buffer_load_dwordx4 v157, s[72:75], s7 offen offset:0 lds
    s_waitcnt lgkmcnt(10)
    v_mfma_f32_16x16x32_bf16 v[12:15], a[136:139], v[196:199], 0
    ds_read_b64_tr_b16 a[164:165], v132 offset:8192
    v_mfma_f32_16x16x32_bf16 v[12:15], a[140:143], v[204:207], v[12:15]
    ds_read_b64_tr_b16 a[166:167], v132 offset:12288
    buffer_load_dwordx4 v158, s[72:75], s7 offen offset:1024 lds
    v_mfma_f32_16x16x32_bf16 v[8:11], a[140:143], v[200:203], 0
    ds_read_b64_tr_b16 a[168:169], v133 offset:0
    s_add_u32 m0, s62, 73728
    v_mfma_f32_16x16x32_bf16 v[8:11], a[136:139], v[192:195], v[8:11]
    ds_read_b64_tr_b16 a[170:171], v133 offset:4096
    s_waitcnt lgkmcnt(10)
    v_mfma_f32_16x16x32_bf16 v[16:19], a[144:147], v[192:195], 0
    ds_read_b64_tr_b16 a[172:173], v133 offset:8192
    s_add_u32 s7, s61, 143360
    v_mfma_f32_16x16x32_bf16 v[16:19], a[148:151], v[200:203], v[16:19]
    ds_read_b64_tr_b16 a[174:175], v133 offset:12288
    buffer_store_dwordx4 v[216:219], v155, s[16:19], s90 offen offset:2048 sc0 sc1
    v_mfma_f32_16x16x32_bf16 v[20:23], a[148:151], v[204:207], 0
    ds_read_b64_tr_b16 a[176:177], v134 offset:0
    v_mfma_f32_16x16x32_bf16 v[20:23], a[144:147], v[196:199], v[20:23]
    ds_read_b64_tr_b16 a[178:179], v134 offset:4096
    buffer_load_dwordx4 v157, s[72:75], s7 offen offset:0 lds
    s_waitcnt lgkmcnt(10)
    v_mfma_f32_16x16x32_bf16 v[28:31], a[152:155], v[196:199], 0
    ds_read_b64_tr_b16 a[180:181], v134 offset:8192
    v_mfma_f32_16x16x32_bf16 v[28:31], a[156:159], v[204:207], v[28:31]
    ds_read_b64_tr_b16 a[182:183], v134 offset:12288
    buffer_load_dwordx4 v158, s[72:75], s7 offen offset:1024 lds
    v_mfma_f32_16x16x32_bf16 v[24:27], a[156:159], v[200:203], 0
    ds_read_b64_tr_b16 a[184:185], v135 offset:0
    s_add_u32 m0, s62, 81920
    v_mfma_f32_16x16x32_bf16 v[24:27], a[152:155], v[192:195], v[24:27]
    ds_read_b64_tr_b16 a[186:187], v135 offset:4096
    s_waitcnt lgkmcnt(10)
    v_mfma_f32_16x16x32_bf16 v[32:35], a[160:163], v[192:195], 0
    ds_read_b64_tr_b16 a[188:189], v135 offset:8192
    s_add_u32 s7, s61, 114944
    v_mfma_f32_16x16x32_bf16 v[32:35], a[164:167], v[200:203], v[32:35]
    ds_read_b64_tr_b16 a[190:191], v135 offset:12288
    buffer_load_dwordx4 v188, s[72:75], s7 offen offset:0 lds
    v_mfma_f32_16x16x32_bf16 v[36:39], a[164:167], v[204:207], 0
    ds_read_b64_tr_b16 a[128:129], v128 offset:16384
    v_mfma_f32_16x16x32_bf16 v[36:39], a[160:163], v[196:199], v[36:39]
    ds_read_b64_tr_b16 a[130:131], v128 offset:20480
    buffer_load_dwordx4 v189, s[72:75], s7 offen offset:1024 lds
    s_waitcnt lgkmcnt(10)
    v_mfma_f32_16x16x32_bf16 v[44:47], a[168:171], v[196:199], 0
    ds_read_b64_tr_b16 a[132:133], v128 offset:24576
    s_add_u32 m0, s62, 90112
    v_mfma_f32_16x16x32_bf16 v[44:47], a[172:175], v[204:207], v[44:47]
    ds_read_b64_tr_b16 a[134:135], v128 offset:28672
    s_add_u32 s7, s61, 143616
    v_mfma_f32_16x16x32_bf16 v[40:43], a[172:175], v[200:203], 0
    ds_read_b64_tr_b16 a[136:137], v129 offset:16384
    v_mfma_f32_16x16x32_bf16 v[40:43], a[168:171], v[192:195], v[40:43]
    ds_read_b64_tr_b16 a[138:139], v129 offset:20480
    buffer_load_dwordx4 v188, s[72:75], s7 offen offset:0 lds
    s_waitcnt lgkmcnt(10)
    v_mfma_f32_16x16x32_bf16 v[48:51], a[176:179], v[192:195], 0
    ds_read_b64_tr_b16 a[140:141], v129 offset:24576
    v_mfma_f32_16x16x32_bf16 v[48:51], a[180:183], v[200:203], v[48:51]
    ds_read_b64_tr_b16 a[142:143], v129 offset:28672
    buffer_store_dwordx4 v[220:223], v155, s[16:19], s90 offen offset:3072 sc0 sc1
    v_mfma_f32_16x16x32_bf16 v[52:55], a[180:183], v[204:207], 0
    ds_read_b64_tr_b16 a[144:145], v130 offset:16384
    v_mfma_f32_16x16x32_bf16 v[52:55], a[176:179], v[196:199], v[52:55]
    ds_read_b64_tr_b16 a[146:147], v130 offset:20480
    buffer_load_dwordx4 v189, s[72:75], s7 offen offset:1024 lds
    s_waitcnt lgkmcnt(10)
    v_mfma_f32_16x16x32_bf16 v[60:63], a[184:187], v[196:199], 0
    ds_read_b64_tr_b16 a[148:149], v130 offset:24576
    s_lshl_b32 s4, s3, 5
    v_mfma_f32_16x16x32_bf16 v[60:63], a[188:191], v[204:207], v[60:63]
    ds_read_b64_tr_b16 a[150:151], v130 offset:28672
    s_lshr_b32 s5, s59, 1
    v_mfma_f32_16x16x32_bf16 v[56:59], a[188:191], v[200:203], 0
    ds_read_b64_tr_b16 a[152:153], v131 offset:16384
    s_add_u32 s4, s4, s5
    v_mfma_f32_16x16x32_bf16 v[56:59], a[184:187], v[192:195], v[56:59]
    ds_read_b64_tr_b16 a[154:155], v131 offset:20480
    s_mul_i32 s4, s4, 14336
    s_waitcnt lgkmcnt(10)
    v_mfma_f32_16x16x32_bf16 v[64:67], a[128:131], v[192:195], 0
    ds_read_b64_tr_b16 a[156:157], v131 offset:24576
    s_add_u32 m0, s62, 98304
    v_mfma_f32_16x16x32_bf16 v[64:67], a[132:135], v[200:203], v[64:67]
    ds_read_b64_tr_b16 a[158:159], v131 offset:28672
    s_add_u32 s7, s61, 172032
    v_mfma_f32_16x16x32_bf16 v[68:71], a[132:135], v[204:207], 0
    ds_read_b64_tr_b16 a[160:161], v132 offset:16384
    v_mfma_f32_16x16x32_bf16 v[68:71], a[128:131], v[196:199], v[68:71]
    ds_read_b64_tr_b16 a[162:163], v132 offset:20480
    buffer_load_dwordx4 v157, s[72:75], s7 offen offset:0 lds
    s_waitcnt lgkmcnt(10)
    v_mfma_f32_16x16x32_bf16 v[76:79], a[136:139], v[196:199], 0
    ds_read_b64_tr_b16 a[164:165], v132 offset:24576
    v_mfma_f32_16x16x32_bf16 v[76:79], a[140:143], v[204:207], v[76:79]
    ds_read_b64_tr_b16 a[166:167], v132 offset:28672
    buffer_load_dwordx4 v158, s[72:75], s7 offen offset:1024 lds
    v_mfma_f32_16x16x32_bf16 v[72:75], a[140:143], v[200:203], 0
    ds_read_b64_tr_b16 a[168:169], v133 offset:16384
    s_add_u32 m0, s62, 106496
    v_mfma_f32_16x16x32_bf16 v[72:75], a[136:139], v[192:195], v[72:75]
    ds_read_b64_tr_b16 a[170:171], v133 offset:20480
    s_waitcnt lgkmcnt(10)
    v_mfma_f32_16x16x32_bf16 v[80:83], a[144:147], v[192:195], 0
    ds_read_b64_tr_b16 a[172:173], v133 offset:24576
    s_add_u32 s7, s61, 200704
    v_mfma_f32_16x16x32_bf16 v[80:83], a[148:151], v[200:203], v[80:83]
    ds_read_b64_tr_b16 a[174:175], v133 offset:28672
    s_add_u32 s90, s90, 4096
    buffer_store_dwordx4 v[224:227], v155, s[16:19], s90 offen offset:0 sc0 sc1
    v_mfma_f32_16x16x32_bf16 v[84:87], a[148:151], v[204:207], 0
    s_waitcnt vmcnt(13)
    s_barrier
    ds_read_b64_tr_b16 a[176:177], v128 offset:32768
    v_mfma_f32_16x16x32_bf16 v[84:87], a[144:147], v[196:199], v[84:87]
    ds_read_b64_tr_b16 a[178:179], v128 offset:36864
    buffer_load_dwordx4 v157, s[72:75], s7 offen offset:0 lds
    s_waitcnt lgkmcnt(10)
    v_mfma_f32_16x16x32_bf16 v[92:95], a[152:155], v[196:199], 0
    ds_read_b64_tr_b16 a[180:181], v128 offset:40960
    v_mfma_f32_16x16x32_bf16 v[92:95], a[156:159], v[204:207], v[92:95]
    ds_read_b64_tr_b16 a[182:183], v128 offset:45056
    buffer_load_dwordx4 v158, s[72:75], s7 offen offset:1024 lds
    v_mfma_f32_16x16x32_bf16 v[88:91], a[156:159], v[200:203], 0
    ds_read_b64_tr_b16 a[184:185], v129 offset:32768
    s_add_u32 m0, s62, 114688
    v_mfma_f32_16x16x32_bf16 v[88:91], a[152:155], v[192:195], v[88:91]
    ds_read_b64_tr_b16 a[186:187], v129 offset:36864
    s_waitcnt lgkmcnt(10)
    v_mfma_f32_16x16x32_bf16 v[96:99], a[160:163], v[192:195], 0
    ds_read_b64_tr_b16 a[188:189], v129 offset:40960
    s_add_u32 s7, s61, 172288
    v_mfma_f32_16x16x32_bf16 v[96:99], a[164:167], v[200:203], v[96:99]
    ds_read_b64_tr_b16 a[190:191], v129 offset:45056
    buffer_load_dwordx4 v188, s[72:75], s7 offen offset:0 lds
    v_mfma_f32_16x16x32_bf16 v[100:103], a[164:167], v[204:207], 0
    ds_read_b64_tr_b16 a[128:129], v130 offset:32768
    v_mfma_f32_16x16x32_bf16 v[100:103], a[160:163], v[196:199], v[100:103]
    ds_read_b64_tr_b16 a[130:131], v130 offset:36864
    buffer_load_dwordx4 v189, s[72:75], s7 offen offset:1024 lds
    s_waitcnt lgkmcnt(10)
    v_mfma_f32_16x16x32_bf16 v[108:111], a[168:171], v[196:199], 0
    ds_read_b64_tr_b16 a[132:133], v130 offset:40960
    s_add_u32 m0, s62, 122880
    v_mfma_f32_16x16x32_bf16 v[108:111], a[172:175], v[204:207], v[108:111]
    ds_read_b64_tr_b16 a[134:135], v130 offset:45056
    s_add_u32 s7, s61, 200960
    v_mfma_f32_16x16x32_bf16 v[104:107], a[172:175], v[200:203], 0
    ds_read_b64_tr_b16 a[136:137], v131 offset:32768
    v_mfma_f32_16x16x32_bf16 v[104:107], a[168:171], v[192:195], v[104:107]
    ds_read_b64_tr_b16 a[138:139], v131 offset:36864
    buffer_load_dwordx4 v188, s[72:75], s7 offen offset:0 lds
    s_waitcnt lgkmcnt(10)
    v_mfma_f32_16x16x32_bf16 v[0:3], a[176:179], v[208:211], v[0:3]
    ds_read_b64_tr_b16 a[140:141], v131 offset:40960
    v_mfma_f32_16x16x32_bf16 v[0:3], a[180:183], v[216:219], v[0:3]
    ds_read_b64_tr_b16 a[142:143], v131 offset:45056
    buffer_store_dwordx4 v[228:231], v155, s[16:19], s90 offen offset:1024 sc0 sc1
    v_mfma_f32_16x16x32_bf16 v[4:7], a[180:183], v[220:223], v[4:7]
    ds_read_b64_tr_b16 a[144:145], v132 offset:32768
    v_mfma_f32_16x16x32_bf16 v[4:7], a[176:179], v[212:215], v[4:7]
    ds_read_b64_tr_b16 a[146:147], v132 offset:36864
    buffer_load_dwordx4 v189, s[72:75], s7 offen offset:1024 lds
    s_waitcnt lgkmcnt(10)
    v_mfma_f32_16x16x32_bf16 v[12:15], a[184:187], v[212:215], v[12:15]
    ds_read_b64_tr_b16 a[148:149], v132 offset:40960
    s_add_u32 m0, s62, 131072
    v_mfma_f32_16x16x32_bf16 v[12:15], a[188:191], v[220:223], v[12:15]
    ds_read_b64_tr_b16 a[150:151], v132 offset:45056
    s_add_u32 s7, s60, 0
    v_mfma_f32_16x16x32_bf16 v[8:11], a[188:191], v[216:219], v[8:11]
    ds_read_b64_tr_b16 a[152:153], v133 offset:32768
    v_mfma_f32_16x16x32_bf16 v[8:11], a[184:187], v[208:211], v[8:11]
    ds_read_b64_tr_b16 a[154:155], v133 offset:36864
    buffer_load_dwordx4 v157, s[68:71], s7 offen offset:0 lds
    s_waitcnt lgkmcnt(10)
    v_mfma_f32_16x16x32_bf16 v[16:19], a[128:131], v[208:211], v[16:19]
    ds_read_b64_tr_b16 a[156:157], v133 offset:40960
    v_mfma_f32_16x16x32_bf16 v[16:19], a[132:135], v[216:219], v[16:19]
    ds_read_b64_tr_b16 a[158:159], v133 offset:45056
    buffer_load_dwordx4 v158, s[68:71], s7 offen offset:1024 lds
    v_mfma_f32_16x16x32_bf16 v[20:23], a[132:135], v[220:223], v[20:23]
    ds_read_b64_tr_b16 a[160:161], v134 offset:32768
    s_add_u32 m0, s62, 139264
    v_mfma_f32_16x16x32_bf16 v[20:23], a[128:131], v[212:215], v[20:23]
    ds_read_b64_tr_b16 a[162:163], v134 offset:36864
    s_waitcnt lgkmcnt(10)
    v_mfma_f32_16x16x32_bf16 v[28:31], a[136:139], v[212:215], v[28:31]
    ds_read_b64_tr_b16 a[164:165], v134 offset:40960
    s_add_u32 s7, s60, 28672
    v_mfma_f32_16x16x32_bf16 v[28:31], a[140:143], v[220:223], v[28:31]
    ds_read_b64_tr_b16 a[166:167], v134 offset:45056
    buffer_load_dwordx4 v157, s[68:71], s7 offen offset:0 lds
    v_mfma_f32_16x16x32_bf16 v[24:27], a[140:143], v[216:219], v[24:27]
    ds_read_b64_tr_b16 a[168:169], v135 offset:32768
    v_mfma_f32_16x16x32_bf16 v[24:27], a[136:139], v[208:211], v[24:27]
    ds_read_b64_tr_b16 a[170:171], v135 offset:36864
    buffer_load_dwordx4 v158, s[68:71], s7 offen offset:1024 lds
    s_waitcnt lgkmcnt(10)
    v_mfma_f32_16x16x32_bf16 v[32:35], a[144:147], v[208:211], v[32:35]
    ds_read_b64_tr_b16 a[172:173], v135 offset:40960
    s_and_b32 s6, s59, 1
    v_mfma_f32_16x16x32_bf16 v[32:35], a[148:151], v[216:219], v[32:35]
    ds_read_b64_tr_b16 a[174:175], v135 offset:45056
    buffer_store_dwordx4 v[232:235], v155, s[16:19], s90 offen offset:2048 sc0 sc1
    v_mfma_f32_16x16x32_bf16 v[36:39], a[148:151], v[220:223], v[36:39]
    ds_read_b64_tr_b16 a[176:177], v128 offset:49152
    s_mul_i32 s66, s6, 7168
    v_mfma_f32_16x16x32_bf16 v[36:39], a[144:147], v[212:215], v[36:39]
    ds_read_b64_tr_b16 a[178:179], v128 offset:53248
    s_add_u32 s66, s66, s4
    s_waitcnt lgkmcnt(10)
    v_mfma_f32_16x16x32_bf16 v[44:47], a[152:155], v[212:215], v[44:47]
    ds_read_b64_tr_b16 a[180:181], v128 offset:57344
    s_add_u32 s66, s66, 117440512
    v_mfma_f32_16x16x32_bf16 v[44:47], a[156:159], v[220:223], v[44:47]
    ds_read_b64_tr_b16 a[182:183], v128 offset:61440
    s_lshl_b32 s4, s58, 11
    v_mfma_f32_16x16x32_bf16 v[40:43], a[156:159], v[216:219], v[40:43]
    ds_read_b64_tr_b16 a[184:185], v129 offset:49152
    s_add_u32 s66, s66, s4
    v_mfma_f32_16x16x32_bf16 v[40:43], a[152:155], v[208:211], v[40:43]
    ds_read_b64_tr_b16 a[186:187], v129 offset:53248
    s_lshl_b32 s4, s36, 7
    s_waitcnt lgkmcnt(10)
    v_mfma_f32_16x16x32_bf16 v[48:51], a[160:163], v[208:211], v[48:51]
    ds_read_b64_tr_b16 a[188:189], v129 offset:57344
    s_lshl_b32 s5, s5, 4
    v_mfma_f32_16x16x32_bf16 v[48:51], a[164:167], v[216:219], v[48:51]
    ds_read_b64_tr_b16 a[190:191], v129 offset:61440
    s_add_u32 s4, s4, s5
    v_mfma_f32_16x16x32_bf16 v[52:55], a[164:167], v[220:223], v[52:55]
    ds_read_b64_tr_b16 a[128:129], v130 offset:49152
    s_mul_i32 s67, s4, 896
    v_mfma_f32_16x16x32_bf16 v[52:55], a[160:163], v[212:215], v[52:55]
    ds_read_b64_tr_b16 a[130:131], v130 offset:53248
    s_mul_i32 s6, s6, 224
    s_waitcnt lgkmcnt(10)
    v_mfma_f32_16x16x32_bf16 v[60:63], a[168:171], v[212:215], v[60:63]
    ds_read_b64_tr_b16 a[132:133], v130 offset:57344
    s_add_u32 s67, s67, s6
    v_mfma_f32_16x16x32_bf16 v[60:63], a[172:175], v[220:223], v[60:63]
    ds_read_b64_tr_b16 a[134:135], v130 offset:61440
    s_lshl_b32 s4, s58, 6
    v_mfma_f32_16x16x32_bf16 v[56:59], a[172:175], v[216:219], v[56:59]
    ds_read_b64_tr_b16 a[136:137], v131 offset:49152
    s_add_u32 s67, s67, s4
    v_mfma_f32_16x16x32_bf16 v[56:59], a[168:171], v[208:211], v[56:59]
    ds_read_b64_tr_b16 a[138:139], v131 offset:53248
    s_and_b32 s4, s23, 1
    s_waitcnt lgkmcnt(10)
    v_mfma_f32_16x16x32_bf16 v[64:67], a[176:179], v[208:211], v[64:67]
    ds_read_b64_tr_b16 a[140:141], v131 offset:57344
    s_add_u32 m0, s62, 147456
    v_mfma_f32_16x16x32_bf16 v[64:67], a[180:183], v[216:219], v[64:67]
    ds_read_b64_tr_b16 a[142:143], v131 offset:61440
    buffer_store_dwordx4 v[236:239], v155, s[16:19], s90 offen offset:3072 sc0 sc1
    v_mfma_f32_16x16x32_bf16 v[68:71], a[180:183], v[220:223], v[68:71]
    ds_read_b64_tr_b16 a[144:145], v132 offset:49152
    s_add_u32 s7, s60, 256
    v_mfma_f32_16x16x32_bf16 v[68:71], a[176:179], v[212:215], v[68:71]
    ds_read_b64_tr_b16 a[146:147], v132 offset:53248
    buffer_load_dwordx4 v188, s[68:71], s7 offen offset:0 lds
    s_waitcnt lgkmcnt(10)
    v_mfma_f32_16x16x32_bf16 v[76:79], a[184:187], v[212:215], v[76:79]
    ds_read_b64_tr_b16 a[148:149], v132 offset:57344
    v_mfma_f32_16x16x32_bf16 v[76:79], a[188:191], v[220:223], v[76:79]
    ds_read_b64_tr_b16 a[150:151], v132 offset:61440
    buffer_load_dwordx4 v189, s[68:71], s7 offen offset:1024 lds
    v_mfma_f32_16x16x32_bf16 v[72:75], a[188:191], v[216:219], v[72:75]
    ds_read_b64_tr_b16 a[152:153], v133 offset:49152
    s_add_u32 m0, s62, 155648
    v_mfma_f32_16x16x32_bf16 v[72:75], a[184:187], v[208:211], v[72:75]
    ds_read_b64_tr_b16 a[154:155], v133 offset:53248
    s_waitcnt lgkmcnt(10)
    v_mfma_f32_16x16x32_bf16 v[80:83], a[128:131], v[208:211], v[80:83]
    ds_read_b64_tr_b16 a[156:157], v133 offset:57344
    s_add_u32 s7, s60, 28928
    v_mfma_f32_16x16x32_bf16 v[80:83], a[132:135], v[216:219], v[80:83]
    ds_read_b64_tr_b16 a[158:159], v133 offset:61440
    buffer_load_dwordx4 v188, s[68:71], s7 offen offset:0 lds
    v_mfma_f32_16x16x32_bf16 v[84:87], a[132:135], v[220:223], v[84:87]
    s_waitcnt vmcnt(19)
    s_barrier
    v_add_u32 v128, 65536, v128
    ds_read_b64_tr_b16 a[160:161], v128 offset:0
    v_mfma_f32_16x16x32_bf16 v[84:87], a[128:131], v[212:215], v[84:87]
    ds_read_b64_tr_b16 a[162:163], v128 offset:4096
    buffer_load_dwordx4 v189, s[68:71], s7 offen offset:1024 lds
    s_waitcnt lgkmcnt(10)
    v_mfma_f32_16x16x32_bf16 v[92:95], a[136:139], v[212:215], v[92:95]
    ds_read_b64_tr_b16 a[164:165], v128 offset:8192
    s_mul_i32 s4, s4, 448
    v_mfma_f32_16x16x32_bf16 v[92:95], a[140:143], v[220:223], v[92:95]
    ds_read_b64_tr_b16 a[166:167], v128 offset:12288
    s_add_u32 s67, s67, s4
    v_mfma_f32_16x16x32_bf16 v[88:91], a[140:143], v[216:219], v[88:91]
    v_add_u32 v129, 65536, v129
    ds_read_b64_tr_b16 a[168:169], v129 offset:0
    v_and_b32 v185, 15, v182
    v_mfma_f32_16x16x32_bf16 v[88:91], a[136:139], v[208:211], v[88:91]
    ds_read_b64_tr_b16 a[170:171], v129 offset:4096
    v_mul_u32_u24 v185, 896, v185
    s_waitcnt lgkmcnt(10)
    v_mfma_f32_16x16x32_bf16 v[96:99], a[144:147], v[208:211], v[96:99]
    ds_read_b64_tr_b16 a[172:173], v129 offset:8192
    v_lshl_add_u32 v184, v176, 3, v185
    v_mfma_f32_16x16x32_bf16 v[96:99], a[148:151], v[216:219], v[96:99]
    ds_read_b64_tr_b16 a[174:175], v129 offset:12288
    s_add_u32 s90, s90, 4096
    buffer_store_dwordx4 v[240:243], v155, s[16:19], s90 offen offset:0 sc0 sc1
    v_mfma_f32_16x16x32_bf16 v[100:103], a[148:151], v[220:223], v[100:103]
    v_add_u32 v130, 65536, v130
    ds_read_b64_tr_b16 a[176:177], v130 offset:0
    v_add_u32 v185, 57344, v184
    v_mfma_f32_16x16x32_bf16 v[100:103], a[144:147], v[212:215], v[100:103]
    ds_read_b64_tr_b16 a[178:179], v130 offset:4096
    s_lshl_b32 s89, 1, s59
    s_waitcnt lgkmcnt(10)
    v_mfma_f32_16x16x32_bf16 v[108:111], a[152:155], v[212:215], v[108:111]
    ds_read_b64_tr_b16 a[180:181], v130 offset:8192
    s_sub_u32 s4, 2, s58
    v_mfma_f32_16x16x32_bf16 v[108:111], a[156:159], v[220:223], v[108:111]
    ds_read_b64_tr_b16 a[182:183], v130 offset:12288
    s_and_b32 s4, s4, 0x40000000
    v_mfma_f32_16x16x32_bf16 v[104:107], a[156:159], v[216:219], v[104:107]
    v_add_u32 v131, 65536, v131
    ds_read_b64_tr_b16 a[184:185], v131 offset:0
    s_add_u32 s4, s4, 1024
    v_mfma_f32_16x16x32_bf16 v[104:107], a[152:155], v[208:211], v[104:107]
    ds_read_b64_tr_b16 a[186:187], v131 offset:4096
    v_add_u32 v186, s4, v155
    s_waitcnt lgkmcnt(10)
    v_mfma_f32_16x16x32_bf16 v[0:3], a[160:163], v[224:227], v[0:3]
    ds_read_b64_tr_b16 a[188:189], v131 offset:8192
    s_add_u32 m0, s62, 0
    v_mfma_f32_16x16x32_bf16 v[0:3], a[164:167], v[232:235], v[0:3]
    ds_read_b64_tr_b16 a[190:191], v131 offset:12288
    s_add_u32 s7, s60, 57344
    v_mfma_f32_16x16x32_bf16 v[4:7], a[164:167], v[236:239], v[4:7]
    v_add_u32 v132, 65536, v132
    ds_read_b64_tr_b16 a[128:129], v132 offset:0
    v_mfma_f32_16x16x32_bf16 v[4:7], a[160:163], v[228:231], v[4:7]
    ds_read_b64_tr_b16 a[130:131], v132 offset:4096
    buffer_load_dwordx4 v157, s[68:71], s7 offen offset:0 lds
    s_waitcnt lgkmcnt(10)
    v_mfma_f32_16x16x32_bf16 v[12:15], a[168:171], v[228:231], v[12:15]
    ds_read_b64_tr_b16 a[132:133], v132 offset:8192
    v_mfma_f32_16x16x32_bf16 v[12:15], a[172:175], v[236:239], v[12:15]
    ds_read_b64_tr_b16 a[134:135], v132 offset:12288
    buffer_load_dwordx4 v158, s[68:71], s7 offen offset:1024 lds
    v_mfma_f32_16x16x32_bf16 v[8:11], a[172:175], v[232:235], v[8:11]
    v_add_u32 v133, 65536, v133
    ds_read_b64_tr_b16 a[136:137], v133 offset:0
    s_add_u32 m0, s62, 8192
    v_mfma_f32_16x16x32_bf16 v[8:11], a[168:171], v[224:227], v[8:11]
    ds_read_b64_tr_b16 a[138:139], v133 offset:4096
    s_waitcnt lgkmcnt(10)
    v_mfma_f32_16x16x32_bf16 v[16:19], a[176:179], v[224:227], v[16:19]
    ds_read_b64_tr_b16 a[140:141], v133 offset:8192
    s_add_u32 s7, s60, 86016
    v_mfma_f32_16x16x32_bf16 v[16:19], a[180:183], v[232:235], v[16:19]
    ds_read_b64_tr_b16 a[142:143], v133 offset:12288
    buffer_store_dwordx4 v[244:247], v155, s[16:19], s90 offen offset:1024 sc0 sc1
    v_mfma_f32_16x16x32_bf16 v[20:23], a[180:183], v[236:239], v[20:23]
    v_add_u32 v134, 65536, v134
    ds_read_b64_tr_b16 a[144:145], v134 offset:0
    v_mfma_f32_16x16x32_bf16 v[20:23], a[176:179], v[228:231], v[20:23]
    ds_read_b64_tr_b16 a[146:147], v134 offset:4096
    buffer_load_dwordx4 v157, s[68:71], s7 offen offset:0 lds
    s_waitcnt lgkmcnt(10)
    v_mfma_f32_16x16x32_bf16 v[28:31], a[184:187], v[228:231], v[28:31]
    ds_read_b64_tr_b16 a[148:149], v134 offset:8192
    v_mfma_f32_16x16x32_bf16 v[28:31], a[188:191], v[236:239], v[28:31]
    ds_read_b64_tr_b16 a[150:151], v134 offset:12288
    buffer_load_dwordx4 v158, s[68:71], s7 offen offset:1024 lds
    v_mfma_f32_16x16x32_bf16 v[24:27], a[188:191], v[232:235], v[24:27]
    v_add_u32 v135, 65536, v135
    ds_read_b64_tr_b16 a[152:153], v135 offset:0
    v_mfma_f32_16x16x32_bf16 v[24:27], a[184:187], v[224:227], v[24:27]
    ds_read_b64_tr_b16 a[154:155], v135 offset:4096
    s_waitcnt lgkmcnt(10)
    v_mfma_f32_16x16x32_bf16 v[32:35], a[128:131], v[224:227], v[32:35]
    ds_read_b64_tr_b16 a[156:157], v135 offset:8192
    v_mfma_f32_16x16x32_bf16 v[32:35], a[132:135], v[232:235], v[32:35]
    ds_read_b64_tr_b16 a[158:159], v135 offset:12288
    v_mfma_f32_16x16x32_bf16 v[36:39], a[132:135], v[236:239], v[36:39]
    ds_read_b64_tr_b16 a[160:161], v128 offset:16384
    v_mfma_f32_16x16x32_bf16 v[36:39], a[128:131], v[228:231], v[36:39]
    ds_read_b64_tr_b16 a[162:163], v128 offset:20480
    s_waitcnt lgkmcnt(10)
    v_mfma_f32_16x16x32_bf16 v[44:47], a[136:139], v[228:231], v[44:47]
    ds_read_b64_tr_b16 a[164:165], v128 offset:24576
    v_mfma_f32_16x16x32_bf16 v[44:47], a[140:143], v[236:239], v[44:47]
    ds_read_b64_tr_b16 a[166:167], v128 offset:28672
    v_mfma_f32_16x16x32_bf16 v[40:43], a[140:143], v[232:235], v[40:43]
    ds_read_b64_tr_b16 a[168:169], v129 offset:16384
    v_mfma_f32_16x16x32_bf16 v[40:43], a[136:139], v[224:227], v[40:43]
    ds_read_b64_tr_b16 a[170:171], v129 offset:20480
    s_waitcnt lgkmcnt(10)
    v_mfma_f32_16x16x32_bf16 v[48:51], a[144:147], v[224:227], v[48:51]
    ds_read_b64_tr_b16 a[172:173], v129 offset:24576
    v_mfma_f32_16x16x32_bf16 v[48:51], a[148:151], v[232:235], v[48:51]
    ds_read_b64_tr_b16 a[174:175], v129 offset:28672
    buffer_store_dwordx4 v[248:251], v155, s[16:19], s90 offen offset:2048 sc0 sc1
    v_mfma_f32_16x16x32_bf16 v[52:55], a[148:151], v[236:239], v[52:55]
    ds_read_b64_tr_b16 a[176:177], v130 offset:16384
    v_mfma_f32_16x16x32_bf16 v[52:55], a[144:147], v[228:231], v[52:55]
    ds_read_b64_tr_b16 a[178:179], v130 offset:20480
    s_waitcnt lgkmcnt(10)
    v_mfma_f32_16x16x32_bf16 v[60:63], a[152:155], v[228:231], v[60:63]
    ds_read_b64_tr_b16 a[180:181], v130 offset:24576
    v_mfma_f32_16x16x32_bf16 v[60:63], a[156:159], v[236:239], v[60:63]
    ds_read_b64_tr_b16 a[182:183], v130 offset:28672
    v_mfma_f32_16x16x32_bf16 v[56:59], a[156:159], v[232:235], v[56:59]
    ds_read_b64_tr_b16 a[184:185], v131 offset:16384
    v_mfma_f32_16x16x32_bf16 v[56:59], a[152:155], v[224:227], v[56:59]
    ds_read_b64_tr_b16 a[186:187], v131 offset:20480
    s_waitcnt lgkmcnt(10)
    v_mfma_f32_16x16x32_bf16 v[64:67], a[160:163], v[224:227], v[64:67]
    ds_read_b64_tr_b16 a[188:189], v131 offset:24576
    s_add_u32 m0, s62, 16384
    v_mfma_f32_16x16x32_bf16 v[64:67], a[164:167], v[232:235], v[64:67]
    ds_read_b64_tr_b16 a[190:191], v131 offset:28672
    s_add_u32 s7, s60, 57600
    v_mfma_f32_16x16x32_bf16 v[68:71], a[164:167], v[236:239], v[68:71]
    ds_read_b64_tr_b16 a[128:129], v132 offset:16384
    v_mfma_f32_16x16x32_bf16 v[68:71], a[160:163], v[228:231], v[68:71]
    ds_read_b64_tr_b16 a[130:131], v132 offset:20480
    buffer_load_dwordx4 v188, s[68:71], s7 offen offset:0 lds
    s_waitcnt lgkmcnt(10)
    v_mfma_f32_16x16x32_bf16 v[76:79], a[168:171], v[228:231], v[76:79]
    ds_read_b64_tr_b16 a[132:133], v132 offset:24576
    v_mfma_f32_16x16x32_bf16 v[76:79], a[172:175], v[236:239], v[76:79]
    ds_read_b64_tr_b16 a[134:135], v132 offset:28672
    buffer_load_dwordx4 v189, s[68:71], s7 offen offset:1024 lds
    v_mfma_f32_16x16x32_bf16 v[72:75], a[172:175], v[232:235], v[72:75]
    ds_read_b64_tr_b16 a[136:137], v133 offset:16384
    s_add_u32 m0, s62, 24576
    v_mfma_f32_16x16x32_bf16 v[72:75], a[168:171], v[224:227], v[72:75]
    ds_read_b64_tr_b16 a[138:139], v133 offset:20480
    s_waitcnt lgkmcnt(10)
    v_mfma_f32_16x16x32_bf16 v[80:83], a[176:179], v[224:227], v[80:83]
    ds_read_b64_tr_b16 a[140:141], v133 offset:24576
    s_add_u32 s7, s60, 86272
    v_mfma_f32_16x16x32_bf16 v[80:83], a[180:183], v[232:235], v[80:83]
    ds_read_b64_tr_b16 a[142:143], v133 offset:28672
    buffer_store_dwordx4 v[252:255], v155, s[16:19], s90 offen offset:3072 sc0 sc1
    v_mfma_f32_16x16x32_bf16 v[84:87], a[180:183], v[236:239], v[84:87]
    s_waitcnt vmcnt(20)
    s_barrier
    ds_read_b64_tr_b16 a[144:145], v128 offset:32768
    v_mfma_f32_16x16x32_bf16 v[84:87], a[176:179], v[228:231], v[84:87]
    ds_read_b64_tr_b16 a[146:147], v128 offset:36864
    buffer_load_dwordx4 v188, s[68:71], s7 offen offset:0 lds
    s_waitcnt lgkmcnt(10)
    v_mfma_f32_16x16x32_bf16 v[92:95], a[184:187], v[228:231], v[92:95]
    ds_read_b64_tr_b16 a[148:149], v128 offset:40960
    v_mfma_f32_16x16x32_bf16 v[92:95], a[188:191], v[236:239], v[92:95]
    ds_read_b64_tr_b16 a[150:151], v128 offset:45056
    buffer_load_dwordx4 v189, s[68:71], s7 offen offset:1024 lds
    v_mfma_f32_16x16x32_bf16 v[88:91], a[188:191], v[232:235], v[88:91]
    ds_read_b64_tr_b16 a[152:153], v129 offset:32768
    v_mfma_f32_16x16x32_bf16 v[88:91], a[184:187], v[224:227], v[88:91]
    ds_read_b64_tr_b16 a[154:155], v129 offset:36864
    s_waitcnt lgkmcnt(10)
    v_mfma_f32_16x16x32_bf16 v[96:99], a[128:131], v[224:227], v[96:99]
    ds_read_b64_tr_b16 a[156:157], v129 offset:40960
    v_mfma_f32_16x16x32_bf16 v[96:99], a[132:135], v[232:235], v[96:99]
    ds_read_b64_tr_b16 a[158:159], v129 offset:45056
    v_mfma_f32_16x16x32_bf16 v[100:103], a[132:135], v[236:239], v[100:103]
    ds_read_b64_tr_b16 a[160:161], v130 offset:32768
    v_mfma_f32_16x16x32_bf16 v[100:103], a[128:131], v[228:231], v[100:103]
    ds_read_b64_tr_b16 a[162:163], v130 offset:36864
    s_waitcnt lgkmcnt(10)
    v_mfma_f32_16x16x32_bf16 v[108:111], a[136:139], v[228:231], v[108:111]
    ds_read_b64_tr_b16 a[164:165], v130 offset:40960
    v_mfma_f32_16x16x32_bf16 v[108:111], a[140:143], v[236:239], v[108:111]
    ds_read_b64_tr_b16 a[166:167], v130 offset:45056
    v_mfma_f32_16x16x32_bf16 v[104:107], a[140:143], v[232:235], v[104:107]
    ds_read_b64_tr_b16 a[168:169], v131 offset:32768
    v_mfma_f32_16x16x32_bf16 v[104:107], a[136:139], v[224:227], v[104:107]
    ds_read_b64_tr_b16 a[170:171], v131 offset:36864
    s_waitcnt lgkmcnt(10)
    v_mfma_f32_16x16x32_bf16 v[0:3], a[144:147], v[240:243], v[0:3]
    ds_read_b64_tr_b16 a[172:173], v131 offset:40960
    s_add_u32 m0, s62, 32768
    v_mfma_f32_16x16x32_bf16 v[0:3], a[148:151], v[248:251], v[0:3]
    ds_read_b64_tr_b16 a[174:175], v131 offset:45056
    s_add_u32 s7, s60, 114688
    v_mfma_f32_16x16x32_bf16 v[4:7], a[148:151], v[252:255], v[4:7]
    ds_read_b64_tr_b16 a[176:177], v132 offset:32768
    buffer_load_dwordx4 a[64:67], v155, s[16:19], s65 offen offset:0 sc0 sc1
    v_mfma_f32_16x16x32_bf16 v[4:7], a[144:147], v[244:247], v[4:7]
    ds_read_b64_tr_b16 a[178:179], v132 offset:36864
    buffer_load_dwordx4 v157, s[68:71], s7 offen offset:0 lds
    s_waitcnt lgkmcnt(10)
    v_mfma_f32_16x16x32_bf16 v[12:15], a[152:155], v[244:247], v[12:15]
    ds_read_b64_tr_b16 a[180:181], v132 offset:40960
    v_mfma_f32_16x16x32_bf16 v[12:15], a[156:159], v[252:255], v[12:15]
    ds_read_b64_tr_b16 a[182:183], v132 offset:45056
    buffer_load_dwordx4 v158, s[68:71], s7 offen offset:1024 lds
    v_mfma_f32_16x16x32_bf16 v[8:11], a[156:159], v[248:251], v[8:11]
    ds_read_b64_tr_b16 a[184:185], v133 offset:32768
    s_add_u32 m0, s62, 40960
    v_mfma_f32_16x16x32_bf16 v[8:11], a[152:155], v[240:243], v[8:11]
    ds_read_b64_tr_b16 a[186:187], v133 offset:36864
    s_waitcnt lgkmcnt(10)
    v_mfma_f32_16x16x32_bf16 v[16:19], a[160:163], v[240:243], v[16:19]
    ds_read_b64_tr_b16 a[188:189], v133 offset:40960
    buffer_load_dwordx4 a[68:71], v190, s[16:19], s65 offen offset:0 sc0 sc1
    v_mfma_f32_16x16x32_bf16 v[16:19], a[164:167], v[248:251], v[16:19]
    ds_read_b64_tr_b16 a[190:191], v133 offset:45056
    s_add_u32 s7, s60, 143360
    v_mfma_f32_16x16x32_bf16 v[20:23], a[164:167], v[252:255], v[20:23]
    ds_read_b64_tr_b16 a[128:129], v134 offset:32768
    v_mfma_f32_16x16x32_bf16 v[20:23], a[160:163], v[244:247], v[20:23]
    ds_read_b64_tr_b16 a[130:131], v134 offset:36864
    buffer_load_dwordx4 v157, s[68:71], s7 offen offset:0 lds
    s_waitcnt lgkmcnt(10)
    v_mfma_f32_16x16x32_bf16 v[28:31], a[168:171], v[244:247], v[28:31]
    ds_read_b64_tr_b16 a[132:133], v134 offset:40960
    v_mfma_f32_16x16x32_bf16 v[28:31], a[172:175], v[252:255], v[28:31]
    ds_read_b64_tr_b16 a[134:135], v134 offset:45056
    buffer_load_dwordx4 v158, s[68:71], s7 offen offset:1024 lds
    v_mfma_f32_16x16x32_bf16 v[24:27], a[172:175], v[248:251], v[24:27]
    ds_read_b64_tr_b16 a[136:137], v135 offset:32768
    buffer_load_dwordx4 a[72:75], v155, s[16:19], s65 offen offset:1024 sc0 sc1
    v_mfma_f32_16x16x32_bf16 v[24:27], a[168:171], v[240:243], v[24:27]
    ds_read_b64_tr_b16 a[138:139], v135 offset:36864
    s_waitcnt lgkmcnt(10)
    v_mfma_f32_16x16x32_bf16 v[32:35], a[176:179], v[240:243], v[32:35]
    ds_read_b64_tr_b16 a[140:141], v135 offset:40960
    v_mfma_f32_16x16x32_bf16 v[32:35], a[180:183], v[248:251], v[32:35]
    ds_read_b64_tr_b16 a[142:143], v135 offset:45056
    v_mfma_f32_16x16x32_bf16 v[36:39], a[180:183], v[252:255], v[36:39]
    ds_read_b64_tr_b16 a[144:145], v128 offset:49152
    v_mfma_f32_16x16x32_bf16 v[36:39], a[176:179], v[244:247], v[36:39]
    ds_read_b64_tr_b16 a[146:147], v128 offset:53248
    s_waitcnt lgkmcnt(10)
    v_mfma_f32_16x16x32_bf16 v[44:47], a[184:187], v[244:247], v[44:47]
    ds_read_b64_tr_b16 a[148:149], v128 offset:57344
    buffer_load_dwordx4 a[76:79], v190, s[16:19], s65 offen offset:1024 sc0 sc1
    v_mfma_f32_16x16x32_bf16 v[44:47], a[188:191], v[252:255], v[44:47]
    ds_read_b64_tr_b16 a[150:151], v128 offset:61440
    v_mfma_f32_16x16x32_bf16 v[40:43], a[188:191], v[248:251], v[40:43]
    ds_read_b64_tr_b16 a[152:153], v129 offset:49152
    v_mfma_f32_16x16x32_bf16 v[40:43], a[184:187], v[240:243], v[40:43]
    ds_read_b64_tr_b16 a[154:155], v129 offset:53248
    s_waitcnt lgkmcnt(10)
    v_mfma_f32_16x16x32_bf16 v[48:51], a[128:131], v[240:243], v[48:51]
    ds_read_b64_tr_b16 a[156:157], v129 offset:57344
    v_mfma_f32_16x16x32_bf16 v[48:51], a[132:135], v[248:251], v[48:51]
    ds_read_b64_tr_b16 a[158:159], v129 offset:61440
    v_mfma_f32_16x16x32_bf16 v[52:55], a[132:135], v[252:255], v[52:55]
    ds_read_b64_tr_b16 a[160:161], v130 offset:49152
    buffer_load_dwordx4 a[80:83], v155, s[16:19], s65 offen offset:2048 sc0 sc1
    v_mfma_f32_16x16x32_bf16 v[52:55], a[128:131], v[244:247], v[52:55]
    ds_read_b64_tr_b16 a[162:163], v130 offset:53248
    s_waitcnt lgkmcnt(10)
    v_mfma_f32_16x16x32_bf16 v[60:63], a[136:139], v[244:247], v[60:63]
    ds_read_b64_tr_b16 a[164:165], v130 offset:57344
    v_mfma_f32_16x16x32_bf16 v[60:63], a[140:143], v[252:255], v[60:63]
    ds_read_b64_tr_b16 a[166:167], v130 offset:61440
    v_mfma_f32_16x16x32_bf16 v[56:59], a[140:143], v[248:251], v[56:59]
    ds_read_b64_tr_b16 a[168:169], v131 offset:49152
    v_mfma_f32_16x16x32_bf16 v[56:59], a[136:139], v[240:243], v[56:59]
    ds_read_b64_tr_b16 a[170:171], v131 offset:53248
    s_waitcnt lgkmcnt(10)
    v_mfma_f32_16x16x32_bf16 v[64:67], a[144:147], v[240:243], v[64:67]
    ds_read_b64_tr_b16 a[172:173], v131 offset:57344
    buffer_load_dwordx4 a[84:87], v190, s[16:19], s65 offen offset:2048 sc0 sc1
    v_mfma_f32_16x16x32_bf16 v[64:67], a[148:151], v[248:251], v[64:67]
    ds_read_b64_tr_b16 a[174:175], v131 offset:61440
    s_add_u32 m0, s62, 49152
    v_mfma_f32_16x16x32_bf16 v[68:71], a[148:151], v[252:255], v[68:71]
    ds_read_b64_tr_b16 a[176:177], v132 offset:49152
    s_add_u32 s7, s60, 114944
    v_mfma_f32_16x16x32_bf16 v[68:71], a[144:147], v[244:247], v[68:71]
    ds_read_b64_tr_b16 a[178:179], v132 offset:53248
    buffer_load_dwordx4 v188, s[68:71], s7 offen offset:0 lds
    s_waitcnt lgkmcnt(10)
    v_mfma_f32_16x16x32_bf16 v[76:79], a[152:155], v[244:247], v[76:79]
    ds_read_b64_tr_b16 a[180:181], v132 offset:57344
    v_mfma_f32_16x16x32_bf16 v[76:79], a[156:159], v[252:255], v[76:79]
    ds_read_b64_tr_b16 a[182:183], v132 offset:61440
    buffer_load_dwordx4 v189, s[68:71], s7 offen offset:1024 lds
    v_mfma_f32_16x16x32_bf16 v[72:75], a[156:159], v[248:251], v[72:75]
    ds_read_b64_tr_b16 a[184:185], v133 offset:49152
    s_add_u32 m0, s62, 57344
    v_mfma_f32_16x16x32_bf16 v[72:75], a[152:155], v[240:243], v[72:75]
    ds_read_b64_tr_b16 a[186:187], v133 offset:53248
    s_waitcnt lgkmcnt(10)
    v_mfma_f32_16x16x32_bf16 v[80:83], a[160:163], v[240:243], v[80:83]
    ds_read_b64_tr_b16 a[188:189], v133 offset:57344
    s_add_u32 s7, s60, 143616
    v_mfma_f32_16x16x32_bf16 v[80:83], a[164:167], v[248:251], v[80:83]
    ds_read_b64_tr_b16 a[190:191], v133 offset:61440
    buffer_load_dwordx4 v188, s[68:71], s7 offen offset:0 lds
    v_mfma_f32_16x16x32_bf16 v[84:87], a[164:167], v[252:255], v[84:87]
    s_waitcnt vmcnt(15)
    s_barrier
    s_cmp_lg_u32 s58, 0
    s_cbranch_scc1 Lpub25
    v_mov_b32 v161, 4
    s_mov_b64 exec, 1
    buffer_store_dword v161, off, s[16:19], s99 sc0 sc1
    s_mov_b64 exec, -1
Lpub25:
    v_add_u32 v128, 65536, v128
    ds_read_b64_tr_b16 a[128:129], v128 offset:0
    v_mfma_f32_16x16x32_bf16 v[84:87], a[160:163], v[244:247], v[84:87]
    ds_read_b64_tr_b16 a[130:131], v128 offset:4096
    buffer_load_dwordx4 v189, s[68:71], s7 offen offset:1024 lds
    s_waitcnt lgkmcnt(10)
    v_mfma_f32_16x16x32_bf16 v[92:95], a[168:171], v[244:247], v[92:95]
    ds_read_b64_tr_b16 a[132:133], v128 offset:8192
    v_mfma_f32_16x16x32_bf16 v[92:95], a[172:175], v[252:255], v[92:95]
    ds_read_b64_tr_b16 a[134:135], v128 offset:12288
    v_mfma_f32_16x16x32_bf16 v[88:91], a[172:175], v[248:251], v[88:91]
    v_add_u32 v129, 65536, v129
    ds_read_b64_tr_b16 a[136:137], v129 offset:0
    v_mfma_f32_16x16x32_bf16 v[88:91], a[168:171], v[240:243], v[88:91]
    ds_read_b64_tr_b16 a[138:139], v129 offset:4096
    s_waitcnt lgkmcnt(10)
    v_mfma_f32_16x16x32_bf16 v[96:99], a[176:179], v[240:243], v[96:99]
    ds_read_b64_tr_b16 a[140:141], v129 offset:8192
    v_mfma_f32_16x16x32_bf16 v[96:99], a[180:183], v[248:251], v[96:99]
    ds_read_b64_tr_b16 a[142:143], v129 offset:12288
    v_mfma_f32_16x16x32_bf16 v[100:103], a[180:183], v[252:255], v[100:103]
    v_add_u32 v130, 65536, v130
    ds_read_b64_tr_b16 a[144:145], v130 offset:0
    v_mfma_f32_16x16x32_bf16 v[100:103], a[176:179], v[244:247], v[100:103]
    ds_read_b64_tr_b16 a[146:147], v130 offset:4096
    s_waitcnt lgkmcnt(10)
    v_mfma_f32_16x16x32_bf16 v[108:111], a[184:187], v[244:247], v[108:111]
    ds_read_b64_tr_b16 a[148:149], v130 offset:8192
    v_mfma_f32_16x16x32_bf16 v[108:111], a[188:191], v[252:255], v[108:111]
    ds_read_b64_tr_b16 a[150:151], v130 offset:12288
    v_mfma_f32_16x16x32_bf16 v[104:107], a[188:191], v[248:251], v[104:107]
    v_add_u32 v131, 65536, v131
    ds_read_b64_tr_b16 a[152:153], v131 offset:0
    v_mfma_f32_16x16x32_bf16 v[104:107], a[184:187], v[240:243], v[104:107]
    ds_read_b64_tr_b16 a[154:155], v131 offset:4096
    s_waitcnt lgkmcnt(10)
    v_mfma_f32_16x16x32_bf16 v[0:3], a[128:131], a[192:195], v[0:3]
    ds_read_b64_tr_b16 a[156:157], v131 offset:8192
    s_add_u32 m0, s62, 65536
    v_mfma_f32_16x16x32_bf16 v[0:3], a[132:135], a[200:203], v[0:3]
    ds_read_b64_tr_b16 a[158:159], v131 offset:12288
    s_add_u32 s7, s60, 172032
    v_mfma_f32_16x16x32_bf16 v[4:7], a[132:135], a[204:207], v[4:7]
    v_add_u32 v132, 65536, v132
    ds_read_b64_tr_b16 a[160:161], v132 offset:0
    v_mfma_f32_16x16x32_bf16 v[4:7], a[128:131], a[196:199], v[4:7]
    ds_read_b64_tr_b16 a[162:163], v132 offset:4096
    buffer_load_dwordx4 v157, s[68:71], s7 offen offset:0 lds
    s_waitcnt lgkmcnt(10)
    v_mfma_f32_16x16x32_bf16 v[12:15], a[136:139], a[196:199], v[12:15]
    ds_read_b64_tr_b16 a[164:165], v132 offset:8192
    v_mfma_f32_16x16x32_bf16 v[12:15], a[140:143], a[204:207], v[12:15]
    ds_read_b64_tr_b16 a[166:167], v132 offset:12288
    buffer_load_dwordx4 v158, s[68:71], s7 offen offset:1024 lds
    v_mfma_f32_16x16x32_bf16 v[8:11], a[140:143], a[200:203], v[8:11]
    v_add_u32 v133, 65536, v133
    ds_read_b64_tr_b16 a[168:169], v133 offset:0
    s_add_u32 m0, s62, 73728
    v_mfma_f32_16x16x32_bf16 v[8:11], a[136:139], a[192:195], v[8:11]
    ds_read_b64_tr_b16 a[170:171], v133 offset:4096
    s_waitcnt lgkmcnt(10)
    v_mfma_f32_16x16x32_bf16 v[16:19], a[144:147], a[192:195], v[16:19]
    ds_read_b64_tr_b16 a[172:173], v133 offset:8192
    s_add_u32 s7, s63, 0
    v_mfma_f32_16x16x32_bf16 v[16:19], a[148:151], a[200:203], v[16:19]
    ds_read_b64_tr_b16 a[174:175], v133 offset:12288
    buffer_load_dwordx4 v157, s[72:75], s7 offen offset:0 lds
    v_mfma_f32_16x16x32_bf16 v[20:23], a[148:151], a[204:207], v[20:23]
    v_add_u32 v134, 65536, v134
    ds_read_b64_tr_b16 a[176:177], v134 offset:0
    v_mfma_f32_16x16x32_bf16 v[20:23], a[144:147], a[196:199], v[20:23]
    ds_read_b64_tr_b16 a[178:179], v134 offset:4096
    buffer_load_dwordx4 v158, s[72:75], s7 offen offset:1024 lds
    s_waitcnt lgkmcnt(10)
    v_mfma_f32_16x16x32_bf16 v[28:31], a[152:155], a[196:199], v[28:31]
    ds_read_b64_tr_b16 a[180:181], v134 offset:8192
    v_mfma_f32_16x16x32_bf16 v[28:31], a[156:159], a[204:207], v[28:31]
    ds_read_b64_tr_b16 a[182:183], v134 offset:12288
    v_mfma_f32_16x16x32_bf16 v[24:27], a[156:159], a[200:203], v[24:27]
    v_add_u32 v135, 65536, v135
    ds_read_b64_tr_b16 a[184:185], v135 offset:0
    v_mfma_f32_16x16x32_bf16 v[24:27], a[152:155], a[192:195], v[24:27]
    ds_read_b64_tr_b16 a[186:187], v135 offset:4096
    s_waitcnt lgkmcnt(10)
    v_mfma_f32_16x16x32_bf16 v[32:35], a[160:163], a[192:195], v[32:35]
    ds_read_b64_tr_b16 a[188:189], v135 offset:8192
    v_mfma_f32_16x16x32_bf16 v[32:35], a[164:167], a[200:203], v[32:35]
    ds_read_b64_tr_b16 a[190:191], v135 offset:12288
    v_mfma_f32_16x16x32_bf16 v[36:39], a[164:167], a[204:207], v[36:39]
    ds_read_b64_tr_b16 a[128:129], v128 offset:16384
    v_mfma_f32_16x16x32_bf16 v[36:39], a[160:163], a[196:199], v[36:39]
    ds_read_b64_tr_b16 a[130:131], v128 offset:20480
    s_waitcnt lgkmcnt(10)
    v_mfma_f32_16x16x32_bf16 v[44:47], a[168:171], a[196:199], v[44:47]
    ds_read_b64_tr_b16 a[132:133], v128 offset:24576
    v_mfma_f32_16x16x32_bf16 v[44:47], a[172:175], a[204:207], v[44:47]
    ds_read_b64_tr_b16 a[134:135], v128 offset:28672
    v_mfma_f32_16x16x32_bf16 v[40:43], a[172:175], a[200:203], v[40:43]
    ds_read_b64_tr_b16 a[136:137], v129 offset:16384
    v_mfma_f32_16x16x32_bf16 v[40:43], a[168:171], a[192:195], v[40:43]
    ds_read_b64_tr_b16 a[138:139], v129 offset:20480
    s_waitcnt lgkmcnt(10)
    v_mfma_f32_16x16x32_bf16 v[48:51], a[176:179], a[192:195], v[48:51]
    ds_read_b64_tr_b16 a[140:141], v129 offset:24576
    v_mfma_f32_16x16x32_bf16 v[48:51], a[180:183], a[200:203], v[48:51]
    ds_read_b64_tr_b16 a[142:143], v129 offset:28672
    v_mfma_f32_16x16x32_bf16 v[52:55], a[180:183], a[204:207], v[52:55]
    ds_read_b64_tr_b16 a[144:145], v130 offset:16384
    v_mfma_f32_16x16x32_bf16 v[52:55], a[176:179], a[196:199], v[52:55]
    ds_read_b64_tr_b16 a[146:147], v130 offset:20480
    s_waitcnt lgkmcnt(10)
    v_mfma_f32_16x16x32_bf16 v[60:63], a[184:187], a[196:199], v[60:63]
    ds_read_b64_tr_b16 a[148:149], v130 offset:24576
    v_mfma_f32_16x16x32_bf16 v[60:63], a[188:191], a[204:207], v[60:63]
    ds_read_b64_tr_b16 a[150:151], v130 offset:28672
    v_mfma_f32_16x16x32_bf16 v[56:59], a[188:191], a[200:203], v[56:59]
    ds_read_b64_tr_b16 a[152:153], v131 offset:16384
    v_mfma_f32_16x16x32_bf16 v[56:59], a[184:187], a[192:195], v[56:59]
    ds_read_b64_tr_b16 a[154:155], v131 offset:20480
    s_waitcnt lgkmcnt(10)
    v_mfma_f32_16x16x32_bf16 v[64:67], a[128:131], a[192:195], v[64:67]
    ds_read_b64_tr_b16 a[156:157], v131 offset:24576
    s_add_u32 m0, s62, 81920
    v_mfma_f32_16x16x32_bf16 v[64:67], a[132:135], a[200:203], v[64:67]
    ds_read_b64_tr_b16 a[158:159], v131 offset:28672
    s_add_u32 s7, s63, 28672
    v_mfma_f32_16x16x32_bf16 v[68:71], a[132:135], a[204:207], v[68:71]
    ds_read_b64_tr_b16 a[160:161], v132 offset:16384
    v_mfma_f32_16x16x32_bf16 v[68:71], a[128:131], a[196:199], v[68:71]
    ds_read_b64_tr_b16 a[162:163], v132 offset:20480
    buffer_load_dwordx4 v157, s[72:75], s7 offen offset:0 lds
    s_waitcnt lgkmcnt(10)
    v_mfma_f32_16x16x32_bf16 v[76:79], a[136:139], a[196:199], v[76:79]
    ds_read_b64_tr_b16 a[164:165], v132 offset:24576
    v_mfma_f32_16x16x32_bf16 v[76:79], a[140:143], a[204:207], v[76:79]
    ds_read_b64_tr_b16 a[166:167], v132 offset:28672
    buffer_load_dwordx4 v158, s[72:75], s7 offen offset:1024 lds
    v_mfma_f32_16x16x32_bf16 v[72:75], a[140:143], a[200:203], v[72:75]
    ds_read_b64_tr_b16 a[168:169], v133 offset:16384
    s_add_u32 m0, s62, 90112
    v_mfma_f32_16x16x32_bf16 v[72:75], a[136:139], a[192:195], v[72:75]
    ds_read_b64_tr_b16 a[170:171], v133 offset:20480
    s_waitcnt lgkmcnt(10)
    v_mfma_f32_16x16x32_bf16 v[80:83], a[144:147], a[192:195], v[80:83]
    ds_read_b64_tr_b16 a[172:173], v133 offset:24576
    s_add_u32 s7, s63, 57344
    v_mfma_f32_16x16x32_bf16 v[80:83], a[148:151], a[200:203], v[80:83]
    ds_read_b64_tr_b16 a[174:175], v133 offset:28672
    buffer_load_dwordx4 v157, s[72:75], s7 offen offset:0 lds
    v_mfma_f32_16x16x32_bf16 v[84:87], a[148:151], a[204:207], v[84:87]
    s_waitcnt vmcnt(21)
    s_barrier
    v_add_u32 v128, 4294836224, v128
    ds_read_b64_tr_b16 a[176:177], v128 offset:0
    v_mfma_f32_16x16x32_bf16 v[84:87], a[144:147], a[196:199], v[84:87]
    ds_read_b64_tr_b16 a[178:179], v128 offset:4096
    buffer_load_dwordx4 v158, s[72:75], s7 offen offset:1024 lds
    s_waitcnt lgkmcnt(10)
    v_mfma_f32_16x16x32_bf16 v[92:95], a[152:155], a[196:199], v[92:95]
    ds_read_b64_tr_b16 a[180:181], v128 offset:8192
    v_mfma_f32_16x16x32_bf16 v[92:95], a[156:159], a[204:207], v[92:95]
    ds_read_b64_tr_b16 a[182:183], v128 offset:12288
    v_mfma_f32_16x16x32_bf16 v[88:91], a[156:159], a[200:203], v[88:91]
    v_add_u32 v129, 4294836224, v129
    ds_read_b64_tr_b16 a[184:185], v129 offset:0
    v_mfma_f32_16x16x32_bf16 v[88:91], a[152:155], a[192:195], v[88:91]
    ds_read_b64_tr_b16 a[186:187], v129 offset:4096
    s_waitcnt lgkmcnt(10)
    v_mfma_f32_16x16x32_bf16 v[96:99], a[160:163], a[192:195], v[96:99]
    ds_read_b64_tr_b16 a[188:189], v129 offset:8192
    v_mfma_f32_16x16x32_bf16 v[96:99], a[164:167], a[200:203], v[96:99]
    ds_read_b64_tr_b16 a[190:191], v129 offset:12288
    v_mfma_f32_16x16x32_bf16 v[100:103], a[164:167], a[204:207], v[100:103]
    v_add_u32 v130, 4294836224, v130
    ds_read_b64_tr_b16 a[128:129], v130 offset:0
    v_mfma_f32_16x16x32_bf16 v[100:103], a[160:163], a[196:199], v[100:103]
    ds_read_b64_tr_b16 a[130:131], v130 offset:4096
    s_waitcnt lgkmcnt(10)
    v_mfma_f32_16x16x32_bf16 v[108:111], a[168:171], a[196:199], v[108:111]
    ds_read_b64_tr_b16 a[132:133], v130 offset:8192
    v_mfma_f32_16x16x32_bf16 v[108:111], a[172:175], a[204:207], v[108:111]
    ds_read_b64_tr_b16 a[134:135], v130 offset:12288
    v_mfma_f32_16x16x32_bf16 v[104:107], a[172:175], a[200:203], v[104:107]
    v_add_u32 v131, 4294836224, v131
    ds_read_b64_tr_b16 a[136:137], v131 offset:0
    v_mfma_f32_16x16x32_bf16 v[104:107], a[168:171], a[192:195], v[104:107]
    ds_read_b64_tr_b16 a[138:139], v131 offset:4096
    s_waitcnt lgkmcnt(10)
    v_mfma_f32_16x16x32_bf16 v[0:3], a[176:179], a[208:211], v[0:3]
    ds_read_b64_tr_b16 a[140:141], v131 offset:8192
    s_add_u32 m0, s62, 98304
    v_mfma_f32_16x16x32_bf16 v[0:3], a[180:183], a[216:219], v[0:3]
    ds_read_b64_tr_b16 a[142:143], v131 offset:12288
    s_add_u32 s7, s63, 86016
    v_mfma_f32_16x16x32_bf16 v[4:7], a[180:183], a[220:223], v[4:7]
    v_add_u32 v132, 4294836224, v132
    ds_read_b64_tr_b16 a[144:145], v132 offset:0
    v_mfma_f32_16x16x32_bf16 v[4:7], a[176:179], a[212:215], v[4:7]
    ds_read_b64_tr_b16 a[146:147], v132 offset:4096
    buffer_load_dwordx4 v157, s[72:75], s7 offen offset:0 lds
    s_waitcnt lgkmcnt(10)
    v_mfma_f32_16x16x32_bf16 v[12:15], a[184:187], a[212:215], v[12:15]
    ds_read_b64_tr_b16 a[148:149], v132 offset:8192
    v_mfma_f32_16x16x32_bf16 v[12:15], a[188:191], a[220:223], v[12:15]
    ds_read_b64_tr_b16 a[150:151], v132 offset:12288
    buffer_load_dwordx4 v158, s[72:75], s7 offen offset:1024 lds
    v_mfma_f32_16x16x32_bf16 v[8:11], a[188:191], a[216:219], v[8:11]
    v_add_u32 v133, 4294836224, v133
    ds_read_b64_tr_b16 a[152:153], v133 offset:0
    s_add_u32 m0, s62, 106496
    v_mfma_f32_16x16x32_bf16 v[8:11], a[184:187], a[208:211], v[8:11]
    ds_read_b64_tr_b16 a[154:155], v133 offset:4096
    s_waitcnt lgkmcnt(10)
    v_mfma_f32_16x16x32_bf16 v[16:19], a[128:131], a[208:211], v[16:19]
    ds_read_b64_tr_b16 a[156:157], v133 offset:8192
    s_add_u32 s7, s63, 114688
    v_mfma_f32_16x16x32_bf16 v[16:19], a[132:135], a[216:219], v[16:19]
    ds_read_b64_tr_b16 a[158:159], v133 offset:12288
    buffer_load_dwordx4 v157, s[72:75], s7 offen offset:0 lds
    v_mfma_f32_16x16x32_bf16 v[20:23], a[132:135], a[220:223], v[20:23]
    v_add_u32 v134, 4294836224, v134
    ds_read_b64_tr_b16 a[160:161], v134 offset:0
    v_mfma_f32_16x16x32_bf16 v[20:23], a[128:131], a[212:215], v[20:23]
    ds_read_b64_tr_b16 a[162:163], v134 offset:4096
    buffer_load_dwordx4 v158, s[72:75], s7 offen offset:1024 lds
    s_waitcnt lgkmcnt(10)
    v_mfma_f32_16x16x32_bf16 v[28:31], a[136:139], a[212:215], v[28:31]
    ds_read_b64_tr_b16 a[164:165], v134 offset:8192
    v_mfma_f32_16x16x32_bf16 v[28:31], a[140:143], a[220:223], v[28:31]
    ds_read_b64_tr_b16 a[166:167], v134 offset:12288
    v_mfma_f32_16x16x32_bf16 v[24:27], a[140:143], a[216:219], v[24:27]
    v_add_u32 v135, 4294836224, v135
    ds_read_b64_tr_b16 a[168:169], v135 offset:0
    v_mfma_f32_16x16x32_bf16 v[24:27], a[136:139], a[208:211], v[24:27]
    ds_read_b64_tr_b16 a[170:171], v135 offset:4096
    s_waitcnt lgkmcnt(10)
    v_mfma_f32_16x16x32_bf16 v[32:35], a[144:147], a[208:211], v[32:35]
    ds_read_b64_tr_b16 a[172:173], v135 offset:8192
    v_mfma_f32_16x16x32_bf16 v[32:35], a[148:151], a[216:219], v[32:35]
    ds_read_b64_tr_b16 a[174:175], v135 offset:12288
    v_mfma_f32_16x16x32_bf16 v[36:39], a[148:151], a[220:223], v[36:39]
    ds_read_b64_tr_b16 a[176:177], v128 offset:16384
    v_mfma_f32_16x16x32_bf16 v[36:39], a[144:147], a[212:215], v[36:39]
    ds_read_b64_tr_b16 a[178:179], v128 offset:20480
    s_waitcnt lgkmcnt(10)
    v_mfma_f32_16x16x32_bf16 v[44:47], a[152:155], a[212:215], v[44:47]
    ds_read_b64_tr_b16 a[180:181], v128 offset:24576
    v_mfma_f32_16x16x32_bf16 v[44:47], a[156:159], a[220:223], v[44:47]
    ds_read_b64_tr_b16 a[182:183], v128 offset:28672
    v_mfma_f32_16x16x32_bf16 v[40:43], a[156:159], a[216:219], v[40:43]
    ds_read_b64_tr_b16 a[184:185], v129 offset:16384
    v_mfma_f32_16x16x32_bf16 v[40:43], a[152:155], a[208:211], v[40:43]
    ds_read_b64_tr_b16 a[186:187], v129 offset:20480
    s_mov_b64 exec, 67108864
    buffer_load_dword v166, v164, s[16:19], 0 offen sc0 sc1
    s_mov_b64 exec, -1
    s_waitcnt lgkmcnt(10)
    v_mfma_f32_16x16x32_bf16 v[48:51], a[160:163], a[208:211], v[48:51]
    ds_read_b64_tr_b16 a[188:189], v129 offset:24576
    v_mfma_f32_16x16x32_bf16 v[48:51], a[164:167], a[216:219], v[48:51]
    ds_read_b64_tr_b16 a[190:191], v129 offset:28672
    v_mfma_f32_16x16x32_bf16 v[52:55], a[164:167], a[220:223], v[52:55]
    ds_read_b64_tr_b16 a[128:129], v130 offset:16384
    v_mfma_f32_16x16x32_bf16 v[52:55], a[160:163], a[212:215], v[52:55]
    ds_read_b64_tr_b16 a[130:131], v130 offset:20480
    s_waitcnt lgkmcnt(10)
    v_mfma_f32_16x16x32_bf16 v[60:63], a[168:171], a[212:215], v[60:63]
    ds_read_b64_tr_b16 a[132:133], v130 offset:24576
    v_mfma_f32_16x16x32_bf16 v[60:63], a[172:175], a[220:223], v[60:63]
    ds_read_b64_tr_b16 a[134:135], v130 offset:28672
    v_mfma_f32_16x16x32_bf16 v[56:59], a[172:175], a[216:219], v[56:59]
    ds_read_b64_tr_b16 a[136:137], v131 offset:16384
    v_mfma_f32_16x16x32_bf16 v[56:59], a[168:171], a[208:211], v[56:59]
    ds_read_b64_tr_b16 a[138:139], v131 offset:20480
    s_waitcnt lgkmcnt(10)
    v_mfma_f32_16x16x32_bf16 v[64:67], a[176:179], a[208:211], v[64:67]
    ds_read_b64_tr_b16 a[140:141], v131 offset:24576
    s_add_u32 m0, s62, 114688
    v_mfma_f32_16x16x32_bf16 v[64:67], a[180:183], a[216:219], v[64:67]
    ds_read_b64_tr_b16 a[142:143], v131 offset:28672
    s_add_u32 s7, s63, 143360
    v_mfma_f32_16x16x32_bf16 v[68:71], a[180:183], a[220:223], v[68:71]
    ds_read_b64_tr_b16 a[144:145], v132 offset:16384
    v_mfma_f32_16x16x32_bf16 v[68:71], a[176:179], a[212:215], v[68:71]
    ds_read_b64_tr_b16 a[146:147], v132 offset:20480
    buffer_load_dwordx4 v157, s[72:75], s7 offen offset:0 lds
    s_waitcnt lgkmcnt(10)
    v_mfma_f32_16x16x32_bf16 v[76:79], a[184:187], a[212:215], v[76:79]
    ds_read_b64_tr_b16 a[148:149], v132 offset:24576
    v_mfma_f32_16x16x32_bf16 v[76:79], a[188:191], a[220:223], v[76:79]
    ds_read_b64_tr_b16 a[150:151], v132 offset:28672
    buffer_load_dwordx4 v158, s[72:75], s7 offen offset:1024 lds
    v_mfma_f32_16x16x32_bf16 v[72:75], a[188:191], a[216:219], v[72:75]
    ds_read_b64_tr_b16 a[152:153], v133 offset:16384
    s_add_u32 m0, s62, 122880
    v_mfma_f32_16x16x32_bf16 v[72:75], a[184:187], a[208:211], v[72:75]
    ds_read_b64_tr_b16 a[154:155], v133 offset:20480
    s_waitcnt lgkmcnt(10)
    v_mfma_f32_16x16x32_bf16 v[80:83], a[128:131], a[208:211], v[80:83]
    ds_read_b64_tr_b16 a[156:157], v133 offset:24576
    s_add_u32 s7, s63, 172032
    v_mfma_f32_16x16x32_bf16 v[80:83], a[132:135], a[216:219], v[80:83]
    ds_read_b64_tr_b16 a[158:159], v133 offset:28672
    buffer_load_dwordx4 v157, s[72:75], s7 offen offset:0 lds
    v_mfma_f32_16x16x32_bf16 v[84:87], a[132:135], a[220:223], v[84:87]
    s_waitcnt vmcnt(16)
    s_barrier
    ds_read_b64_tr_b16 a[160:161], v128 offset:32768
    v_mfma_f32_16x16x32_bf16 v[84:87], a[128:131], a[212:215], v[84:87]
    ds_read_b64_tr_b16 a[162:163], v128 offset:36864
    buffer_load_dwordx4 v158, s[72:75], s7 offen offset:1024 lds
    s_waitcnt lgkmcnt(10)
    v_mfma_f32_16x16x32_bf16 v[92:95], a[136:139], a[212:215], v[92:95]
    ds_read_b64_tr_b16 a[164:165], v128 offset:40960
    v_mfma_f32_16x16x32_bf16 v[92:95], a[140:143], a[220:223], v[92:95]
    ds_read_b64_tr_b16 a[166:167], v128 offset:45056
    v_mfma_f32_16x16x32_bf16 v[88:91], a[140:143], a[216:219], v[88:91]
    ds_read_b64_tr_b16 a[168:169], v129 offset:32768
    v_mfma_f32_16x16x32_bf16 v[88:91], a[136:139], a[208:211], v[88:91]
    ds_read_b64_tr_b16 a[170:171], v129 offset:36864
    s_waitcnt lgkmcnt(10)
    v_mfma_f32_16x16x32_bf16 v[96:99], a[144:147], a[208:211], v[96:99]
    ds_read_b64_tr_b16 a[172:173], v129 offset:40960
    v_mfma_f32_16x16x32_bf16 v[96:99], a[148:151], a[216:219], v[96:99]
    ds_read_b64_tr_b16 a[174:175], v129 offset:45056
    v_mfma_f32_16x16x32_bf16 v[100:103], a[148:151], a[220:223], v[100:103]
    ds_read_b64_tr_b16 a[176:177], v130 offset:32768
    v_mfma_f32_16x16x32_bf16 v[100:103], a[144:147], a[212:215], v[100:103]
    ds_read_b64_tr_b16 a[178:179], v130 offset:36864
    s_waitcnt lgkmcnt(10)
    v_mfma_f32_16x16x32_bf16 v[108:111], a[152:155], a[212:215], v[108:111]
    ds_read_b64_tr_b16 a[180:181], v130 offset:40960
    v_mfma_f32_16x16x32_bf16 v[108:111], a[156:159], a[220:223], v[108:111]
    ds_read_b64_tr_b16 a[182:183], v130 offset:45056
    v_mfma_f32_16x16x32_bf16 v[104:107], a[156:159], a[216:219], v[104:107]
    ds_read_b64_tr_b16 a[184:185], v131 offset:32768
    v_mfma_f32_16x16x32_bf16 v[104:107], a[152:155], a[208:211], v[104:107]
    ds_read_b64_tr_b16 a[186:187], v131 offset:36864
    s_waitcnt lgkmcnt(10)
    v_mfma_f32_16x16x32_bf16 v[0:3], a[160:163], a[64:67], v[0:3]
    ds_read_b64_tr_b16 a[188:189], v131 offset:40960
    s_add_u32 m0, s62, 131072
    v_mfma_f32_16x16x32_bf16 v[0:3], a[164:167], a[72:75], v[0:3]
    ds_read_b64_tr_b16 a[190:191], v131 offset:45056
    s_add_u32 s7, s63, 200704
    v_mfma_f32_16x16x32_bf16 v[4:7], a[164:167], a[76:79], v[4:7]
    ds_read_b64_tr_b16 a[128:129], v132 offset:32768
    v_mfma_f32_16x16x32_bf16 v[4:7], a[160:163], a[68:71], v[4:7]
    ds_read_b64_tr_b16 a[130:131], v132 offset:36864
    buffer_load_dwordx4 v157, s[72:75], s7 offen offset:0 lds
    s_waitcnt lgkmcnt(10)
    v_mfma_f32_16x16x32_bf16 v[12:15], a[168:171], a[68:71], v[12:15]
    ds_read_b64_tr_b16 a[132:133], v132 offset:40960
    v_mfma_f32_16x16x32_bf16 v[12:15], a[172:175], a[76:79], v[12:15]
    ds_read_b64_tr_b16 a[134:135], v132 offset:45056
    buffer_load_dwordx4 v158, s[72:75], s7 offen offset:1024 lds
    v_mfma_f32_16x16x32_bf16 v[8:11], a[172:175], a[72:75], v[8:11]
    ds_read_b64_tr_b16 a[136:137], v133 offset:32768
    s_add_u32 m0, s62, 139264
    v_mfma_f32_16x16x32_bf16 v[8:11], a[168:171], a[64:67], v[8:11]
    ds_read_b64_tr_b16 a[138:139], v133 offset:36864
    s_waitcnt lgkmcnt(10)
    v_mfma_f32_16x16x32_bf16 v[16:19], a[176:179], a[64:67], v[16:19]
    ds_read_b64_tr_b16 a[140:141], v133 offset:40960
    s_add_u32 s7, s60, 172288
    v_mfma_f32_16x16x32_bf16 v[16:19], a[180:183], a[72:75], v[16:19]
    ds_read_b64_tr_b16 a[142:143], v133 offset:45056
    buffer_load_dwordx4 v188, s[68:71], s7 offen offset:0 lds
    v_mfma_f32_16x16x32_bf16 v[20:23], a[180:183], a[76:79], v[20:23]
    ds_read_b64_tr_b16 a[144:145], v134 offset:32768
    v_mfma_f32_16x16x32_bf16 v[20:23], a[176:179], a[68:71], v[20:23]
    ds_read_b64_tr_b16 a[146:147], v134 offset:36864
    buffer_load_dwordx4 v189, s[68:71], s7 offen offset:1024 lds
    s_waitcnt lgkmcnt(10)
    v_mfma_f32_16x16x32_bf16 v[28:31], a[184:187], a[68:71], v[28:31]
    ds_read_b64_tr_b16 a[148:149], v134 offset:40960
    v_mfma_f32_16x16x32_bf16 v[28:31], a[188:191], a[76:79], v[28:31]
    ds_read_b64_tr_b16 a[150:151], v134 offset:45056
    v_mfma_f32_16x16x32_bf16 v[24:27], a[188:191], a[72:75], v[24:27]
    ds_read_b64_tr_b16 a[152:153], v135 offset:32768
    v_mfma_f32_16x16x32_bf16 v[24:27], a[184:187], a[64:67], v[24:27]
    ds_read_b64_tr_b16 a[154:155], v135 offset:36864
    s_waitcnt vmcnt(8)
    s_mov_b32 s57, 1048576
Lpl26:
    v_cmp_ge_u32 s[50:51], v166, v165
    s_nop 1
    s_and_b32 s50, s50, 67108864
    s_cmp_eq_u32 s50, 67108864
    s_cbranch_scc1 Lpo27
    s_sub_u32 s57, s57, 1
    s_cbranch_scc1 Lpo27
    s_mov_b64 exec, 67108864
    buffer_load_dword v166, v164, s[16:19], 0 offen sc0 sc1
    s_mov_b64 exec, -1
    s_waitcnt vmcnt(0)
    s_branch Lpl26
Lpo27:
    s_waitcnt lgkmcnt(10)
    v_mfma_f32_16x16x32_bf16 v[32:35], a[128:131], a[64:67], v[32:35]
    ds_read_b64_tr_b16 a[156:157], v135 offset:40960
    v_mfma_f32_16x16x32_bf16 v[32:35], a[132:135], a[72:75], v[32:35]
    ds_read_b64_tr_b16 a[158:159], v135 offset:45056
    buffer_load_dwordx4 a[0:3], v155, s[16:19], s91 offen offset:0 sc0 sc1
    v_mfma_f32_16x16x32_bf16 v[36:39], a[132:135], a[76:79], v[36:39]
    ds_read_b64_tr_b16 a[160:161], v128 offset:49152
    v_mfma_f32_16x16x32_bf16 v[36:39], a[128:131], a[68:71], v[36:39]
    ds_read_b64_tr_b16 a[162:163], v128 offset:53248
    s_waitcnt lgkmcnt(10)
    v_mfma_f32_16x16x32_bf16 v[44:47], a[136:139], a[68:71], v[44:47]
    ds_read_b64_tr_b16 a[164:165], v128 offset:57344
    v_mfma_f32_16x16x32_bf16 v[44:47], a[140:143], a[76:79], v[44:47]
    ds_read_b64_tr_b16 a[166:167], v128 offset:61440
    buffer_load_dwordx4 a[4:7], v155, s[16:19], s91 offen offset:1024 sc0 sc1
    v_mfma_f32_16x16x32_bf16 v[40:43], a[140:143], a[72:75], v[40:43]
    ds_read_b64_tr_b16 a[168:169], v129 offset:49152
    v_mfma_f32_16x16x32_bf16 v[40:43], a[136:139], a[64:67], v[40:43]
    ds_read_b64_tr_b16 a[170:171], v129 offset:53248
    s_waitcnt lgkmcnt(10)
    v_mfma_f32_16x16x32_bf16 v[48:51], a[144:147], a[64:67], v[48:51]
    ds_read_b64_tr_b16 a[172:173], v129 offset:57344
    v_mfma_f32_16x16x32_bf16 v[48:51], a[148:151], a[72:75], v[48:51]
    ds_read_b64_tr_b16 a[174:175], v129 offset:61440
    buffer_load_dwordx4 a[8:11], v155, s[16:19], s91 offen offset:2048 sc0 sc1
    v_mfma_f32_16x16x32_bf16 v[52:55], a[148:151], a[76:79], v[52:55]
    ds_read_b64_tr_b16 a[176:177], v130 offset:49152
    v_mfma_f32_16x16x32_bf16 v[52:55], a[144:147], a[68:71], v[52:55]
    ds_read_b64_tr_b16 a[178:179], v130 offset:53248
    s_waitcnt lgkmcnt(10)
    v_mfma_f32_16x16x32_bf16 v[60:63], a[152:155], a[68:71], v[60:63]
    ds_read_b64_tr_b16 a[180:181], v130 offset:57344
    v_mfma_f32_16x16x32_bf16 v[60:63], a[156:159], a[76:79], v[60:63]
    ds_read_b64_tr_b16 a[182:183], v130 offset:61440
    buffer_load_dwordx4 a[12:15], v155, s[16:19], s91 offen offset:3072 sc0 sc1
    v_mfma_f32_16x16x32_bf16 v[56:59], a[156:159], a[72:75], v[56:59]
    ds_read_b64_tr_b16 a[184:185], v131 offset:49152
    v_mfma_f32_16x16x32_bf16 v[56:59], a[152:155], a[64:67], v[56:59]
    ds_read_b64_tr_b16 a[186:187], v131 offset:53248
    s_waitcnt lgkmcnt(10)
    v_mfma_f32_16x16x32_bf16 v[64:67], a[160:163], a[64:67], v[64:67]
    ds_read_b64_tr_b16 a[188:189], v131 offset:57344
    s_add_u32 m0, s62, 147456
    v_mfma_f32_16x16x32_bf16 v[64:67], a[164:167], a[72:75], v[64:67]
    ds_read_b64_tr_b16 a[190:191], v131 offset:61440
    s_add_u32 s91, s91, 4096
    buffer_load_dwordx4 a[16:19], v155, s[16:19], s91 offen offset:0 sc0 sc1
    v_mfma_f32_16x16x32_bf16 v[68:71], a[164:167], a[76:79], v[68:71]
    ds_read_b64_tr_b16 a[128:129], v132 offset:49152
    s_add_u32 s7, s63, 256
    v_mfma_f32_16x16x32_bf16 v[68:71], a[160:163], a[68:71], v[68:71]
    ds_read_b64_tr_b16 a[130:131], v132 offset:53248
    buffer_load_dwordx4 v188, s[72:75], s7 offen offset:0 lds
    s_waitcnt lgkmcnt(10)
    v_mfma_f32_16x16x32_bf16 v[76:79], a[168:171], a[68:71], v[76:79]
    ds_read_b64_tr_b16 a[132:133], v132 offset:57344
    v_mfma_f32_16x16x32_bf16 v[76:79], a[172:175], a[76:79], v[76:79]
    ds_read_b64_tr_b16 a[134:135], v132 offset:61440
    buffer_load_dwordx4 a[20:23], v155, s[16:19], s91 offen offset:1024 sc0 sc1
    v_mfma_f32_16x16x32_bf16 v[72:75], a[172:175], a[72:75], v[72:75]
    ds_read_b64_tr_b16 a[136:137], v133 offset:49152
    v_mfma_f32_16x16x32_bf16 v[72:75], a[168:171], a[64:67], v[72:75]
    ds_read_b64_tr_b16 a[138:139], v133 offset:53248
    buffer_load_dwordx4 v189, s[72:75], s7 offen offset:1024 lds
    s_waitcnt lgkmcnt(10)
    v_mfma_f32_16x16x32_bf16 v[80:83], a[176:179], a[64:67], v[80:83]
    ds_read_b64_tr_b16 a[140:141], v133 offset:57344
    s_add_u32 m0, s62, 155648
    v_mfma_f32_16x16x32_bf16 v[80:83], a[180:183], a[72:75], v[80:83]
    ds_read_b64_tr_b16 a[142:143], v133 offset:61440
    buffer_load_dwordx4 a[24:27], v155, s[16:19], s91 offen offset:2048 sc0 sc1
    v_mfma_f32_16x16x32_bf16 v[84:87], a[180:183], a[76:79], v[84:87]
    s_waitcnt vmcnt(22)
    s_barrier
    v_add_u32 v128, 65536, v128
    ds_read_b64_tr_b16 a[144:145], v128 offset:0
    s_add_u32 s7, s63, 28928
    v_mfma_f32_16x16x32_bf16 v[84:87], a[176:179], a[68:71], v[84:87]
    ds_read_b64_tr_b16 a[146:147], v128 offset:4096
    buffer_load_dwordx4 v188, s[72:75], s7 offen offset:0 lds
    s_waitcnt lgkmcnt(10)
    v_mfma_f32_16x16x32_bf16 v[92:95], a[184:187], a[68:71], v[92:95]
    ds_read_b64_tr_b16 a[148:149], v128 offset:8192
    v_mfma_f32_16x16x32_bf16 v[92:95], a[188:191], a[76:79], v[92:95]
    ds_read_b64_tr_b16 a[150:151], v128 offset:12288
    buffer_load_dwordx4 a[28:31], v155, s[16:19], s91 offen offset:3072 sc0 sc1
    v_mfma_f32_16x16x32_bf16 v[88:91], a[188:191], a[72:75], v[88:91]
    v_add_u32 v129, 65536, v129
    ds_read_b64_tr_b16 a[152:153], v129 offset:0
    v_mfma_f32_16x16x32_bf16 v[88:91], a[184:187], a[64:67], v[88:91]
    ds_read_b64_tr_b16 a[154:155], v129 offset:4096
    buffer_load_dwordx4 v189, s[72:75], s7 offen offset:1024 lds
    s_waitcnt lgkmcnt(10)
    v_mfma_f32_16x16x32_bf16 v[96:99], a[128:131], a[64:67], v[96:99]
    ds_read_b64_tr_b16 a[156:157], v129 offset:8192
    v_mfma_f32_16x16x32_bf16 v[96:99], a[132:135], a[72:75], v[96:99]
    ds_read_b64_tr_b16 a[158:159], v129 offset:12288
    s_add_u32 s91, s91, 4096
    buffer_load_dwordx4 a[32:35], v155, s[16:19], s91 offen offset:0 sc0 sc1
    v_mfma_f32_16x16x32_bf16 v[100:103], a[132:135], a[76:79], v[100:103]
    v_add_u32 v130, 65536, v130
    ds_read_b64_tr_b16 a[160:161], v130 offset:0
    v_mfma_f32_16x16x32_bf16 v[100:103], a[128:131], a[68:71], v[100:103]
    ds_read_b64_tr_b16 a[162:163], v130 offset:4096
    s_waitcnt lgkmcnt(10)
    v_mfma_f32_16x16x32_bf16 v[108:111], a[136:139], a[68:71], v[108:111]
    ds_read_b64_tr_b16 a[164:165], v130 offset:8192
    v_mfma_f32_16x16x32_bf16 v[108:111], a[140:143], a[76:79], v[108:111]
    ds_read_b64_tr_b16 a[166:167], v130 offset:12288
    buffer_load_dwordx4 a[36:39], v155, s[16:19], s91 offen offset:1024 sc0 sc1
    v_mfma_f32_16x16x32_bf16 v[104:107], a[140:143], a[72:75], v[104:107]
    v_add_u32 v131, 65536, v131
    ds_read_b64_tr_b16 a[168:169], v131 offset:0
    v_mfma_f32_16x16x32_bf16 v[104:107], a[136:139], a[64:67], v[104:107]
    ds_read_b64_tr_b16 a[170:171], v131 offset:4096
    s_waitcnt vmcnt(12)
    s_waitcnt lgkmcnt(10)
    v_mfma_f32_16x16x32_bf16 v[0:3], a[144:147], a[80:83], v[0:3]
    ds_read_b64_tr_b16 a[172:173], v131 offset:8192
    s_add_u32 m0, s62, 0
    v_mfma_f32_16x16x32_bf16 v[0:3], a[148:151], a[0:3], v[0:3]
    ds_read_b64_tr_b16 a[174:175], v131 offset:12288
    buffer_load_dwordx4 a[40:43], v155, s[16:19], s91 offen offset:2048 sc0 sc1
    v_mfma_f32_16x16x32_bf16 v[4:7], a[148:151], a[4:7], v[4:7]
    v_add_u32 v132, 65536, v132
    ds_read_b64_tr_b16 a[176:177], v132 offset:0
    s_add_u32 s7, s63, 57600
    v_mfma_f32_16x16x32_bf16 v[4:7], a[144:147], a[84:87], v[4:7]
    ds_read_b64_tr_b16 a[178:179], v132 offset:4096
    buffer_load_dwordx4 v188, s[72:75], s7 offen offset:0 lds
    s_waitcnt lgkmcnt(10)
    v_mfma_f32_16x16x32_bf16 v[12:15], a[152:155], a[84:87], v[12:15]
    ds_read_b64_tr_b16 a[180:181], v132 offset:8192
    v_mfma_f32_16x16x32_bf16 v[12:15], a[156:159], a[4:7], v[12:15]
    ds_read_b64_tr_b16 a[182:183], v132 offset:12288
    buffer_load_dwordx4 a[44:47], v155, s[16:19], s91 offen offset:3072 sc0 sc1
    v_mfma_f32_16x16x32_bf16 v[8:11], a[156:159], a[0:3], v[8:11]
    v_add_u32 v133, 65536, v133
    ds_read_b64_tr_b16 a[184:185], v133 offset:0
    v_mfma_f32_16x16x32_bf16 v[8:11], a[152:155], a[80:83], v[8:11]
    ds_read_b64_tr_b16 a[186:187], v133 offset:4096
    buffer_load_dwordx4 v189, s[72:75], s7 offen offset:1024 lds
    s_waitcnt lgkmcnt(10)
    v_mfma_f32_16x16x32_bf16 v[16:19], a[160:163], a[80:83], v[16:19]
    ds_read_b64_tr_b16 a[188:189], v133 offset:8192
    s_add_u32 m0, s62, 8192
    v_mfma_f32_16x16x32_bf16 v[16:19], a[164:167], a[0:3], v[16:19]
    ds_read_b64_tr_b16 a[190:191], v133 offset:12288
    s_add_u32 s91, s91, 4096
    buffer_load_dwordx4 a[48:51], v155, s[16:19], s91 offen offset:0 sc0 sc1
    v_mfma_f32_16x16x32_bf16 v[20:23], a[164:167], a[4:7], v[20:23]
    v_add_u32 v134, 65536, v134
    ds_read_b64_tr_b16 a[128:129], v134 offset:0
    s_add_u32 s7, s63, 86272
    v_mfma_f32_16x16x32_bf16 v[20:23], a[160:163], a[84:87], v[20:23]
    ds_read_b64_tr_b16 a[130:131], v134 offset:4096
    buffer_load_dwordx4 v188, s[72:75], s7 offen offset:0 lds
    s_waitcnt lgkmcnt(10)
    v_mfma_f32_16x16x32_bf16 v[28:31], a[168:171], a[84:87], v[28:31]
    ds_read_b64_tr_b16 a[132:133], v134 offset:8192
    v_mfma_f32_16x16x32_bf16 v[28:31], a[172:175], a[4:7], v[28:31]
    ds_read_b64_tr_b16 a[134:135], v134 offset:12288
    buffer_load_dwordx4 a[52:55], v155, s[16:19], s91 offen offset:1024 sc0 sc1
    v_mfma_f32_16x16x32_bf16 v[24:27], a[172:175], a[0:3], v[24:27]
    v_add_u32 v135, 65536, v135
    ds_read_b64_tr_b16 a[136:137], v135 offset:0
    v_mfma_f32_16x16x32_bf16 v[24:27], a[168:171], a[80:83], v[24:27]
    ds_read_b64_tr_b16 a[138:139], v135 offset:4096
    buffer_load_dwordx4 v189, s[72:75], s7 offen offset:1024 lds
    s_waitcnt lgkmcnt(10)
    v_mfma_f32_16x16x32_bf16 v[32:35], a[176:179], a[80:83], v[32:35]
    ds_read_b64_tr_b16 a[140:141], v135 offset:8192
    v_mfma_f32_16x16x32_bf16 v[32:35], a[180:183], a[0:3], v[32:35]
    ds_read_b64_tr_b16 a[142:143], v135 offset:12288
    buffer_load_dwordx4 a[56:59], v155, s[16:19], s91 offen offset:2048 sc0 sc1
    v_mfma_f32_16x16x32_bf16 v[36:39], a[180:183], a[4:7], v[36:39]
    ds_read_b64_tr_b16 a[144:145], v128 offset:16384
    v_mfma_f32_16x16x32_bf16 v[36:39], a[176:179], a[84:87], v[36:39]
    ds_read_b64_tr_b16 a[146:147], v128 offset:20480
    s_waitcnt lgkmcnt(10)
    v_mfma_f32_16x16x32_bf16 v[44:47], a[184:187], a[84:87], v[44:47]
    ds_read_b64_tr_b16 a[148:149], v128 offset:24576
    v_mfma_f32_16x16x32_bf16 v[44:47], a[188:191], a[4:7], v[44:47]
    ds_read_b64_tr_b16 a[150:151], v128 offset:28672
    buffer_load_dwordx4 a[60:63], v155, s[16:19], s91 offen offset:3072 sc0 sc1
    v_mfma_f32_16x16x32_bf16 v[40:43], a[188:191], a[0:3], v[40:43]
    ds_read_b64_tr_b16 a[152:153], v129 offset:16384
    v_mfma_f32_16x16x32_bf16 v[40:43], a[184:187], a[80:83], v[40:43]
    ds_read_b64_tr_b16 a[154:155], v129 offset:20480
    s_waitcnt lgkmcnt(10)
    v_mfma_f32_16x16x32_bf16 v[48:51], a[128:131], a[80:83], v[48:51]
    ds_read_b64_tr_b16 a[156:157], v129 offset:24576
    v_mfma_f32_16x16x32_bf16 v[48:51], a[132:135], a[0:3], v[48:51]
    ds_read_b64_tr_b16 a[158:159], v129 offset:28672
    v_mfma_f32_16x16x32_bf16 v[52:55], a[132:135], a[4:7], v[52:55]
    ds_read_b64_tr_b16 a[160:161], v130 offset:16384
    v_mfma_f32_16x16x32_bf16 v[52:55], a[128:131], a[84:87], v[52:55]
    ds_read_b64_tr_b16 a[162:163], v130 offset:20480
    s_waitcnt lgkmcnt(10)
    v_mfma_f32_16x16x32_bf16 v[60:63], a[136:139], a[84:87], v[60:63]
    ds_read_b64_tr_b16 a[164:165], v130 offset:24576
    v_mfma_f32_16x16x32_bf16 v[60:63], a[140:143], a[4:7], v[60:63]
    ds_read_b64_tr_b16 a[166:167], v130 offset:28672
    v_mfma_f32_16x16x32_bf16 v[56:59], a[140:143], a[0:3], v[56:59]
    ds_read_b64_tr_b16 a[168:169], v131 offset:16384
    v_mfma_f32_16x16x32_bf16 v[56:59], a[136:139], a[80:83], v[56:59]
    ds_read_b64_tr_b16 a[170:171], v131 offset:20480
    s_waitcnt vmcnt(17)
    s_waitcnt lgkmcnt(10)
    v_mfma_f32_16x16x32_bf16 v[0:3], a[144:147], a[8:11], v[0:3]
    ds_read_b64_tr_b16 a[172:173], v131 offset:24576
    s_add_u32 m0, s62, 16384
    v_mfma_f32_16x16x32_bf16 v[0:3], a[148:151], a[16:19], v[0:3]
    ds_read_b64_tr_b16 a[174:175], v131 offset:28672
    s_add_u32 s7, s63, 114944
    v_mfma_f32_16x16x32_bf16 v[4:7], a[148:151], a[20:23], v[4:7]
    ds_read_b64_tr_b16 a[176:177], v132 offset:16384
    v_mfma_f32_16x16x32_bf16 v[4:7], a[144:147], a[12:15], v[4:7]
    ds_read_b64_tr_b16 a[178:179], v132 offset:20480
    buffer_load_dwordx4 v188, s[72:75], s7 offen offset:0 lds
    s_waitcnt lgkmcnt(10)
    v_mfma_f32_16x16x32_bf16 v[12:15], a[152:155], a[12:15], v[12:15]
    ds_read_b64_tr_b16 a[180:181], v132 offset:24576
    v_mfma_f32_16x16x32_bf16 v[12:15], a[156:159], a[20:23], v[12:15]
    ds_read_b64_tr_b16 a[182:183], v132 offset:28672
    buffer_load_dwordx4 v189, s[72:75], s7 offen offset:1024 lds
    v_mfma_f32_16x16x32_bf16 v[8:11], a[156:159], a[16:19], v[8:11]
    ds_read_b64_tr_b16 a[184:185], v133 offset:16384
    s_add_u32 m0, s62, 24576
    v_mfma_f32_16x16x32_bf16 v[8:11], a[152:155], a[8:11], v[8:11]
    ds_read_b64_tr_b16 a[186:187], v133 offset:20480
    s_waitcnt lgkmcnt(10)
    v_mfma_f32_16x16x32_bf16 v[16:19], a[160:163], a[8:11], v[16:19]
    ds_read_b64_tr_b16 a[188:189], v133 offset:24576
    s_add_u32 s7, s63, 143616
    v_mfma_f32_16x16x32_bf16 v[16:19], a[164:167], a[16:19], v[16:19]
    ds_read_b64_tr_b16 a[190:191], v133 offset:28672
    buffer_load_dwordx4 v188, s[72:75], s7 offen offset:0 lds
    v_mfma_f32_16x16x32_bf16 v[20:23], a[164:167], a[20:23], v[20:23]
    ds_read_b64_tr_b16 a[128:129], v134 offset:16384
    v_mfma_f32_16x16x32_bf16 v[20:23], a[160:163], a[12:15], v[20:23]
    ds_read_b64_tr_b16 a[130:131], v134 offset:20480
    buffer_load_dwordx4 v189, s[72:75], s7 offen offset:1024 lds
    s_waitcnt lgkmcnt(10)
    v_mfma_f32_16x16x32_bf16 v[28:31], a[168:171], a[12:15], v[28:31]
    ds_read_b64_tr_b16 a[132:133], v134 offset:24576
    v_mfma_f32_16x16x32_bf16 v[28:31], a[172:175], a[20:23], v[28:31]
    ds_read_b64_tr_b16 a[134:135], v134 offset:28672
    v_mfma_f32_16x16x32_bf16 v[24:27], a[172:175], a[16:19], v[24:27]
    ds_read_b64_tr_b16 a[136:137], v135 offset:16384
    v_mfma_f32_16x16x32_bf16 v[24:27], a[168:171], a[8:11], v[24:27]
    ds_read_b64_tr_b16 a[138:139], v135 offset:20480
    s_waitcnt lgkmcnt(10)
    v_mfma_f32_16x16x32_bf16 v[32:35], a[176:179], a[8:11], v[32:35]
    ds_read_b64_tr_b16 a[140:141], v135 offset:24576
    v_mfma_f32_16x16x32_bf16 v[32:35], a[180:183], a[16:19], v[32:35]
    ds_read_b64_tr_b16 a[142:143], v135 offset:28672
    v_mfma_f32_16x16x32_bf16 v[36:39], a[180:183], a[20:23], v[36:39]
    s_waitcnt vmcnt(32)
    s_barrier
    ds_read_b64_tr_b16 a[144:145], v128 offset:32768
    v_mfma_f32_16x16x32_bf16 v[36:39], a[176:179], a[12:15], v[36:39]
    ds_read_b64_tr_b16 a[146:147], v128 offset:36864
    s_waitcnt lgkmcnt(10)
    v_mfma_f32_16x16x32_bf16 v[44:47], a[184:187], a[12:15], v[44:47]
    ds_read_b64_tr_b16 a[148:149], v128 offset:40960
    v_mfma_f32_16x16x32_bf16 v[44:47], a[188:191], a[20:23], v[44:47]
    ds_read_b64_tr_b16 a[150:151], v128 offset:45056
    v_mfma_f32_16x16x32_bf16 v[40:43], a[188:191], a[16:19], v[40:43]
    ds_read_b64_tr_b16 a[152:153], v129 offset:32768
    v_mfma_f32_16x16x32_bf16 v[40:43], a[184:187], a[8:11], v[40:43]
    ds_read_b64_tr_b16 a[154:155], v129 offset:36864
    s_waitcnt lgkmcnt(10)
    v_mfma_f32_16x16x32_bf16 v[48:51], a[128:131], a[8:11], v[48:51]
    ds_read_b64_tr_b16 a[156:157], v129 offset:40960
    v_mfma_f32_16x16x32_bf16 v[48:51], a[132:135], a[16:19], v[48:51]
    ds_read_b64_tr_b16 a[158:159], v129 offset:45056
    v_mfma_f32_16x16x32_bf16 v[52:55], a[132:135], a[20:23], v[52:55]
    ds_read_b64_tr_b16 a[160:161], v130 offset:32768
    v_mfma_f32_16x16x32_bf16 v[52:55], a[128:131], a[12:15], v[52:55]
    ds_read_b64_tr_b16 a[162:163], v130 offset:36864
    s_waitcnt lgkmcnt(10)
    v_mfma_f32_16x16x32_bf16 v[60:63], a[136:139], a[12:15], v[60:63]
    ds_read_b64_tr_b16 a[164:165], v130 offset:40960
    v_mfma_f32_16x16x32_bf16 v[60:63], a[140:143], a[20:23], v[60:63]
    ds_read_b64_tr_b16 a[166:167], v130 offset:45056
    v_mfma_f32_16x16x32_bf16 v[56:59], a[140:143], a[16:19], v[56:59]
    ds_read_b64_tr_b16 a[168:169], v131 offset:32768
    v_mfma_f32_16x16x32_bf16 v[56:59], a[136:139], a[8:11], v[56:59]
    ds_read_b64_tr_b16 a[170:171], v131 offset:36864
    s_waitcnt vmcnt(14)
    s_waitcnt lgkmcnt(10)
    v_mfma_f32_16x16x32_bf16 v[0:3], a[144:147], a[24:27], v[0:3]
    ds_read_b64_tr_b16 a[172:173], v131 offset:40960
    s_add_u32 m0, s62, 32768
    v_mfma_f32_16x16x32_bf16 v[0:3], a[148:151], a[32:35], v[0:3]
    ds_read_b64_tr_b16 a[174:175], v131 offset:45056
    s_add_u32 s7, s63, 172288
    v_mfma_f32_16x16x32_bf16 v[4:7], a[148:151], a[36:39], v[4:7]
    ds_read_b64_tr_b16 a[176:177], v132 offset:32768
    v_mfma_f32_16x16x32_bf16 v[4:7], a[144:147], a[28:31], v[4:7]
    ds_read_b64_tr_b16 a[178:179], v132 offset:36864
    buffer_load_dwordx4 v188, s[72:75], s7 offen offset:0 lds
    s_waitcnt lgkmcnt(10)
    v_mfma_f32_16x16x32_bf16 v[12:15], a[152:155], a[28:31], v[12:15]
    ds_read_b64_tr_b16 a[180:181], v132 offset:40960
    v_mfma_f32_16x16x32_bf16 v[12:15], a[156:159], a[36:39], v[12:15]
    ds_read_b64_tr_b16 a[182:183], v132 offset:45056
    buffer_load_dwordx4 v189, s[72:75], s7 offen offset:1024 lds
    v_mfma_f32_16x16x32_bf16 v[8:11], a[156:159], a[32:35], v[8:11]
    ds_read_b64_tr_b16 a[184:185], v133 offset:32768
    s_add_u32 m0, s62, 40960
    v_mfma_f32_16x16x32_bf16 v[8:11], a[152:155], a[24:27], v[8:11]
    ds_read_b64_tr_b16 a[186:187], v133 offset:36864
    s_waitcnt lgkmcnt(10)
    v_mfma_f32_16x16x32_bf16 v[16:19], a[160:163], a[24:27], v[16:19]
    ds_read_b64_tr_b16 a[188:189], v133 offset:40960
    s_add_u32 s7, s63, 200960
    v_mfma_f32_16x16x32_bf16 v[16:19], a[164:167], a[32:35], v[16:19]
    ds_read_b64_tr_b16 a[190:191], v133 offset:45056
    buffer_load_dwordx4 v188, s[72:75], s7 offen offset:0 lds
    v_mfma_f32_16x16x32_bf16 v[20:23], a[164:167], a[36:39], v[20:23]
    ds_read_b64_tr_b16 a[128:129], v134 offset:32768
    v_mfma_f32_16x16x32_bf16 v[20:23], a[160:163], a[28:31], v[20:23]
    ds_read_b64_tr_b16 a[130:131], v134 offset:36864
    buffer_load_dwordx4 v189, s[72:75], s7 offen offset:1024 lds
    s_waitcnt lgkmcnt(10)
    v_mfma_f32_16x16x32_bf16 v[28:31], a[168:171], a[28:31], v[28:31]
    ds_read_b64_tr_b16 a[132:133], v134 offset:40960
    v_mfma_f32_16x16x32_bf16 v[28:31], a[172:175], a[36:39], v[28:31]
    ds_read_b64_tr_b16 a[134:135], v134 offset:45056
    v_mfma_f32_16x16x32_bf16 v[24:27], a[172:175], a[32:35], v[24:27]
    ds_read_b64_tr_b16 a[136:137], v135 offset:32768
    v_mfma_f32_16x16x32_bf16 v[24:27], a[168:171], a[24:27], v[24:27]
    ds_read_b64_tr_b16 a[138:139], v135 offset:36864
    s_waitcnt lgkmcnt(10)
    v_mfma_f32_16x16x32_bf16 v[32:35], a[176:179], a[24:27], v[32:35]
    ds_read_b64_tr_b16 a[140:141], v135 offset:40960
    v_mfma_f32_16x16x32_bf16 v[32:35], a[180:183], a[32:35], v[32:35]
    ds_read_b64_tr_b16 a[142:143], v135 offset:45056
    v_mfma_f32_16x16x32_bf16 v[36:39], a[180:183], a[36:39], v[36:39]
    ds_read_b64_tr_b16 a[144:145], v128 offset:49152
    v_mfma_f32_16x16x32_bf16 v[36:39], a[176:179], a[28:31], v[36:39]
    ds_read_b64_tr_b16 a[146:147], v128 offset:53248
    s_waitcnt lgkmcnt(10)
    v_mfma_f32_16x16x32_bf16 v[44:47], a[184:187], a[28:31], v[44:47]
    ds_read_b64_tr_b16 a[148:149], v128 offset:57344
    v_mfma_f32_16x16x32_bf16 v[44:47], a[188:191], a[36:39], v[44:47]
    ds_read_b64_tr_b16 a[150:151], v128 offset:61440
    v_mfma_f32_16x16x32_bf16 v[40:43], a[188:191], a[32:35], v[40:43]
    ds_read_b64_tr_b16 a[152:153], v129 offset:49152
    v_mfma_f32_16x16x32_bf16 v[40:43], a[184:187], a[24:27], v[40:43]
    ds_read_b64_tr_b16 a[154:155], v129 offset:53248
    s_waitcnt lgkmcnt(10)
    v_mfma_f32_16x16x32_bf16 v[48:51], a[128:131], a[24:27], v[48:51]
    ds_read_b64_tr_b16 a[156:157], v129 offset:57344
    v_mfma_f32_16x16x32_bf16 v[48:51], a[132:135], a[32:35], v[48:51]
    ds_read_b64_tr_b16 a[158:159], v129 offset:61440
    v_mfma_f32_16x16x32_bf16 v[52:55], a[132:135], a[36:39], v[52:55]
    ds_read_b64_tr_b16 a[160:161], v130 offset:49152
    v_mfma_f32_16x16x32_bf16 v[52:55], a[128:131], a[28:31], v[52:55]
    ds_read_b64_tr_b16 a[162:163], v130 offset:53248
    s_waitcnt lgkmcnt(10)
    v_mfma_f32_16x16x32_bf16 v[60:63], a[136:139], a[28:31], v[60:63]
    ds_read_b64_tr_b16 a[164:165], v130 offset:57344
    v_mfma_f32_16x16x32_bf16 v[60:63], a[140:143], a[36:39], v[60:63]
    ds_read_b64_tr_b16 a[166:167], v130 offset:61440
    v_mfma_f32_16x16x32_bf16 v[56:59], a[140:143], a[32:35], v[56:59]
    ds_read_b64_tr_b16 a[168:169], v131 offset:49152
    v_mfma_f32_16x16x32_bf16 v[56:59], a[136:139], a[24:27], v[56:59]
    ds_read_b64_tr_b16 a[170:171], v131 offset:53248
    s_waitcnt vmcnt(11)
    s_waitcnt lgkmcnt(10)
    v_mfma_f32_16x16x32_bf16 v[0:3], a[144:147], a[40:43], v[0:3]
    ds_read_b64_tr_b16 a[172:173], v131 offset:57344
    v_mfma_f32_16x16x32_bf16 v[0:3], a[148:151], a[48:51], v[0:3]
    ds_read_b64_tr_b16 a[174:175], v131 offset:61440
    v_mfma_f32_16x16x32_bf16 v[4:7], a[148:151], a[52:55], v[4:7]
    ds_read_b64_tr_b16 a[176:177], v132 offset:49152
    v_mfma_f32_16x16x32_bf16 v[4:7], a[144:147], a[44:47], v[4:7]
    ds_read_b64_tr_b16 a[178:179], v132 offset:53248
    s_waitcnt lgkmcnt(10)
    v_mfma_f32_16x16x32_bf16 v[12:15], a[152:155], a[44:47], v[12:15]
    ds_read_b64_tr_b16 a[180:181], v132 offset:57344
    v_mfma_f32_16x16x32_bf16 v[12:15], a[156:159], a[52:55], v[12:15]
    ds_read_b64_tr_b16 a[182:183], v132 offset:61440
    v_mfma_f32_16x16x32_bf16 v[8:11], a[156:159], a[48:51], v[8:11]
    ds_read_b64_tr_b16 a[184:185], v133 offset:49152
    v_mfma_f32_16x16x32_bf16 v[8:11], a[152:155], a[40:43], v[8:11]
    ds_read_b64_tr_b16 a[186:187], v133 offset:53248
    s_waitcnt lgkmcnt(10)
    v_mfma_f32_16x16x32_bf16 v[16:19], a[160:163], a[40:43], v[16:19]
    ds_read_b64_tr_b16 a[188:189], v133 offset:57344
    v_mfma_f32_16x16x32_bf16 v[16:19], a[164:167], a[48:51], v[16:19]
    ds_read_b64_tr_b16 a[190:191], v133 offset:61440
    v_mfma_f32_16x16x32_bf16 v[20:23], a[164:167], a[52:55], v[20:23]
    ds_read_b64_tr_b16 a[128:129], v134 offset:49152
    v_mfma_f32_16x16x32_bf16 v[20:23], a[160:163], a[44:47], v[20:23]
    ds_read_b64_tr_b16 a[130:131], v134 offset:53248
    s_waitcnt lgkmcnt(10)
    v_mfma_f32_16x16x32_bf16 v[28:31], a[168:171], a[44:47], v[28:31]
    ds_read_b64_tr_b16 a[132:133], v134 offset:57344
    v_mfma_f32_16x16x32_bf16 v[28:31], a[172:175], a[52:55], v[28:31]
    ds_read_b64_tr_b16 a[134:135], v134 offset:61440
    v_mfma_f32_16x16x32_bf16 v[24:27], a[172:175], a[48:51], v[24:27]
    ds_read_b64_tr_b16 a[136:137], v135 offset:49152
    v_mfma_f32_16x16x32_bf16 v[24:27], a[168:171], a[40:43], v[24:27]
    ds_read_b64_tr_b16 a[138:139], v135 offset:53248
    s_waitcnt lgkmcnt(10)
    v_mfma_f32_16x16x32_bf16 v[32:35], a[176:179], a[40:43], v[32:35]
    ds_read_b64_tr_b16 a[140:141], v135 offset:57344
    v_mfma_f32_16x16x32_bf16 v[32:35], a[180:183], a[48:51], v[32:35]
    ds_read_b64_tr_b16 a[142:143], v135 offset:61440
    v_mfma_f32_16x16x32_bf16 v[36:39], a[180:183], a[52:55], v[36:39]
    s_waitcnt vmcnt(20)
    s_barrier
    v_add_u32 v128, 65536, v128
    ds_read_b64_tr_b16 a[144:145], v128 offset:0
    v_mfma_f32_16x16x32_bf16 v[36:39], a[176:179], a[44:47], v[36:39]
    ds_read_b64_tr_b16 a[146:147], v128 offset:4096
    s_waitcnt lgkmcnt(10)
    v_mfma_f32_16x16x32_bf16 v[44:47], a[184:187], a[44:47], v[44:47]
    v_add_u32 v129, 65536, v129
    ds_read_b64_tr_b16 a[148:149], v129 offset:0
    v_mfma_f32_16x16x32_bf16 v[44:47], a[188:191], a[52:55], v[44:47]
    ds_read_b64_tr_b16 a[150:151], v129 offset:4096
    v_mfma_f32_16x16x32_bf16 v[40:43], a[188:191], a[48:51], v[40:43]
    v_add_u32 v130, 65536, v130
    ds_read_b64_tr_b16 a[152:153], v130 offset:0
    v_mfma_f32_16x16x32_bf16 v[40:43], a[184:187], a[40:43], v[40:43]
    ds_read_b64_tr_b16 a[154:155], v130 offset:4096
    s_waitcnt lgkmcnt(10)
    v_mfma_f32_16x16x32_bf16 v[48:51], a[128:131], a[40:43], v[48:51]
    v_add_u32 v131, 65536, v131
    ds_read_b64_tr_b16 a[156:157], v131 offset:0
    v_mfma_f32_16x16x32_bf16 v[48:51], a[132:135], a[48:51], v[48:51]
    ds_read_b64_tr_b16 a[158:159], v131 offset:4096
    v_mfma_f32_16x16x32_bf16 v[52:55], a[132:135], a[52:55], v[52:55]
    v_add_u32 v132, 65536, v132
    ds_read_b64_tr_b16 a[160:161], v132 offset:0
    v_mfma_f32_16x16x32_bf16 v[52:55], a[128:131], a[44:47], v[52:55]
    ds_read_b64_tr_b16 a[162:163], v132 offset:4096
    s_waitcnt lgkmcnt(10)
    v_mfma_f32_16x16x32_bf16 v[60:63], a[136:139], a[44:47], v[60:63]
    v_add_u32 v133, 65536, v133
    ds_read_b64_tr_b16 a[164:165], v133 offset:0
    v_mfma_f32_16x16x32_bf16 v[60:63], a[140:143], a[52:55], v[60:63]
    ds_read_b64_tr_b16 a[166:167], v133 offset:4096
    v_mfma_f32_16x16x32_bf16 v[56:59], a[140:143], a[48:51], v[56:59]
    v_add_u32 v134, 65536, v134
    ds_read_b64_tr_b16 a[168:169], v134 offset:0
    v_mfma_f32_16x16x32_bf16 v[56:59], a[136:139], a[40:43], v[56:59]
    ds_read_b64_tr_b16 a[170:171], v134 offset:4096
    s_waitcnt vmcnt(8)
    s_waitcnt lgkmcnt(10)
    v_mfma_f32_16x16x32_bf16 v[0:3], a[144:147], a[56:59], v[0:3]
    v_add_u32 v135, 65536, v135
    ds_read_b64_tr_b16 a[172:173], v135 offset:0
    v_mfma_f32_16x16x32_bf16 v[4:7], a[144:147], a[60:63], v[4:7]
    ds_read_b64_tr_b16 a[174:175], v135 offset:4096
    v_mfma_f32_16x16x32_bf16 v[12:15], a[148:151], a[60:63], v[12:15]
    ds_read_b64_tr_b16 a[176:177], v128 offset:8192
    v_mfma_f32_16x16x32_bf16 v[8:11], a[148:151], a[56:59], v[8:11]
    ds_read_b64_tr_b16 a[178:179], v128 offset:12288
    s_waitcnt lgkmcnt(10)
    v_mfma_f32_16x16x32_bf16 v[16:19], a[152:155], a[56:59], v[16:19]
    ds_read_b64_tr_b16 a[180:181], v128 offset:16384
    v_mfma_f32_16x16x32_bf16 v[20:23], a[152:155], a[60:63], v[20:23]
    ds_read_b64_tr_b16 a[182:183], v128 offset:20480
    v_mfma_f32_16x16x32_bf16 v[28:31], a[156:159], a[60:63], v[28:31]
    ds_read_b64_tr_b16 a[184:185], v129 offset:8192
    v_mfma_f32_16x16x32_bf16 v[24:27], a[156:159], a[56:59], v[24:27]
    ds_read_b64_tr_b16 a[186:187], v129 offset:12288
    s_waitcnt lgkmcnt(10)
    v_mfma_f32_16x16x32_bf16 v[32:35], a[160:163], a[56:59], v[32:35]
    ds_read_b64_tr_b16 a[188:189], v129 offset:16384
    v_mfma_f32_16x16x32_bf16 v[36:39], a[160:163], a[60:63], v[36:39]
    ds_read_b64_tr_b16 a[190:191], v129 offset:20480
    v_mfma_f32_16x16x32_bf16 v[44:47], a[164:167], a[60:63], v[44:47]
    ds_read_b64_tr_b16 a[128:129], v130 offset:8192
    v_mfma_f32_16x16x32_bf16 v[40:43], a[164:167], a[56:59], v[40:43]
    ds_read_b64_tr_b16 a[130:131], v130 offset:12288
    s_waitcnt lgkmcnt(10)
    v_mfma_f32_16x16x32_bf16 v[48:51], a[168:171], a[56:59], v[48:51]
    ds_read_b64_tr_b16 a[132:133], v130 offset:16384
    v_mfma_f32_16x16x32_bf16 v[52:55], a[168:171], a[60:63], v[52:55]
    ds_read_b64_tr_b16 a[134:135], v130 offset:20480
    v_mfma_f32_16x16x32_bf16 v[60:63], a[172:175], a[60:63], v[60:63]
    ds_read_b64_tr_b16 a[136:137], v131 offset:8192
    v_mfma_f32_16x16x32_bf16 v[56:59], a[172:175], a[56:59], v[56:59]
    ds_read_b64_tr_b16 a[138:139], v131 offset:12288
    s_waitcnt lgkmcnt(10)
    v_mfma_f32_16x16x32_bf16 v[64:67], a[176:179], a[80:83], v[64:67]
    ds_read_b64_tr_b16 a[140:141], v131 offset:16384
    v_mfma_f32_16x16x32_bf16 v[64:67], a[180:183], a[0:3], v[64:67]
    ds_read_b64_tr_b16 a[142:143], v131 offset:20480
    v_mfma_f32_16x16x32_bf16 v[68:71], a[180:183], a[4:7], v[68:71]
    ds_read_b64_tr_b16 a[144:145], v132 offset:8192
    v_mfma_f32_16x16x32_bf16 v[68:71], a[176:179], a[84:87], v[68:71]
    ds_read_b64_tr_b16 a[146:147], v132 offset:12288
    s_waitcnt lgkmcnt(10)
    v_mfma_f32_16x16x32_bf16 v[76:79], a[184:187], a[84:87], v[76:79]
    ds_read_b64_tr_b16 a[148:149], v132 offset:16384
    v_mfma_f32_16x16x32_bf16 v[76:79], a[188:191], a[4:7], v[76:79]
    ds_read_b64_tr_b16 a[150:151], v132 offset:20480
    v_mfma_f32_16x16x32_bf16 v[72:75], a[188:191], a[0:3], v[72:75]
    ds_read_b64_tr_b16 a[152:153], v133 offset:8192
    v_mfma_f32_16x16x32_bf16 v[72:75], a[184:187], a[80:83], v[72:75]
    ds_read_b64_tr_b16 a[154:155], v133 offset:12288
    s_waitcnt lgkmcnt(10)
    v_mfma_f32_16x16x32_bf16 v[80:83], a[128:131], a[80:83], v[80:83]
    ds_read_b64_tr_b16 a[156:157], v133 offset:16384
    v_cvt_pk_bf16_f32 v0, v0, v1
    v_mfma_f32_16x16x32_bf16 v[80:83], a[132:135], a[0:3], v[80:83]
    ds_read_b64_tr_b16 a[158:159], v133 offset:20480
    v_cvt_pk_bf16_f32 v1, v2, v3
    v_mfma_f32_16x16x32_bf16 v[84:87], a[132:135], a[4:7], v[84:87]
    ds_read_b64_tr_b16 a[160:161], v128 offset:24576
    v_cvt_pk_bf16_f32 v2, v4, v5
    v_mfma_f32_16x16x32_bf16 v[84:87], a[128:131], a[84:87], v[84:87]
    ds_read_b64_tr_b16 a[162:163], v128 offset:28672
    v_cvt_pk_bf16_f32 v3, v6, v7
    s_waitcnt lgkmcnt(10)
    v_mfma_f32_16x16x32_bf16 v[92:95], a[136:139], a[84:87], v[92:95]
    s_waitcnt vmcnt(4)
    s_barrier
    v_add_u32 v128, 4294836224, v128
    ds_read_b64_tr_b16 a[164:165], v128 offset:0
    s_mov_b32 s88, 0
    v_mfma_f32_16x16x32_bf16 v[92:95], a[140:143], a[4:7], v[92:95]
    ds_read_b64_tr_b16 a[166:167], v128 offset:4096
    buffer_store_dwordx4 v[0:3], v155, s[84:87], s88 offen offset:0 sc0 sc1
    v_mfma_f32_16x16x32_bf16 v[88:91], a[140:143], a[0:3], v[88:91]
    ds_read_b64_tr_b16 a[168:169], v129 offset:24576
    v_mfma_f32_16x16x32_bf16 v[88:91], a[136:139], a[80:83], v[88:91]
    ds_read_b64_tr_b16 a[170:171], v129 offset:28672
    s_waitcnt lgkmcnt(10)
    v_mfma_f32_16x16x32_bf16 v[96:99], a[144:147], a[80:83], v[96:99]
    v_add_u32 v129, 4294836224, v129
    ds_read_b64_tr_b16 a[172:173], v129 offset:0
    v_cvt_pk_bf16_f32 v8, v8, v9
    v_mfma_f32_16x16x32_bf16 v[96:99], a[148:151], a[0:3], v[96:99]
    ds_read_b64_tr_b16 a[174:175], v129 offset:4096
    v_cvt_pk_bf16_f32 v9, v10, v11
    v_mfma_f32_16x16x32_bf16 v[100:103], a[148:151], a[4:7], v[100:103]
    ds_read_b64_tr_b16 a[176:177], v130 offset:24576
    v_cvt_pk_bf16_f32 v10, v12, v13
    v_mfma_f32_16x16x32_bf16 v[100:103], a[144:147], a[84:87], v[100:103]
    ds_read_b64_tr_b16 a[178:179], v130 offset:28672
    v_cvt_pk_bf16_f32 v11, v14, v15
    s_waitcnt lgkmcnt(10)
    v_mfma_f32_16x16x32_bf16 v[108:111], a[152:155], a[84:87], v[108:111]
    v_add_u32 v130, 4294836224, v130
    ds_read_b64_tr_b16 a[180:181], v130 offset:0
    buffer_store_dwordx4 v[8:11], v155, s[84:87], s88 offen offset:1024 sc0 sc1
    v_mfma_f32_16x16x32_bf16 v[108:111], a[156:159], a[4:7], v[108:111]
    ds_read_b64_tr_b16 a[182:183], v130 offset:4096
    v_mfma_f32_16x16x32_bf16 v[104:107], a[156:159], a[0:3], v[104:107]
    ds_read_b64_tr_b16 a[184:185], v131 offset:24576
    v_mfma_f32_16x16x32_bf16 v[104:107], a[152:155], a[80:83], v[104:107]
    ds_read_b64_tr_b16 a[186:187], v131 offset:28672
    s_waitcnt lgkmcnt(10)
    v_mfma_f32_16x16x32_bf16 v[64:67], a[160:163], a[8:11], v[64:67]
    v_add_u32 v131, 4294836224, v131
    ds_read_b64_tr_b16 a[188:189], v131 offset:0
    v_cvt_pk_bf16_f32 v16, v16, v17
    v_mfma_f32_16x16x32_bf16 v[64:67], a[164:167], a[16:19], v[64:67]
    ds_read_b64_tr_b16 a[190:191], v131 offset:4096
    v_cvt_pk_bf16_f32 v17, v18, v19
    v_mfma_f32_16x16x32_bf16 v[68:71], a[164:167], a[20:23], v[68:71]
    ds_read_b64_tr_b16 a[128:129], v132 offset:24576
    v_cvt_pk_bf16_f32 v18, v20, v21
    v_mfma_f32_16x16x32_bf16 v[68:71], a[160:163], a[12:15], v[68:71]
    ds_read_b64_tr_b16 a[130:131], v132 offset:28672
    v_cvt_pk_bf16_f32 v19, v22, v23
    s_waitcnt lgkmcnt(10)
    v_mfma_f32_16x16x32_bf16 v[76:79], a[168:171], a[12:15], v[76:79]
    v_add_u32 v132, 4294836224, v132
    ds_read_b64_tr_b16 a[132:133], v132 offset:0
    buffer_store_dwordx4 v[16:19], v155, s[84:87], s88 offen offset:2048 sc0 sc1
    v_mfma_f32_16x16x32_bf16 v[76:79], a[172:175], a[20:23], v[76:79]
    ds_read_b64_tr_b16 a[134:135], v132 offset:4096
    v_mfma_f32_16x16x32_bf16 v[72:75], a[172:175], a[16:19], v[72:75]
    ds_read_b64_tr_b16 a[136:137], v133 offset:24576
    v_mfma_f32_16x16x32_bf16 v[72:75], a[168:171], a[8:11], v[72:75]
    ds_read_b64_tr_b16 a[138:139], v133 offset:28672
    s_waitcnt lgkmcnt(10)
    v_mfma_f32_16x16x32_bf16 v[80:83], a[176:179], a[8:11], v[80:83]
    v_add_u32 v133, 4294836224, v133
    ds_read_b64_tr_b16 a[140:141], v133 offset:0
    v_cvt_pk_bf16_f32 v24, v24, v25
    v_mfma_f32_16x16x32_bf16 v[80:83], a[180:183], a[16:19], v[80:83]
    ds_read_b64_tr_b16 a[142:143], v133 offset:4096
    v_cvt_pk_bf16_f32 v25, v26, v27
    v_mfma_f32_16x16x32_bf16 v[84:87], a[180:183], a[20:23], v[84:87]
    ds_read_b64_tr_b16 a[144:145], v128 offset:8192
    v_cvt_pk_bf16_f32 v26, v28, v29
    v_mfma_f32_16x16x32_bf16 v[84:87], a[176:179], a[12:15], v[84:87]
    ds_read_b64_tr_b16 a[146:147], v128 offset:12288
    v_cvt_pk_bf16_f32 v27, v30, v31
    s_waitcnt lgkmcnt(10)
    v_mfma_f32_16x16x32_bf16 v[92:95], a[184:187], a[12:15], v[92:95]
    ds_read_b64_tr_b16 a[148:149], v128 offset:16384
    buffer_store_dwordx4 v[24:27], v155, s[84:87], s88 offen offset:3072 sc0 sc1
    v_mfma_f32_16x16x32_bf16 v[92:95], a[188:191], a[20:23], v[92:95]
    ds_read_b64_tr_b16 a[150:151], v128 offset:20480
    v_mfma_f32_16x16x32_bf16 v[88:91], a[188:191], a[16:19], v[88:91]
    ds_read_b64_tr_b16 a[152:153], v129 offset:8192
    v_mfma_f32_16x16x32_bf16 v[88:91], a[184:187], a[8:11], v[88:91]
    ds_read_b64_tr_b16 a[154:155], v129 offset:12288
    s_waitcnt lgkmcnt(10)
    v_mfma_f32_16x16x32_bf16 v[96:99], a[128:131], a[8:11], v[96:99]
    ds_read_b64_tr_b16 a[156:157], v129 offset:16384
    v_cvt_pk_bf16_f32 v32, v32, v33
    v_mfma_f32_16x16x32_bf16 v[96:99], a[132:135], a[16:19], v[96:99]
    ds_read_b64_tr_b16 a[158:159], v129 offset:20480
    v_cvt_pk_bf16_f32 v33, v34, v35
    v_mfma_f32_16x16x32_bf16 v[100:103], a[132:135], a[20:23], v[100:103]
    ds_read_b64_tr_b16 a[160:161], v130 offset:8192
    v_cvt_pk_bf16_f32 v34, v36, v37
    v_mfma_f32_16x16x32_bf16 v[100:103], a[128:131], a[12:15], v[100:103]
    ds_read_b64_tr_b16 a[162:163], v130 offset:12288
    v_cvt_pk_bf16_f32 v35, v38, v39
    s_waitcnt lgkmcnt(10)
    v_mfma_f32_16x16x32_bf16 v[108:111], a[136:139], a[12:15], v[108:111]
    ds_read_b64_tr_b16 a[164:165], v130 offset:16384
    s_mov_b32 s88, 4096
    v_mfma_f32_16x16x32_bf16 v[108:111], a[140:143], a[20:23], v[108:111]
    ds_read_b64_tr_b16 a[166:167], v130 offset:20480
    buffer_store_dwordx4 v[32:35], v155, s[84:87], s88 offen offset:0 sc0 sc1
    v_mfma_f32_16x16x32_bf16 v[104:107], a[140:143], a[16:19], v[104:107]
    ds_read_b64_tr_b16 a[168:169], v131 offset:8192
    v_mfma_f32_16x16x32_bf16 v[104:107], a[136:139], a[8:11], v[104:107]
    ds_read_b64_tr_b16 a[170:171], v131 offset:12288
    s_waitcnt lgkmcnt(10)
    v_mfma_f32_16x16x32_bf16 v[64:67], a[144:147], a[24:27], v[64:67]
    ds_read_b64_tr_b16 a[172:173], v131 offset:16384
    v_cvt_pk_bf16_f32 v40, v40, v41
    v_mfma_f32_16x16x32_bf16 v[64:67], a[148:151], a[32:35], v[64:67]
    ds_read_b64_tr_b16 a[174:175], v131 offset:20480
    v_cvt_pk_bf16_f32 v41, v42, v43
    v_mfma_f32_16x16x32_bf16 v[68:71], a[148:151], a[36:39], v[68:71]
    ds_read_b64_tr_b16 a[176:177], v132 offset:8192
    v_cvt_pk_bf16_f32 v42, v44, v45
    v_mfma_f32_16x16x32_bf16 v[68:71], a[144:147], a[28:31], v[68:71]
    ds_read_b64_tr_b16 a[178:179], v132 offset:12288
    v_cvt_pk_bf16_f32 v43, v46, v47
    s_waitcnt lgkmcnt(10)
    v_mfma_f32_16x16x32_bf16 v[76:79], a[152:155], a[28:31], v[76:79]
    ds_read_b64_tr_b16 a[180:181], v132 offset:16384
    buffer_store_dwordx4 v[40:43], v155, s[84:87], s88 offen offset:1024 sc0 sc1
    v_mfma_f32_16x16x32_bf16 v[76:79], a[156:159], a[36:39], v[76:79]
    ds_read_b64_tr_b16 a[182:183], v132 offset:20480
    v_mfma_f32_16x16x32_bf16 v[72:75], a[156:159], a[32:35], v[72:75]
    ds_read_b64_tr_b16 a[184:185], v133 offset:8192
    v_mfma_f32_16x16x32_bf16 v[72:75], a[152:155], a[24:27], v[72:75]
    ds_read_b64_tr_b16 a[186:187], v133 offset:12288
    s_waitcnt lgkmcnt(10)
    v_mfma_f32_16x16x32_bf16 v[80:83], a[160:163], a[24:27], v[80:83]
    ds_read_b64_tr_b16 a[188:189], v133 offset:16384
    v_cvt_pk_bf16_f32 v48, v48, v49
    v_mfma_f32_16x16x32_bf16 v[80:83], a[164:167], a[32:35], v[80:83]
    ds_read_b64_tr_b16 a[190:191], v133 offset:20480
    v_cvt_pk_bf16_f32 v49, v50, v51
    v_mfma_f32_16x16x32_bf16 v[84:87], a[164:167], a[36:39], v[84:87]
    ds_read_b64_tr_b16 a[128:129], v128 offset:24576
    v_cvt_pk_bf16_f32 v50, v52, v53
    v_mfma_f32_16x16x32_bf16 v[84:87], a[160:163], a[28:31], v[84:87]
    ds_read_b64_tr_b16 a[130:131], v128 offset:28672
    v_cvt_pk_bf16_f32 v51, v54, v55
    s_mov_b32 exec_lo, 0
    s_mov_b32 exec_hi, 255
    buffer_load_dword v166, v164, s[16:19], 0 offen sc0 sc1
    s_mov_b64 exec, -1
    s_waitcnt lgkmcnt(10)
    v_mfma_f32_16x16x32_bf16 v[92:95], a[168:171], a[28:31], v[92:95]
    s_waitcnt vmcnt(7)
    s_barrier
    ds_read_b64_tr_b16 a[132:133], v128 offset:32768
    buffer_store_dwordx4 v[48:51], v155, s[84:87], s88 offen offset:2048 sc0 sc1
    v_mfma_f32_16x16x32_bf16 v[92:95], a[172:175], a[36:39], v[92:95]
    ds_read_b64_tr_b16 a[134:135], v128 offset:36864
    v_mfma_f32_16x16x32_bf16 v[88:91], a[172:175], a[32:35], v[88:91]
    ds_read_b64_tr_b16 a[136:137], v129 offset:24576
    v_mfma_f32_16x16x32_bf16 v[88:91], a[168:171], a[24:27], v[88:91]
    ds_read_b64_tr_b16 a[138:139], v129 offset:28672
    s_waitcnt lgkmcnt(10)
    v_mfma_f32_16x16x32_bf16 v[96:99], a[176:179], a[24:27], v[96:99]
    ds_read_b64_tr_b16 a[140:141], v129 offset:32768
    v_cvt_pk_bf16_f32 v56, v56, v57
    v_mfma_f32_16x16x32_bf16 v[96:99], a[180:183], a[32:35], v[96:99]
    ds_read_b64_tr_b16 a[142:143], v129 offset:36864
    v_cvt_pk_bf16_f32 v57, v58, v59
    v_mfma_f32_16x16x32_bf16 v[100:103], a[180:183], a[36:39], v[100:103]
    ds_read_b64_tr_b16 a[144:145], v130 offset:24576
    v_cvt_pk_bf16_f32 v58, v60, v61
    v_mfma_f32_16x16x32_bf16 v[100:103], a[176:179], a[28:31], v[100:103]
    ds_read_b64_tr_b16 a[146:147], v130 offset:28672
    v_cvt_pk_bf16_f32 v59, v62, v63
    s_waitcnt lgkmcnt(10)
    v_mfma_f32_16x16x32_bf16 v[108:111], a[184:187], a[28:31], v[108:111]
    ds_read_b64_tr_b16 a[148:149], v130 offset:32768
    buffer_store_dwordx4 v[56:59], v155, s[84:87], s88 offen offset:3072 sc0 sc1
    v_mfma_f32_16x16x32_bf16 v[108:111], a[188:191], a[36:39], v[108:111]
    ds_read_b64_tr_b16 a[150:151], v130 offset:36864
    v_mfma_f32_16x16x32_bf16 v[104:107], a[188:191], a[32:35], v[104:107]
    ds_read_b64_tr_b16 a[152:153], v131 offset:24576
    v_mfma_f32_16x16x32_bf16 v[104:107], a[184:187], a[24:27], v[104:107]
    ds_read_b64_tr_b16 a[154:155], v131 offset:28672
    s_waitcnt lgkmcnt(10)
    v_mfma_f32_16x16x32_bf16 v[64:67], a[128:131], a[40:43], v[64:67]
    ds_read_b64_tr_b16 a[156:157], v131 offset:32768
    v_mfma_f32_16x16x32_bf16 v[64:67], a[132:135], a[48:51], v[64:67]
    ds_read_b64_tr_b16 a[158:159], v131 offset:36864
    v_mfma_f32_16x16x32_bf16 v[68:71], a[132:135], a[52:55], v[68:71]
    ds_read_b64_tr_b16 a[160:161], v132 offset:24576
    v_mfma_f32_16x16x32_bf16 v[68:71], a[128:131], a[44:47], v[68:71]
    ds_read_b64_tr_b16 a[162:163], v132 offset:28672
    s_waitcnt lgkmcnt(10)
    v_mfma_f32_16x16x32_bf16 v[76:79], a[136:139], a[44:47], v[76:79]
    ds_read_b64_tr_b16 a[164:165], v132 offset:32768
    v_mfma_f32_16x16x32_bf16 v[76:79], a[140:143], a[52:55], v[76:79]
    ds_read_b64_tr_b16 a[166:167], v132 offset:36864
    v_mfma_f32_16x16x32_bf16 v[72:75], a[140:143], a[48:51], v[72:75]
    ds_read_b64_tr_b16 a[168:169], v133 offset:24576
    v_mfma_f32_16x16x32_bf16 v[72:75], a[136:139], a[40:43], v[72:75]
    ds_read_b64_tr_b16 a[170:171], v133 offset:28672
    s_waitcnt lgkmcnt(10)
    v_mfma_f32_16x16x32_bf16 v[80:83], a[144:147], a[40:43], v[80:83]
    ds_read_b64_tr_b16 a[172:173], v133 offset:32768
    v_mfma_f32_16x16x32_bf16 v[80:83], a[148:151], a[48:51], v[80:83]
    ds_read_b64_tr_b16 a[174:175], v133 offset:36864
    v_mfma_f32_16x16x32_bf16 v[84:87], a[148:151], a[52:55], v[84:87]
    ds_read_b64_tr_b16 a[176:177], v128 offset:40960
    v_mfma_f32_16x16x32_bf16 v[84:87], a[144:147], a[44:47], v[84:87]
    ds_read_b64_tr_b16 a[178:179], v128 offset:45056
    s_waitcnt lgkmcnt(10)
    v_mfma_f32_16x16x32_bf16 v[92:95], a[152:155], a[44:47], v[92:95]
    ds_read_b64_tr_b16 a[180:181], v129 offset:40960
    v_mfma_f32_16x16x32_bf16 v[92:95], a[156:159], a[52:55], v[92:95]
    ds_read_b64_tr_b16 a[182:183], v129 offset:45056
    v_mfma_f32_16x16x32_bf16 v[88:91], a[156:159], a[48:51], v[88:91]
    ds_read_b64_tr_b16 a[184:185], v130 offset:40960
    v_mfma_f32_16x16x32_bf16 v[88:91], a[152:155], a[40:43], v[88:91]
    ds_read_b64_tr_b16 a[186:187], v130 offset:45056
    s_waitcnt lgkmcnt(10)
    v_mfma_f32_16x16x32_bf16 v[96:99], a[160:163], a[40:43], v[96:99]
    ds_read_b64_tr_b16 a[188:189], v131 offset:40960
    v_mfma_f32_16x16x32_bf16 v[96:99], a[164:167], a[48:51], v[96:99]
    ds_read_b64_tr_b16 a[190:191], v131 offset:45056
    v_mfma_f32_16x16x32_bf16 v[100:103], a[164:167], a[52:55], v[100:103]
    ds_read_b64_tr_b16 a[128:129], v132 offset:40960
    v_mfma_f32_16x16x32_bf16 v[100:103], a[160:163], a[44:47], v[100:103]
    ds_read_b64_tr_b16 a[130:131], v132 offset:45056
    s_waitcnt lgkmcnt(10)
    v_mfma_f32_16x16x32_bf16 v[108:111], a[168:171], a[44:47], v[108:111]
    ds_read_b64_tr_b16 a[132:133], v133 offset:40960
    v_mfma_f32_16x16x32_bf16 v[108:111], a[172:175], a[52:55], v[108:111]
    ds_read_b64_tr_b16 a[134:135], v133 offset:45056
    v_mfma_f32_16x16x32_bf16 v[104:107], a[172:175], a[48:51], v[104:107]
    v_mfma_f32_16x16x32_bf16 v[104:107], a[168:171], a[40:43], v[104:107]
    s_waitcnt lgkmcnt(8)
    v_mfma_f32_16x16x32_bf16 v[64:67], a[176:179], a[56:59], v[64:67]
    v_mfma_f32_16x16x32_bf16 v[68:71], a[176:179], a[60:63], v[68:71]
    v_mfma_f32_16x16x32_bf16 v[76:79], a[180:183], a[60:63], v[76:79]
    v_mfma_f32_16x16x32_bf16 v[72:75], a[180:183], a[56:59], v[72:75]
    s_waitcnt lgkmcnt(4)
    v_mfma_f32_16x16x32_bf16 v[80:83], a[184:187], a[56:59], v[80:83]
    v_mfma_f32_16x16x32_bf16 v[84:87], a[184:187], a[60:63], v[84:87]
    v_mfma_f32_16x16x32_bf16 v[92:95], a[188:191], a[60:63], v[92:95]
    v_mfma_f32_16x16x32_bf16 v[88:91], a[188:191], a[56:59], v[88:91]
    s_waitcnt lgkmcnt(0)
    v_mfma_f32_16x16x32_bf16 v[96:99], a[128:131], a[56:59], v[96:99]
    v_mfma_f32_16x16x32_bf16 v[100:103], a[128:131], a[60:63], v[100:103]
    v_mfma_f32_16x16x32_bf16 v[108:111], a[132:135], a[60:63], v[108:111]
    v_mfma_f32_16x16x32_bf16 v[104:107], a[132:135], a[56:59], v[104:107]
    s_nop 7
    v_cvt_pk_bf16_f32 v64, v64, v65
    v_cvt_pk_bf16_f32 v65, v66, v67
    v_cvt_pk_bf16_f32 v66, v68, v69
    v_cvt_pk_bf16_f32 v67, v70, v71
    s_mov_b32 s88, 8192
    buffer_store_dwordx4 v[64:67], v155, s[84:87], s88 offen offset:0 sc0 sc1
    v_cvt_pk_bf16_f32 v72, v72, v73
    v_cvt_pk_bf16_f32 v73, v74, v75
    v_cvt_pk_bf16_f32 v74, v76, v77
    v_cvt_pk_bf16_f32 v75, v78, v79
    buffer_store_dwordx4 v[72:75], v155, s[84:87], s88 offen offset:1024 sc0 sc1
    v_cvt_pk_bf16_f32 v80, v80, v81
    v_cvt_pk_bf16_f32 v81, v82, v83
    v_cvt_pk_bf16_f32 v82, v84, v85
    v_cvt_pk_bf16_f32 v83, v86, v87
    buffer_store_dwordx4 v[80:83], v155, s[84:87], s88 offen offset:2048 sc0 sc1
    v_cvt_pk_bf16_f32 v88, v88, v89
    v_cvt_pk_bf16_f32 v89, v90, v91
    v_cvt_pk_bf16_f32 v90, v92, v93
    v_cvt_pk_bf16_f32 v91, v94, v95
    buffer_store_dwordx4 v[88:91], v155, s[84:87], s88 offen offset:3072 sc0 sc1
    v_cvt_pk_bf16_f32 v96, v96, v97
    v_cvt_pk_bf16_f32 v97, v98, v99
    v_cvt_pk_bf16_f32 v98, v100, v101
    v_cvt_pk_bf16_f32 v99, v102, v103
    s_mov_b32 s88, 12288
    buffer_store_dwordx4 v[96:99], v155, s[84:87], s88 offen offset:0 sc0 sc1
    v_cvt_pk_bf16_f32 v104, v104, v105
    v_cvt_pk_bf16_f32 v105, v106, v107
    v_cvt_pk_bf16_f32 v106, v108, v109
    v_cvt_pk_bf16_f32 v107, v110, v111
    buffer_store_dwordx4 v[104:107], v155, s[84:87], s88 offen offset:1024 sc0 sc1
    s_waitcnt vmcnt(8)
    v_cmp_ge_u32 s[50:51], v166, v165
    s_nop 1
    s_and_b32 s61, s51, 0xff
    s_and_b32 s60, s61, 15
    s_add_u32 s5, s66, 0
    s_bitcmp1_b32 s60, 0
    s_cselect_b32 s5, s5, 0x40000000
    buffer_load_dwordx4 v[192:195], v155, s[16:19], s5 offen sc0 sc1
    buffer_load_dwordx4 v[224:227], v186, s[16:19], s5 offen sc0 sc1
    s_add_u32 s5, s66, 57344
    s_bitcmp1_b32 s60, 1
    s_cselect_b32 s5, s5, 0x40000000
    buffer_load_dwordx4 v[196:199], v155, s[16:19], s5 offen sc0 sc1
    buffer_load_dwordx4 v[228:231], v186, s[16:19], s5 offen sc0 sc1
    s_add_u32 s5, s66, 114688
    s_bitcmp1_b32 s60, 2
    s_cselect_b32 s5, s5, 0x40000000
    buffer_load_dwordx4 v[200:203], v155, s[16:19], s5 offen sc0 sc1
    buffer_load_dwordx4 v[232:235], v186, s[16:19], s5 offen sc0 sc1
    s_add_u32 s5, s66, 172032
    s_bitcmp1_b32 s60, 3
    s_cselect_b32 s5, s5, 0x40000000
    buffer_load_dwordx4 v[204:207], v155, s[16:19], s5 offen sc0 sc1
    buffer_load_dwordx4 v[236:239], v186, s[16:19], s5 offen sc0 sc1
    s_or_b32 s61, s61, s89
    v_mov_b32 v176, 0
    v_mov_b32 v177, s61
    s_mov_b32 s57, 1048576
    s_waitcnt vmcnt(8)
    s_barrier
    s_cmp_lg_u32 s58, 3
    s_cbranch_scc1 L3_w
    ds_write_b32 v176, v177
    s_waitcnt lgkmcnt(0)
    s_barrier
L3_p:
    s_cmp_eq_u32 s61, 0xff
    s_cbranch_scc1 L3_pd
    s_mov_b32 exec_lo, 0
    s_mov_b32 exec_hi, 255
    buffer_load_dword v166, v164, s[16:19], 0 offen sc0 sc1
    s_mov_b64 exec, -1
    s_waitcnt vmcnt(0)
    v_cmp_ge_u32 s[50:51], v166, v165
    s_nop 1
    s_and_b32 s61, s51, 0xff
    s_or_b32 s61, s61, s89
    s_sub_u32 s57, s57, 1
    s_cselect_b32 s61, 0xff, s61
    v_mov_b32 v177, s61
    ds_write_b32 v176, v177
    s_branch L3_p
L3_pd:
    s_andn2_b32 s61, s61, s60
    s_branch L3_r2
L3_w:
    s_cmp_lg_u32 s58, 0
    s_cbranch_scc1 Lpub28
    v_mov_b32 v161, 5
    s_mov_b64 exec, 1
    buffer_store_dword v161, off, s[16:19], s99 sc0 sc1
    s_mov_b64 exec, -1
Lpub28:
    s_barrier
    s_andn2_b32 s61, s61, s60
    s_branch L3_r2
L3_r1:
    ds_read_b32 v177, v176
    s_waitcnt lgkmcnt(0)
    v_readfirstlane_b32 s61, v177
    s_nop 0
    s_andn2_b32 s61, s61, s60
    s_cbranch_scc0 L3_r1
L3_r2:
    s_bitcmp1_b32 s61, 0
    s_cbranch_scc0 L3_s0
    s_add_u32 s5, s66, 0
    buffer_load_dwordx4 v[192:195], v155, s[16:19], s5 offen sc0 sc1
    buffer_load_dwordx4 v[224:227], v186, s[16:19], s5 offen sc0 sc1
L3_s0:
    s_bitcmp1_b32 s61, 1
    s_cbranch_scc0 L3_s1
    s_add_u32 s5, s66, 57344
    buffer_load_dwordx4 v[196:199], v155, s[16:19], s5 offen sc0 sc1
    buffer_load_dwordx4 v[228:231], v186, s[16:19], s5 offen sc0 sc1
L3_s1:
    s_bitcmp1_b32 s61, 2
    s_cbranch_scc0 L3_s2
    s_add_u32 s5, s66, 114688
    buffer_load_dwordx4 v[200:203], v155, s[16:19], s5 offen sc0 sc1
    buffer_load_dwordx4 v[232:235], v186, s[16:19], s5 offen sc0 sc1
L3_s2:
    s_bitcmp1_b32 s61, 3
    s_cbranch_scc0 L3_s3
    s_add_u32 s5, s66, 172032
    buffer_load_dwordx4 v[204:207], v155, s[16:19], s5 offen sc0 sc1
    buffer_load_dwordx4 v[236:239], v186, s[16:19], s5 offen sc0 sc1
L3_s3:
    s_bitcmp1_b32 s61, 4
    s_cbranch_scc0 L3_s4
    s_add_u32 s5, s66, 229376
    buffer_load_dwordx4 v[208:211], v155, s[16:19], s5 offen sc0 sc1
    buffer_load_dwordx4 v[240:243], v186, s[16:19], s5 offen sc0 sc1
L3_s4:
    s_bitcmp1_b32 s61, 5
    s_cbranch_scc0 L3_s5
    s_add_u32 s5, s66, 286720
    buffer_load_dwordx4 v[212:215], v155, s[16:19], s5 offen sc0 sc1
    buffer_load_dwordx4 v[244:247], v186, s[16:19], s5 offen sc0 sc1
L3_s5:
    s_bitcmp1_b32 s61, 6
    s_cbranch_scc0 L3_s6
    s_add_u32 s5, s66, 344064
    buffer_load_dwordx4 v[216:219], v155, s[16:19], s5 offen sc0 sc1
    buffer_load_dwordx4 v[248:251], v186, s[16:19], s5 offen sc0 sc1
L3_s6:
    s_bitcmp1_b32 s61, 7
    s_cbranch_scc0 L3_s7
    s_add_u32 s5, s66, 401408
    buffer_load_dwordx4 v[220:223], v155, s[16:19], s5 offen sc0 sc1
    buffer_load_dwordx4 v[252:255], v186, s[16:19], s5 offen sc0 sc1
L3_s7:
    s_or_b32 s60, s60, s61
    s_cmp_lg_u32 s60, 0xff
    s_cbranch_scc1 L3_r1
    s_mov_b32 s6, 0x00003f80
    s_mov_b32 s7, 0x3f800000
    s_waitcnt vmcnt(0)
    v_lshlrev_b32 v0, 16, v192
    v_and_b32 v1, 0xffff0000, v192
    v_lshlrev_b32 v2, 16, v193
    v_and_b32 v3, 0xffff0000, v193
    v_lshlrev_b32 v4, 16, v194
    v_and_b32 v5, 0xffff0000, v194
    v_lshlrev_b32 v6, 16, v195
    v_and_b32 v7, 0xffff0000, v195
    v_dot2_f32_bf16 v0, v196, s6, v0
    v_dot2_f32_bf16 v1, v196, s7, v1
    v_dot2_f32_bf16 v2, v197, s6, v2
    v_dot2_f32_bf16 v3, v197, s7, v3
    v_dot2_f32_bf16 v4, v198, s6, v4
    v_dot2_f32_bf16 v5, v198, s7, v5
    v_dot2_f32_bf16 v6, v199, s6, v6
    v_dot2_f32_bf16 v7, v199, s7, v7
    v_dot2_f32_bf16 v0, v200, s6, v0
    v_dot2_f32_bf16 v1, v200, s7, v1
    v_dot2_f32_bf16 v2, v201, s6, v2
    v_dot2_f32_bf16 v3, v201, s7, v3
    v_dot2_f32_bf16 v4, v202, s6, v4
    v_dot2_f32_bf16 v5, v202, s7, v5
    v_dot2_f32_bf16 v6, v203, s6, v6
    v_dot2_f32_bf16 v7, v203, s7, v7
    v_dot2_f32_bf16 v0, v204, s6, v0
    v_dot2_f32_bf16 v1, v204, s7, v1
    v_dot2_f32_bf16 v2, v205, s6, v2
    v_dot2_f32_bf16 v3, v205, s7, v3
    v_dot2_f32_bf16 v4, v206, s6, v4
    v_dot2_f32_bf16 v5, v206, s7, v5
    v_dot2_f32_bf16 v6, v207, s6, v6
    v_dot2_f32_bf16 v7, v207, s7, v7
    v_dot2_f32_bf16 v0, v208, s6, v0
    v_dot2_f32_bf16 v1, v208, s7, v1
    v_dot2_f32_bf16 v2, v209, s6, v2
    v_dot2_f32_bf16 v3, v209, s7, v3
    v_dot2_f32_bf16 v4, v210, s6, v4
    v_dot2_f32_bf16 v5, v210, s7, v5
    v_dot2_f32_bf16 v6, v211, s6, v6
    v_dot2_f32_bf16 v7, v211, s7, v7
    v_dot2_f32_bf16 v0, v212, s6, v0
    v_dot2_f32_bf16 v1, v212, s7, v1
    v_dot2_f32_bf16 v2, v213, s6, v2
    v_dot2_f32_bf16 v3, v213, s7, v3
    v_dot2_f32_bf16 v4, v214, s6, v4
    v_dot2_f32_bf16 v5, v214, s7, v5
    v_dot2_f32_bf16 v6, v215, s6, v6
    v_dot2_f32_bf16 v7, v215, s7, v7
    v_dot2_f32_bf16 v0, v216, s6, v0
    v_dot2_f32_bf16 v1, v216, s7, v1
    v_dot2_f32_bf16 v2, v217, s6, v2
    v_dot2_f32_bf16 v3, v217, s7, v3
    v_dot2_f32_bf16 v4, v218, s6, v4
    v_dot2_f32_bf16 v5, v218, s7, v5
    v_dot2_f32_bf16 v6, v219, s6, v6
    v_dot2_f32_bf16 v7, v219, s7, v7
    v_dot2_f32_bf16 v0, v220, s6, v0
    v_dot2_f32_bf16 v1, v220, s7, v1
    v_dot2_f32_bf16 v2, v221, s6, v2
    v_dot2_f32_bf16 v3, v221, s7, v3
    v_dot2_f32_bf16 v4, v222, s6, v4
    v_dot2_f32_bf16 v5, v222, s7, v5
    v_dot2_f32_bf16 v6, v223, s6, v6
    v_dot2_f32_bf16 v7, v223, s7, v7
    s_nop 2
    v_cvt_pk_bf16_f32 v0, v0, v1
    v_cvt_pk_bf16_f32 v1, v2, v3
    v_cvt_pk_bf16_f32 v2, v4, v5
    v_cvt_pk_bf16_f32 v3, v6, v7
    buffer_store_dwordx2 v[0:1], v184, s[80:83], s67 offen offset:0 sc0 sc1
    buffer_store_dwordx2 v[2:3], v185, s[80:83], s67 offen offset:0 sc0 sc1
    s_cmp_eq_u32 s58, 3
    s_cbranch_scc1 L3_fin
    v_lshlrev_b32 v16, 16, v224
    v_and_b32 v17, 0xffff0000, v224
    v_lshlrev_b32 v18, 16, v225
    v_and_b32 v19, 0xffff0000, v225
    v_lshlrev_b32 v20, 16, v226
    v_and_b32 v21, 0xffff0000, v226
    v_lshlrev_b32 v22, 16, v227
    v_and_b32 v23, 0xffff0000, v227
    v_dot2_f32_bf16 v16, v228, s6, v16
    v_dot2_f32_bf16 v17, v228, s7, v17
    v_dot2_f32_bf16 v18, v229, s6, v18
    v_dot2_f32_bf16 v19, v229, s7, v19
    v_dot2_f32_bf16 v20, v230, s6, v20
    v_dot2_f32_bf16 v21, v230, s7, v21
    v_dot2_f32_bf16 v22, v231, s6, v22
    v_dot2_f32_bf16 v23, v231, s7, v23
    v_dot2_f32_bf16 v16, v232, s6, v16
    v_dot2_f32_bf16 v17, v232, s7, v17
    v_dot2_f32_bf16 v18, v233, s6, v18
    v_dot2_f32_bf16 v19, v233, s7, v19
    v_dot2_f32_bf16 v20, v234, s6, v20
    v_dot2_f32_bf16 v21, v234, s7, v21
    v_dot2_f32_bf16 v22, v235, s6, v22
    v_dot2_f32_bf16 v23, v235, s7, v23
    v_dot2_f32_bf16 v16, v236, s6, v16
    v_dot2_f32_bf16 v17, v236, s7, v17
    v_dot2_f32_bf16 v18, v237, s6, v18
    v_dot2_f32_bf16 v19, v237, s7, v19
    v_dot2_f32_bf16 v20, v238, s6, v20
    v_dot2_f32_bf16 v21, v238, s7, v21
    v_dot2_f32_bf16 v22, v239, s6, v22
    v_dot2_f32_bf16 v23, v239, s7, v23
    v_dot2_f32_bf16 v16, v240, s6, v16
    v_dot2_f32_bf16 v17, v240, s7, v17
    v_dot2_f32_bf16 v18, v241, s6, v18
    v_dot2_f32_bf16 v19, v241, s7, v19
    v_dot2_f32_bf16 v20, v242, s6, v20
    v_dot2_f32_bf16 v21, v242, s7, v21
    v_dot2_f32_bf16 v22, v243, s6, v22
    v_dot2_f32_bf16 v23, v243, s7, v23
    v_dot2_f32_bf16 v16, v244, s6, v16
    v_dot2_f32_bf16 v17, v244, s7, v17
    v_dot2_f32_bf16 v18, v245, s6, v18
    v_dot2_f32_bf16 v19, v245, s7, v19
    v_dot2_f32_bf16 v20, v246, s6, v20
    v_dot2_f32_bf16 v21, v246, s7, v21
    v_dot2_f32_bf16 v22, v247, s6, v22
    v_dot2_f32_bf16 v23, v247, s7, v23
    v_dot2_f32_bf16 v16, v248, s6, v16
    v_dot2_f32_bf16 v17, v248, s7, v17
    v_dot2_f32_bf16 v18, v249, s6, v18
    v_dot2_f32_bf16 v19, v249, s7, v19
    v_dot2_f32_bf16 v20, v250, s6, v20
    v_dot2_f32_bf16 v21, v250, s7, v21
    v_dot2_f32_bf16 v22, v251, s6, v22
    v_dot2_f32_bf16 v23, v251, s7, v23
    v_dot2_f32_bf16 v16, v252, s6, v16
    v_dot2_f32_bf16 v17, v252, s7, v17
    v_dot2_f32_bf16 v18, v253, s6, v18
    v_dot2_f32_bf16 v19, v253, s7, v19
    v_dot2_f32_bf16 v20, v254, s6, v20
    v_dot2_f32_bf16 v21, v254, s7, v21
    v_dot2_f32_bf16 v22, v255, s6, v22
    v_dot2_f32_bf16 v23, v255, s7, v23
    s_nop 2
    v_cvt_pk_bf16_f32 v16, v16, v17
    v_cvt_pk_bf16_f32 v17, v18, v19
    v_cvt_pk_bf16_f32 v18, v20, v21
    v_cvt_pk_bf16_f32 v19, v22, v23
    buffer_store_dwordx2 v[16:17], v184, s[80:83], s67 offen offset:32 sc0 sc1
    buffer_store_dwordx2 v[18:19], v185, s[80:83], s67 offen offset:32 sc0 sc1
L3_fin:
L_end:
    s_endpgm
L2_hk1:
    s_call_b64 s[100:101], L2_mask
    s_branch L2_hkr1
L2_hk2:
    s_call_b64 s[100:101], L2_mask
    s_branch L2_hkr2
L2_hk3:
    s_call_b64 s[100:101], L2_mask
    s_branch L2_hkr3
L2_hk4:
    s_call_b64 s[100:101], L2_event
    s_branch L2_hkr4
L2_sl5:
    s_call_b64 s[100:101], L2_slow0
    s_branch L2_slr5
L2_hk6:
    s_call_b64 s[100:101], L2_mask
    s_branch L2_hkr6
L2_hk7:
    s_call_b64 s[100:101], L2_event
    s_branch L2_hkr7
L2_sl8:
    s_call_b64 s[100:101], L2_slow1
    s_branch L2_slr8
L2_hk9:
    s_call_b64 s[100:101], L2_mask
    s_branch L2_hkr9
L2_hk10:
    s_call_b64 s[100:101], L2_event
    s_branch L2_hkr10
L2_sl11:
    s_call_b64 s[100:101], L2_slow0
    s_branch L2_slr11
L2_hk12:
    s_call_b64 s[100:101], L2_mask
    s_branch L2_hkr12
L2_hk13:
    s_call_b64 s[100:101], L2_event
    s_branch L2_hkr13
L2_sl14:
    s_call_b64 s[100:101], L2_slow1
    s_branch L2_slr14
L2_hk15:
    s_call_b64 s[100:101], L2_mask
    s_branch L2_hkr15
L2_hk16:
    s_call_b64 s[100:101], L2_event
    s_branch L2_hkr16
L2_sl17:
    s_call_b64 s[100:101], L2_slow0
    s_branch L2_slr17
L2_sl18:
    s_call_b64 s[100:101], L2_slow1
    s_branch L2_slr18
L2_sl19:
    s_call_b64 s[100:101], L2_slow1
    s_branch L2_slr19
L2_sl20:
    s_call_b64 s[100:101], L2_slow0
    s_branch L2_slr20
L2_sl21:
    s_call_b64 s[100:101], L2_slow1
    s_branch L2_slr21
L2_slow0:
    s_nop 7
    s_nop 7
    v_max3_f32 v176, v64, v65, v66
    v_max3_f32 v176, v176, v67, v68
    v_max3_f32 v176, v176, v69, v70
    v_max_f32 v176, v176, v71
    v_mov_b32 v178, v176
    s_nop 1
    v_permlane32_swap_b32 v176, v178
    s_nop 1
    v_max_f32 v176, v176, v178
    v_mov_b32 v178, v176
    s_nop 1
    v_permlane16_swap_b32 v176, v178
    s_nop 1
    v_max_f32 v176, v176, v178
    v_max3_f32 v177, v72, v73, v74
    v_max3_f32 v177, v177, v75, v76
    v_max3_f32 v177, v177, v77, v78
    v_max_f32 v177, v177, v79
    v_mov_b32 v178, v177
    s_nop 1
    v_permlane32_swap_b32 v177, v178
    s_nop 1
    v_max_f32 v177, v177, v178
    v_mov_b32 v178, v177
    s_nop 1
    v_permlane16_swap_b32 v177, v178
    s_nop 1
    v_max_f32 v177, v177, v178
    v_max_f32 v176, 0, v176
    v_sub_f32 v64, v64, v176
    v_sub_f32 v80, v80, v176
    v_sub_f32 v128, v128, v176
    v_sub_f32 v65, v65, v176
    v_sub_f32 v81, v81, v176
    v_sub_f32 v129, v129, v176
    v_sub_f32 v66, v66, v176
    v_sub_f32 v82, v82, v176
    v_sub_f32 v130, v130, v176
    v_sub_f32 v67, v67, v176
    v_sub_f32 v83, v83, v176
    v_sub_f32 v131, v131, v176
    v_sub_f32 v68, v68, v176
    v_sub_f32 v84, v84, v176
    v_sub_f32 v132, v132, v176
    v_sub_f32 v69, v69, v176
    v_sub_f32 v85, v85, v176
    v_sub_f32 v133, v133, v176
    v_sub_f32 v70, v70, v176
    v_sub_f32 v86, v86, v176
    v_sub_f32 v134, v134, v176
    v_sub_f32 v71, v71, v176
    v_sub_f32 v87, v87, v176
    v_sub_f32 v135, v135, v176
    v_add_f32 v148, v148, v176
    v_exp_f32 v180, -v176
    s_nop 0
    v_mul_f32 v146, v146, v180
    v_max_f32 v177, 0, v177
    v_sub_f32 v72, v72, v177
    v_sub_f32 v88, v88, v177
    v_sub_f32 v136, v136, v177
    v_sub_f32 v73, v73, v177
    v_sub_f32 v89, v89, v177
    v_sub_f32 v137, v137, v177
    v_sub_f32 v74, v74, v177
    v_sub_f32 v90, v90, v177
    v_sub_f32 v138, v138, v177
    v_sub_f32 v75, v75, v177
    v_sub_f32 v91, v91, v177
    v_sub_f32 v139, v139, v177
    v_sub_f32 v76, v76, v177
    v_sub_f32 v92, v92, v177
    v_sub_f32 v140, v140, v177
    v_sub_f32 v77, v77, v177
    v_sub_f32 v93, v93, v177
    v_sub_f32 v141, v141, v177
    v_sub_f32 v78, v78, v177
    v_sub_f32 v94, v94, v177
    v_sub_f32 v142, v142, v177
    v_sub_f32 v79, v79, v177
    v_sub_f32 v95, v95, v177
    v_sub_f32 v143, v143, v177
    v_add_f32 v149, v149, v177
    v_exp_f32 v181, -v177
    s_nop 0
    v_mul_f32 v147, v147, v181
    v_exp_f32 v112, v64
    s_nop 0
    v_exp_f32 v113, v65
    s_nop 0
    v_exp_f32 v114, v66
    s_nop 0
    v_cvt_pk_bf16_f32 v96, v112, v113
    v_add_f32 v144, v112, v113
    v_exp_f32 v115, v67
    s_nop 0
    v_exp_f32 v116, v68
    s_nop 0
    v_cvt_pk_bf16_f32 v97, v114, v115
    v_add_f32 v144, v144, v114
    v_add_f32 v144, v144, v115
    v_exp_f32 v117, v69
    s_nop 0
    v_exp_f32 v118, v70
    s_nop 0
    v_cvt_pk_bf16_f32 v98, v116, v117
    v_add_f32 v144, v144, v116
    v_add_f32 v144, v144, v117
    v_exp_f32 v119, v71
    s_nop 0
    v_exp_f32 v120, v72
    s_nop 0
    v_cvt_pk_bf16_f32 v99, v118, v119
    v_add_f32 v144, v144, v118
    v_add_f32 v144, v144, v119
    v_exp_f32 v121, v73
    s_nop 0
    v_exp_f32 v122, v74
    s_nop 0
    v_cvt_pk_bf16_f32 v100, v120, v121
    v_add_f32 v145, v120, v121
    v_exp_f32 v123, v75
    s_nop 0
    v_exp_f32 v124, v76
    s_nop 0
    v_cvt_pk_bf16_f32 v101, v122, v123
    v_add_f32 v145, v145, v122
    v_add_f32 v145, v145, v123
    v_exp_f32 v125, v77
    s_nop 0
    v_exp_f32 v126, v78
    s_nop 0
    v_cvt_pk_bf16_f32 v102, v124, v125
    v_add_f32 v145, v145, v124
    v_add_f32 v145, v145, v125
    v_exp_f32 v127, v79
    s_nop 0
    v_cvt_pk_bf16_f32 v103, v126, v127
    v_add_f32 v145, v145, v126
    v_add_f32 v145, v145, v127
    s_branch L2_slowo
L2_slow1:
    s_nop 7
    s_nop 7
    v_max3_f32 v176, v80, v81, v82
    v_max3_f32 v176, v176, v83, v84
    v_max3_f32 v176, v176, v85, v86
    v_max_f32 v176, v176, v87
    v_mov_b32 v178, v176
    s_nop 1
    v_permlane32_swap_b32 v176, v178
    s_nop 1
    v_max_f32 v176, v176, v178
    v_mov_b32 v178, v176
    s_nop 1
    v_permlane16_swap_b32 v176, v178
    s_nop 1
    v_max_f32 v176, v176, v178
    v_max3_f32 v177, v88, v89, v90
    v_max3_f32 v177, v177, v91, v92
    v_max3_f32 v177, v177, v93, v94
    v_max_f32 v177, v177, v95
    v_mov_b32 v178, v177
    s_nop 1
    v_permlane32_swap_b32 v177, v178
    s_nop 1
    v_max_f32 v177, v177, v178
    v_mov_b32 v178, v177
    s_nop 1
    v_permlane16_swap_b32 v177, v178
    s_nop 1
    v_max_f32 v177, v177, v178
    v_max_f32 v176, 0, v176
    v_sub_f32 v80, v80, v176
    v_sub_f32 v64, v64, v176
    v_sub_f32 v128, v128, v176
    v_sub_f32 v81, v81, v176
    v_sub_f32 v65, v65, v176
    v_sub_f32 v129, v129, v176
    v_sub_f32 v82, v82, v176
    v_sub_f32 v66, v66, v176
    v_sub_f32 v130, v130, v176
    v_sub_f32 v83, v83, v176
    v_sub_f32 v67, v67, v176
    v_sub_f32 v131, v131, v176
    v_sub_f32 v84, v84, v176
    v_sub_f32 v68, v68, v176
    v_sub_f32 v132, v132, v176
    v_sub_f32 v85, v85, v176
    v_sub_f32 v69, v69, v176
    v_sub_f32 v133, v133, v176
    v_sub_f32 v86, v86, v176
    v_sub_f32 v70, v70, v176
    v_sub_f32 v134, v134, v176
    v_sub_f32 v87, v87, v176
    v_sub_f32 v71, v71, v176
    v_sub_f32 v135, v135, v176
    v_add_f32 v148, v148, v176
    v_exp_f32 v180, -v176
    s_nop 0
    v_mul_f32 v146, v146, v180
    v_max_f32 v177, 0, v177
    v_sub_f32 v88, v88, v177
    v_sub_f32 v72, v72, v177
    v_sub_f32 v136, v136, v177
    v_sub_f32 v89, v89, v177
    v_sub_f32 v73, v73, v177
    v_sub_f32 v137, v137, v177
    v_sub_f32 v90, v90, v177
    v_sub_f32 v74, v74, v177
    v_sub_f32 v138, v138, v177
    v_sub_f32 v91, v91, v177
    v_sub_f32 v75, v75, v177
    v_sub_f32 v139, v139, v177
    v_sub_f32 v92, v92, v177
    v_sub_f32 v76, v76, v177
    v_sub_f32 v140, v140, v177
    v_sub_f32 v93, v93, v177
    v_sub_f32 v77, v77, v177
    v_sub_f32 v141, v141, v177
    v_sub_f32 v94, v94, v177
    v_sub_f32 v78, v78, v177
    v_sub_f32 v142, v142, v177
    v_sub_f32 v95, v95, v177
    v_sub_f32 v79, v79, v177
    v_sub_f32 v143, v143, v177
    v_add_f32 v149, v149, v177
    v_exp_f32 v181, -v177
    s_nop 0
    v_mul_f32 v147, v147, v181
    v_exp_f32 v112, v80
    s_nop 0
    v_exp_f32 v113, v81
    s_nop 0
    v_exp_f32 v114, v82
    s_nop 0
    v_cvt_pk_bf16_f32 v104, v112, v113
    v_add_f32 v144, v112, v113
    v_exp_f32 v115, v83
    s_nop 0
    v_exp_f32 v116, v84
    s_nop 0
    v_cvt_pk_bf16_f32 v105, v114, v115
    v_add_f32 v144, v144, v114
    v_add_f32 v144, v144, v115
    v_exp_f32 v117, v85
    s_nop 0
    v_exp_f32 v118, v86
    s_nop 0
    v_cvt_pk_bf16_f32 v106, v116, v117
    v_add_f32 v144, v144, v116
    v_add_f32 v144, v144, v117
    v_exp_f32 v119, v87
    s_nop 0
    v_exp_f32 v120, v88
    s_nop 0
    v_cvt_pk_bf16_f32 v107, v118, v119
    v_add_f32 v144, v144, v118
    v_add_f32 v144, v144, v119
    v_exp_f32 v121, v89
    s_nop 0
    v_exp_f32 v122, v90
    s_nop 0
    v_cvt_pk_bf16_f32 v108, v120, v121
    v_add_f32 v145, v120, v121
    v_exp_f32 v123, v91
    s_nop 0
    v_exp_f32 v124, v92
    s_nop 0
    v_cvt_pk_bf16_f32 v109, v122, v123
    v_add_f32 v145, v145, v122
    v_add_f32 v145, v145, v123
    v_exp_f32 v125, v93
    s_nop 0
    v_exp_f32 v126, v94
    s_nop 0
    v_cvt_pk_bf16_f32 v110, v124, v125
    v_add_f32 v145, v145, v124
    v_add_f32 v145, v145, v125
    v_exp_f32 v127, v95
    s_nop 0
    v_cvt_pk_bf16_f32 v111, v126, v127
    v_add_f32 v145, v145, v126
    v_add_f32 v145, v145, v127
L2_slowo:
    v_accvgpr_read_b32 v184, a0
    v_accvgpr_read_b32 v185, a1
    v_accvgpr_read_b32 v186, a2
    v_accvgpr_read_b32 v187, a3
    v_pk_mul_f32 v[184:185], v[184:185], v[180:181] op_sel_hi:[1,0]
    v_pk_mul_f32 v[186:187], v[186:187], v[180:181] op_sel_hi:[1,0]
    v_accvgpr_write_b32 a0, v184
    v_accvgpr_write_b32 a1, v185
    v_accvgpr_write_b32 a2, v186
    v_accvgpr_write_b32 a3, v187
    v_accvgpr_read_b32 v184, a4
    v_accvgpr_read_b32 v185, a5
    v_accvgpr_read_b32 v186, a6
    v_accvgpr_read_b32 v187, a7
    v_pk_mul_f32 v[184:185], v[184:185], v[180:181] op_sel:[0,1] op_sel_hi:[1,1]
    v_pk_mul_f32 v[186:187], v[186:187], v[180:181] op_sel:[0,1] op_sel_hi:[1,1]
    v_accvgpr_write_b32 a4, v184
    v_accvgpr_write_b32 a5, v185
    v_accvgpr_write_b32 a6, v186
    v_accvgpr_write_b32 a7, v187
    v_accvgpr_read_b32 v184, a8
    v_accvgpr_read_b32 v185, a9
    v_accvgpr_read_b32 v186, a10
    v_accvgpr_read_b32 v187, a11
    v_pk_mul_f32 v[184:185], v[184:185], v[180:181] op_sel_hi:[1,0]
    v_pk_mul_f32 v[186:187], v[186:187], v[180:181] op_sel_hi:[1,0]
    v_accvgpr_write_b32 a8, v184
    v_accvgpr_write_b32 a9, v185
    v_accvgpr_write_b32 a10, v186
    v_accvgpr_write_b32 a11, v187
    v_accvgpr_read_b32 v184, a12
    v_accvgpr_read_b32 v185, a13
    v_accvgpr_read_b32 v186, a14
    v_accvgpr_read_b32 v187, a15
    v_pk_mul_f32 v[184:185], v[184:185], v[180:181] op_sel:[0,1] op_sel_hi:[1,1]
    v_pk_mul_f32 v[186:187], v[186:187], v[180:181] op_sel:[0,1] op_sel_hi:[1,1]
    v_accvgpr_write_b32 a12, v184
    v_accvgpr_write_b32 a13, v185
    v_accvgpr_write_b32 a14, v186
    v_accvgpr_write_b32 a15, v187
    v_accvgpr_read_b32 v184, a16
    v_accvgpr_read_b32 v185, a17
    v_accvgpr_read_b32 v186, a18
    v_accvgpr_read_b32 v187, a19
    v_pk_mul_f32 v[184:185], v[184:185], v[180:181] op_sel_hi:[1,0]
    v_pk_mul_f32 v[186:187], v[186:187], v[180:181] op_sel_hi:[1,0]
    v_accvgpr_write_b32 a16, v184
    v_accvgpr_write_b32 a17, v185
    v_accvgpr_write_b32 a18, v186
    v_accvgpr_write_b32 a19, v187
    v_accvgpr_read_b32 v184, a20
    v_accvgpr_read_b32 v185, a21
    v_accvgpr_read_b32 v186, a22
    v_accvgpr_read_b32 v187, a23
    v_pk_mul_f32 v[184:185], v[184:185], v[180:181] op_sel:[0,1] op_sel_hi:[1,1]
    v_pk_mul_f32 v[186:187], v[186:187], v[180:181] op_sel:[0,1] op_sel_hi:[1,1]
    v_accvgpr_write_b32 a20, v184
    v_accvgpr_write_b32 a21, v185
    v_accvgpr_write_b32 a22, v186
    v_accvgpr_write_b32 a23, v187
    v_accvgpr_read_b32 v184, a24
    v_accvgpr_read_b32 v185, a25
    v_accvgpr_read_b32 v186, a26
    v_accvgpr_read_b32 v187, a27
    v_pk_mul_f32 v[184:185], v[184:185], v[180:181] op_sel_hi:[1,0]
    v_pk_mul_f32 v[186:187], v[186:187], v[180:181] op_sel_hi:[1,0]
    v_accvgpr_write_b32 a24, v184
    v_accvgpr_write_b32 a25, v185
    v_accvgpr_write_b32 a26, v186
    v_accvgpr_write_b32 a27, v187
    v_accvgpr_read_b32 v184, a28
    v_accvgpr_read_b32 v185, a29
    v_accvgpr_read_b32 v186, a30
    v_accvgpr_read_b32 v187, a31
    v_pk_mul_f32 v[184:185], v[184:185], v[180:181] op_sel:[0,1] op_sel_hi:[1,1]
    v_pk_mul_f32 v[186:187], v[186:187], v[180:181] op_sel:[0,1] op_sel_hi:[1,1]
    v_accvgpr_write_b32 a28, v184
    v_accvgpr_write_b32 a29, v185
    v_accvgpr_write_b32 a30, v186
    v_accvgpr_write_b32 a31, v187
    v_accvgpr_read_b32 v184, a32
    v_accvgpr_read_b32 v185, a33
    v_accvgpr_read_b32 v186, a34
    v_accvgpr_read_b32 v187, a35
    v_pk_mul_f32 v[184:185], v[184:185], v[180:181] op_sel_hi:[1,0]
    v_pk_mul_f32 v[186:187], v[186:187], v[180:181] op_sel_hi:[1,0]
    v_accvgpr_write_b32 a32, v184
    v_accvgpr_write_b32 a33, v185
    v_accvgpr_write_b32 a34, v186
    v_accvgpr_write_b32 a35, v187
    v_accvgpr_read_b32 v184, a36
    v_accvgpr_read_b32 v185, a37
    v_accvgpr_read_b32 v186, a38
    v_accvgpr_read_b32 v187, a39
    v_pk_mul_f32 v[184:185], v[184:185], v[180:181] op_sel:[0,1] op_sel_hi:[1,1]
    v_pk_mul_f32 v[186:187], v[186:187], v[180:181] op_sel:[0,1] op_sel_hi:[1,1]
    v_accvgpr_write_b32 a36, v184
    v_accvgpr_write_b32 a37, v185
    v_accvgpr_write_b32 a38, v186
    v_accvgpr_write_b32 a39, v187
    v_accvgpr_read_b32 v184, a40
    v_accvgpr_read_b32 v185, a41
    v_accvgpr_read_b32 v186, a42
    v_accvgpr_read_b32 v187, a43
    v_pk_mul_f32 v[184:185], v[184:185], v[180:181] op_sel_hi:[1,0]
    v_pk_mul_f32 v[186:187], v[186:187], v[180:181] op_sel_hi:[1,0]
    v_accvgpr_write_b32 a40, v184
    v_accvgpr_write_b32 a41, v185
    v_accvgpr_write_b32 a42, v186
    v_accvgpr_write_b32 a43, v187
    v_accvgpr_read_b32 v184, a44
    v_accvgpr_read_b32 v185, a45
    v_accvgpr_read_b32 v186, a46
    v_accvgpr_read_b32 v187, a47
    v_pk_mul_f32 v[184:185], v[184:185], v[180:181] op_sel:[0,1] op_sel_hi:[1,1]
    v_pk_mul_f32 v[186:187], v[186:187], v[180:181] op_sel:[0,1] op_sel_hi:[1,1]
    v_accvgpr_write_b32 a44, v184
    v_accvgpr_write_b32 a45, v185
    v_accvgpr_write_b32 a46, v186
    v_accvgpr_write_b32 a47, v187
    v_accvgpr_read_b32 v184, a48
    v_accvgpr_read_b32 v185, a49
    v_accvgpr_read_b32 v186, a50
    v_accvgpr_read_b32 v187, a51
    v_pk_mul_f32 v[184:185], v[184:185], v[180:181] op_sel_hi:[1,0]
    v_pk_mul_f32 v[186:187], v[186:187], v[180:181] op_sel_hi:[1,0]
    v_accvgpr_write_b32 a48, v184
    v_accvgpr_write_b32 a49, v185
    v_accvgpr_write_b32 a50, v186
    v_accvgpr_write_b32 a51, v187
    v_accvgpr_read_b32 v184, a52
    v_accvgpr_read_b32 v185, a53
    v_accvgpr_read_b32 v186, a54
    v_accvgpr_read_b32 v187, a55
    v_pk_mul_f32 v[184:185], v[184:185], v[180:181] op_sel:[0,1] op_sel_hi:[1,1]
    v_pk_mul_f32 v[186:187], v[186:187], v[180:181] op_sel:[0,1] op_sel_hi:[1,1]
    v_accvgpr_write_b32 a52, v184
    v_accvgpr_write_b32 a53, v185
    v_accvgpr_write_b32 a54, v186
    v_accvgpr_write_b32 a55, v187
    v_accvgpr_read_b32 v184, a56
    v_accvgpr_read_b32 v185, a57
    v_accvgpr_read_b32 v186, a58
    v_accvgpr_read_b32 v187, a59
    v_pk_mul_f32 v[184:185], v[184:185], v[180:181] op_sel_hi:[1,0]
    v_pk_mul_f32 v[186:187], v[186:187], v[180:181] op_sel_hi:[1,0]
    v_accvgpr_write_b32 a56, v184
    v_accvgpr_write_b32 a57, v185
    v_accvgpr_write_b32 a58, v186
    v_accvgpr_write_b32 a59, v187
    v_accvgpr_read_b32 v184, a60
    v_accvgpr_read_b32 v185, a61
    v_accvgpr_read_b32 v186, a62
    v_accvgpr_read_b32 v187, a63
    v_pk_mul_f32 v[184:185], v[184:185], v[180:181] op_sel:[0,1] op_sel_hi:[1,1]
    v_pk_mul_f32 v[186:187], v[186:187], v[180:181] op_sel:[0,1] op_sel_hi:[1,1]
    v_accvgpr_write_b32 a60, v184
    v_accvgpr_write_b32 a61, v185
    v_accvgpr_write_b32 a62, v186
    v_accvgpr_write_b32 a63, v187
    v_accvgpr_read_b32 v184, a64
    v_accvgpr_read_b32 v185, a65
    v_accvgpr_read_b32 v186, a66
    v_accvgpr_read_b32 v187, a67
    v_pk_mul_f32 v[184:185], v[184:185], v[180:181] op_sel_hi:[1,0]
    v_pk_mul_f32 v[186:187], v[186:187], v[180:181] op_sel_hi:[1,0]
    v_accvgpr_write_b32 a64, v184
    v_accvgpr_write_b32 a65, v185
    v_accvgpr_write_b32 a66, v186
    v_accvgpr_write_b32 a67, v187
    v_accvgpr_read_b32 v184, a68
    v_accvgpr_read_b32 v185, a69
    v_accvgpr_read_b32 v186, a70
    v_accvgpr_read_b32 v187, a71
    v_pk_mul_f32 v[184:185], v[184:185], v[180:181] op_sel:[0,1] op_sel_hi:[1,1]
    v_pk_mul_f32 v[186:187], v[186:187], v[180:181] op_sel:[0,1] op_sel_hi:[1,1]
    v_accvgpr_write_b32 a68, v184
    v_accvgpr_write_b32 a69, v185
    v_accvgpr_write_b32 a70, v186
    v_accvgpr_write_b32 a71, v187
    v_accvgpr_read_b32 v184, a72
    v_accvgpr_read_b32 v185, a73
    v_accvgpr_read_b32 v186, a74
    v_accvgpr_read_b32 v187, a75
    v_pk_mul_f32 v[184:185], v[184:185], v[180:181] op_sel_hi:[1,0]
    v_pk_mul_f32 v[186:187], v[186:187], v[180:181] op_sel_hi:[1,0]
    v_accvgpr_write_b32 a72, v184
    v_accvgpr_write_b32 a73, v185
    v_accvgpr_write_b32 a74, v186
    v_accvgpr_write_b32 a75, v187
    v_accvgpr_read_b32 v184, a76
    v_accvgpr_read_b32 v185, a77
    v_accvgpr_read_b32 v186, a78
    v_accvgpr_read_b32 v187, a79
    v_pk_mul_f32 v[184:185], v[184:185], v[180:181] op_sel:[0,1] op_sel_hi:[1,1]
    v_pk_mul_f32 v[186:187], v[186:187], v[180:181] op_sel:[0,1] op_sel_hi:[1,1]
    v_accvgpr_write_b32 a76, v184
    v_accvgpr_write_b32 a77, v185
    v_accvgpr_write_b32 a78, v186
    v_accvgpr_write_b32 a79, v187
    v_accvgpr_read_b32 v184, a80
    v_accvgpr_read_b32 v185, a81
    v_accvgpr_read_b32 v186, a82
    v_accvgpr_read_b32 v187, a83
    v_pk_mul_f32 v[184:185], v[184:185], v[180:181] op_sel_hi:[1,0]
    v_pk_mul_f32 v[186:187], v[186:187], v[180:181] op_sel_hi:[1,0]
    v_accvgpr_write_b32 a80, v184
    v_accvgpr_write_b32 a81, v185
    v_accvgpr_write_b32 a82, v186
    v_accvgpr_write_b32 a83, v187
    v_accvgpr_read_b32 v184, a84
    v_accvgpr_read_b32 v185, a85
    v_accvgpr_read_b32 v186, a86
    v_accvgpr_read_b32 v187, a87
    v_pk_mul_f32 v[184:185], v[184:185], v[180:181] op_sel:[0,1] op_sel_hi:[1,1]
    v_pk_mul_f32 v[186:187], v[186:187], v[180:181] op_sel:[0,1] op_sel_hi:[1,1]
    v_accvgpr_write_b32 a84, v184
    v_accvgpr_write_b32 a85, v185
    v_accvgpr_write_b32 a86, v186
    v_accvgpr_write_b32 a87, v187
    v_accvgpr_read_b32 v184, a88
    v_accvgpr_read_b32 v185, a89
    v_accvgpr_read_b32 v186, a90
    v_accvgpr_read_b32 v187, a91
    v_pk_mul_f32 v[184:185], v[184:185], v[180:181] op_sel_hi:[1,0]
    v_pk_mul_f32 v[186:187], v[186:187], v[180:181] op_sel_hi:[1,0]
    v_accvgpr_write_b32 a88, v184
    v_accvgpr_write_b32 a89, v185
    v_accvgpr_write_b32 a90, v186
    v_accvgpr_write_b32 a91, v187
    v_accvgpr_read_b32 v184, a92
    v_accvgpr_read_b32 v185, a93
    v_accvgpr_read_b32 v186, a94
    v_accvgpr_read_b32 v187, a95
    v_pk_mul_f32 v[184:185], v[184:185], v[180:181] op_sel:[0,1] op_sel_hi:[1,1]
    v_pk_mul_f32 v[186:187], v[186:187], v[180:181] op_sel:[0,1] op_sel_hi:[1,1]
    v_accvgpr_write_b32 a92, v184
    v_accvgpr_write_b32 a93, v185
    v_accvgpr_write_b32 a94, v186
    v_accvgpr_write_b32 a95, v187
    v_accvgpr_read_b32 v184, a96
    v_accvgpr_read_b32 v185, a97
    v_accvgpr_read_b32 v186, a98
    v_accvgpr_read_b32 v187, a99
    v_pk_mul_f32 v[184:185], v[184:185], v[180:181] op_sel_hi:[1,0]
    v_pk_mul_f32 v[186:187], v[186:187], v[180:181] op_sel_hi:[1,0]
    v_accvgpr_write_b32 a96, v184
    v_accvgpr_write_b32 a97, v185
    v_accvgpr_write_b32 a98, v186
    v_accvgpr_write_b32 a99, v187
    v_accvgpr_read_b32 v184, a100
    v_accvgpr_read_b32 v185, a101
    v_accvgpr_read_b32 v186, a102
    v_accvgpr_read_b32 v187, a103
    v_pk_mul_f32 v[184:185], v[184:185], v[180:181] op_sel:[0,1] op_sel_hi:[1,1]
    v_pk_mul_f32 v[186:187], v[186:187], v[180:181] op_sel:[0,1] op_sel_hi:[1,1]
    v_accvgpr_write_b32 a100, v184
    v_accvgpr_write_b32 a101, v185
    v_accvgpr_write_b32 a102, v186
    v_accvgpr_write_b32 a103, v187
    v_accvgpr_read_b32 v184, a104
    v_accvgpr_read_b32 v185, a105
    v_accvgpr_read_b32 v186, a106
    v_accvgpr_read_b32 v187, a107
    v_pk_mul_f32 v[184:185], v[184:185], v[180:181] op_sel_hi:[1,0]
    v_pk_mul_f32 v[186:187], v[186:187], v[180:181] op_sel_hi:[1,0]
    v_accvgpr_write_b32 a104, v184
    v_accvgpr_write_b32 a105, v185
    v_accvgpr_write_b32 a106, v186
    v_accvgpr_write_b32 a107, v187
    v_accvgpr_read_b32 v184, a108
    v_accvgpr_read_b32 v185, a109
    v_accvgpr_read_b32 v186, a110
    v_accvgpr_read_b32 v187, a111
    v_pk_mul_f32 v[184:185], v[184:185], v[180:181] op_sel:[0,1] op_sel_hi:[1,1]
    v_pk_mul_f32 v[186:187], v[186:187], v[180:181] op_sel:[0,1] op_sel_hi:[1,1]
    v_accvgpr_write_b32 a108, v184
    v_accvgpr_write_b32 a109, v185
    v_accvgpr_write_b32 a110, v186
    v_accvgpr_write_b32 a111, v187
    v_accvgpr_read_b32 v184, a112
    v_accvgpr_read_b32 v185, a113
    v_accvgpr_read_b32 v186, a114
    v_accvgpr_read_b32 v187, a115
    v_pk_mul_f32 v[184:185], v[184:185], v[180:181] op_sel_hi:[1,0]
    v_pk_mul_f32 v[186:187], v[186:187], v[180:181] op_sel_hi:[1,0]
    v_accvgpr_write_b32 a112, v184
    v_accvgpr_write_b32 a113, v185
    v_accvgpr_write_b32 a114, v186
    v_accvgpr_write_b32 a115, v187
    v_accvgpr_read_b32 v184, a116
    v_accvgpr_read_b32 v185, a117
    v_accvgpr_read_b32 v186, a118
    v_accvgpr_read_b32 v187, a119
    v_pk_mul_f32 v[184:185], v[184:185], v[180:181] op_sel:[0,1] op_sel_hi:[1,1]
    v_pk_mul_f32 v[186:187], v[186:187], v[180:181] op_sel:[0,1] op_sel_hi:[1,1]
    v_accvgpr_write_b32 a116, v184
    v_accvgpr_write_b32 a117, v185
    v_accvgpr_write_b32 a118, v186
    v_accvgpr_write_b32 a119, v187
    v_accvgpr_read_b32 v184, a120
    v_accvgpr_read_b32 v185, a121
    v_accvgpr_read_b32 v186, a122
    v_accvgpr_read_b32 v187, a123
    v_pk_mul_f32 v[184:185], v[184:185], v[180:181] op_sel_hi:[1,0]
    v_pk_mul_f32 v[186:187], v[186:187], v[180:181] op_sel_hi:[1,0]
    v_accvgpr_write_b32 a120, v184
    v_accvgpr_write_b32 a121, v185
    v_accvgpr_write_b32 a122, v186
    v_accvgpr_write_b32 a123, v187
    v_accvgpr_read_b32 v184, a124
    v_accvgpr_read_b32 v185, a125
    v_accvgpr_read_b32 v186, a126
    v_accvgpr_read_b32 v187, a127
    v_pk_mul_f32 v[184:185], v[184:185], v[180:181] op_sel:[0,1] op_sel_hi:[1,1]
    v_pk_mul_f32 v[186:187], v[186:187], v[180:181] op_sel:[0,1] op_sel_hi:[1,1]
    v_accvgpr_write_b32 a124, v184
    v_accvgpr_write_b32 a125, v185
    v_accvgpr_write_b32 a126, v186
    v_accvgpr_write_b32 a127, v187
    s_nop 1
    s_setpc_b64 s[100:101]
L2_mask:
    v_mov_b32 v175, s49
    s_nop 1
    s_cmp_lg_u32 s32, 0
    s_cbranch_scc1 L2_mask2
    s_mov_b32 s32, 1
    s_mov_b32 s31, 0
    v_cmp_gt_i32 s[50:51], 0, v162
    v_cmp_gt_i32 s[54:55], 1, v162
    s_nop 0
    v_cndmask_b32 v128, v128, v175, s[50:51]
    v_cndmask_b32 v129, v129, v175, s[54:55]
    v_cmp_gt_i32 s[50:51], 2, v162
    v_cmp_gt_i32 s[54:55], 3, v162
    s_nop 0
    v_cndmask_b32 v130, v130, v175, s[50:51]
    v_cndmask_b32 v131, v131, v175, s[54:55]
    v_cmp_gt_i32 s[50:51], 16, v162
    v_cmp_gt_i32 s[54:55], 17, v162
    s_nop 0
    v_cndmask_b32 v132, v132, v175, s[50:51]
    v_cndmask_b32 v133, v133, v175, s[54:55]
    v_cmp_gt_i32 s[50:51], 18, v162
    v_cmp_gt_i32 s[54:55], 19, v162
    s_nop 0
    v_cndmask_b32 v134, v134, v175, s[50:51]
    v_cndmask_b32 v135, v135, v175, s[54:55]
    s_nop 1
    s_setpc_b64 s[100:101]
L2_mask2:
    s_mov_b32 s31, 0x7fffffff
    v_cmp_gt_i32 s[50:51], 32, v162
    v_cmp_gt_i32 s[54:55], 33, v162
    s_nop 0
    v_cndmask_b32 v128, v128, v175, s[50:51]
    v_cndmask_b32 v129, v129, v175, s[54:55]
    v_cmp_gt_i32 s[50:51], 34, v162
    v_cmp_gt_i32 s[54:55], 35, v162
    s_nop 0
    v_cndmask_b32 v130, v130, v175, s[50:51]
    v_cndmask_b32 v131, v131, v175, s[54:55]
    v_cmp_gt_i32 s[50:51], 48, v162
    v_cmp_gt_i32 s[54:55], 49, v162
    s_nop 0
    v_cndmask_b32 v132, v132, v175, s[50:51]
    v_cndmask_b32 v133, v133, v175, s[54:55]
    v_cmp_gt_i32 s[50:51], 50, v162
    v_cmp_gt_i32 s[54:55], 51, v162
    s_nop 0
    v_cndmask_b32 v134, v134, v175, s[50:51]
    v_cndmask_b32 v135, v135, v175, s[54:55]
    s_nop 1
    s_setpc_b64 s[100:101]
L2_event:
    s_cmp_eq_u32 s35, 1
    s_cbranch_scc1 L2_ev1
    s_cmp_eq_u32 s35, 2
    s_cbranch_scc1 L2_ev2
    s_cmp_eq_u32 s35, 3
    s_cbranch_scc1 L2_ev3
    s_cmp_lg_u32 s58, 0
    s_cbranch_scc1 Lpub29
    v_mov_b32 v161, s41
    s_mov_b64 exec, 1
    buffer_store_dword v161, off, s[16:19], s99 sc0 sc1
    s_mov_b64 exec, -1
Lpub29:
    buffer_load_dword v171, v169, s[72:75], s61 offen
    buffer_load_dword v171, v170, s[68:71], s60 offen
    s_sub_u32 s34, s43, 1
    s_cselect_b32 s35, 3, 1
    s_cselect_b32 s34, s42, s34
    s_setpc_b64 s[100:101]
L2_ev1:
    s_mov_b64 exec, 253952
    buffer_load_dword v166, v164, s[16:19], 0 offen sc0 sc1
    s_mov_b64 exec, -1
    s_mov_b32 s35, 2
    s_mov_b32 s34, 0
    s_setpc_b64 s[100:101]
L2_ev2:
    s_waitcnt vmcnt(8)
    s_mov_b32 s57, 1048576
Lpl30:
    v_cmp_ge_u32 s[50:51], v166, v165
    s_nop 1
    s_and_b32 s50, s50, 253952
    s_cmp_eq_u32 s50, 253952
    s_cbranch_scc1 Lpo31
    s_sub_u32 s57, s57, 1
    s_cbranch_scc1 Lpo31
    s_mov_b64 exec, 253952
    buffer_load_dword v166, v164, s[16:19], 0 offen sc0 sc1
    s_mov_b64 exec, -1
    s_waitcnt vmcnt(0)
    s_branch Lpl30
Lpo31:
    s_mov_b32 s35, 3
    s_mov_b32 s34, s42
    s_setpc_b64 s[100:101]
L2_ev3:
    s_mov_b64 exec, 60559360
    buffer_load_dword v166, v164, s[16:19], 0 offen sc0 sc1
    s_mov_b64 exec, -1
    global_load_dword v171, v167, s[76:77]
    s_mov_b32 s35, 5
    s_mov_b32 s34, 0x7fffffff
    s_setpc_b64 s[100:101]
L_code_end:
.section .rodata,"a"
.p2align 6
.amdhsa_kernel gated_mix__compressed_kv_cla__glu_gated_glu__prompt_kernel
  .amdhsa_next_free_vgpr 512
  .amdhsa_next_free_sgpr 102
  .amdhsa_accum_offset 256
  .amdhsa_group_segment_fixed_size 0
  .amdhsa_kernarg_size 112
  .amdhsa_user_sgpr_count 2
  .amdhsa_user_sgpr_kernarg_segment_ptr 1
  .amdhsa_system_sgpr_workgroup_id_x 1
.end_amdhsa_kernel
```
